```python
import torch

def _softmax(x, axis=-1):
    return torch.softmax(x, dim=axis)
def _gelu(x):
    return torch.nn.functional.gelu(x, approximate="tanh")
def _silu(x):
    return torch.nn.functional.silu(x)
def _sigmoid(x):
    return torch.sigmoid(x)
def _layernorm(x, axis=-1, eps=1e-5):
    m = x.mean(dim=axis, keepdim=True)
    v = x.var(dim=axis, keepdim=True, unbiased=False)
    return (x - m) / torch.sqrt(v + eps)
def _scatter_add(tgt, idx, src, axis=0):
    return tgt.clone().index_add_(axis, idx, src)
def _segment_sum(src, seg, n):
    out = torch.zeros((n,) + src.shape[1:], dtype=src.dtype)
    return out.index_add_(0, seg, src)
def _pad(x, pw):
    flat = tuple(v for pair in reversed(pw) for v in pair)
    return torch.nn.functional.pad(x, flat)

kernel_name = 'recurrent_scan__spectral_gfnet__dense_activation_squared_relu__prompt'

def setup_inputs():

    _w = (lambda a: (lambda t: t.to(torch.bfloat16) if t.is_floating_point() else t)(torch.as_tensor(a)))
    def _A_setup():
        B, S, D = 1, 2048, 576
        Df = D // 2 + 1
        return {
            "x": _w((lambda *s: torch.randn(*s, dtype=torch.bfloat16) * 0.05)(B, S, D)),
            "w_r": _w((lambda *s: torch.randn(*s, dtype=torch.bfloat16) * 0.05)(S, Df) * 0.02),
            "w_i": _w((lambda *s: torch.randn(*s, dtype=torch.bfloat16) * 0.05)(S, Df) * 0.02),
        }
    _A_in = _A_setup()

    def _B_setup():
        B, S, D, F = 1, 2048, 576, 4608
        return {
            "x": _w((lambda *s: torch.randn(*s, dtype=torch.bfloat16) * 0.05)(B, S, D)),
            "w1": _w((lambda *s: torch.randn(*s, dtype=torch.bfloat16) * 0.05)(D, F)),
            "b1": _w((lambda *s: torch.randn(*s, dtype=torch.bfloat16) * 0.4)(F)),
            "w2": _w((lambda *s: torch.randn(*s, dtype=torch.bfloat16) * 0.05)(F, D)),
            "b2": _w((lambda *s: torch.randn(*s, dtype=torch.bfloat16) * 3.2)(D)),
        }
    _B_in = _B_setup()

    return {
        "A_x": _A_in["x"],
        "A_w_r": _A_in["w_r"],
        "A_w_i": _A_in["w_i"],
        "B_x": _B_in["x"],
        "B_w1": _B_in["w1"],
        "B_b1": _B_in["b1"],
        "B_w2": _B_in["w2"],
        "B_b2": _B_in["b2"],
    }

def reference(A_x, A_w_r, A_w_i, B_x, B_w1, B_b1, B_w2, B_b2):
    def _A_ref(x, w_r, w_i):
        B, S, D = x.shape
        X = (lambda x, axes=(-2,-1): torch.fft.rfft2(x.float(), dim=axes))(x, axes=(-2, -1))
        W = w_r + 1j * w_i
        X = X * W
        y = (lambda x, s, axes=(-2,-1): torch.fft.irfft2(x, s=s, dim=axes).to(torch.bfloat16))(X, (S, D), axes=(-2, -1))
        return y

    def _B_ref(x, w1, b1, w2, b2):
        h = torch.einsum("bsd,df->bsf", x, w1) + b1
        zero = torch.zeros_like(h)
        r = torch.where(h > zero, h, zero)
        h = r * r
        out = torch.einsum("bsf,fd->bsd", h, w2) + b2
        return out

    x = A_x
    xn = _layernorm(x, axis=-1)
    s = _A_ref(xn, A_w_r, A_w_i)
    g = _silu(_B_ref(xn, B_w1, B_b1, B_w2, B_b2))
    return x + s * g
```

```asm
; @launch grid=(256,1,1) block=(512,1,1) lds=163840
.amdgcn_target "amdgcn-amd-amdhsa--gfx950"
.text
.globl recurrent_scan__spectral_gfnet__dense_activation_squared_relu__prompt_kernel
.p2align 8
.type recurrent_scan__spectral_gfnet__dense_activation_squared_relu__prompt_kernel,@function
recurrent_scan__spectral_gfnet__dense_activation_squared_relu__prompt_kernel:
    s_cmp_ge_u32 s2, 256
    s_cbranch_scc1 g2_exit
    s_memrealtime s[76:77]
    s_load_dwordx2 s[4:5], s[0:1], 0
    s_load_dwordx4 s[92:95], s[0:1], 8
    s_load_dwordx4 s[60:63], s[0:1], 32
    s_load_dwordx4 s[64:67], s[0:1], 72
    s_getpc_b64 s[68:69]
    s_add_u32 s68, s68, tab_T@rel32@lo+4
    s_addc_u32 s69, s69, tab_T@rel32@hi+12
    v_lshrrev_b32 v1, 6, v0
    v_and_b32 v0, 63, v0
    s_and_b32 s52, s2, 7
    s_lshr_b32 s53, s2, 3
    s_lshr_b32 s41, s52, 1
    s_and_b32 s52, s52, 1
    s_lshl_b32 s52, s52, 3
    s_lshr_b32 s39, s53, 2
    s_add_u32 s39, s39, s52
    s_and_b32 s40, s53, 3
    v_readfirstlane_b32 s36, v1
    s_nop 0
    s_cmp_lg_u32 s36, 7
    s_cbranch_scc1 p1_ct_1
    s_getpc_b64 s[24:25]
code_here:
    s_and_b32 s25, s25, 0xffff
    s_mov_b32 s26, code_end-code_here
    s_mov_b32 s27, 0x20000
    s_lshr_b32 s52, s2, 3
    s_lshl_b32 s52, s52, 13
    v_lshlrev_b32 v1, 7, v0
    buffer_load_dword v26, v1, s[24:27], s52 offen
p1_ct_1:
    s_lshr_b32 s37, s36, 2
    s_and_b32 s38, s36, 3
    s_cmp_eq_u32 s41, 0
    s_cselect_b32 s50, 3, 2
    s_cselect_b32 s51, 0, 1
    s_lshl_b32 s52, s41, 1
    s_add_u32 s51, s51, s52
    s_add_u32 s51, s51, 72
    s_or_b32 s52, s41, s40
    s_cmp_eq_u32 s52, 0
    s_cselect_b32 s42, 6, 5
    s_mul_i32 s55, s36, 3072
    s_cmp_eq_u32 s40, 0
    s_cselect_b32 s78, s42, 99
    s_cselect_b32 s101, 99, s42
    v_lshrrev_b32 v108, 3, v0
    v_and_b32 v109, 7, v0
    v_bfe_u32 v104, v0, 4, 1
    s_mul_i32 s52, s36, 3
    s_add_u32 s53, s52, 0
    s_lshl_b32 s54, s53, 3
    v_add_u32 v106, s54, v108
    s_and_b32 s53, s53, 1
    s_lshl_b32 s53, s53, 1
    v_add_u32 v105, s53, v104
    v_lshlrev_b32 v105, 1, v105
    v_xor_b32 v105, v105, v109
    v_lshl_or_b32 v6, v105, 20, v106
    s_add_u32 s53, s52, 1
    s_lshl_b32 s54, s53, 3
    v_add_u32 v106, s54, v108
    s_and_b32 s53, s53, 1
    s_lshl_b32 s53, s53, 1
    v_add_u32 v105, s53, v104
    v_lshlrev_b32 v105, 1, v105
    v_xor_b32 v105, v105, v109
    v_lshl_or_b32 v7, v105, 20, v106
    s_add_u32 s53, s52, 2
    s_lshl_b32 s54, s53, 3
    v_add_u32 v106, s54, v108
    s_and_b32 s53, s53, 1
    s_lshl_b32 s53, s53, 1
    v_add_u32 v105, s53, v104
    v_lshlrev_b32 v105, 1, v105
    v_xor_b32 v105, v105, v109
    v_lshl_or_b32 v8, v105, 20, v106
    s_lshl_b32 s58, s39, 2
    s_lshr_b32 s52, s36, 1
    s_add_u32 s52, s52, s58
    s_and_b32 s53, s36, 1
    s_lshl_b32 s53, s53, 6
    s_add_u32 s52, s52, s53
    s_add_u32 s58, s58, s38
    v_add_u32 v104, 0, v108
    v_lshrrev_b32 v105, 1, v104
    v_xor_b32 v105, v105, v109
    v_lshlrev_b32 v104, 7, v104
    v_add_u32 v104, s52, v104
    v_mul_u32_u24 v104, 1152, v104
    v_lshl_add_u32 v80, v105, 4, v104
    v_add_u32 v104, 8, v108
    v_lshrrev_b32 v105, 1, v104
    v_xor_b32 v105, v105, v109
    v_lshlrev_b32 v104, 7, v104
    v_add_u32 v104, s52, v104
    v_mul_u32_u24 v104, 1152, v104
    v_lshl_add_u32 v81, v105, 4, v104
    s_mov_b32 s43, 0
    s_mov_b32 s45, 0
    s_mov_b32 s23, 0x20000
    s_waitcnt lgkmcnt(0)
    s_mov_b32 s8, s4
    s_mov_b32 s9, s5
    s_and_b32 s9, s9, 0xffff
    s_mov_b32 s10, 0x240000
    s_mov_b32 s11, 0x20000
    s_mov_b32 s12, s60
    s_mov_b32 s13, s61
    s_and_b32 s13, s13, 0xffff
    s_mov_b32 s14, 0x510000
    s_mov_b32 s15, 0x20000
    s_mov_b32 s16, s68
    s_mov_b32 s17, s69
    s_and_b32 s17, s17, 0xffff
    s_mov_b32 s18, 0xa2000
    s_mov_b32 s19, 0x20000
    s_lshl_b32 s52, s43, 2
    s_add_u32 s52, s52, s40
    s_add_u32 s53, s52, s51
    s_mul_i32 s54, s41, 18
    s_add_u32 s54, s54, s52
    s_sub_u32 s54, s54, s50
    s_cmp_lt_u32 s52, s50
    s_cselect_b32 s52, s53, s54
    s_cmp_lt_u32 s52, 72
    s_cselect_b32 s20, s12, s16
    s_cselect_b32 s21, s13, s17
    s_cselect_b32 s22, s14, s18
    s_cselect_b32 s46, 8, 1
    s_cselect_b32 s53, 0, 72
    s_mul_i32 s46, s46, 1152
    s_sub_u32 s52, s52, s53
    s_lshl_b32 s47, s52, 7
    s_cmp_lt_u32 s43, s42
    s_cselect_b32 s22, s22, 0
    s_cmp_eq_u32 s43, s78
    s_cselect_b32 s20, s16, s20
    s_cselect_b32 s21, s17, s21
    s_cselect_b32 s22, 1388544, s22
    s_cselect_b32 s46, 128, s46
    s_cselect_b32 s47, 1327104, s47
    v_and_b32 v54, 0xffff, v6
    v_lshrrev_b32 v55, 16, v6
    v_mad_u32_u24 v9, v54, s46, v55
    v_and_b32 v54, 0xffff, v7
    v_lshrrev_b32 v55, 16, v7
    v_mad_u32_u24 v10, v54, s46, v55
    v_and_b32 v54, 0xffff, v8
    v_lshrrev_b32 v55, 16, v8
    v_mad_u32_u24 v11, v54, s46, v55
    v_mul_u32_u24 v100, 57, v0
    v_lshrrev_b32 v100, 9, v100
    v_mul_u32_u24 v101, 9, v100
    v_sub_u32 v101, v0, v101
    s_lshl_b32 s52, s36, 2
    v_add_u32 v102, s52, v100
    v_and_b32 v103, 15, v102
    v_lshrrev_b32 v102, 4, v102
    v_lshl_add_u32 v102, v103, 1, v102
    s_lshl_b32 s52, s39, 2
    s_add_u32 s52, s52, s40
    v_lshl_add_u32 v102, v102, 6, s52
    v_mul_u32_u24 v102, 1152, v102
    v_lshl_add_u32 v102, v101, 7, v102
    v_cmp_gt_u32 vcc, 36, v0
    v_mov_b32 v103, 0x7fffffff
    s_nop 0
    v_cndmask_b32 v102, v103, v102, vcc
    buffer_load_dword v26, v102, s[8:11], 0 offen
    s_and_b32 s52, s39, 7
    s_lshl_b32 s52, s52, 3
    s_add_u32 s52, s52, s36
    s_mul_i32 s52, s52, 9
    v_min_u32 v101, 8, v0
    v_add_u32 v101, s52, v101
    v_mul_lo_u32 v101, v101, s46
    buffer_load_dword v26, v101, s[20:23], s47 offen
    s_lshl_b32 s53, s36, 11
    s_add_u32 m0, s53, 73728
    s_nop 0
    buffer_load_dwordx4 v80, s[8:11], 0 offen offset:0 lds
    s_add_u32 m0, s53, 74752
    s_nop 0
    buffer_load_dwordx4 v81, s[8:11], 0 offen offset:0 lds
    s_lshl_b32 s53, s36, 11
    s_add_u32 m0, s53, 89984
    s_nop 0
    buffer_load_dwordx4 v80, s[8:11], 0 offen offset:128 lds
    s_add_u32 m0, s53, 91008
    s_nop 0
    buffer_load_dwordx4 v81, s[8:11], 0 offen offset:128 lds
    s_mul_i32 s52, s46, 0
    s_add_u32 s53, s45, s55
    s_add_u32 m0, s53, 0
    s_add_u32 s52, s52, s47
    buffer_load_dwordx4 v9, s[20:23], s52 offen lds
    s_mul_i32 s52, s46, 0
    s_add_u32 s53, s45, s55
    s_add_u32 m0, s53, 1024
    s_add_u32 s52, s52, s47
    buffer_load_dwordx4 v10, s[20:23], s52 offen lds
    s_mul_i32 s52, s46, 0
    s_add_u32 s53, s45, s55
    s_add_u32 m0, s53, 2048
    s_add_u32 s52, s52, s47
    buffer_load_dwordx4 v11, s[20:23], s52 offen lds
    s_add_u32 s45, s45, 24576
    s_cmp_ge_u32 s45, 147456
    s_cselect_b32 s45, 0, s45
    s_lshl_b32 s53, s36, 11
    s_add_u32 m0, s53, 106240
    s_nop 0
    buffer_load_dwordx4 v80, s[8:11], 0 offen offset:256 lds
    s_add_u32 m0, s53, 107264
    s_nop 0
    buffer_load_dwordx4 v81, s[8:11], 0 offen offset:256 lds
    s_lshl_b32 s53, s36, 11
    s_add_u32 m0, s53, 122496
    s_nop 0
    buffer_load_dwordx4 v80, s[8:11], 0 offen offset:384 lds
    s_add_u32 m0, s53, 123520
    s_nop 0
    buffer_load_dwordx4 v81, s[8:11], 0 offen offset:384 lds
    s_lshl_b32 s53, s36, 11
    s_add_u32 m0, s53, 138752
    s_nop 0
    buffer_load_dwordx4 v80, s[8:11], 0 offen offset:512 lds
    s_add_u32 m0, s53, 139776
    s_nop 0
    buffer_load_dwordx4 v81, s[8:11], 0 offen offset:512 lds
    s_mov_b32 s84, s64
    s_mov_b32 s85, s65
    s_and_b32 s85, s85, 0xffff
    s_mov_b32 s86, 0x100
    s_mov_b32 s87, 0x20000
    s_or_b32 s52, s2, s36
    s_cmp_lg_u32 s52, 0
    s_cbranch_scc1 p1_nn_2
    s_or_b32 s52, s76, 1
    v_mov_b32 v104, s52
    v_mov_b32 v105, 0
    buffer_store_dword v104, v105, s[84:87], 0 offen sc1
p1_nn_2:
    s_add_u32 s96, s66, 0xa50000
    s_addc_u32 s97, s67, 0
    s_and_b32 s97, s97, 0xffff
    s_mov_b32 s98, 0x1000
    s_mov_b32 s99, 0x20000
    s_lshl_b32 s79, s39, 2
    s_add_u32 s79, s79, s41
    s_lshl_b32 s79, s79, 4
    s_add_u32 s79, s79, s40
    s_lshl_b32 s79, s79, 2
    s_and_b32 s59, s38, 1
    s_lshr_b32 s49, s38, 1
    s_lshl_b32 s80, s37, 11
    s_xor_b32 s81, s80, 2048
    s_lshl_b32 s82, s49, 16
    s_xor_b32 s83, s82, 0x10000
    v_and_b32 v110, 15, v0
    v_lshrrev_b32 v111, 4, v0
    v_and_b32 v105, 1, v111
    v_xor_b32 v105, s49, v105
    v_lshrrev_b32 v106, 1, v111
    v_lshl_add_u32 v105, v105, 1, v106
    v_lshrrev_b32 v106, 2, v110
    v_and_b32 v106, 2, v106
    v_xor_b32 v105, v105, v106
    v_lshlrev_b32 v104, 6, v110
    v_lshl_add_u32 v104, v105, 4, v104
    s_mul_i32 s54, s39, 1179648
    s_lshl_b32 s53, s38, 11
    s_add_u32 s54, s54, s53
    s_lshl_b32 s53, s37, 13
    s_add_u32 s54, s54, s53
    v_add_u32 v52, s54, v104
    v_lshlrev_b32 v104, 14, v111
    v_lshl_add_u32 v104, v110, 3, v104
    s_lshl_b32 s54, s37, 17
    s_lshl_b32 s53, s58, 7
    s_add_u32 s54, s54, s53
    v_add_u32 v53, s54, v104
    s_lshl_b32 s54, s37, 7
    s_lshl_b32 s53, s49, 6
    s_add_u32 s54, s54, s53
    v_lshl_add_u32 v104, v111, 4, s54
    v_xor_b32 v105, 64, v104
    v_add_u32 v12, 155648, v104
    v_add_u32 v13, 155648, v105
    v_add_u32 v14, 157696, v104
    v_add_u32 v15, 157696, v105
    s_lshl_b32 s53, s59, 8
    v_add_u32 v20, s53, v14
    s_lshl_b32 s54, s38, 12
    s_add_u32 s54, s54, 73728
    v_lshrrev_b32 v104, 1, v110
    v_xor_b32 v104, v104, v111
    s_lshl_b32 s53, s59, 2
    v_xor_b32 v104, s53, v104
    v_lshlrev_b32 v105, 7, v110
    v_add_u32 v105, s54, v105
    v_lshl_add_u32 v106, v104, 4, v105
    v_xor_b32 v104, 4, v104
    v_lshl_add_u32 v107, v104, 4, v105
    v_add_u32 v82, s80, v106
    v_add_u32 v86, 0x10000, v82
    v_add_u32 v83, s80, v107
    v_add_u32 v87, 0x10000, v83
    v_add_u32 v84, s81, v106
    v_add_u32 v88, 0x10000, v84
    v_add_u32 v85, s81, v107
    v_add_u32 v89, 0x10000, v85
    v_bfe_u32 v104, v0, 2, 2
    v_and_b32 v105, 3, v0
    v_lshl_add_u32 v106, v111, 3, v104
    v_lshlrev_b32 v106, 7, v106
    v_and_b32 v107, 1, v105
    v_lshl_add_u32 v106, v107, 3, v106
    v_lshrrev_b32 v107, 1, v104
    v_and_b32 v108, 1, v111
    v_lshl_add_u32 v107, v108, 1, v107
    v_lshlrev_b32 v107, 1, v107
    v_lshrrev_b32 v108, 1, v105
    s_lshl_b32 s54, s37, 2
    s_lshl_b32 s53, s49, 1
    s_add_u32 s54, s54, s53
    s_lshl_b32 s53, s59, 12
    v_add_u32 v109, s54, v108
    v_xor_b32 v109, v109, v107
    v_lshl_add_u32 v104, v109, 4, v106
    v_add_u32 v2, s53, v104
    v_subrev_u32 v4, s53, v104
    v_xor_b32 v109, 2, v109
    v_lshl_add_u32 v104, v109, 4, v106
    v_add_u32 v3, s53, v104
    v_subrev_u32 v5, s53, v104
    v_mov_b32 v22, 0x3f803f80
    v_mov_b32 v23, 0x3f803f80
    v_mov_b32 v24, 0x3f803f80
    v_mov_b32 v25, 0x3f803f80
    s_mov_b32 s44, 0
    s_mov_b32 s88, 0
    s_mov_b32 s89, 0
    s_mov_b32 s90, 0
    s_lshl_b32 s52, s43, 2
    s_add_u32 s52, s52, s40
    s_add_u32 s53, s52, s51
    s_mul_i32 s54, s41, 18
    s_add_u32 s54, s54, s52
    s_sub_u32 s54, s54, s50
    s_cmp_lt_u32 s52, s50
    s_cselect_b32 s48, s53, s54
    s_lshr_b32 s52, s2, 2
    s_and_b32 s54, s2, 3
    s_lshl_b32 s54, s54, 3
    s_add_u32 s54, s54, s36
    s_lshl_b32 s54, s54, 3
    v_lshrrev_b32 v54, 3, v0
    v_add_u32 v54, s54, v54
    v_cmp_eq_u32 vcc, 0, v54
    v_mov_b32 v55, 288
    s_nop 0
    v_cndmask_b32 v55, v54, v55, vcc
    v_lshlrev_b32 v55, 13, v55
    v_and_b32 v1, 7, v0
    v_lshl_add_u32 v55, v1, 4, v55
    s_lshl_b32 s53, s52, 7
    v_add_u32 v90, s53, v55
    s_and_b32 s53, s52, 3
    s_lshl_b32 s53, s53, 3
    s_lshr_b32 s52, s52, 2
    s_lshl_b32 s52, s52, 7
    s_add_u32 s53, s53, s52
    s_mul_i32 s53, s53, 578
    v_add_u32 v54, s54, v1
    v_lshrrev_b32 v1, 3, v0
    v_mul_u32_u24 v1, 578, v1
    v_lshl_add_u32 v54, v54, 1, v1
    v_add_u32 v94, s53, v54
    s_lshr_b32 s52, s2, 2
    s_and_b32 s54, s2, 3
    s_lshl_b32 s53, s36, 2
    s_add_u32 s54, s54, s53
    s_add_u32 s54, s54, 32
    s_lshl_b32 s54, s54, 3
    v_lshrrev_b32 v54, 3, v0
    v_add_u32 v54, s54, v54
    v_mov_b32 v55, 288
    v_cmp_eq_u32 vcc, v55, v54
    s_nop 1
    v_cndmask_b32 v55, v54, 0, vcc
    v_lshlrev_b32 v55, 13, v55
    v_and_b32 v1, 7, v0
    v_lshl_add_u32 v55, v1, 4, v55
    s_lshl_b32 s53, s52, 7
    v_add_u32 v91, s53, v55
    s_and_b32 s53, s52, 3
    s_lshl_b32 s53, s53, 3
    s_lshr_b32 s52, s52, 2
    s_lshl_b32 s52, s52, 7
    s_add_u32 s53, s53, s52
    s_mul_i32 s53, s53, 578
    v_cmp_gt_u32 vcc, 0x121, v54
    v_mov_b32 v55, 0x7fffffff
    s_nop 0
    v_cndmask_b32 v91, v55, v91, vcc
    v_add_u32 v54, s54, v1
    v_lshrrev_b32 v1, 3, v0
    v_cmp_gt_u32 vcc, 0x121, v54
    v_mul_u32_u24 v1, 578, v1
    v_lshl_add_u32 v54, v54, 1, v1
    v_cndmask_b32 v54, v55, v54, vcc
    v_add_u32 v95, s53, v54
    s_waitcnt vmcnt(0)
    s_barrier
    v_add_u32 v2, s89, v2
    ds_read_b64_tr_b16 v[56:57], v2 offset:0
    ds_read_b64_tr_b16 v[58:59], v2 offset:512
    v_add_u32 v3, s90, v3
    ds_read_b64_tr_b16 v[68:69], v3 offset:0
    ds_read_b64_tr_b16 v[70:71], v3 offset:512
    v_add_u32 v4, s89, v4
    ds_read_b64_tr_b16 v[60:61], v4 offset:4096
    ds_read_b64_tr_b16 v[62:63], v4 offset:4608
    s_add_u32 s44, s44, 24576
    s_cmp_ge_u32 s44, 147456
    s_cselect_b32 s44, 0, s44
    s_mov_b32 s89, -122880
    s_cselect_b32 s89, s89, 24576
    ds_read_b128 v[112:115], v82 offset:0
    ds_read_b128 v[184:187], v84 offset:0
    ds_read_b128 v[116:119], v83 offset:0
    ds_read_b128 v[188:191], v85 offset:0
    ds_read_b128 v[120:123], v82 offset:16384
    ds_read_b128 v[192:195], v84 offset:16384
    ds_read_b128 v[124:127], v83 offset:16384
    ds_read_b128 v[196:199], v85 offset:16384
    s_mul_i32 s52, s46, 192
    s_add_u32 s53, s45, s55
    s_add_u32 m0, s53, 0
    s_add_u32 s52, s52, s47
    buffer_load_dwordx4 v9, s[20:23], s52 offen lds
    s_mul_i32 s52, s46, 192
    s_add_u32 s53, s45, s55
    s_add_u32 m0, s53, 1024
    s_add_u32 s52, s52, s47
    buffer_load_dwordx4 v10, s[20:23], s52 offen lds
    s_mul_i32 s52, s46, 192
    s_add_u32 s53, s45, s55
    s_add_u32 m0, s53, 2048
    s_add_u32 s52, s52, s47
    buffer_load_dwordx4 v11, s[20:23], s52 offen lds
    s_add_u32 s45, s45, 24576
    s_cmp_ge_u32 s45, 147456
    s_cselect_b32 s45, 0, s45
    s_mov_b32 s24, s92
    s_mov_b32 s25, s93
    s_and_b32 s25, s25, 0xffff
    s_mov_b32 s26, 0x121000
    s_mov_b32 s27, 0x20000
    s_mov_b32 s28, s94
    s_mov_b32 s29, s95
    s_and_b32 s29, s29, 0xffff
    s_mov_b32 s30, 0x121000
    s_mov_b32 s31, 0x20000
    s_mul_i32 s52, s46, 384
    s_add_u32 s53, s45, s55
    s_add_u32 m0, s53, 0
    s_add_u32 s52, s52, s47
    buffer_load_dwordx4 v9, s[20:23], s52 offen lds
    s_mul_i32 s52, s46, 384
    s_add_u32 s53, s45, s55
    s_add_u32 m0, s53, 1024
    s_add_u32 s52, s52, s47
    buffer_load_dwordx4 v10, s[20:23], s52 offen lds
    s_mul_i32 s52, s46, 384
    s_add_u32 s53, s45, s55
    s_add_u32 m0, s53, 2048
    s_add_u32 s52, s52, s47
    buffer_load_dwordx4 v11, s[20:23], s52 offen lds
    s_add_u32 s45, s45, 24576
    s_cmp_ge_u32 s45, 147456
    s_cselect_b32 s45, 0, s45
    s_cmp_lt_u32 s36, 6
    s_cbranch_scc1 p1_tw_3
    s_add_u32 s56, s43, 1
    s_cmp_ge_u32 s56, s42
    s_cbranch_scc1 p1_tw_3
    s_lshl_b32 s52, s56, 2
    s_add_u32 s52, s52, s40
    s_add_u32 s53, s52, s51
    s_mul_i32 s54, s41, 18
    s_add_u32 s54, s54, s52
    s_sub_u32 s54, s54, s50
    s_cmp_lt_u32 s52, s50
    s_cselect_b32 s56, s53, s54
    s_lshl_b32 s56, s56, 7
    s_and_b32 s52, s39, 7
    s_lshl_b32 s52, s52, 1
    s_add_u32 s52, s52, s36
    s_sub_u32 s52, s52, 6
    s_mul_i32 s52, s52, 331776
    s_add_u32 s56, s56, s52
    v_min_u32 v1, 35, v0
    v_mul_u32_u24 v1, 9216, v1
    buffer_load_dword v26, v1, s[12:15], s56 offen
p1_tw_3:
    ds_read_b128 v[128:131], v82 offset:32768
    ds_read_b128 v[200:203], v84 offset:32768
    ds_read_b128 v[132:135], v83 offset:32768
    ds_read_b128 v[204:207], v85 offset:32768
    ds_read_b128 v[136:139], v82 offset:49152
    ds_read_b128 v[208:211], v84 offset:49152
    ds_read_b128 v[140:143], v83 offset:49152
    ds_read_b128 v[212:215], v85 offset:49152
    ds_read_b128 v[144:147], v86 offset:0
    ds_read_b128 v[216:219], v88 offset:0
    ds_read_b128 v[148:151], v87 offset:0
    ds_read_b128 v[220:223], v89 offset:0
    s_mov_b32 s32, s62
    s_mov_b32 s33, s63
    s_and_b32 s33, s33, 0xffff
    s_mov_b32 s34, 0x2400
    s_mov_b32 s35, 0x20000
    s_lshl_b32 s52, s36, 2
    s_add_u32 s52, s52, s40
    s_add_u32 s53, s52, s51
    s_mul_i32 s54, s41, 18
    s_add_u32 s54, s54, s52
    s_sub_u32 s54, s54, s50
    s_cmp_lt_u32 s52, s50
    s_cselect_b32 s56, s53, s54
    s_lshl_b32 s56, s56, 7
    v_lshlrev_b32 v92, 1, v0
    buffer_load_ushort v93, v92, s[32:35], s56 offen
    s_mov_b32 s56, 1
    s_lshl_b32 s52, s56, 2
    s_add_u32 s52, s52, s40
    s_add_u32 s53, s52, s51
    s_mul_i32 s54, s41, 18
    s_add_u32 s54, s54, s52
    s_sub_u32 s54, s54, s50
    s_cmp_lt_u32 s52, s50
    s_cselect_b32 s52, s53, s54
    s_cmp_lt_u32 s52, 72
    s_cselect_b32 s20, s12, s16
    s_cselect_b32 s21, s13, s17
    s_cselect_b32 s22, s14, s18
    s_cselect_b32 s46, 8, 1
    s_cselect_b32 s53, 0, 72
    s_mul_i32 s46, s46, 1152
    s_sub_u32 s52, s52, s53
    s_lshl_b32 s47, s52, 7
    s_cmp_lt_u32 s56, s42
    s_cselect_b32 s22, s22, 0
    s_cmp_eq_u32 s56, s78
    s_cselect_b32 s20, s16, s20
    s_cselect_b32 s21, s17, s21
    s_cselect_b32 s22, 1388544, s22
    s_cselect_b32 s46, 128, s46
    s_cselect_b32 s47, 1327104, s47
    v_and_b32 v54, 0xffff, v6
    v_lshrrev_b32 v55, 16, v6
    v_mad_u32_u24 v9, v54, s46, v55
    v_and_b32 v54, 0xffff, v7
    v_lshrrev_b32 v55, 16, v7
    v_mad_u32_u24 v10, v54, s46, v55
    v_and_b32 v54, 0xffff, v8
    v_lshrrev_b32 v55, 16, v8
    v_mad_u32_u24 v11, v54, s46, v55
    s_cmp_eq_u32 s36, 0
    s_cselect_b32 s52, 0, 0x7fffffff
    v_mov_b32 v54, 0
    buffer_load_dword v27, v54, s[84:87], s52 offen
    s_waitcnt lgkmcnt(0)
    s_barrier
    v_mfma_f32_16x16x32_bf16 v[96:99], v[56:59], v[112:115], 0
    v_add_u32 v5, s90, v5
    ds_read_b64_tr_b16 v[72:73], v5 offset:4096
    ds_read_b64_tr_b16 v[74:75], v5 offset:4608
    s_add_u32 s88, s88, 24576
    s_cmp_ge_u32 s88, 147456
    s_cselect_b32 s88, 0, s88
    s_mov_b32 s90, -122880
    s_cselect_b32 s90, s90, 24576
    v_mfma_f32_16x16x32_bf16 v[104:107], v[56:59], v[184:187], 0
    v_mfma_f32_16x16x32_bf16 v[76:79], v[56:59], v[22:25], 0
    ds_read_b64_tr_b16 v[64:65], v2 offset:8192
    ds_read_b64_tr_b16 v[66:67], v2 offset:8704
    v_mfma_f32_16x16x32_bf16 v[100:103], v[68:71], v[112:115], 0
    v_mfma_f32_16x16x32_bf16 v[36:39], v[22:25], v[112:115], 0
    s_lshl_b32 s53, s36, 11
    s_add_u32 m0, s53, 73088
    s_nop 0
    buffer_load_dwordx4 v80, s[8:11], 0 offen offset:640 lds
    s_add_u32 m0, s53, 74112
    s_nop 0
    buffer_load_dwordx4 v81, s[8:11], 0 offen offset:640 lds
    s_lshl_b32 s53, s36, 11
    s_add_u32 m0, s53, 89344
    s_nop 0
    buffer_load_dwordx4 v80, s[8:11], 0 offen offset:768 lds
    s_add_u32 m0, s53, 90368
    s_nop 0
    buffer_load_dwordx4 v81, s[8:11], 0 offen offset:768 lds
    v_mfma_f32_16x16x32_bf16 v[108:111], v[68:71], v[184:187], 0
    v_mfma_f32_16x16x32_bf16 v[40:43], v[112:115], v[112:115], 0
    v_mfma_f32_16x16x32_bf16 v[96:99], v[60:63], v[116:119], v[96:99]
    ds_read_b64_tr_b16 v[68:69], v3 offset:8192
    ds_read_b64_tr_b16 v[70:71], v3 offset:8704
    v_mfma_f32_16x16x32_bf16 v[104:107], v[60:63], v[188:191], v[104:107]
    ds_read_b64_tr_b16 v[56:57], v4 offset:12288
    ds_read_b64_tr_b16 v[58:59], v4 offset:12800
    s_waitcnt lgkmcnt(6)
    v_mfma_f32_16x16x32_bf16 v[100:103], v[72:75], v[116:119], v[100:103]
    v_mfma_f32_16x16x32_bf16 v[36:39], v[22:25], v[116:119], v[36:39]
    s_lshl_b32 s53, s36, 11
    s_add_u32 m0, s53, 105600
    s_nop 0
    buffer_load_dwordx4 v80, s[8:11], 0 offen offset:896 lds
    s_add_u32 m0, s53, 106624
    s_nop 0
    buffer_load_dwordx4 v81, s[8:11], 0 offen offset:896 lds
    s_lshl_b32 s53, s36, 11
    s_add_u32 m0, s53, 121856
    s_nop 0
    buffer_load_dwordx4 v80, s[8:11], 0 offen offset:1024 lds
    s_add_u32 m0, s53, 122880
    s_nop 0
    buffer_load_dwordx4 v81, s[8:11], 0 offen offset:1024 lds
    v_mfma_f32_16x16x32_bf16 v[108:111], v[72:75], v[188:191], v[108:111]
    v_mfma_f32_16x16x32_bf16 v[40:43], v[116:119], v[116:119], v[40:43]
    s_waitcnt lgkmcnt(4)
    v_mfma_f32_16x16x32_bf16 v[96:99], v[64:67], v[120:123], v[96:99]
    ds_read_b64_tr_b16 v[72:73], v5 offset:12288
    ds_read_b64_tr_b16 v[74:75], v5 offset:12800
    v_mfma_f32_16x16x32_bf16 v[104:107], v[64:67], v[192:195], v[104:107]
    v_mfma_f32_16x16x32_bf16 v[76:79], v[64:67], v[22:25], v[76:79]
    ds_read_b64_tr_b16 v[60:61], v2 offset:16384
    ds_read_b64_tr_b16 v[62:63], v2 offset:16896
    s_mov_b32 s54, 0
    buffer_load_ushort v44, v94, s[24:27], s54 offen
    buffer_load_ushort v28, v94, s[28:31], s54 offen
    s_mov_b32 s54, 18496
    buffer_load_ushort v45, v94, s[24:27], s54 offen
    buffer_load_ushort v29, v94, s[28:31], s54 offen
    s_waitcnt lgkmcnt(6)
    v_mfma_f32_16x16x32_bf16 v[100:103], v[68:71], v[120:123], v[100:103]
    v_mfma_f32_16x16x32_bf16 v[36:39], v[22:25], v[120:123], v[36:39]
    v_mfma_f32_16x16x32_bf16 v[108:111], v[68:71], v[192:195], v[108:111]
    v_mfma_f32_16x16x32_bf16 v[40:43], v[120:123], v[120:123], v[40:43]
    s_waitcnt lgkmcnt(4)
    v_mfma_f32_16x16x32_bf16 v[96:99], v[56:59], v[124:127], v[96:99]
    ds_read_b64_tr_b16 v[68:69], v3 offset:16384
    ds_read_b64_tr_b16 v[70:71], v3 offset:16896
    v_mfma_f32_16x16x32_bf16 v[104:107], v[56:59], v[196:199], v[104:107]
    ds_read_b64_tr_b16 v[64:65], v4 offset:20480
    ds_read_b64_tr_b16 v[66:67], v4 offset:20992
    s_mov_b32 s54, 36992
    buffer_load_ushort v46, v94, s[24:27], s54 offen
    buffer_load_ushort v30, v94, s[28:31], s54 offen
    s_mov_b32 s54, 55488
    buffer_load_ushort v47, v94, s[24:27], s54 offen
    buffer_load_ushort v31, v94, s[28:31], s54 offen
    s_waitcnt lgkmcnt(6)
    v_mfma_f32_16x16x32_bf16 v[100:103], v[72:75], v[124:127], v[100:103]
    v_mfma_f32_16x16x32_bf16 v[36:39], v[22:25], v[124:127], v[36:39]
    v_mfma_f32_16x16x32_bf16 v[108:111], v[72:75], v[196:199], v[108:111]
    v_mfma_f32_16x16x32_bf16 v[40:43], v[124:127], v[124:127], v[40:43]
    s_waitcnt lgkmcnt(4)
    v_mfma_f32_16x16x32_bf16 v[96:99], v[60:63], v[128:131], v[96:99]
    s_waitcnt vmcnt(21)
    s_barrier
    ds_read_b64_tr_b16 v[72:73], v5 offset:20480
    ds_read_b64_tr_b16 v[74:75], v5 offset:20992
    v_mfma_f32_16x16x32_bf16 v[104:107], v[60:63], v[200:203], v[104:107]
    v_mfma_f32_16x16x32_bf16 v[76:79], v[60:63], v[22:25], v[76:79]
    v_add_u32 v2, s89, v2
    ds_read_b64_tr_b16 v[56:57], v2 offset:0
    ds_read_b64_tr_b16 v[58:59], v2 offset:512
    s_waitcnt lgkmcnt(6)
    v_mfma_f32_16x16x32_bf16 v[100:103], v[68:71], v[128:131], v[100:103]
    v_mfma_f32_16x16x32_bf16 v[36:39], v[22:25], v[128:131], v[36:39]
    v_mfma_f32_16x16x32_bf16 v[108:111], v[68:71], v[200:203], v[108:111]
    v_mfma_f32_16x16x32_bf16 v[40:43], v[128:131], v[128:131], v[40:43]
    s_waitcnt lgkmcnt(4)
    v_mfma_f32_16x16x32_bf16 v[96:99], v[64:67], v[132:135], v[96:99]
    v_add_u32 v3, s90, v3
    ds_read_b64_tr_b16 v[68:69], v3 offset:0
    ds_read_b64_tr_b16 v[70:71], v3 offset:512
    v_mfma_f32_16x16x32_bf16 v[104:107], v[64:67], v[204:207], v[104:107]
    v_add_u32 v4, s89, v4
    ds_read_b64_tr_b16 v[60:61], v4 offset:4096
    ds_read_b64_tr_b16 v[62:63], v4 offset:4608
    s_add_u32 s44, s44, 24576
    s_cmp_ge_u32 s44, 147456
    s_cselect_b32 s44, 0, s44
    s_mov_b32 s89, -122880
    s_cselect_b32 s89, s89, 24576
    s_cmp_lt_u32 s36, 6
    s_cbranch_scc1 p1_tw_4
    s_add_u32 s56, s43, 2
    s_cmp_ge_u32 s56, s42
    s_cbranch_scc1 p1_tw_4
    s_lshl_b32 s52, s56, 2
    s_add_u32 s52, s52, s40
    s_add_u32 s53, s52, s51
    s_mul_i32 s54, s41, 18
    s_add_u32 s54, s54, s52
    s_sub_u32 s54, s54, s50
    s_cmp_lt_u32 s52, s50
    s_cselect_b32 s56, s53, s54
    s_lshl_b32 s56, s56, 7
    s_and_b32 s52, s39, 7
    s_lshl_b32 s52, s52, 1
    s_add_u32 s52, s52, s36
    s_sub_u32 s52, s52, 6
    s_mul_i32 s52, s52, 331776
    s_add_u32 s56, s56, s52
    v_min_u32 v1, 35, v0
    v_mul_u32_u24 v1, 9216, v1
    buffer_load_dword v26, v1, s[12:15], s56 offen
p1_tw_4:
    s_mov_b32 s54, 0
    buffer_load_ushort v48, v95, s[24:27], s54 offen
    buffer_load_ushort v32, v95, s[28:31], s54 offen
    s_mov_b32 s54, 18496
    buffer_load_ushort v49, v95, s[24:27], s54 offen
    buffer_load_ushort v33, v95, s[28:31], s54 offen
    s_waitcnt lgkmcnt(6)
    v_mfma_f32_16x16x32_bf16 v[100:103], v[72:75], v[132:135], v[100:103]
    v_mfma_f32_16x16x32_bf16 v[36:39], v[22:25], v[132:135], v[36:39]
    v_mfma_f32_16x16x32_bf16 v[108:111], v[72:75], v[204:207], v[108:111]
    v_mfma_f32_16x16x32_bf16 v[40:43], v[132:135], v[132:135], v[40:43]
    s_waitcnt lgkmcnt(4)
    v_mfma_f32_16x16x32_bf16 v[96:99], v[56:59], v[136:139], v[96:99]
    v_add_u32 v5, s90, v5
    ds_read_b64_tr_b16 v[72:73], v5 offset:4096
    ds_read_b64_tr_b16 v[74:75], v5 offset:4608
    s_add_u32 s88, s88, 24576
    s_cmp_ge_u32 s88, 147456
    s_cselect_b32 s88, 0, s88
    s_mov_b32 s90, -122880
    s_cselect_b32 s90, s90, 24576
    v_mfma_f32_16x16x32_bf16 v[104:107], v[56:59], v[208:211], v[104:107]
    v_mfma_f32_16x16x32_bf16 v[76:79], v[56:59], v[22:25], v[76:79]
    ds_read_b64_tr_b16 v[64:65], v2 offset:8192
    ds_read_b64_tr_b16 v[66:67], v2 offset:8704
    s_mov_b32 s54, 36992
    buffer_load_ushort v50, v95, s[24:27], s54 offen
    buffer_load_ushort v34, v95, s[28:31], s54 offen
    s_mov_b32 s54, 55488
    buffer_load_ushort v51, v95, s[24:27], s54 offen
    buffer_load_ushort v35, v95, s[28:31], s54 offen
    s_waitcnt lgkmcnt(6)
    v_mfma_f32_16x16x32_bf16 v[100:103], v[68:71], v[136:139], v[100:103]
    v_mfma_f32_16x16x32_bf16 v[36:39], v[22:25], v[136:139], v[36:39]
    v_mfma_f32_16x16x32_bf16 v[108:111], v[68:71], v[208:211], v[108:111]
    v_mfma_f32_16x16x32_bf16 v[40:43], v[136:139], v[136:139], v[40:43]
    s_waitcnt lgkmcnt(4)
    v_mfma_f32_16x16x32_bf16 v[96:99], v[60:63], v[140:143], v[96:99]
    ds_read_b64_tr_b16 v[68:69], v3 offset:8192
    ds_read_b64_tr_b16 v[70:71], v3 offset:8704
    v_mfma_f32_16x16x32_bf16 v[104:107], v[60:63], v[212:215], v[104:107]
    ds_read_b64_tr_b16 v[56:57], v4 offset:12288
    ds_read_b64_tr_b16 v[58:59], v4 offset:12800
    s_waitcnt lgkmcnt(6)
    v_mfma_f32_16x16x32_bf16 v[100:103], v[72:75], v[140:143], v[100:103]
    v_mfma_f32_16x16x32_bf16 v[36:39], v[22:25], v[140:143], v[36:39]
    v_mfma_f32_16x16x32_bf16 v[108:111], v[72:75], v[212:215], v[108:111]
    v_mfma_f32_16x16x32_bf16 v[40:43], v[140:143], v[140:143], v[40:43]
    s_waitcnt lgkmcnt(4)
    v_mfma_f32_16x16x32_bf16 v[96:99], v[64:67], v[144:147], v[96:99]
    s_waitcnt vmcnt(16)
    s_barrier
    ds_read_b128 v[152:155], v82 offset:0
    ds_read_b128 v[224:227], v84 offset:0
    ds_read_b128 v[156:159], v83 offset:0
    ds_read_b128 v[228:231], v85 offset:0
    ds_read_b64_tr_b16 v[72:73], v5 offset:12288
    ds_read_b64_tr_b16 v[74:75], v5 offset:12800
    v_mfma_f32_16x16x32_bf16 v[104:107], v[64:67], v[216:219], v[104:107]
    v_mfma_f32_16x16x32_bf16 v[76:79], v[64:67], v[22:25], v[76:79]
    ds_read_b64_tr_b16 v[60:61], v2 offset:16384
    ds_read_b64_tr_b16 v[62:63], v2 offset:16896
    s_waitcnt lgkmcnt(10)
    v_mfma_f32_16x16x32_bf16 v[100:103], v[68:71], v[144:147], v[100:103]
    v_mfma_f32_16x16x32_bf16 v[36:39], v[22:25], v[144:147], v[36:39]
    ds_read_b128 v[160:163], v82 offset:16384
    ds_read_b128 v[232:235], v84 offset:16384
    ds_read_b128 v[164:167], v83 offset:16384
    ds_read_b128 v[236:239], v85 offset:16384
    v_mfma_f32_16x16x32_bf16 v[108:111], v[68:71], v[216:219], v[108:111]
    v_mfma_f32_16x16x32_bf16 v[40:43], v[144:147], v[144:147], v[40:43]
    s_waitcnt lgkmcnt(12)
    v_mfma_f32_16x16x32_bf16 v[96:99], v[56:59], v[148:151], v[96:99]
    ds_read_b128 v[168:171], v82 offset:32768
    ds_read_b128 v[240:243], v84 offset:32768
    ds_read_b128 v[172:175], v83 offset:32768
    ds_read_b128 v[244:247], v85 offset:32768
    ds_read_b64_tr_b16 v[68:69], v3 offset:16384
    ds_read_b64_tr_b16 v[70:71], v3 offset:16896
    v_mfma_f32_16x16x32_bf16 v[104:107], v[56:59], v[220:223], v[104:107]
    ds_read_b64_tr_b16 v[64:65], v4 offset:20480
    ds_read_b64_tr_b16 v[66:67], v4 offset:20992
    v_lshlrev_b32 v93, 16, v93
    s_lshl_b32 s52, s36, 8
    s_add_u32 s52, s52, 155648
    v_lshl_add_u32 v92, v0, 2, s52
    ds_write_b32 v92, v93
    s_waitcnt lgkmcnt(15)
    v_mfma_f32_16x16x32_bf16 v[100:103], v[72:75], v[148:151], v[100:103]
    v_mfma_f32_16x16x32_bf16 v[36:39], v[22:25], v[148:151], v[36:39]
    ds_read_b128 v[176:179], v82 offset:49152
    ds_read_b128 v[248:251], v84 offset:49152
    ds_read_b128 v[180:183], v83 offset:49152
    ds_read_b128 v[252:255], v85 offset:49152
    v_mfma_f32_16x16x32_bf16 v[108:111], v[72:75], v[220:223], v[108:111]
    v_mfma_f32_16x16x32_bf16 v[40:43], v[148:151], v[148:151], v[40:43]
    s_waitcnt lgkmcnt(15)
    s_waitcnt lgkmcnt(0)
    v_mfma_f32_16x16x32_bf16 v[96:99], v[60:63], v[152:155], v[96:99]
    s_barrier
    ds_read_b64_tr_b16 v[72:73], v5 offset:20480
    ds_read_b64_tr_b16 v[74:75], v5 offset:20992
    v_mfma_f32_16x16x32_bf16 v[104:107], v[60:63], v[224:227], v[104:107]
    v_mfma_f32_16x16x32_bf16 v[76:79], v[60:63], v[22:25], v[76:79]
    v_add_u32 v2, s89, v2
    ds_read_b64_tr_b16 v[56:57], v2 offset:0
    ds_read_b64_tr_b16 v[58:59], v2 offset:512
    v_mfma_f32_16x16x32_bf16 v[100:103], v[68:71], v[152:155], v[100:103]
    v_mfma_f32_16x16x32_bf16 v[36:39], v[22:25], v[152:155], v[36:39]
    s_mul_i32 s52, s46, 0
    s_add_u32 s53, s45, s55
    s_add_u32 m0, s53, 0
    s_add_u32 s52, s52, s47
    buffer_load_dwordx4 v9, s[20:23], s52 offen lds
    s_mul_i32 s52, s46, 0
    s_add_u32 s53, s45, s55
    s_add_u32 m0, s53, 1024
    s_add_u32 s52, s52, s47
    buffer_load_dwordx4 v10, s[20:23], s52 offen lds
    v_mfma_f32_16x16x32_bf16 v[108:111], v[68:71], v[224:227], v[108:111]
    v_mfma_f32_16x16x32_bf16 v[40:43], v[152:155], v[152:155], v[40:43]
    v_mfma_f32_16x16x32_bf16 v[96:99], v[64:67], v[156:159], v[96:99]
    v_add_u32 v3, s90, v3
    ds_read_b64_tr_b16 v[68:69], v3 offset:0
    ds_read_b64_tr_b16 v[70:71], v3 offset:512
    v_mfma_f32_16x16x32_bf16 v[104:107], v[64:67], v[228:231], v[104:107]
    v_add_u32 v4, s89, v4
    ds_read_b64_tr_b16 v[60:61], v4 offset:4096
    ds_read_b64_tr_b16 v[62:63], v4 offset:4608
    s_add_u32 s44, s44, 24576
    s_cmp_ge_u32 s44, 147456
    s_cselect_b32 s44, 0, s44
    s_mov_b32 s89, -122880
    s_cselect_b32 s89, s89, 24576
    s_waitcnt lgkmcnt(6)
    v_mfma_f32_16x16x32_bf16 v[100:103], v[72:75], v[156:159], v[100:103]
    v_mfma_f32_16x16x32_bf16 v[36:39], v[22:25], v[156:159], v[36:39]
    s_mul_i32 s52, s46, 0
    s_add_u32 s53, s45, s55
    s_add_u32 m0, s53, 2048
    s_add_u32 s52, s52, s47
    buffer_load_dwordx4 v11, s[20:23], s52 offen lds
    s_add_u32 s45, s45, 24576
    s_cmp_ge_u32 s45, 147456
    s_cselect_b32 s45, 0, s45
    s_mul_i32 s52, s46, 192
    s_add_u32 s53, s45, s55
    s_add_u32 m0, s53, 0
    s_add_u32 s52, s52, s47
    buffer_load_dwordx4 v9, s[20:23], s52 offen lds
    v_mfma_f32_16x16x32_bf16 v[108:111], v[72:75], v[228:231], v[108:111]
    v_mfma_f32_16x16x32_bf16 v[40:43], v[156:159], v[156:159], v[40:43]
    s_waitcnt lgkmcnt(4)
    v_mfma_f32_16x16x32_bf16 v[96:99], v[56:59], v[160:163], v[96:99]
    v_add_u32 v5, s90, v5
    ds_read_b64_tr_b16 v[72:73], v5 offset:4096
    ds_read_b64_tr_b16 v[74:75], v5 offset:4608
    s_add_u32 s88, s88, 24576
    s_cmp_ge_u32 s88, 147456
    s_cselect_b32 s88, 0, s88
    s_mov_b32 s90, -122880
    s_cselect_b32 s90, s90, 24576
    v_mfma_f32_16x16x32_bf16 v[104:107], v[56:59], v[232:235], v[104:107]
    v_mfma_f32_16x16x32_bf16 v[76:79], v[56:59], v[22:25], v[76:79]
    ds_read_b64_tr_b16 v[64:65], v2 offset:8192
    ds_read_b64_tr_b16 v[66:67], v2 offset:8704
    s_waitcnt lgkmcnt(6)
    v_mfma_f32_16x16x32_bf16 v[100:103], v[68:71], v[160:163], v[100:103]
    v_mfma_f32_16x16x32_bf16 v[36:39], v[22:25], v[160:163], v[36:39]
    s_mul_i32 s52, s46, 192
    s_add_u32 s53, s45, s55
    s_add_u32 m0, s53, 1024
    s_add_u32 s52, s52, s47
    buffer_load_dwordx4 v10, s[20:23], s52 offen lds
    s_mul_i32 s52, s46, 192
    s_add_u32 s53, s45, s55
    s_add_u32 m0, s53, 2048
    s_add_u32 s52, s52, s47
    buffer_load_dwordx4 v11, s[20:23], s52 offen lds
    s_add_u32 s45, s45, 24576
    s_cmp_ge_u32 s45, 147456
    s_cselect_b32 s45, 0, s45
    v_mfma_f32_16x16x32_bf16 v[108:111], v[68:71], v[232:235], v[108:111]
    v_mfma_f32_16x16x32_bf16 v[40:43], v[160:163], v[160:163], v[40:43]
    s_waitcnt lgkmcnt(4)
    v_mfma_f32_16x16x32_bf16 v[96:99], v[60:63], v[164:167], v[96:99]
    ds_read_b64_tr_b16 v[68:69], v3 offset:8192
    ds_read_b64_tr_b16 v[70:71], v3 offset:8704
    v_mfma_f32_16x16x32_bf16 v[104:107], v[60:63], v[236:239], v[104:107]
    ds_read_b64_tr_b16 v[56:57], v4 offset:12288
    ds_read_b64_tr_b16 v[58:59], v4 offset:12800
    s_waitcnt lgkmcnt(6)
    v_mfma_f32_16x16x32_bf16 v[100:103], v[72:75], v[164:167], v[100:103]
    v_mfma_f32_16x16x32_bf16 v[36:39], v[22:25], v[164:167], v[36:39]
    s_mul_i32 s52, s46, 384
    s_add_u32 s53, s45, s55
    s_add_u32 m0, s53, 0
    s_add_u32 s52, s52, s47
    buffer_load_dwordx4 v9, s[20:23], s52 offen lds
    v_mfma_f32_16x16x32_bf16 v[108:111], v[72:75], v[236:239], v[108:111]
    v_mfma_f32_16x16x32_bf16 v[40:43], v[164:167], v[164:167], v[40:43]
    s_waitcnt lgkmcnt(4)
    v_mfma_f32_16x16x32_bf16 v[96:99], v[64:67], v[168:171], v[96:99]
    ds_read_b64_tr_b16 v[72:73], v5 offset:12288
    ds_read_b64_tr_b16 v[74:75], v5 offset:12800
    v_mfma_f32_16x16x32_bf16 v[104:107], v[64:67], v[240:243], v[104:107]
    v_mfma_f32_16x16x32_bf16 v[76:79], v[64:67], v[22:25], v[76:79]
    ds_read_b64_tr_b16 v[60:61], v2 offset:16384
    ds_read_b64_tr_b16 v[62:63], v2 offset:16896
    s_waitcnt vmcnt(7)
    s_add_u32 s24, s66, 0x280000
    s_addc_u32 s25, s67, 0
    s_and_b32 s25, s25, 0xffff
    s_mov_b32 s26, 0x242000
    s_mov_b32 s27, 0x20000
    v_lshl_or_b32 v28, v28, 16, v44
    v_lshl_or_b32 v29, v29, 16, v45
    v_lshl_or_b32 v30, v30, 16, v46
    v_lshl_or_b32 v31, v31, 16, v47
    v_lshl_or_b32 v32, v32, 16, v48
    v_lshl_or_b32 v33, v33, 16, v49
    v_lshl_or_b32 v34, v34, 16, v50
    v_lshl_or_b32 v35, v35, 16, v51
    v_and_b32 v54, 7, v0
    v_lshrrev_b32 v55, 3, v0
    v_lshl_add_u32 v54, v54, 3, v55
    v_lshlrev_b32 v54, 2, v54
    ds_bpermute_b32 v44, v54, v28
    ds_bpermute_b32 v45, v54, v29
    ds_bpermute_b32 v46, v54, v30
    ds_bpermute_b32 v47, v54, v31
    ds_bpermute_b32 v48, v54, v32
    ds_bpermute_b32 v49, v54, v33
    ds_bpermute_b32 v50, v54, v34
    ds_bpermute_b32 v51, v54, v35
    s_waitcnt lgkmcnt(0)
    buffer_store_dwordx4 v[44:47], v90, s[24:27], 0 offen sc1
    buffer_store_dwordx4 v[48:51], v91, s[24:27], 0 offen sc1
    s_add_u32 s24, s66, 0x1000000
    s_addc_u32 s25, s67, 0
    s_and_b32 s25, s25, 0xffff
    s_mov_b32 s26, 0x1200000
    s_mov_b32 s27, 0x20000
    s_add_u32 s28, s66, 0x500000
    s_addc_u32 s29, s67, 0
    s_and_b32 s29, s29, 0xffff
    s_mov_b32 s30, 0x240000
    s_mov_b32 s31, 0x20000
    s_load_dwordx2 s[92:93], s[0:1], 48
    s_waitcnt lgkmcnt(0)
    s_waitcnt lgkmcnt(6)
    v_mfma_f32_16x16x32_bf16 v[100:103], v[68:71], v[168:171], v[100:103]
    v_mfma_f32_16x16x32_bf16 v[36:39], v[22:25], v[168:171], v[36:39]
    s_mul_i32 s52, s46, 384
    s_add_u32 s53, s45, s55
    s_add_u32 m0, s53, 1024
    s_add_u32 s52, s52, s47
    buffer_load_dwordx4 v10, s[20:23], s52 offen lds
    v_mfma_f32_16x16x32_bf16 v[108:111], v[68:71], v[240:243], v[108:111]
    v_mfma_f32_16x16x32_bf16 v[40:43], v[168:171], v[168:171], v[40:43]
    s_waitcnt lgkmcnt(4)
    v_mfma_f32_16x16x32_bf16 v[96:99], v[56:59], v[172:175], v[96:99]
    ds_read_b64_tr_b16 v[68:69], v3 offset:16384
    ds_read_b64_tr_b16 v[70:71], v3 offset:16896
    v_mfma_f32_16x16x32_bf16 v[104:107], v[56:59], v[244:247], v[104:107]
    ds_read_b64_tr_b16 v[64:65], v4 offset:20480
    ds_read_b64_tr_b16 v[66:67], v4 offset:20992
    s_waitcnt lgkmcnt(6)
    v_mfma_f32_16x16x32_bf16 v[100:103], v[72:75], v[172:175], v[100:103]
    v_mfma_f32_16x16x32_bf16 v[36:39], v[22:25], v[172:175], v[36:39]
    s_mul_i32 s52, s46, 384
    s_add_u32 s53, s45, s55
    s_add_u32 m0, s53, 2048
    s_add_u32 s52, s52, s47
    buffer_load_dwordx4 v11, s[20:23], s52 offen lds
    s_add_u32 s45, s45, 24576
    s_cmp_ge_u32 s45, 147456
    s_cselect_b32 s45, 0, s45
    v_mfma_f32_16x16x32_bf16 v[108:111], v[72:75], v[244:247], v[108:111]
    v_mfma_f32_16x16x32_bf16 v[40:43], v[172:175], v[172:175], v[40:43]
    s_waitcnt lgkmcnt(4)
    v_mfma_f32_16x16x32_bf16 v[96:99], v[60:63], v[176:179], v[96:99]
    s_waitcnt vmcnt(8)
    s_cmp_lg_u32 s36, 0
    s_cbranch_scc1 p1_nb_7
    s_mov_b32 s59, 0
    v_mov_b32 v54, 0
p1_nw_5:
    v_readfirstlane_b32 s57, v27
    s_add_u32 s59, s59, 1
    s_cmp_lg_u32 s57, 0
    s_cbranch_scc1 p1_ng_6
    s_sleep 4
    buffer_load_dword v27, v54, s[84:87], 0 offen sc1
    s_waitcnt vmcnt(0)
    s_cmp_lt_u32 s59, 20000
    s_cbranch_scc1 p1_nw_5
p1_ng_6:
    v_mov_b32 v54, 163836
    ds_write_b32 v54, v27
    s_waitcnt lgkmcnt(0)
p1_nb_7:
    s_barrier
    v_mov_b32 v1, 163836
    ds_read_b32 v27, v1
    ds_read_b64_tr_b16 v[72:73], v5 offset:20480
    ds_read_b64_tr_b16 v[74:75], v5 offset:20992
    v_mfma_f32_16x16x32_bf16 v[104:107], v[60:63], v[248:251], v[104:107]
    v_mfma_f32_16x16x32_bf16 v[76:79], v[60:63], v[22:25], v[76:79]
    v_add_u32 v2, s89, v2
    ds_read_b64_tr_b16 v[56:57], v2 offset:0
    ds_read_b64_tr_b16 v[58:59], v2 offset:512
    s_add_u32 s56, s43, 2
    s_add_u32 s47, s47, 512
    s_waitcnt lgkmcnt(7)
    v_mfma_f32_16x16x32_bf16 v[100:103], v[68:71], v[176:179], v[100:103]
    v_mfma_f32_16x16x32_bf16 v[36:39], v[22:25], v[176:179], v[36:39]
    s_mul_i32 s52, s46, 0
    s_add_u32 s53, s45, s55
    s_add_u32 m0, s53, 0
    s_add_u32 s52, s52, s47
    buffer_load_dwordx4 v9, s[20:23], s52 offen lds
    v_mfma_f32_16x16x32_bf16 v[108:111], v[68:71], v[248:251], v[108:111]
    v_mfma_f32_16x16x32_bf16 v[40:43], v[176:179], v[176:179], v[40:43]
    s_waitcnt lgkmcnt(5)
    v_mfma_f32_16x16x32_bf16 v[96:99], v[64:67], v[180:183], v[96:99]
    v_add_u32 v3, s90, v3
    ds_read_b64_tr_b16 v[68:69], v3 offset:0
    ds_read_b64_tr_b16 v[70:71], v3 offset:512
    v_mfma_f32_16x16x32_bf16 v[104:107], v[64:67], v[252:255], v[104:107]
    v_add_u32 v4, s89, v4
    ds_read_b64_tr_b16 v[60:61], v4 offset:4096
    ds_read_b64_tr_b16 v[62:63], v4 offset:4608
    s_add_u32 s44, s44, 24576
    s_cmp_ge_u32 s44, 147456
    s_cselect_b32 s44, 0, s44
    s_mov_b32 s89, -122880
    s_cselect_b32 s89, s89, 24576
    s_waitcnt lgkmcnt(6)
    v_mfma_f32_16x16x32_bf16 v[100:103], v[72:75], v[180:183], v[100:103]
    v_mfma_f32_16x16x32_bf16 v[36:39], v[22:25], v[180:183], v[36:39]
    v_mfma_f32_16x16x32_bf16 v[108:111], v[72:75], v[252:255], v[108:111]
    v_mfma_f32_16x16x32_bf16 v[40:43], v[180:183], v[180:183], v[40:43]
    ds_write_b128 v20, v[76:79]
    v_and_b32 v44, 3, v0
    v_cmp_eq_u32 vcc, 1, v44
    s_nop 4
    v_cndmask_b32 v40, v40, v41, vcc
    v_cmp_eq_u32 vcc, 2, v44
    s_nop 1
    v_cndmask_b32 v40, v40, v42, vcc
    v_cmp_eq_u32 vcc, 3, v44
    s_nop 1
    v_cndmask_b32 v40, v40, v43, vcc
    v_mul_f32 v36, 0x3ae38e39, v36
    v_mul_f32 v40, 0x3ae38e39, v40
    v_fma_f32 v40, -v36, v36, v40
    v_max_f32 v40, 0, v40
    v_cvt_pk_bf16_f32 v36, v36, v36
    v_lshlrev_b32 v36, 16, v36
    v_cvt_pk_bf16_f32 v40, v40, v40
    v_lshlrev_b32 v40, 16, v40
    v_add_f32 v40, 0x3727c5ac, v40
    v_cvt_pk_bf16_f32 v40, v40, v40
    v_lshlrev_b32 v40, 16, v40
    v_sqrt_f32 v40, v40
    s_nop 0
    v_cvt_pk_bf16_f32 v40, v40, v40
    v_lshlrev_b32 v40, 16, v40
    v_rcp_f32 v46, v40
    v_mov_b32 v47, v36
    v_and_b32 v44, 15, v0
    v_lshrrev_b32 v45, 2, v44
    v_lshrrev_b32 v48, 4, v0
    v_cmp_eq_u32 vcc, v45, v48
    s_lshl_b32 s52, s38, 8
    s_lshl_b32 s53, s37, 7
    s_add_u32 s52, s52, s53
    s_add_u32 s52, s52, 158208
    v_lshl_add_u32 v44, v44, 3, s52
    v_mov_b32 v45, 159232
    v_cndmask_b32 v44, v45, v44, vcc
    ds_write_b64 v44, v[46:47]
    v_readfirstlane_b32 s57, v27
    s_mov_b32 s49, s48
    s_add_u32 s43, s43, 1
    s_lshl_b32 s52, s43, 2
    s_add_u32 s52, s52, s40
    s_add_u32 s53, s52, s51
    s_mul_i32 s54, s41, 18
    s_add_u32 s54, s54, s52
    s_sub_u32 s54, s54, s50
    s_cmp_lt_u32 s52, s50
    s_cselect_b32 s48, s53, s54
    s_cmp_ge_u32 s49, 72
    s_cbranch_scc1 p1_bT_8
p1_b1_13:
    s_waitcnt lgkmcnt(5)
    v_mfma_f32_16x16x32_bf16 v[80:83], v[56:59], v[112:115], 0
    v_add_u32 v5, s90, v5
    ds_read_b64_tr_b16 v[72:73], v5 offset:4096
    ds_read_b64_tr_b16 v[74:75], v5 offset:4608
    s_add_u32 s88, s88, 24576
    s_cmp_ge_u32 s88, 147456
    s_cselect_b32 s88, 0, s88
    s_mov_b32 s90, -122880
    s_cselect_b32 s90, s90, 24576
    v_mfma_f32_16x16x32_bf16 v[88:91], v[56:59], v[184:187], 0
    v_mfma_f32_16x16x32_bf16 v[76:79], v[56:59], v[22:25], 0
    ds_read_b64_tr_b16 v[64:65], v2 offset:8192
    ds_read_b64_tr_b16 v[66:67], v2 offset:8704
    s_waitcnt lgkmcnt(7)
    v_mfma_f32_16x16x32_bf16 v[84:87], v[68:71], v[112:115], 0
    s_mul_i32 s52, s46, 0
    s_add_u32 s53, s45, s55
    s_add_u32 m0, s53, 1024
    s_add_u32 s52, s52, s47
    buffer_load_dwordx4 v10, s[20:23], s52 offen lds
    v_mfma_f32_16x16x32_bf16 v[92:95], v[68:71], v[184:187], 0
    s_waitcnt lgkmcnt(5)
    v_mfma_f32_16x16x32_bf16 v[80:83], v[60:63], v[116:119], v[80:83]
    ds_read_b64_tr_b16 v[68:69], v3 offset:8192
    ds_read_b64_tr_b16 v[70:71], v3 offset:8704
    v_mfma_f32_16x16x32_bf16 v[88:91], v[60:63], v[188:191], v[88:91]
    ds_read_b64_tr_b16 v[56:57], v4 offset:12288
    ds_read_b64_tr_b16 v[58:59], v4 offset:12800
    s_waitcnt lgkmcnt(6)
    v_mfma_f32_16x16x32_bf16 v[84:87], v[72:75], v[116:119], v[84:87]
    v_mfma_f32_16x16x32_bf16 v[92:95], v[72:75], v[188:191], v[92:95]
    s_waitcnt lgkmcnt(4)
    v_mfma_f32_16x16x32_bf16 v[80:83], v[64:67], v[120:123], v[80:83]
    ds_read_b64_tr_b16 v[72:73], v5 offset:12288
    ds_read_b64_tr_b16 v[74:75], v5 offset:12800
    v_mfma_f32_16x16x32_bf16 v[88:91], v[64:67], v[192:195], v[88:91]
    v_mfma_f32_16x16x32_bf16 v[76:79], v[64:67], v[22:25], v[76:79]
    ds_read_b64_tr_b16 v[60:61], v2 offset:16384
    ds_read_b64_tr_b16 v[62:63], v2 offset:16896
    s_waitcnt lgkmcnt(6)
    v_mfma_f32_16x16x32_bf16 v[84:87], v[68:71], v[120:123], v[84:87]
    s_mul_i32 s52, s46, 0
    s_add_u32 s53, s45, s55
    s_add_u32 m0, s53, 2048
    s_add_u32 s52, s52, s47
    buffer_load_dwordx4 v11, s[20:23], s52 offen lds
    s_add_u32 s45, s45, 24576
    s_cmp_ge_u32 s45, 147456
    s_cselect_b32 s45, 0, s45
    v_mfma_f32_16x16x32_bf16 v[92:95], v[68:71], v[192:195], v[92:95]
    s_waitcnt lgkmcnt(4)
    v_mfma_f32_16x16x32_bf16 v[80:83], v[56:59], v[124:127], v[80:83]
    ds_read_b64_tr_b16 v[68:69], v3 offset:16384
    ds_read_b64_tr_b16 v[70:71], v3 offset:16896
    v_mfma_f32_16x16x32_bf16 v[88:91], v[56:59], v[196:199], v[88:91]
    ds_read_b64_tr_b16 v[64:65], v4 offset:20480
    ds_read_b64_tr_b16 v[66:67], v4 offset:20992
    s_waitcnt lgkmcnt(6)
    v_mfma_f32_16x16x32_bf16 v[84:87], v[72:75], v[124:127], v[84:87]
    v_mfma_f32_16x16x32_bf16 v[92:95], v[72:75], v[196:199], v[92:95]
    s_waitcnt lgkmcnt(4)
    v_mfma_f32_16x16x32_bf16 v[80:83], v[60:63], v[128:131], v[80:83]
    s_waitcnt vmcnt(3)
    s_barrier
    s_cmp_lg_u32 s36, 0
    s_cbranch_scc1 p1_pub_14
    s_add_u32 s52, s57, s43
    s_add_i32 s52, s52, -1
    v_mov_b32 v1, s52
    v_mov_b32 v54, 0
    buffer_store_dword v1, v54, s[96:99], s79 offen sc1
p1_pub_14:
    ds_read_b64_tr_b16 v[72:73], v5 offset:20480
    ds_read_b64_tr_b16 v[74:75], v5 offset:20992
    v_mfma_f32_16x16x32_bf16 v[88:91], v[60:63], v[200:203], v[88:91]
    v_mfma_f32_16x16x32_bf16 v[76:79], v[60:63], v[22:25], v[76:79]
    v_add_u32 v2, s89, v2
    ds_read_b64_tr_b16 v[56:57], v2 offset:0
    ds_read_b64_tr_b16 v[58:59], v2 offset:512
    s_waitcnt lgkmcnt(6)
    v_mfma_f32_16x16x32_bf16 v[84:87], v[68:71], v[128:131], v[84:87]
    s_mul_i32 s52, s46, 192
    s_add_u32 s53, s45, s55
    s_add_u32 m0, s53, 0
    s_add_u32 s52, s52, s47
    buffer_load_dwordx4 v9, s[20:23], s52 offen lds
    v_mfma_f32_16x16x32_bf16 v[92:95], v[68:71], v[200:203], v[92:95]
    s_waitcnt lgkmcnt(4)
    v_mfma_f32_16x16x32_bf16 v[80:83], v[64:67], v[132:135], v[80:83]
    v_add_u32 v3, s90, v3
    ds_read_b64_tr_b16 v[68:69], v3 offset:0
    ds_read_b64_tr_b16 v[70:71], v3 offset:512
    v_mfma_f32_16x16x32_bf16 v[88:91], v[64:67], v[204:207], v[88:91]
    v_add_u32 v4, s89, v4
    ds_read_b64_tr_b16 v[60:61], v4 offset:4096
    ds_read_b64_tr_b16 v[62:63], v4 offset:4608
    s_add_u32 s44, s44, 24576
    s_cmp_ge_u32 s44, 147456
    s_cselect_b32 s44, 0, s44
    s_mov_b32 s89, -122880
    s_cselect_b32 s89, s89, 24576
    ds_read_b128 v[36:39], v14
    ds_read_b128 v[44:47], v14 offset:256
    ds_read_b128 v[28:31], v12
    v_add_u32 v12, 256, v12
    ds_read_b128 v[40:43], v15
    ds_read_b128 v[48:51], v15 offset:256
    ds_read_b128 v[32:35], v13
    v_add_u32 v13, 256, v13
    s_cmp_eq_u32 s43, 1
    s_cbranch_scc1 p1_sl_15
p1_slb2_16:
    s_cmp_ge_u32 s36, 4
    s_cbranch_scc1 p1_tsk_17
p1_tbk_18:
    s_waitcnt lgkmcnt(12)
    v_mfma_f32_16x16x32_bf16 v[84:87], v[72:75], v[132:135], v[84:87]
    v_mfma_f32_16x16x32_bf16 v[92:95], v[72:75], v[204:207], v[92:95]
    s_waitcnt lgkmcnt(10)
    v_mfma_f32_16x16x32_bf16 v[80:83], v[56:59], v[136:139], v[80:83]
    v_add_u32 v5, s90, v5
    ds_read_b64_tr_b16 v[72:73], v5 offset:4096
    ds_read_b64_tr_b16 v[74:75], v5 offset:4608
    s_add_u32 s88, s88, 24576
    s_cmp_ge_u32 s88, 147456
    s_cselect_b32 s88, 0, s88
    s_mov_b32 s90, -122880
    s_cselect_b32 s90, s90, 24576
    s_waitcnt lgkmcnt(2)
    v_add_f32 v36, v36, v44
    v_add_f32 v37, v37, v45
    v_mfma_f32_16x16x32_bf16 v[88:91], v[56:59], v[208:211], v[88:91]
    v_mfma_f32_16x16x32_bf16 v[76:79], v[56:59], v[22:25], v[76:79]
    ds_read_b64_tr_b16 v[64:65], v2 offset:8192
    ds_read_b64_tr_b16 v[66:67], v2 offset:8704
    v_add_f32 v38, v38, v46
    v_add_f32 v39, v39, v47
    v_mfma_f32_16x16x32_bf16 v[84:87], v[68:71], v[136:139], v[84:87]
    s_mul_i32 s52, s46, 192
    s_add_u32 s53, s45, s55
    s_add_u32 m0, s53, 1024
    s_add_u32 s52, s52, s47
    buffer_load_dwordx4 v10, s[20:23], s52 offen lds
    v_add_f32 v40, v40, v48
    v_add_f32 v41, v41, v49
    v_add_f32 v42, v42, v50
    v_mfma_f32_16x16x32_bf16 v[92:95], v[68:71], v[208:211], v[92:95]
    v_add_f32 v43, v43, v51
    v_fma_f32 v96, -v17, v36, v96
    v_mfma_f32_16x16x32_bf16 v[80:83], v[60:63], v[140:143], v[80:83]
    ds_read_b64_tr_b16 v[68:69], v3 offset:8192
    ds_read_b64_tr_b16 v[70:71], v3 offset:8704
    v_fma_f32 v97, -v17, v37, v97
    v_fma_f32 v96, v16, v96, v28
    v_fma_f32 v97, v16, v97, v29
    v_mfma_f32_16x16x32_bf16 v[88:91], v[60:63], v[212:215], v[88:91]
    ds_read_b64_tr_b16 v[56:57], v4 offset:12288
    ds_read_b64_tr_b16 v[58:59], v4 offset:12800
    v_max_f32 v96, 0, v96
    v_max_f32 v97, 0, v97
    s_waitcnt lgkmcnt(6)
    v_mfma_f32_16x16x32_bf16 v[84:87], v[72:75], v[140:143], v[84:87]
    v_mul_f32 v96, v96, v96
    v_mul_f32 v97, v97, v97
    v_cvt_pk_bf16_f32 v44, v96, v97
    v_mfma_f32_16x16x32_bf16 v[92:95], v[72:75], v[212:215], v[92:95]
    v_fma_f32 v98, -v17, v38, v98
    v_fma_f32 v99, -v17, v39, v99
    s_waitcnt lgkmcnt(4)
    v_mfma_f32_16x16x32_bf16 v[80:83], v[64:67], v[144:147], v[80:83]
    ds_read_b64_tr_b16 v[72:73], v5 offset:12288
    ds_read_b64_tr_b16 v[74:75], v5 offset:12800
    v_fma_f32 v98, v16, v98, v30
    v_fma_f32 v99, v16, v99, v31
    v_max_f32 v98, 0, v98
    v_mfma_f32_16x16x32_bf16 v[88:91], v[64:67], v[216:219], v[88:91]
    v_mfma_f32_16x16x32_bf16 v[76:79], v[64:67], v[22:25], v[76:79]
    ds_read_b64_tr_b16 v[60:61], v2 offset:16384
    ds_read_b64_tr_b16 v[62:63], v2 offset:16896
    v_max_f32 v99, 0, v99
    v_mul_f32 v98, v98, v98
    s_waitcnt lgkmcnt(6)
    v_mfma_f32_16x16x32_bf16 v[84:87], v[68:71], v[144:147], v[84:87]
    s_mul_i32 s52, s46, 192
    s_add_u32 s53, s45, s55
    s_add_u32 m0, s53, 2048
    s_add_u32 s52, s52, s47
    buffer_load_dwordx4 v11, s[20:23], s52 offen lds
    s_add_u32 s45, s45, 24576
    s_cmp_ge_u32 s45, 147456
    s_cselect_b32 s45, 0, s45
    v_mul_f32 v99, v99, v99
    v_cvt_pk_bf16_f32 v45, v98, v99
    v_mfma_f32_16x16x32_bf16 v[92:95], v[68:71], v[216:219], v[92:95]
    v_fma_f32 v100, -v17, v40, v100
    v_fma_f32 v101, -v17, v41, v101
    v_fma_f32 v100, v16, v100, v32
    s_waitcnt lgkmcnt(4)
    v_mfma_f32_16x16x32_bf16 v[80:83], v[56:59], v[148:151], v[80:83]
    ds_read_b64_tr_b16 v[68:69], v3 offset:16384
    ds_read_b64_tr_b16 v[70:71], v3 offset:16896
    v_fma_f32 v101, v16, v101, v33
    v_max_f32 v100, 0, v100
    v_mfma_f32_16x16x32_bf16 v[88:91], v[56:59], v[220:223], v[88:91]
    ds_read_b64_tr_b16 v[64:65], v4 offset:20480
    ds_read_b64_tr_b16 v[66:67], v4 offset:20992
    v_max_f32 v101, 0, v101
    v_mul_f32 v100, v100, v100
    v_mul_f32 v101, v101, v101
    s_waitcnt lgkmcnt(6)
    v_mfma_f32_16x16x32_bf16 v[84:87], v[72:75], v[148:151], v[84:87]
    v_cvt_pk_bf16_f32 v46, v100, v101
    v_fma_f32 v102, -v17, v42, v102
    v_mfma_f32_16x16x32_bf16 v[92:95], v[72:75], v[220:223], v[92:95]
    v_fma_f32 v103, -v17, v43, v103
    v_fma_f32 v102, v16, v102, v34
    v_fma_f32 v103, v16, v103, v35
    s_waitcnt lgkmcnt(4)
    v_mfma_f32_16x16x32_bf16 v[80:83], v[60:63], v[152:155], v[80:83]
    s_barrier
    ds_read_b64_tr_b16 v[72:73], v5 offset:20480
    ds_read_b64_tr_b16 v[74:75], v5 offset:20992
    v_max_f32 v102, 0, v102
    v_max_f32 v103, 0, v103
    v_mfma_f32_16x16x32_bf16 v[88:91], v[60:63], v[224:227], v[88:91]
    v_mfma_f32_16x16x32_bf16 v[76:79], v[60:63], v[22:25], v[76:79]
    v_add_u32 v2, s89, v2
    ds_read_b64_tr_b16 v[56:57], v2 offset:0
    ds_read_b64_tr_b16 v[58:59], v2 offset:512
    v_mul_f32 v102, v102, v102
    v_mul_f32 v103, v103, v103
    v_cvt_pk_bf16_f32 v47, v102, v103
    s_waitcnt lgkmcnt(6)
    v_mfma_f32_16x16x32_bf16 v[84:87], v[68:71], v[152:155], v[84:87]
    s_mul_i32 s52, s46, 384
    s_add_u32 s53, s45, s55
    s_add_u32 m0, s53, 0
    s_add_u32 s52, s52, s47
    buffer_load_dwordx4 v9, s[20:23], s52 offen lds
    s_lshl_b32 s56, s49, 15
    s_add_u32 s56, s56, s80
    s_lshr_b32 s56, s56, 1
    v_permlane16_swap_b32 v44, v46
    v_mfma_f32_16x16x32_bf16 v[92:95], v[68:71], v[224:227], v[92:95]
    v_permlane16_swap_b32 v45, v47
    buffer_store_dwordx4 v[44:47], v52, s[24:27], s56 offen sc1
    s_waitcnt lgkmcnt(4)
    v_mfma_f32_16x16x32_bf16 v[80:83], v[64:67], v[156:159], v[80:83]
    v_add_u32 v3, s90, v3
    ds_read_b64_tr_b16 v[68:69], v3 offset:0
    ds_read_b64_tr_b16 v[70:71], v3 offset:512
    v_fma_f32 v104, -v19, v36, v104
    v_fma_f32 v105, -v19, v37, v105
    v_fma_f32 v104, v18, v104, v28
    v_mfma_f32_16x16x32_bf16 v[88:91], v[64:67], v[228:231], v[88:91]
    v_add_u32 v4, s89, v4
    ds_read_b64_tr_b16 v[60:61], v4 offset:4096
    ds_read_b64_tr_b16 v[62:63], v4 offset:4608
    s_add_u32 s44, s44, 24576
    s_cmp_ge_u32 s44, 147456
    s_cselect_b32 s44, 0, s44
    s_mov_b32 s89, -122880
    s_cselect_b32 s89, s89, 24576
    v_fma_f32 v105, v18, v105, v29
    v_max_f32 v104, 0, v104
    s_waitcnt lgkmcnt(6)
    v_mfma_f32_16x16x32_bf16 v[84:87], v[72:75], v[156:159], v[84:87]
    v_max_f32 v105, 0, v105
    v_mul_f32 v104, v104, v104
    v_mul_f32 v105, v105, v105
    v_mfma_f32_16x16x32_bf16 v[92:95], v[72:75], v[228:231], v[92:95]
    v_cvt_pk_bf16_f32 v48, v104, v105
    v_fma_f32 v106, -v19, v38, v106
    s_waitcnt lgkmcnt(4)
    v_mfma_f32_16x16x32_bf16 v[80:83], v[56:59], v[160:163], v[80:83]
    v_add_u32 v5, s90, v5
    ds_read_b64_tr_b16 v[72:73], v5 offset:4096
    ds_read_b64_tr_b16 v[74:75], v5 offset:4608
    s_add_u32 s88, s88, 24576
    s_cmp_ge_u32 s88, 147456
    s_cselect_b32 s88, 0, s88
    s_mov_b32 s90, -122880
    s_cselect_b32 s90, s90, 24576
    v_fma_f32 v107, -v19, v39, v107
    v_fma_f32 v106, v18, v106, v30
    v_fma_f32 v107, v18, v107, v31
    v_mfma_f32_16x16x32_bf16 v[88:91], v[56:59], v[232:235], v[88:91]
    v_mfma_f32_16x16x32_bf16 v[76:79], v[56:59], v[22:25], v[76:79]
    ds_read_b64_tr_b16 v[64:65], v2 offset:8192
    ds_read_b64_tr_b16 v[66:67], v2 offset:8704
    v_max_f32 v106, 0, v106
    v_max_f32 v107, 0, v107
    s_waitcnt lgkmcnt(6)
    v_mfma_f32_16x16x32_bf16 v[84:87], v[68:71], v[160:163], v[84:87]
    s_mul_i32 s52, s46, 384
    s_add_u32 s53, s45, s55
    s_add_u32 m0, s53, 1024
    s_add_u32 s52, s52, s47
    buffer_load_dwordx4 v10, s[20:23], s52 offen lds
    v_mul_f32 v106, v106, v106
    v_mul_f32 v107, v107, v107
    v_cvt_pk_bf16_f32 v49, v106, v107
    v_mfma_f32_16x16x32_bf16 v[92:95], v[68:71], v[232:235], v[92:95]
    v_fma_f32 v108, -v19, v40, v108
    v_fma_f32 v109, -v19, v41, v109
    s_waitcnt lgkmcnt(4)
    v_mfma_f32_16x16x32_bf16 v[80:83], v[60:63], v[164:167], v[80:83]
    ds_read_b64_tr_b16 v[68:69], v3 offset:8192
    ds_read_b64_tr_b16 v[70:71], v3 offset:8704
    v_fma_f32 v108, v18, v108, v32
    v_fma_f32 v109, v18, v109, v33
    v_mfma_f32_16x16x32_bf16 v[88:91], v[60:63], v[236:239], v[88:91]
    ds_read_b64_tr_b16 v[56:57], v4 offset:12288
    ds_read_b64_tr_b16 v[58:59], v4 offset:12800
    v_max_f32 v108, 0, v108
    v_max_f32 v109, 0, v109
    v_mul_f32 v108, v108, v108
    s_waitcnt lgkmcnt(6)
    v_mfma_f32_16x16x32_bf16 v[84:87], v[72:75], v[164:167], v[84:87]
    v_mul_f32 v109, v109, v109
    v_cvt_pk_bf16_f32 v50, v108, v109
    v_mfma_f32_16x16x32_bf16 v[92:95], v[72:75], v[236:239], v[92:95]
    v_fma_f32 v110, -v19, v42, v110
    v_fma_f32 v111, -v19, v43, v111
    v_fma_f32 v110, v18, v110, v34
    s_waitcnt lgkmcnt(4)
    v_mfma_f32_16x16x32_bf16 v[80:83], v[64:67], v[168:171], v[80:83]
    ds_read_b64_tr_b16 v[72:73], v5 offset:12288
    ds_read_b64_tr_b16 v[74:75], v5 offset:12800
    v_fma_f32 v111, v18, v111, v35
    v_max_f32 v110, 0, v110
    v_mfma_f32_16x16x32_bf16 v[88:91], v[64:67], v[240:243], v[88:91]
    v_mfma_f32_16x16x32_bf16 v[76:79], v[64:67], v[22:25], v[76:79]
    ds_read_b64_tr_b16 v[60:61], v2 offset:16384
    ds_read_b64_tr_b16 v[62:63], v2 offset:16896
    v_max_f32 v111, 0, v111
    v_mul_f32 v110, v110, v110
    v_mul_f32 v111, v111, v111
    s_waitcnt lgkmcnt(6)
    v_mfma_f32_16x16x32_bf16 v[84:87], v[68:71], v[168:171], v[84:87]
    s_mul_i32 s52, s46, 384
    s_add_u32 s53, s45, s55
    s_add_u32 m0, s53, 2048
    s_add_u32 s52, s52, s47
    buffer_load_dwordx4 v11, s[20:23], s52 offen lds
    s_add_u32 s45, s45, 24576
    s_cmp_ge_u32 s45, 147456
    s_cselect_b32 s45, 0, s45
    v_cvt_pk_bf16_f32 v51, v110, v111
    s_lshl_b32 s56, s49, 15
    s_add_u32 s56, s56, s81
    s_lshr_b32 s56, s56, 1
    v_mfma_f32_16x16x32_bf16 v[92:95], v[68:71], v[240:243], v[92:95]
    v_permlane16_swap_b32 v48, v50
    v_permlane16_swap_b32 v49, v51
    buffer_store_dwordx4 v[48:51], v52, s[24:27], s56 offen sc1
    s_waitcnt lgkmcnt(4)
    v_mfma_f32_16x16x32_bf16 v[80:83], v[56:59], v[172:175], v[80:83]
    ds_read_b64_tr_b16 v[68:69], v3 offset:16384
    ds_read_b64_tr_b16 v[70:71], v3 offset:16896
    v_mfma_f32_16x16x32_bf16 v[88:91], v[56:59], v[244:247], v[88:91]
    ds_read_b64_tr_b16 v[64:65], v4 offset:20480
    ds_read_b64_tr_b16 v[66:67], v4 offset:20992
    s_waitcnt lgkmcnt(6)
    v_mfma_f32_16x16x32_bf16 v[84:87], v[72:75], v[172:175], v[84:87]
    v_mfma_f32_16x16x32_bf16 v[92:95], v[72:75], v[244:247], v[92:95]
    s_add_u32 s52, s43, 1
    s_cmp_eq_u32 s52, s42
    s_cbranch_scc1 p1_hk_19
p1_hkb_20:
    s_waitcnt lgkmcnt(4)
    v_mfma_f32_16x16x32_bf16 v[80:83], v[60:63], v[176:179], v[80:83]
    s_waitcnt vmcnt(8)
    s_barrier
    ds_read_b64_tr_b16 v[72:73], v5 offset:20480
    ds_read_b64_tr_b16 v[74:75], v5 offset:20992
    v_mfma_f32_16x16x32_bf16 v[88:91], v[60:63], v[248:251], v[88:91]
    v_mfma_f32_16x16x32_bf16 v[76:79], v[60:63], v[22:25], v[76:79]
    v_add_u32 v2, s89, v2
    ds_read_b64_tr_b16 v[56:57], v2 offset:0
    ds_read_b64_tr_b16 v[58:59], v2 offset:512
    s_add_u32 s56, s43, 2
    s_add_u32 s47, s47, 512
    s_cmp_ge_u32 s56, s42
    s_cbranch_scc1 p1_slp_21
p1_slb_22:
    s_waitcnt lgkmcnt(6)
    v_mfma_f32_16x16x32_bf16 v[84:87], v[68:71], v[176:179], v[84:87]
    s_add_u32 s52, s43, 1
    s_cmp_ge_u32 s52, s42
    s_cselect_b32 s45, 0x30000, s45
    s_mul_i32 s52, s46, 0
    s_add_u32 s53, s45, s55
    s_add_u32 m0, s53, 0
    s_add_u32 s52, s52, s47
    buffer_load_dwordx4 v9, s[20:23], s52 offen lds
    v_mfma_f32_16x16x32_bf16 v[92:95], v[68:71], v[248:251], v[92:95]
    s_waitcnt lgkmcnt(4)
    v_mfma_f32_16x16x32_bf16 v[80:83], v[64:67], v[180:183], v[80:83]
    v_add_u32 v3, s90, v3
    ds_read_b64_tr_b16 v[68:69], v3 offset:0
    ds_read_b64_tr_b16 v[70:71], v3 offset:512
    v_mfma_f32_16x16x32_bf16 v[88:91], v[64:67], v[252:255], v[88:91]
    v_add_u32 v4, s89, v4
    ds_read_b64_tr_b16 v[60:61], v4 offset:4096
    ds_read_b64_tr_b16 v[62:63], v4 offset:4608
    s_add_u32 s44, s44, 24576
    s_cmp_ge_u32 s44, 147456
    s_cselect_b32 s44, 0, s44
    s_mov_b32 s89, -122880
    s_cselect_b32 s89, s89, 24576
    s_waitcnt lgkmcnt(6)
    v_mfma_f32_16x16x32_bf16 v[84:87], v[72:75], v[180:183], v[84:87]
    v_mfma_f32_16x16x32_bf16 v[92:95], v[72:75], v[252:255], v[92:95]
    s_add_u32 s52, s43, 1
    s_cmp_eq_u32 s52, s42
    s_cbranch_scc1 p1_hk_23
p1_hkb_24:
    ds_write_b128 v20, v[76:79]
    s_mov_b32 s49, s48
    s_add_u32 s43, s43, 1
    s_add_u32 s48, s48, 4
    s_cmp_ge_u32 s43, s42
    s_cbranch_scc1 p1_e1_11
p1_b0_9:
    s_waitcnt lgkmcnt(5)
    v_mfma_f32_16x16x32_bf16 v[96:99], v[56:59], v[112:115], 0
    v_add_u32 v5, s90, v5
    ds_read_b64_tr_b16 v[72:73], v5 offset:4096
    ds_read_b64_tr_b16 v[74:75], v5 offset:4608
    s_add_u32 s88, s88, 24576
    s_cmp_ge_u32 s88, 147456
    s_cselect_b32 s88, 0, s88
    s_mov_b32 s90, -122880
    s_cselect_b32 s90, s90, 24576
    v_mfma_f32_16x16x32_bf16 v[104:107], v[56:59], v[184:187], 0
    v_mfma_f32_16x16x32_bf16 v[76:79], v[56:59], v[22:25], 0
    ds_read_b64_tr_b16 v[64:65], v2 offset:8192
    ds_read_b64_tr_b16 v[66:67], v2 offset:8704
    s_waitcnt lgkmcnt(7)
    v_mfma_f32_16x16x32_bf16 v[100:103], v[68:71], v[112:115], 0
    s_mul_i32 s52, s46, 0
    s_add_u32 s53, s45, s55
    s_add_u32 m0, s53, 1024
    s_add_u32 s52, s52, s47
    buffer_load_dwordx4 v10, s[20:23], s52 offen lds
    v_mfma_f32_16x16x32_bf16 v[108:111], v[68:71], v[184:187], 0
    s_waitcnt lgkmcnt(5)
    v_mfma_f32_16x16x32_bf16 v[96:99], v[60:63], v[116:119], v[96:99]
    ds_read_b64_tr_b16 v[68:69], v3 offset:8192
    ds_read_b64_tr_b16 v[70:71], v3 offset:8704
    v_mfma_f32_16x16x32_bf16 v[104:107], v[60:63], v[188:191], v[104:107]
    ds_read_b64_tr_b16 v[56:57], v4 offset:12288
    ds_read_b64_tr_b16 v[58:59], v4 offset:12800
    s_waitcnt lgkmcnt(6)
    v_mfma_f32_16x16x32_bf16 v[100:103], v[72:75], v[116:119], v[100:103]
    v_mfma_f32_16x16x32_bf16 v[108:111], v[72:75], v[188:191], v[108:111]
    s_waitcnt lgkmcnt(4)
    v_mfma_f32_16x16x32_bf16 v[96:99], v[64:67], v[120:123], v[96:99]
    ds_read_b64_tr_b16 v[72:73], v5 offset:12288
    ds_read_b64_tr_b16 v[74:75], v5 offset:12800
    v_mfma_f32_16x16x32_bf16 v[104:107], v[64:67], v[192:195], v[104:107]
    v_mfma_f32_16x16x32_bf16 v[76:79], v[64:67], v[22:25], v[76:79]
    ds_read_b64_tr_b16 v[60:61], v2 offset:16384
    ds_read_b64_tr_b16 v[62:63], v2 offset:16896
    s_waitcnt lgkmcnt(6)
    v_mfma_f32_16x16x32_bf16 v[100:103], v[68:71], v[120:123], v[100:103]
    s_mul_i32 s52, s46, 0
    s_add_u32 s53, s45, s55
    s_add_u32 m0, s53, 2048
    s_add_u32 s52, s52, s47
    buffer_load_dwordx4 v11, s[20:23], s52 offen lds
    s_add_u32 s45, s45, 24576
    s_cmp_ge_u32 s45, 147456
    s_cselect_b32 s45, 0, s45
    v_mfma_f32_16x16x32_bf16 v[108:111], v[68:71], v[192:195], v[108:111]
    s_waitcnt lgkmcnt(4)
    v_mfma_f32_16x16x32_bf16 v[96:99], v[56:59], v[124:127], v[96:99]
    ds_read_b64_tr_b16 v[68:69], v3 offset:16384
    ds_read_b64_tr_b16 v[70:71], v3 offset:16896
    v_mfma_f32_16x16x32_bf16 v[104:107], v[56:59], v[196:199], v[104:107]
    ds_read_b64_tr_b16 v[64:65], v4 offset:20480
    ds_read_b64_tr_b16 v[66:67], v4 offset:20992
    s_waitcnt lgkmcnt(6)
    v_mfma_f32_16x16x32_bf16 v[100:103], v[72:75], v[124:127], v[100:103]
    v_mfma_f32_16x16x32_bf16 v[108:111], v[72:75], v[196:199], v[108:111]
    s_waitcnt lgkmcnt(4)
    v_mfma_f32_16x16x32_bf16 v[96:99], v[60:63], v[128:131], v[96:99]
    s_waitcnt vmcnt(3)
    s_barrier
    s_cmp_lg_u32 s36, 0
    s_cbranch_scc1 p1_pub_25
    s_add_u32 s52, s57, s43
    s_add_i32 s52, s52, -1
    v_mov_b32 v1, s52
    v_mov_b32 v54, 0
    buffer_store_dword v1, v54, s[96:99], s79 offen sc1
p1_pub_25:
    ds_read_b64_tr_b16 v[72:73], v5 offset:20480
    ds_read_b64_tr_b16 v[74:75], v5 offset:20992
    v_mfma_f32_16x16x32_bf16 v[104:107], v[60:63], v[200:203], v[104:107]
    v_mfma_f32_16x16x32_bf16 v[76:79], v[60:63], v[22:25], v[76:79]
    v_add_u32 v2, s89, v2
    ds_read_b64_tr_b16 v[56:57], v2 offset:0
    ds_read_b64_tr_b16 v[58:59], v2 offset:512
    s_waitcnt lgkmcnt(6)
    v_mfma_f32_16x16x32_bf16 v[100:103], v[68:71], v[128:131], v[100:103]
    s_mul_i32 s52, s46, 192
    s_add_u32 s53, s45, s55
    s_add_u32 m0, s53, 0
    s_add_u32 s52, s52, s47
    buffer_load_dwordx4 v9, s[20:23], s52 offen lds
    v_mfma_f32_16x16x32_bf16 v[108:111], v[68:71], v[200:203], v[108:111]
    s_waitcnt lgkmcnt(4)
    v_mfma_f32_16x16x32_bf16 v[96:99], v[64:67], v[132:135], v[96:99]
    v_add_u32 v3, s90, v3
    ds_read_b64_tr_b16 v[68:69], v3 offset:0
    ds_read_b64_tr_b16 v[70:71], v3 offset:512
    v_mfma_f32_16x16x32_bf16 v[104:107], v[64:67], v[204:207], v[104:107]
    v_add_u32 v4, s89, v4
    ds_read_b64_tr_b16 v[60:61], v4 offset:4096
    ds_read_b64_tr_b16 v[62:63], v4 offset:4608
    s_add_u32 s44, s44, 24576
    s_cmp_ge_u32 s44, 147456
    s_cselect_b32 s44, 0, s44
    s_mov_b32 s89, -122880
    s_cselect_b32 s89, s89, 24576
    ds_read_b128 v[36:39], v14
    ds_read_b128 v[44:47], v14 offset:256
    ds_read_b128 v[28:31], v12
    v_add_u32 v12, 256, v12
    ds_read_b128 v[40:43], v15
    ds_read_b128 v[48:51], v15 offset:256
    ds_read_b128 v[32:35], v13
    v_add_u32 v13, 256, v13
    s_cmp_ge_u32 s36, 4
    s_cbranch_scc1 p1_tsk_26
p1_tbk_27:
    s_waitcnt lgkmcnt(12)
    v_mfma_f32_16x16x32_bf16 v[100:103], v[72:75], v[132:135], v[100:103]
    v_mfma_f32_16x16x32_bf16 v[108:111], v[72:75], v[204:207], v[108:111]
    s_waitcnt lgkmcnt(10)
    v_mfma_f32_16x16x32_bf16 v[96:99], v[56:59], v[136:139], v[96:99]
    v_add_u32 v5, s90, v5
    ds_read_b64_tr_b16 v[72:73], v5 offset:4096
    ds_read_b64_tr_b16 v[74:75], v5 offset:4608
    s_add_u32 s88, s88, 24576
    s_cmp_ge_u32 s88, 147456
    s_cselect_b32 s88, 0, s88
    s_mov_b32 s90, -122880
    s_cselect_b32 s90, s90, 24576
    s_waitcnt lgkmcnt(2)
    v_add_f32 v36, v36, v44
    v_add_f32 v37, v37, v45
    v_mfma_f32_16x16x32_bf16 v[104:107], v[56:59], v[208:211], v[104:107]
    v_mfma_f32_16x16x32_bf16 v[76:79], v[56:59], v[22:25], v[76:79]
    ds_read_b64_tr_b16 v[64:65], v2 offset:8192
    ds_read_b64_tr_b16 v[66:67], v2 offset:8704
    v_add_f32 v38, v38, v46
    v_add_f32 v39, v39, v47
    v_mfma_f32_16x16x32_bf16 v[100:103], v[68:71], v[136:139], v[100:103]
    s_mul_i32 s52, s46, 192
    s_add_u32 s53, s45, s55
    s_add_u32 m0, s53, 1024
    s_add_u32 s52, s52, s47
    buffer_load_dwordx4 v10, s[20:23], s52 offen lds
    v_add_f32 v40, v40, v48
    v_add_f32 v41, v41, v49
    v_add_f32 v42, v42, v50
    v_mfma_f32_16x16x32_bf16 v[108:111], v[68:71], v[208:211], v[108:111]
    v_add_f32 v43, v43, v51
    v_fma_f32 v80, -v17, v36, v80
    v_mfma_f32_16x16x32_bf16 v[96:99], v[60:63], v[140:143], v[96:99]
    ds_read_b64_tr_b16 v[68:69], v3 offset:8192
    ds_read_b64_tr_b16 v[70:71], v3 offset:8704
    v_fma_f32 v81, -v17, v37, v81
    v_fma_f32 v80, v16, v80, v28
    v_fma_f32 v81, v16, v81, v29
    v_mfma_f32_16x16x32_bf16 v[104:107], v[60:63], v[212:215], v[104:107]
    ds_read_b64_tr_b16 v[56:57], v4 offset:12288
    ds_read_b64_tr_b16 v[58:59], v4 offset:12800
    v_max_f32 v80, 0, v80
    v_max_f32 v81, 0, v81
    s_waitcnt lgkmcnt(6)
    v_mfma_f32_16x16x32_bf16 v[100:103], v[72:75], v[140:143], v[100:103]
    v_mul_f32 v80, v80, v80
    v_mul_f32 v81, v81, v81
    v_cvt_pk_bf16_f32 v44, v80, v81
    v_mfma_f32_16x16x32_bf16 v[108:111], v[72:75], v[212:215], v[108:111]
    v_fma_f32 v82, -v17, v38, v82
    v_fma_f32 v83, -v17, v39, v83
    s_waitcnt lgkmcnt(4)
    v_mfma_f32_16x16x32_bf16 v[96:99], v[64:67], v[144:147], v[96:99]
    ds_read_b64_tr_b16 v[72:73], v5 offset:12288
    ds_read_b64_tr_b16 v[74:75], v5 offset:12800
    v_fma_f32 v82, v16, v82, v30
    v_fma_f32 v83, v16, v83, v31
    v_max_f32 v82, 0, v82
    v_mfma_f32_16x16x32_bf16 v[104:107], v[64:67], v[216:219], v[104:107]
    v_mfma_f32_16x16x32_bf16 v[76:79], v[64:67], v[22:25], v[76:79]
    ds_read_b64_tr_b16 v[60:61], v2 offset:16384
    ds_read_b64_tr_b16 v[62:63], v2 offset:16896
    v_max_f32 v83, 0, v83
    v_mul_f32 v82, v82, v82
    s_waitcnt lgkmcnt(6)
    v_mfma_f32_16x16x32_bf16 v[100:103], v[68:71], v[144:147], v[100:103]
    s_mul_i32 s52, s46, 192
    s_add_u32 s53, s45, s55
    s_add_u32 m0, s53, 2048
    s_add_u32 s52, s52, s47
    buffer_load_dwordx4 v11, s[20:23], s52 offen lds
    s_add_u32 s45, s45, 24576
    s_cmp_ge_u32 s45, 147456
    s_cselect_b32 s45, 0, s45
    v_mul_f32 v83, v83, v83
    v_cvt_pk_bf16_f32 v45, v82, v83
    v_mfma_f32_16x16x32_bf16 v[108:111], v[68:71], v[216:219], v[108:111]
    v_fma_f32 v84, -v17, v40, v84
    v_fma_f32 v85, -v17, v41, v85
    v_fma_f32 v84, v16, v84, v32
    s_waitcnt lgkmcnt(4)
    v_mfma_f32_16x16x32_bf16 v[96:99], v[56:59], v[148:151], v[96:99]
    ds_read_b64_tr_b16 v[68:69], v3 offset:16384
    ds_read_b64_tr_b16 v[70:71], v3 offset:16896
    v_fma_f32 v85, v16, v85, v33
    v_max_f32 v84, 0, v84
    v_mfma_f32_16x16x32_bf16 v[104:107], v[56:59], v[220:223], v[104:107]
    ds_read_b64_tr_b16 v[64:65], v4 offset:20480
    ds_read_b64_tr_b16 v[66:67], v4 offset:20992
    v_max_f32 v85, 0, v85
    v_mul_f32 v84, v84, v84
    v_mul_f32 v85, v85, v85
    s_waitcnt lgkmcnt(6)
    v_mfma_f32_16x16x32_bf16 v[100:103], v[72:75], v[148:151], v[100:103]
    v_cvt_pk_bf16_f32 v46, v84, v85
    v_fma_f32 v86, -v17, v42, v86
    v_mfma_f32_16x16x32_bf16 v[108:111], v[72:75], v[220:223], v[108:111]
    v_fma_f32 v87, -v17, v43, v87
    v_fma_f32 v86, v16, v86, v34
    v_fma_f32 v87, v16, v87, v35
    s_waitcnt lgkmcnt(4)
    v_mfma_f32_16x16x32_bf16 v[96:99], v[60:63], v[152:155], v[96:99]
    s_barrier
    ds_read_b64_tr_b16 v[72:73], v5 offset:20480
    ds_read_b64_tr_b16 v[74:75], v5 offset:20992
    v_max_f32 v86, 0, v86
    v_max_f32 v87, 0, v87
    v_mfma_f32_16x16x32_bf16 v[104:107], v[60:63], v[224:227], v[104:107]
    v_mfma_f32_16x16x32_bf16 v[76:79], v[60:63], v[22:25], v[76:79]
    v_add_u32 v2, s89, v2
    ds_read_b64_tr_b16 v[56:57], v2 offset:0
    ds_read_b64_tr_b16 v[58:59], v2 offset:512
    v_mul_f32 v86, v86, v86
    v_mul_f32 v87, v87, v87
    v_cvt_pk_bf16_f32 v47, v86, v87
    s_waitcnt lgkmcnt(6)
    v_mfma_f32_16x16x32_bf16 v[100:103], v[68:71], v[152:155], v[100:103]
    s_mul_i32 s52, s46, 384
    s_add_u32 s53, s45, s55
    s_add_u32 m0, s53, 0
    s_add_u32 s52, s52, s47
    buffer_load_dwordx4 v9, s[20:23], s52 offen lds
    s_lshl_b32 s56, s49, 15
    s_add_u32 s56, s56, s80
    s_lshr_b32 s56, s56, 1
    v_permlane16_swap_b32 v44, v46
    v_mfma_f32_16x16x32_bf16 v[108:111], v[68:71], v[224:227], v[108:111]
    v_permlane16_swap_b32 v45, v47
    buffer_store_dwordx4 v[44:47], v52, s[24:27], s56 offen sc1
    s_waitcnt lgkmcnt(4)
    v_mfma_f32_16x16x32_bf16 v[96:99], v[64:67], v[156:159], v[96:99]
    v_add_u32 v3, s90, v3
    ds_read_b64_tr_b16 v[68:69], v3 offset:0
    ds_read_b64_tr_b16 v[70:71], v3 offset:512
    v_fma_f32 v88, -v19, v36, v88
    v_fma_f32 v89, -v19, v37, v89
    v_fma_f32 v88, v18, v88, v28
    v_mfma_f32_16x16x32_bf16 v[104:107], v[64:67], v[228:231], v[104:107]
    v_add_u32 v4, s89, v4
    ds_read_b64_tr_b16 v[60:61], v4 offset:4096
    ds_read_b64_tr_b16 v[62:63], v4 offset:4608
    s_add_u32 s44, s44, 24576
    s_cmp_ge_u32 s44, 147456
    s_cselect_b32 s44, 0, s44
    s_mov_b32 s89, -122880
    s_cselect_b32 s89, s89, 24576
    v_fma_f32 v89, v18, v89, v29
    v_max_f32 v88, 0, v88
    s_waitcnt lgkmcnt(6)
    v_mfma_f32_16x16x32_bf16 v[100:103], v[72:75], v[156:159], v[100:103]
    v_max_f32 v89, 0, v89
    v_mul_f32 v88, v88, v88
    v_mul_f32 v89, v89, v89
    v_mfma_f32_16x16x32_bf16 v[108:111], v[72:75], v[228:231], v[108:111]
    v_cvt_pk_bf16_f32 v48, v88, v89
    v_fma_f32 v90, -v19, v38, v90
    s_waitcnt lgkmcnt(4)
    v_mfma_f32_16x16x32_bf16 v[96:99], v[56:59], v[160:163], v[96:99]
    v_add_u32 v5, s90, v5
    ds_read_b64_tr_b16 v[72:73], v5 offset:4096
    ds_read_b64_tr_b16 v[74:75], v5 offset:4608
    s_add_u32 s88, s88, 24576
    s_cmp_ge_u32 s88, 147456
    s_cselect_b32 s88, 0, s88
    s_mov_b32 s90, -122880
    s_cselect_b32 s90, s90, 24576
    v_fma_f32 v91, -v19, v39, v91
    v_fma_f32 v90, v18, v90, v30
    v_fma_f32 v91, v18, v91, v31
    v_mfma_f32_16x16x32_bf16 v[104:107], v[56:59], v[232:235], v[104:107]
    v_mfma_f32_16x16x32_bf16 v[76:79], v[56:59], v[22:25], v[76:79]
    ds_read_b64_tr_b16 v[64:65], v2 offset:8192
    ds_read_b64_tr_b16 v[66:67], v2 offset:8704
    v_max_f32 v90, 0, v90
    v_max_f32 v91, 0, v91
    s_waitcnt lgkmcnt(6)
    v_mfma_f32_16x16x32_bf16 v[100:103], v[68:71], v[160:163], v[100:103]
    s_mul_i32 s52, s46, 384
    s_add_u32 s53, s45, s55
    s_add_u32 m0, s53, 1024
    s_add_u32 s52, s52, s47
    buffer_load_dwordx4 v10, s[20:23], s52 offen lds
    v_mul_f32 v90, v90, v90
    v_mul_f32 v91, v91, v91
    v_cvt_pk_bf16_f32 v49, v90, v91
    v_mfma_f32_16x16x32_bf16 v[108:111], v[68:71], v[232:235], v[108:111]
    v_fma_f32 v92, -v19, v40, v92
    v_fma_f32 v93, -v19, v41, v93
    s_waitcnt lgkmcnt(4)
    v_mfma_f32_16x16x32_bf16 v[96:99], v[60:63], v[164:167], v[96:99]
    ds_read_b64_tr_b16 v[68:69], v3 offset:8192
    ds_read_b64_tr_b16 v[70:71], v3 offset:8704
    v_fma_f32 v92, v18, v92, v32
    v_fma_f32 v93, v18, v93, v33
    v_mfma_f32_16x16x32_bf16 v[104:107], v[60:63], v[236:239], v[104:107]
    ds_read_b64_tr_b16 v[56:57], v4 offset:12288
    ds_read_b64_tr_b16 v[58:59], v4 offset:12800
    v_max_f32 v92, 0, v92
    v_max_f32 v93, 0, v93
    v_mul_f32 v92, v92, v92
    s_waitcnt lgkmcnt(6)
    v_mfma_f32_16x16x32_bf16 v[100:103], v[72:75], v[164:167], v[100:103]
    v_mul_f32 v93, v93, v93
    v_cvt_pk_bf16_f32 v50, v92, v93
    v_mfma_f32_16x16x32_bf16 v[108:111], v[72:75], v[236:239], v[108:111]
    v_fma_f32 v94, -v19, v42, v94
    v_fma_f32 v95, -v19, v43, v95
    v_fma_f32 v94, v18, v94, v34
    s_waitcnt lgkmcnt(4)
    v_mfma_f32_16x16x32_bf16 v[96:99], v[64:67], v[168:171], v[96:99]
    ds_read_b64_tr_b16 v[72:73], v5 offset:12288
    ds_read_b64_tr_b16 v[74:75], v5 offset:12800
    v_fma_f32 v95, v18, v95, v35
    v_max_f32 v94, 0, v94
    v_mfma_f32_16x16x32_bf16 v[104:107], v[64:67], v[240:243], v[104:107]
    v_mfma_f32_16x16x32_bf16 v[76:79], v[64:67], v[22:25], v[76:79]
    ds_read_b64_tr_b16 v[60:61], v2 offset:16384
    ds_read_b64_tr_b16 v[62:63], v2 offset:16896
    v_max_f32 v95, 0, v95
    v_mul_f32 v94, v94, v94
    v_mul_f32 v95, v95, v95
    s_waitcnt lgkmcnt(6)
    v_mfma_f32_16x16x32_bf16 v[100:103], v[68:71], v[168:171], v[100:103]
    s_mul_i32 s52, s46, 384
    s_add_u32 s53, s45, s55
    s_add_u32 m0, s53, 2048
    s_add_u32 s52, s52, s47
    buffer_load_dwordx4 v11, s[20:23], s52 offen lds
    s_add_u32 s45, s45, 24576
    s_cmp_ge_u32 s45, 147456
    s_cselect_b32 s45, 0, s45
    v_cvt_pk_bf16_f32 v51, v94, v95
    s_lshl_b32 s56, s49, 15
    s_add_u32 s56, s56, s81
    s_lshr_b32 s56, s56, 1
    v_mfma_f32_16x16x32_bf16 v[108:111], v[68:71], v[240:243], v[108:111]
    v_permlane16_swap_b32 v48, v50
    v_permlane16_swap_b32 v49, v51
    buffer_store_dwordx4 v[48:51], v52, s[24:27], s56 offen sc1
    s_waitcnt lgkmcnt(4)
    v_mfma_f32_16x16x32_bf16 v[96:99], v[56:59], v[172:175], v[96:99]
    ds_read_b64_tr_b16 v[68:69], v3 offset:16384
    ds_read_b64_tr_b16 v[70:71], v3 offset:16896
    v_mfma_f32_16x16x32_bf16 v[104:107], v[56:59], v[244:247], v[104:107]
    ds_read_b64_tr_b16 v[64:65], v4 offset:20480
    ds_read_b64_tr_b16 v[66:67], v4 offset:20992
    s_waitcnt lgkmcnt(6)
    v_mfma_f32_16x16x32_bf16 v[100:103], v[72:75], v[172:175], v[100:103]
    v_mfma_f32_16x16x32_bf16 v[108:111], v[72:75], v[244:247], v[108:111]
    s_add_u32 s52, s43, 1
    s_cmp_eq_u32 s52, s42
    s_cbranch_scc1 p1_hk_28
p1_hkb_29:
    s_waitcnt lgkmcnt(4)
    v_mfma_f32_16x16x32_bf16 v[96:99], v[60:63], v[176:179], v[96:99]
    s_waitcnt vmcnt(8)
    s_barrier
    ds_read_b64_tr_b16 v[72:73], v5 offset:20480
    ds_read_b64_tr_b16 v[74:75], v5 offset:20992
    v_mfma_f32_16x16x32_bf16 v[104:107], v[60:63], v[248:251], v[104:107]
    v_mfma_f32_16x16x32_bf16 v[76:79], v[60:63], v[22:25], v[76:79]
    v_add_u32 v2, s89, v2
    ds_read_b64_tr_b16 v[56:57], v2 offset:0
    ds_read_b64_tr_b16 v[58:59], v2 offset:512
    s_add_u32 s56, s43, 2
    s_add_u32 s47, s47, 512
    s_cmp_ge_u32 s56, s42
    s_cbranch_scc1 p1_slp_30
p1_slb_31:
    s_waitcnt lgkmcnt(6)
    v_mfma_f32_16x16x32_bf16 v[100:103], v[68:71], v[176:179], v[100:103]
    s_add_u32 s52, s43, 1
    s_cmp_ge_u32 s52, s42
    s_cselect_b32 s45, 0x30000, s45
    s_mul_i32 s52, s46, 0
    s_add_u32 s53, s45, s55
    s_add_u32 m0, s53, 0
    s_add_u32 s52, s52, s47
    buffer_load_dwordx4 v9, s[20:23], s52 offen lds
    v_mfma_f32_16x16x32_bf16 v[108:111], v[68:71], v[248:251], v[108:111]
    s_waitcnt lgkmcnt(4)
    v_mfma_f32_16x16x32_bf16 v[96:99], v[64:67], v[180:183], v[96:99]
    v_add_u32 v3, s90, v3
    ds_read_b64_tr_b16 v[68:69], v3 offset:0
    ds_read_b64_tr_b16 v[70:71], v3 offset:512
    v_mfma_f32_16x16x32_bf16 v[104:107], v[64:67], v[252:255], v[104:107]
    v_add_u32 v4, s89, v4
    ds_read_b64_tr_b16 v[60:61], v4 offset:4096
    ds_read_b64_tr_b16 v[62:63], v4 offset:4608
    s_add_u32 s44, s44, 24576
    s_cmp_ge_u32 s44, 147456
    s_cselect_b32 s44, 0, s44
    s_mov_b32 s89, -122880
    s_cselect_b32 s89, s89, 24576
    s_waitcnt lgkmcnt(6)
    v_mfma_f32_16x16x32_bf16 v[100:103], v[72:75], v[180:183], v[100:103]
    v_mfma_f32_16x16x32_bf16 v[108:111], v[72:75], v[252:255], v[108:111]
    s_add_u32 s52, s43, 1
    s_cmp_eq_u32 s52, s42
    s_cbranch_scc1 p1_hk_32
p1_hkb_33:
    ds_write_b128 v20, v[76:79]
    s_mov_b32 s49, s48
    s_add_u32 s43, s43, 1
    s_add_u32 s48, s48, 4
    s_cmp_lt_u32 s43, s42
    s_cbranch_scc1 p1_b1_13
p1_e0_10:
    s_waitcnt lgkmcnt(0)
    s_barrier
    ds_read_b128 v[36:39], v14
    ds_read_b128 v[44:47], v14 offset:256
    ds_read_b128 v[28:31], v12
    v_add_u32 v12, 256, v12
    ds_read_b128 v[40:43], v15
    ds_read_b128 v[48:51], v15 offset:256
    ds_read_b128 v[32:35], v13
    v_add_u32 v13, 256, v13
    s_waitcnt lgkmcnt(0)
    v_add_f32 v36, v36, v44
    v_add_f32 v37, v37, v45
    v_add_f32 v38, v38, v46
    v_add_f32 v39, v39, v47
    v_add_f32 v40, v40, v48
    v_add_f32 v41, v41, v49
    v_add_f32 v42, v42, v50
    v_add_f32 v43, v43, v51
    v_fma_f32 v96, -v17, v36, v96
    v_fma_f32 v97, -v17, v37, v97
    v_fma_f32 v96, v16, v96, v28
    v_fma_f32 v97, v16, v97, v29
    v_max_f32 v96, 0, v96
    v_max_f32 v97, 0, v97
    v_mul_f32 v96, v96, v96
    v_mul_f32 v97, v97, v97
    v_cvt_pk_bf16_f32 v44, v96, v97
    v_fma_f32 v98, -v17, v38, v98
    v_fma_f32 v99, -v17, v39, v99
    v_fma_f32 v98, v16, v98, v30
    v_fma_f32 v99, v16, v99, v31
    v_max_f32 v98, 0, v98
    v_max_f32 v99, 0, v99
    v_mul_f32 v98, v98, v98
    v_mul_f32 v99, v99, v99
    v_cvt_pk_bf16_f32 v45, v98, v99
    v_fma_f32 v100, -v17, v40, v100
    v_fma_f32 v101, -v17, v41, v101
    v_fma_f32 v100, v16, v100, v32
    v_fma_f32 v101, v16, v101, v33
    v_max_f32 v100, 0, v100
    v_max_f32 v101, 0, v101
    v_mul_f32 v100, v100, v100
    v_mul_f32 v101, v101, v101
    v_cvt_pk_bf16_f32 v46, v100, v101
    v_fma_f32 v102, -v17, v42, v102
    v_fma_f32 v103, -v17, v43, v103
    v_fma_f32 v102, v16, v102, v34
    v_fma_f32 v103, v16, v103, v35
    v_max_f32 v102, 0, v102
    v_max_f32 v103, 0, v103
    v_mul_f32 v102, v102, v102
    v_mul_f32 v103, v103, v103
    v_cvt_pk_bf16_f32 v47, v102, v103
    s_lshl_b32 s56, s49, 15
    s_add_u32 s56, s56, s80
    s_lshr_b32 s56, s56, 1
    v_permlane16_swap_b32 v44, v46
    v_permlane16_swap_b32 v45, v47
    buffer_store_dwordx4 v[44:47], v52, s[24:27], s56 offen sc1
    v_fma_f32 v104, -v19, v36, v104
    v_fma_f32 v105, -v19, v37, v105
    v_fma_f32 v104, v18, v104, v28
    v_fma_f32 v105, v18, v105, v29
    v_max_f32 v104, 0, v104
    v_max_f32 v105, 0, v105
    v_mul_f32 v104, v104, v104
    v_mul_f32 v105, v105, v105
    v_cvt_pk_bf16_f32 v48, v104, v105
    v_fma_f32 v106, -v19, v38, v106
    v_fma_f32 v107, -v19, v39, v107
    v_fma_f32 v106, v18, v106, v30
    v_fma_f32 v107, v18, v107, v31
    v_max_f32 v106, 0, v106
    v_max_f32 v107, 0, v107
    v_mul_f32 v106, v106, v106
    v_mul_f32 v107, v107, v107
    v_cvt_pk_bf16_f32 v49, v106, v107
    v_fma_f32 v108, -v19, v40, v108
    v_fma_f32 v109, -v19, v41, v109
    v_fma_f32 v108, v18, v108, v32
    v_fma_f32 v109, v18, v109, v33
    v_max_f32 v108, 0, v108
    v_max_f32 v109, 0, v109
    v_mul_f32 v108, v108, v108
    v_mul_f32 v109, v109, v109
    v_cvt_pk_bf16_f32 v50, v108, v109
    v_fma_f32 v110, -v19, v42, v110
    v_fma_f32 v111, -v19, v43, v111
    v_fma_f32 v110, v18, v110, v34
    v_fma_f32 v111, v18, v111, v35
    v_max_f32 v110, 0, v110
    v_max_f32 v111, 0, v111
    v_mul_f32 v110, v110, v110
    v_mul_f32 v111, v111, v111
    v_cvt_pk_bf16_f32 v51, v110, v111
    s_lshl_b32 s56, s49, 15
    s_add_u32 s56, s56, s81
    s_lshr_b32 s56, s56, 1
    v_permlane16_swap_b32 v48, v50
    v_permlane16_swap_b32 v49, v51
    buffer_store_dwordx4 v[48:51], v52, s[24:27], s56 offen sc1
    s_branch p1_x_12
p1_e1_11:
    s_waitcnt lgkmcnt(0)
    s_barrier
    ds_read_b128 v[36:39], v14
    ds_read_b128 v[44:47], v14 offset:256
    ds_read_b128 v[28:31], v12
    v_add_u32 v12, 256, v12
    ds_read_b128 v[40:43], v15
    ds_read_b128 v[48:51], v15 offset:256
    ds_read_b128 v[32:35], v13
    v_add_u32 v13, 256, v13
    s_waitcnt lgkmcnt(0)
    v_add_f32 v36, v36, v44
    v_add_f32 v37, v37, v45
    v_add_f32 v38, v38, v46
    v_add_f32 v39, v39, v47
    v_add_f32 v40, v40, v48
    v_add_f32 v41, v41, v49
    v_add_f32 v42, v42, v50
    v_add_f32 v43, v43, v51
    v_fma_f32 v80, -v17, v36, v80
    v_fma_f32 v81, -v17, v37, v81
    v_fma_f32 v80, v16, v80, v28
    v_fma_f32 v81, v16, v81, v29
    v_max_f32 v80, 0, v80
    v_max_f32 v81, 0, v81
    v_mul_f32 v80, v80, v80
    v_mul_f32 v81, v81, v81
    v_cvt_pk_bf16_f32 v44, v80, v81
    v_fma_f32 v82, -v17, v38, v82
    v_fma_f32 v83, -v17, v39, v83
    v_fma_f32 v82, v16, v82, v30
    v_fma_f32 v83, v16, v83, v31
    v_max_f32 v82, 0, v82
    v_max_f32 v83, 0, v83
    v_mul_f32 v82, v82, v82
    v_mul_f32 v83, v83, v83
    v_cvt_pk_bf16_f32 v45, v82, v83
    v_fma_f32 v84, -v17, v40, v84
    v_fma_f32 v85, -v17, v41, v85
    v_fma_f32 v84, v16, v84, v32
    v_fma_f32 v85, v16, v85, v33
    v_max_f32 v84, 0, v84
    v_max_f32 v85, 0, v85
    v_mul_f32 v84, v84, v84
    v_mul_f32 v85, v85, v85
    v_cvt_pk_bf16_f32 v46, v84, v85
    v_fma_f32 v86, -v17, v42, v86
    v_fma_f32 v87, -v17, v43, v87
    v_fma_f32 v86, v16, v86, v34
    v_fma_f32 v87, v16, v87, v35
    v_max_f32 v86, 0, v86
    v_max_f32 v87, 0, v87
    v_mul_f32 v86, v86, v86
    v_mul_f32 v87, v87, v87
    v_cvt_pk_bf16_f32 v47, v86, v87
    s_lshl_b32 s56, s49, 15
    s_add_u32 s56, s56, s80
    s_lshr_b32 s56, s56, 1
    v_permlane16_swap_b32 v44, v46
    v_permlane16_swap_b32 v45, v47
    buffer_store_dwordx4 v[44:47], v52, s[24:27], s56 offen sc1
    v_fma_f32 v88, -v19, v36, v88
    v_fma_f32 v89, -v19, v37, v89
    v_fma_f32 v88, v18, v88, v28
    v_fma_f32 v89, v18, v89, v29
    v_max_f32 v88, 0, v88
    v_max_f32 v89, 0, v89
    v_mul_f32 v88, v88, v88
    v_mul_f32 v89, v89, v89
    v_cvt_pk_bf16_f32 v48, v88, v89
    v_fma_f32 v90, -v19, v38, v90
    v_fma_f32 v91, -v19, v39, v91
    v_fma_f32 v90, v18, v90, v30
    v_fma_f32 v91, v18, v91, v31
    v_max_f32 v90, 0, v90
    v_max_f32 v91, 0, v91
    v_mul_f32 v90, v90, v90
    v_mul_f32 v91, v91, v91
    v_cvt_pk_bf16_f32 v49, v90, v91
    v_fma_f32 v92, -v19, v40, v92
    v_fma_f32 v93, -v19, v41, v93
    v_fma_f32 v92, v18, v92, v32
    v_fma_f32 v93, v18, v93, v33
    v_max_f32 v92, 0, v92
    v_max_f32 v93, 0, v93
    v_mul_f32 v92, v92, v92
    v_mul_f32 v93, v93, v93
    v_cvt_pk_bf16_f32 v50, v92, v93
    v_fma_f32 v94, -v19, v42, v94
    v_fma_f32 v95, -v19, v43, v95
    v_fma_f32 v94, v18, v94, v34
    v_fma_f32 v95, v18, v95, v35
    v_max_f32 v94, 0, v94
    v_max_f32 v95, 0, v95
    v_mul_f32 v94, v94, v94
    v_mul_f32 v95, v95, v95
    v_cvt_pk_bf16_f32 v51, v94, v95
    s_lshl_b32 s56, s49, 15
    s_add_u32 s56, s56, s81
    s_lshr_b32 s56, s56, 1
    v_permlane16_swap_b32 v48, v50
    v_permlane16_swap_b32 v49, v51
    buffer_store_dwordx4 v[48:51], v52, s[24:27], s56 offen sc1
    s_branch p1_x_12
p1_sl_15:
    v_and_b32 v54, 15, v0
    s_lshl_b32 s52, s38, 8
    s_add_u32 s52, s52, 158208
    v_lshl_add_u32 v54, v54, 3, s52
    s_lshr_b32 s52, s80, 4
    v_add_u32 v55, s52, v54
    ds_read_b64 v[16:17], v55
    s_lshr_b32 s52, s81, 4
    v_add_u32 v55, s52, v54
    ds_read_b64 v[18:19], v55
    s_waitcnt lgkmcnt(0)
    s_branch p1_slb2_16
p1_tsk_17:
    s_cmp_gt_u32 s36, 5
    s_cbranch_scc1 p1_pf_34
    s_cmp_gt_u32 s43, 2
    s_cbranch_scc1 p1_pf_34
    s_cmp_eq_u32 s40, 0
    s_cbranch_scc1 p1_pf_34
    s_bfe_u32 s52, s2, 0x10005
    s_add_u32 s52, s52, 1
    s_cmp_lg_u32 s52, s43
    s_cbranch_scc1 p1_pf_34
    s_lshr_b32 s52, s2, 5
    s_lshl_b32 s52, s52, 3
    s_sub_u32 s52, s2, s52
    s_sub_u32 s52, s52, 8
    s_lshl_b32 s52, s52, 1
    s_add_u32 s52, s52, s36
    s_sub_u32 s52, s52, 4
pf_go_36:
    s_getpc_b64 s[94:95]
    s_add_u32 s94, s94, tab_Tinv@rel32@lo+4
    s_addc_u32 s95, s95, tab_Tinv@rel32@hi+12
    s_lshl_b32 s53, s52, 14
    s_sub_u32 s54, s53, 5308416
    v_lshlrev_b32 v1, 8, v0
    s_cmp_lt_u32 s52, 324
    s_cselect_b32 s32, s92, s94
    s_cselect_b32 s33, s93, s95
    s_cselect_b32 s53, s53, s54
    s_mov_b32 s54, 724992
    s_cselect_b32 s34, 5308416, s54
    s_and_b32 s33, s33, 0xffff
    buffer_load_dwordx2 v[26:27], v1, s[32:35], s53 offen offset:124
p1_pf_34:
    s_cmp_lg_u32 s43, 1
    s_cbranch_scc1 p1_tq_37
    s_cmp_lt_u32 s36, 6
    s_cbranch_scc1 p1_tw_38
    s_add_u32 s56, s43, 2
    s_cmp_ge_u32 s56, s42
    s_cbranch_scc1 p1_tw_38
    s_lshl_b32 s52, s56, 2
    s_add_u32 s52, s52, s40
    s_add_u32 s53, s52, s51
    s_mul_i32 s54, s41, 18
    s_add_u32 s54, s54, s52
    s_sub_u32 s54, s54, s50
    s_cmp_lt_u32 s52, s50
    s_cselect_b32 s56, s53, s54
    s_lshl_b32 s56, s56, 7
    s_and_b32 s52, s39, 7
    s_lshl_b32 s52, s52, 1
    s_add_u32 s52, s52, s36
    s_sub_u32 s52, s52, 6
    s_mul_i32 s52, s52, 331776
    s_add_u32 s56, s56, s52
    v_min_u32 v1, 35, v0
    v_mul_u32_u24 v1, 9216, v1
    buffer_load_dword v26, v1, s[12:15], s56 offen
p1_tw_38:
    s_cmp_lt_u32 s36, 6
    s_cbranch_scc1 p1_tw_39
    s_add_u32 s56, s43, 3
    s_cmp_ge_u32 s56, s42
    s_cbranch_scc1 p1_tw_39
    s_lshl_b32 s52, s56, 2
    s_add_u32 s52, s52, s40
    s_add_u32 s53, s52, s51
    s_mul_i32 s54, s41, 18
    s_add_u32 s54, s54, s52
    s_sub_u32 s54, s54, s50
    s_cmp_lt_u32 s52, s50
    s_cselect_b32 s56, s53, s54
    s_lshl_b32 s56, s56, 7
    s_and_b32 s52, s39, 7
    s_lshl_b32 s52, s52, 1
    s_add_u32 s52, s52, s36
    s_sub_u32 s52, s52, 6
    s_mul_i32 s52, s52, 331776
    s_add_u32 s56, s56, s52
    v_min_u32 v1, 35, v0
    v_mul_u32_u24 v1, 9216, v1
    buffer_load_dword v26, v1, s[12:15], s56 offen
p1_tw_39:
    s_cmp_lt_u32 s36, 6
    s_cbranch_scc1 p1_tw_40
    s_add_u32 s56, s43, 4
    s_cmp_ge_u32 s56, s42
    s_cbranch_scc1 p1_tw_40
    s_lshl_b32 s52, s56, 2
    s_add_u32 s52, s52, s40
    s_add_u32 s53, s52, s51
    s_mul_i32 s54, s41, 18
    s_add_u32 s54, s54, s52
    s_sub_u32 s54, s54, s50
    s_cmp_lt_u32 s52, s50
    s_cselect_b32 s56, s53, s54
    s_lshl_b32 s56, s56, 7
    s_and_b32 s52, s39, 7
    s_lshl_b32 s52, s52, 1
    s_add_u32 s52, s52, s36
    s_sub_u32 s52, s52, 6
    s_mul_i32 s52, s52, 331776
    s_add_u32 s56, s56, s52
    v_min_u32 v1, 35, v0
    v_mul_u32_u24 v1, 9216, v1
    buffer_load_dword v26, v1, s[12:15], s56 offen
p1_tw_40:
p1_tq_37:
    s_branch p1_tbk_18
p1_hk_19:
    s_cmp_lg_u32 s40, 0
    s_cbranch_scc1 p1_gx_41
    v_lshlrev_b32 v40, 6, v0
    buffer_load_dwordx4 v[36:39], v40, s[96:99], 0 offen
    s_mul_i32 s91, s39, 3
    s_add_u32 s91, s91, s41
    s_sub_u32 s91, s91, 1
    s_mul_i32 s52, s36, 48
    s_add_u32 s91, s91, s52
    s_cmp_lt_u32 s36, 6
    s_cselect_b32 s91, s91, 999
    s_lshl_b32 s52, s36, 4
    s_add_u32 s52, s52, s39
    s_add_u32 s52, s52, 288
    s_cmp_eq_u32 s41, 0
    s_cselect_b32 s91, s52, s91
    s_and_b32 s100, s43, 1
    s_mul_i32 s100, s100, 73728
    s_sub_u32 s3, 73728, s100
    s_lshl_b32 s52, s36, 13
    s_add_u32 s100, s100, s52
    s_branch p1_gy_42
p1_gx_41:
    v_and_b32 v37, 3, v0
    v_lshlrev_b32 v38, 2, v37
    s_and_b32 s52, s79, 0xffffffc0
    buffer_load_dword v36, v38, s[96:99], s52 offen
p1_gy_42:
    s_branch p1_hkb_20
p1_slp_21:
    s_lshl_b32 s52, s56, 2
    s_add_u32 s52, s52, s40
    s_add_u32 s53, s52, s51
    s_mul_i32 s54, s41, 18
    s_add_u32 s54, s54, s52
    s_sub_u32 s54, s54, s50
    s_cmp_lt_u32 s52, s50
    s_cselect_b32 s52, s53, s54
    s_cmp_lt_u32 s52, 72
    s_cselect_b32 s20, s12, s16
    s_cselect_b32 s21, s13, s17
    s_cselect_b32 s22, s14, s18
    s_cselect_b32 s46, 8, 1
    s_cselect_b32 s53, 0, 72
    s_mul_i32 s46, s46, 1152
    s_sub_u32 s52, s52, s53
    s_lshl_b32 s47, s52, 7
    s_cmp_lt_u32 s56, s42
    s_cselect_b32 s22, s22, 0
    s_cmp_eq_u32 s56, s78
    s_cselect_b32 s20, s16, s20
    s_cselect_b32 s21, s17, s21
    s_cselect_b32 s22, 1388544, s22
    s_cselect_b32 s46, 128, s46
    s_cselect_b32 s47, 1327104, s47
    v_and_b32 v54, 0xffff, v6
    v_lshrrev_b32 v55, 16, v6
    v_mad_u32_u24 v9, v54, s46, v55
    v_and_b32 v54, 0xffff, v7
    v_lshrrev_b32 v55, 16, v7
    v_mad_u32_u24 v10, v54, s46, v55
    v_and_b32 v54, 0xffff, v8
    v_lshrrev_b32 v55, 16, v8
    v_mad_u32_u24 v11, v54, s46, v55
    s_cmp_lg_u32 s56, s101
    s_cbranch_scc1 p1_g2p_43
    s_mov_b32 s20, s92
    s_mov_b32 s21, s93
    s_and_b32 s21, s21, 0xffff
    s_mov_b32 s22, 0x510000
    s_mov_b32 s23, 0x20000
    s_mov_b32 s46, 384
    s_mul_i32 s47, s41, 1327104
    s_mul_i32 s52, s40, 384
    s_add_u32 s47, s47, s52
    s_sub_u32 s47, s47, 384
    v_and_b32 v54, 63, v6
    v_lshrrev_b32 v55, 16, v6
    v_mul_u32_u24 v54, 1152, v54
    v_add_u32 v54, v54, v55
    v_bfe_u32 v55, v6, 6, 2
    v_lshl_add_u32 v9, v55, 7, v54
    v_and_b32 v54, 63, v7
    v_lshrrev_b32 v55, 16, v7
    v_mul_u32_u24 v54, 1152, v54
    v_add_u32 v54, v54, v55
    v_bfe_u32 v55, v7, 6, 2
    v_lshl_add_u32 v10, v55, 7, v54
    v_and_b32 v54, 63, v8
    v_lshrrev_b32 v55, 16, v8
    v_mul_u32_u24 v54, 1152, v54
    v_add_u32 v54, v54, v55
    v_bfe_u32 v55, v8, 6, 2
    v_lshl_add_u32 v11, v55, 7, v54
p1_g2p_43:
    s_branch p1_slb_22
p1_hk_23:
    s_cmp_lg_u32 s40, 0
    s_cbranch_scc1 p1_gx_44
    s_waitcnt vmcnt(1)
    s_cmp_gt_u32 s91, 288
    s_cbranch_scc1 aux_sk_48
    s_mov_b32 s59, 0
aux_rw_46:
    v_subrev_u32 v36, s57, v36
    v_subrev_u32 v36, 1, v36
    v_subrev_u32 v37, s57, v37
    v_subrev_u32 v37, 1, v37
    v_subrev_u32 v38, s57, v38
    v_subrev_u32 v38, 1, v38
    v_subrev_u32 v39, s57, v39
    v_subrev_u32 v39, 1, v39
    v_max3_u32 v36, v36, v37, v38
    v_max_u32 v36, v36, v39
    v_cmp_lt_u32 vcc, 15, v36
    s_add_u32 s59, s59, 1
    s_nop 3
    s_cbranch_vccz aux_go_47
    s_sleep 8
    buffer_load_dwordx4 v[36:39], v40, s[96:99], 0 offen sc1
    s_waitcnt vmcnt(0)
    s_cmp_lt_u32 s59, 20000
    s_cbranch_scc1 aux_rw_46
aux_go_47:
    s_cmp_eq_u32 s91, 288
    s_cselect_b32 s52, 0, s91
    s_lshl_b32 s52, s52, 13
    v_lshrrev_b32 v36, 4, v0
    v_and_b32 v37, 7, v0
    v_xor_b32 v36, v36, v37
    v_and_b32 v37, 0x38, v0
    v_or_b32 v37, v37, v36
    v_lshlrev_b32 v37, 4, v37
    v_xor_b32 v38, 64, v37
    s_add_u32 s53, s52, 0
    s_add_u32 m0, s100, 0
    s_nop 0
    buffer_load_dwordx4 v37, s[28:31], s53 offen offset:0 lds
    buffer_load_dwordx4 v38, s[28:31], s53 offen offset:1024 lds
    buffer_load_dwordx4 v37, s[28:31], s53 offen offset:2048 lds
    buffer_load_dwordx4 v38, s[28:31], s53 offen offset:3072 lds
    s_add_u32 s53, s52, 4096
    s_add_u32 m0, s100, 4096
    s_nop 0
    buffer_load_dwordx4 v37, s[28:31], s53 offen offset:0 lds
    buffer_load_dwordx4 v38, s[28:31], s53 offen offset:1024 lds
    buffer_load_dwordx4 v37, s[28:31], s53 offen offset:2048 lds
    buffer_load_dwordx4 v38, s[28:31], s53 offen offset:3072 lds
aux_sk_48:
    s_branch p1_gy_45
p1_gx_44:
    s_mov_b32 s59, 0
    s_waitcnt vmcnt(1)
g2h_re_49:
    v_subrev_u32 v36, s57, v36
    v_cmp_gt_u32 vcc, 16, v36
    s_nop 1
    v_cndmask_b32 v36, 0, v36, vcc
    v_lshl_add_u32 v36, v36, 2, v37
    s_nop 1
    v_min_u32_dpp v36, v36, v36 quad_perm:[1,0,3,2] row_mask:0xf bank_mask:0xf
    s_nop 1
    v_min_u32_dpp v36, v36, v36 quad_perm:[2,3,0,1] row_mask:0xf bank_mask:0xf
    s_nop 0
    v_readfirstlane_b32 s3, v36
    s_add_u32 s59, s59, 1
    s_cmp_ge_u32 s3, 6
    s_cbranch_scc1 g2h_ok_50
    s_sleep 4
    s_and_b32 s52, s79, 0xffffffc0
    buffer_load_dword v36, v38, s[96:99], s52 offen sc1
    s_waitcnt vmcnt(0)
    s_cmp_lt_u32 s59, 20000
    s_cbranch_scc1 g2h_re_49
g2h_ok_50:
    s_mul_i32 s53, s39, 72
    s_mul_i32 s54, s41, 18
    s_add_u32 s53, s53, s54
    s_lshl_b32 s53, s53, 14
    s_mul_i32 s52, s36, 6144
    s_add_u32 s53, s53, s52
    v_lshlrev_b32 v36, 4, v0
    s_add_u32 m0, s52, 0
    s_add_u32 s54, s53, 0
    buffer_load_dwordx4 v36, s[24:27], s54 offen offset:0 lds
    buffer_load_dwordx4 v36, s[24:27], s54 offen offset:1024 lds
    buffer_load_dwordx4 v36, s[24:27], s54 offen offset:2048 lds
    s_add_u32 m0, s52, 3072
    s_add_u32 s54, s53, 3072
    buffer_load_dwordx4 v36, s[24:27], s54 offen offset:0 lds
    buffer_load_dwordx4 v36, s[24:27], s54 offen offset:1024 lds
    buffer_load_dwordx4 v36, s[24:27], s54 offen offset:2048 lds
p1_gy_45:
    s_branch p1_hkb_24
p1_tsk_26:
    s_cmp_gt_u32 s36, 5
    s_cbranch_scc1 p1_pf_51
    s_cmp_gt_u32 s43, 2
    s_cbranch_scc1 p1_pf_51
    s_cmp_eq_u32 s40, 0
    s_cbranch_scc1 p1_pf_51
    s_bfe_u32 s52, s2, 0x10005
    s_add_u32 s52, s52, 1
    s_cmp_lg_u32 s52, s43
    s_cbranch_scc1 p1_pf_51
    s_lshr_b32 s52, s2, 5
    s_lshl_b32 s52, s52, 3
    s_sub_u32 s52, s2, s52
    s_sub_u32 s52, s52, 8
    s_lshl_b32 s52, s52, 1
    s_add_u32 s52, s52, s36
    s_sub_u32 s52, s52, 4
pf_go_53:
    s_getpc_b64 s[94:95]
    s_add_u32 s94, s94, tab_Tinv@rel32@lo+4
    s_addc_u32 s95, s95, tab_Tinv@rel32@hi+12
    s_lshl_b32 s53, s52, 14
    s_sub_u32 s54, s53, 5308416
    v_lshlrev_b32 v1, 8, v0
    s_cmp_lt_u32 s52, 324
    s_cselect_b32 s32, s92, s94
    s_cselect_b32 s33, s93, s95
    s_cselect_b32 s53, s53, s54
    s_mov_b32 s54, 724992
    s_cselect_b32 s34, 5308416, s54
    s_and_b32 s33, s33, 0xffff
    buffer_load_dwordx2 v[26:27], v1, s[32:35], s53 offen offset:124
p1_pf_51:
    s_cmp_lg_u32 s43, 1
    s_cbranch_scc1 p1_tq_54
    s_cmp_lt_u32 s36, 6
    s_cbranch_scc1 p1_tw_55
    s_add_u32 s56, s43, 2
    s_cmp_ge_u32 s56, s42
    s_cbranch_scc1 p1_tw_55
    s_lshl_b32 s52, s56, 2
    s_add_u32 s52, s52, s40
    s_add_u32 s53, s52, s51
    s_mul_i32 s54, s41, 18
    s_add_u32 s54, s54, s52
    s_sub_u32 s54, s54, s50
    s_cmp_lt_u32 s52, s50
    s_cselect_b32 s56, s53, s54
    s_lshl_b32 s56, s56, 7
    s_and_b32 s52, s39, 7
    s_lshl_b32 s52, s52, 1
    s_add_u32 s52, s52, s36
    s_sub_u32 s52, s52, 6
    s_mul_i32 s52, s52, 331776
    s_add_u32 s56, s56, s52
    v_min_u32 v1, 35, v0
    v_mul_u32_u24 v1, 9216, v1
    buffer_load_dword v26, v1, s[12:15], s56 offen
p1_tw_55:
    s_cmp_lt_u32 s36, 6
    s_cbranch_scc1 p1_tw_56
    s_add_u32 s56, s43, 3
    s_cmp_ge_u32 s56, s42
    s_cbranch_scc1 p1_tw_56
    s_lshl_b32 s52, s56, 2
    s_add_u32 s52, s52, s40
    s_add_u32 s53, s52, s51
    s_mul_i32 s54, s41, 18
    s_add_u32 s54, s54, s52
    s_sub_u32 s54, s54, s50
    s_cmp_lt_u32 s52, s50
    s_cselect_b32 s56, s53, s54
    s_lshl_b32 s56, s56, 7
    s_and_b32 s52, s39, 7
    s_lshl_b32 s52, s52, 1
    s_add_u32 s52, s52, s36
    s_sub_u32 s52, s52, 6
    s_mul_i32 s52, s52, 331776
    s_add_u32 s56, s56, s52
    v_min_u32 v1, 35, v0
    v_mul_u32_u24 v1, 9216, v1
    buffer_load_dword v26, v1, s[12:15], s56 offen
p1_tw_56:
    s_cmp_lt_u32 s36, 6
    s_cbranch_scc1 p1_tw_57
    s_add_u32 s56, s43, 4
    s_cmp_ge_u32 s56, s42
    s_cbranch_scc1 p1_tw_57
    s_lshl_b32 s52, s56, 2
    s_add_u32 s52, s52, s40
    s_add_u32 s53, s52, s51
    s_mul_i32 s54, s41, 18
    s_add_u32 s54, s54, s52
    s_sub_u32 s54, s54, s50
    s_cmp_lt_u32 s52, s50
    s_cselect_b32 s56, s53, s54
    s_lshl_b32 s56, s56, 7
    s_and_b32 s52, s39, 7
    s_lshl_b32 s52, s52, 1
    s_add_u32 s52, s52, s36
    s_sub_u32 s52, s52, 6
    s_mul_i32 s52, s52, 331776
    s_add_u32 s56, s56, s52
    v_min_u32 v1, 35, v0
    v_mul_u32_u24 v1, 9216, v1
    buffer_load_dword v26, v1, s[12:15], s56 offen
p1_tw_57:
p1_tq_54:
    s_branch p1_tbk_27
p1_hk_28:
    s_cmp_lg_u32 s40, 0
    s_cbranch_scc1 p1_gx_58
    v_lshlrev_b32 v40, 6, v0
    buffer_load_dwordx4 v[36:39], v40, s[96:99], 0 offen
    s_mul_i32 s91, s39, 3
    s_add_u32 s91, s91, s41
    s_sub_u32 s91, s91, 1
    s_mul_i32 s52, s36, 48
    s_add_u32 s91, s91, s52
    s_cmp_lt_u32 s36, 6
    s_cselect_b32 s91, s91, 999
    s_lshl_b32 s52, s36, 4
    s_add_u32 s52, s52, s39
    s_add_u32 s52, s52, 288
    s_cmp_eq_u32 s41, 0
    s_cselect_b32 s91, s52, s91
    s_and_b32 s100, s43, 1
    s_mul_i32 s100, s100, 73728
    s_sub_u32 s3, 73728, s100
    s_lshl_b32 s52, s36, 13
    s_add_u32 s100, s100, s52
    s_branch p1_gy_59
p1_gx_58:
    v_and_b32 v37, 3, v0
    v_lshlrev_b32 v38, 2, v37
    s_and_b32 s52, s79, 0xffffffc0
    buffer_load_dword v36, v38, s[96:99], s52 offen
p1_gy_59:
    s_branch p1_hkb_29
p1_slp_30:
    s_lshl_b32 s52, s56, 2
    s_add_u32 s52, s52, s40
    s_add_u32 s53, s52, s51
    s_mul_i32 s54, s41, 18
    s_add_u32 s54, s54, s52
    s_sub_u32 s54, s54, s50
    s_cmp_lt_u32 s52, s50
    s_cselect_b32 s52, s53, s54
    s_cmp_lt_u32 s52, 72
    s_cselect_b32 s20, s12, s16
    s_cselect_b32 s21, s13, s17
    s_cselect_b32 s22, s14, s18
    s_cselect_b32 s46, 8, 1
    s_cselect_b32 s53, 0, 72
    s_mul_i32 s46, s46, 1152
    s_sub_u32 s52, s52, s53
    s_lshl_b32 s47, s52, 7
    s_cmp_lt_u32 s56, s42
    s_cselect_b32 s22, s22, 0
    s_cmp_eq_u32 s56, s78
    s_cselect_b32 s20, s16, s20
    s_cselect_b32 s21, s17, s21
    s_cselect_b32 s22, 1388544, s22
    s_cselect_b32 s46, 128, s46
    s_cselect_b32 s47, 1327104, s47
    v_and_b32 v54, 0xffff, v6
    v_lshrrev_b32 v55, 16, v6
    v_mad_u32_u24 v9, v54, s46, v55
    v_and_b32 v54, 0xffff, v7
    v_lshrrev_b32 v55, 16, v7
    v_mad_u32_u24 v10, v54, s46, v55
    v_and_b32 v54, 0xffff, v8
    v_lshrrev_b32 v55, 16, v8
    v_mad_u32_u24 v11, v54, s46, v55
    s_cmp_lg_u32 s56, s101
    s_cbranch_scc1 p1_g2p_60
    s_mov_b32 s20, s92
    s_mov_b32 s21, s93
    s_and_b32 s21, s21, 0xffff
    s_mov_b32 s22, 0x510000
    s_mov_b32 s23, 0x20000
    s_mov_b32 s46, 384
    s_mul_i32 s47, s41, 1327104
    s_mul_i32 s52, s40, 384
    s_add_u32 s47, s47, s52
    s_sub_u32 s47, s47, 384
    v_and_b32 v54, 63, v6
    v_lshrrev_b32 v55, 16, v6
    v_mul_u32_u24 v54, 1152, v54
    v_add_u32 v54, v54, v55
    v_bfe_u32 v55, v6, 6, 2
    v_lshl_add_u32 v9, v55, 7, v54
    v_and_b32 v54, 63, v7
    v_lshrrev_b32 v55, 16, v7
    v_mul_u32_u24 v54, 1152, v54
    v_add_u32 v54, v54, v55
    v_bfe_u32 v55, v7, 6, 2
    v_lshl_add_u32 v10, v55, 7, v54
    v_and_b32 v54, 63, v8
    v_lshrrev_b32 v55, 16, v8
    v_mul_u32_u24 v54, 1152, v54
    v_add_u32 v54, v54, v55
    v_bfe_u32 v55, v8, 6, 2
    v_lshl_add_u32 v11, v55, 7, v54
p1_g2p_60:
    s_branch p1_slb_31
p1_hk_32:
    s_cmp_lg_u32 s40, 0
    s_cbranch_scc1 p1_gx_61
    s_waitcnt vmcnt(1)
    s_cmp_gt_u32 s91, 288
    s_cbranch_scc1 aux_sk_65
    s_mov_b32 s59, 0
aux_rw_63:
    v_subrev_u32 v36, s57, v36
    v_subrev_u32 v36, 1, v36
    v_subrev_u32 v37, s57, v37
    v_subrev_u32 v37, 1, v37
    v_subrev_u32 v38, s57, v38
    v_subrev_u32 v38, 1, v38
    v_subrev_u32 v39, s57, v39
    v_subrev_u32 v39, 1, v39
    v_max3_u32 v36, v36, v37, v38
    v_max_u32 v36, v36, v39
    v_cmp_lt_u32 vcc, 15, v36
    s_add_u32 s59, s59, 1
    s_nop 3
    s_cbranch_vccz aux_go_64
    s_sleep 8
    buffer_load_dwordx4 v[36:39], v40, s[96:99], 0 offen sc1
    s_waitcnt vmcnt(0)
    s_cmp_lt_u32 s59, 20000
    s_cbranch_scc1 aux_rw_63
aux_go_64:
    s_cmp_eq_u32 s91, 288
    s_cselect_b32 s52, 0, s91
    s_lshl_b32 s52, s52, 13
    v_lshrrev_b32 v36, 4, v0
    v_and_b32 v37, 7, v0
    v_xor_b32 v36, v36, v37
    v_and_b32 v37, 0x38, v0
    v_or_b32 v37, v37, v36
    v_lshlrev_b32 v37, 4, v37
    v_xor_b32 v38, 64, v37
    s_add_u32 s53, s52, 0
    s_add_u32 m0, s100, 0
    s_nop 0
    buffer_load_dwordx4 v37, s[28:31], s53 offen offset:0 lds
    buffer_load_dwordx4 v38, s[28:31], s53 offen offset:1024 lds
    buffer_load_dwordx4 v37, s[28:31], s53 offen offset:2048 lds
    buffer_load_dwordx4 v38, s[28:31], s53 offen offset:3072 lds
    s_add_u32 s53, s52, 4096
    s_add_u32 m0, s100, 4096
    s_nop 0
    buffer_load_dwordx4 v37, s[28:31], s53 offen offset:0 lds
    buffer_load_dwordx4 v38, s[28:31], s53 offen offset:1024 lds
    buffer_load_dwordx4 v37, s[28:31], s53 offen offset:2048 lds
    buffer_load_dwordx4 v38, s[28:31], s53 offen offset:3072 lds
aux_sk_65:
    s_branch p1_gy_62
p1_gx_61:
    s_mov_b32 s59, 0
    s_waitcnt vmcnt(1)
g2h_re_66:
    v_subrev_u32 v36, s57, v36
    v_cmp_gt_u32 vcc, 16, v36
    s_nop 1
    v_cndmask_b32 v36, 0, v36, vcc
    v_lshl_add_u32 v36, v36, 2, v37
    s_nop 1
    v_min_u32_dpp v36, v36, v36 quad_perm:[1,0,3,2] row_mask:0xf bank_mask:0xf
    s_nop 1
    v_min_u32_dpp v36, v36, v36 quad_perm:[2,3,0,1] row_mask:0xf bank_mask:0xf
    s_nop 0
    v_readfirstlane_b32 s3, v36
    s_add_u32 s59, s59, 1
    s_cmp_ge_u32 s3, 6
    s_cbranch_scc1 g2h_ok_67
    s_sleep 4
    s_and_b32 s52, s79, 0xffffffc0
    buffer_load_dword v36, v38, s[96:99], s52 offen sc1
    s_waitcnt vmcnt(0)
    s_cmp_lt_u32 s59, 20000
    s_cbranch_scc1 g2h_re_66
g2h_ok_67:
    s_mul_i32 s53, s39, 72
    s_mul_i32 s54, s41, 18
    s_add_u32 s53, s53, s54
    s_lshl_b32 s53, s53, 14
    s_mul_i32 s52, s36, 6144
    s_add_u32 s53, s53, s52
    v_lshlrev_b32 v36, 4, v0
    s_add_u32 m0, s52, 0
    s_add_u32 s54, s53, 0
    buffer_load_dwordx4 v36, s[24:27], s54 offen offset:0 lds
    buffer_load_dwordx4 v36, s[24:27], s54 offen offset:1024 lds
    buffer_load_dwordx4 v36, s[24:27], s54 offen offset:2048 lds
    s_add_u32 m0, s52, 3072
    s_add_u32 s54, s53, 3072
    buffer_load_dwordx4 v36, s[24:27], s54 offen offset:0 lds
    buffer_load_dwordx4 v36, s[24:27], s54 offen offset:1024 lds
    buffer_load_dwordx4 v36, s[24:27], s54 offen offset:2048 lds
p1_gy_62:
    s_branch p1_hkb_33
p1_bT_8:
    s_waitcnt lgkmcnt(5)
    v_mfma_f32_16x16x32_bf16 v[80:83], v[56:59], v[112:115], 0
    v_add_u32 v5, s90, v5
    ds_read_b64_tr_b16 v[72:73], v5 offset:4096
    ds_read_b64_tr_b16 v[74:75], v5 offset:4608
    s_add_u32 s88, s88, 24576
    s_cmp_ge_u32 s88, 147456
    s_cselect_b32 s88, 0, s88
    s_mov_b32 s90, -122880
    s_cselect_b32 s90, s90, 24576
    v_mfma_f32_16x16x32_bf16 v[88:91], v[56:59], v[184:187], 0
    v_mfma_f32_16x16x32_bf16 v[76:79], v[56:59], v[22:25], 0
    ds_read_b64_tr_b16 v[64:65], v2 offset:8192
    ds_read_b64_tr_b16 v[66:67], v2 offset:8704
    s_waitcnt lgkmcnt(7)
    v_mfma_f32_16x16x32_bf16 v[84:87], v[68:71], v[112:115], 0
    s_mul_i32 s52, s46, 0
    s_add_u32 s53, s45, s55
    s_add_u32 m0, s53, 1024
    s_add_u32 s52, s52, s47
    buffer_load_dwordx4 v10, s[20:23], s52 offen lds
    v_mfma_f32_16x16x32_bf16 v[92:95], v[68:71], v[184:187], 0
    s_waitcnt lgkmcnt(5)
    v_mfma_f32_16x16x32_bf16 v[80:83], v[60:63], v[116:119], v[80:83]
    ds_read_b64_tr_b16 v[68:69], v3 offset:8192
    ds_read_b64_tr_b16 v[70:71], v3 offset:8704
    v_mfma_f32_16x16x32_bf16 v[88:91], v[60:63], v[188:191], v[88:91]
    ds_read_b64_tr_b16 v[56:57], v4 offset:12288
    ds_read_b64_tr_b16 v[58:59], v4 offset:12800
    s_waitcnt lgkmcnt(6)
    v_mfma_f32_16x16x32_bf16 v[84:87], v[72:75], v[116:119], v[84:87]
    v_mfma_f32_16x16x32_bf16 v[92:95], v[72:75], v[188:191], v[92:95]
    s_waitcnt lgkmcnt(4)
    v_mfma_f32_16x16x32_bf16 v[80:83], v[64:67], v[120:123], v[80:83]
    ds_read_b64_tr_b16 v[72:73], v5 offset:12288
    ds_read_b64_tr_b16 v[74:75], v5 offset:12800
    v_mfma_f32_16x16x32_bf16 v[88:91], v[64:67], v[192:195], v[88:91]
    v_mfma_f32_16x16x32_bf16 v[76:79], v[64:67], v[22:25], v[76:79]
    ds_read_b64_tr_b16 v[60:61], v2 offset:16384
    ds_read_b64_tr_b16 v[62:63], v2 offset:16896
    s_waitcnt lgkmcnt(6)
    v_mfma_f32_16x16x32_bf16 v[84:87], v[68:71], v[120:123], v[84:87]
    s_mul_i32 s52, s46, 0
    s_add_u32 s53, s45, s55
    s_add_u32 m0, s53, 2048
    s_add_u32 s52, s52, s47
    buffer_load_dwordx4 v11, s[20:23], s52 offen lds
    s_add_u32 s45, s45, 24576
    s_cmp_ge_u32 s45, 147456
    s_cselect_b32 s45, 0, s45
    v_mfma_f32_16x16x32_bf16 v[92:95], v[68:71], v[192:195], v[92:95]
    s_waitcnt lgkmcnt(4)
    v_mfma_f32_16x16x32_bf16 v[80:83], v[56:59], v[124:127], v[80:83]
    ds_read_b64_tr_b16 v[68:69], v3 offset:16384
    ds_read_b64_tr_b16 v[70:71], v3 offset:16896
    v_mfma_f32_16x16x32_bf16 v[88:91], v[56:59], v[196:199], v[88:91]
    ds_read_b64_tr_b16 v[64:65], v4 offset:20480
    ds_read_b64_tr_b16 v[66:67], v4 offset:20992
    s_waitcnt lgkmcnt(6)
    v_mfma_f32_16x16x32_bf16 v[84:87], v[72:75], v[124:127], v[84:87]
    v_mfma_f32_16x16x32_bf16 v[92:95], v[72:75], v[196:199], v[92:95]
    s_waitcnt lgkmcnt(4)
    v_mfma_f32_16x16x32_bf16 v[80:83], v[60:63], v[128:131], v[80:83]
    s_waitcnt vmcnt(8)
    s_barrier
    ds_read_b64_tr_b16 v[72:73], v5 offset:20480
    ds_read_b64_tr_b16 v[74:75], v5 offset:20992
    v_mfma_f32_16x16x32_bf16 v[88:91], v[60:63], v[200:203], v[88:91]
    v_mfma_f32_16x16x32_bf16 v[76:79], v[60:63], v[22:25], v[76:79]
    v_add_u32 v2, s89, v2
    ds_read_b64_tr_b16 v[56:57], v2 offset:0
    ds_read_b64_tr_b16 v[58:59], v2 offset:512
    s_waitcnt lgkmcnt(6)
    v_mfma_f32_16x16x32_bf16 v[84:87], v[68:71], v[128:131], v[84:87]
    s_mul_i32 s52, s46, 192
    s_add_u32 s53, s45, s55
    s_add_u32 m0, s53, 0
    s_add_u32 s52, s52, s47
    buffer_load_dwordx4 v9, s[20:23], s52 offen lds
    v_mfma_f32_16x16x32_bf16 v[92:95], v[68:71], v[200:203], v[92:95]
    s_waitcnt lgkmcnt(4)
    v_mfma_f32_16x16x32_bf16 v[80:83], v[64:67], v[132:135], v[80:83]
    v_add_u32 v3, s90, v3
    ds_read_b64_tr_b16 v[68:69], v3 offset:0
    ds_read_b64_tr_b16 v[70:71], v3 offset:512
    v_mfma_f32_16x16x32_bf16 v[88:91], v[64:67], v[204:207], v[88:91]
    v_add_u32 v4, s89, v4
    ds_read_b64_tr_b16 v[60:61], v4 offset:4096
    ds_read_b64_tr_b16 v[62:63], v4 offset:4608
    s_add_u32 s44, s44, 24576
    s_cmp_ge_u32 s44, 147456
    s_cselect_b32 s44, 0, s44
    s_mov_b32 s89, -122880
    s_cselect_b32 s89, s89, 24576
    ds_read_b128 v[36:39], v14
    ds_read_b128 v[44:47], v14 offset:256
    ds_read_b128 v[28:31], v12
    v_add_u32 v12, 256, v12
    ds_read_b128 v[40:43], v15
    ds_read_b128 v[48:51], v15 offset:256
    ds_read_b128 v[32:35], v13
    v_add_u32 v13, 256, v13
    v_and_b32 v54, 15, v0
    s_lshl_b32 s52, s38, 8
    s_add_u32 s52, s52, 158208
    v_lshl_add_u32 v54, v54, 3, s52
    s_lshr_b32 s52, s80, 4
    v_add_u32 v55, s52, v54
    ds_read_b64 v[16:17], v55
    s_lshr_b32 s52, s81, 4
    v_add_u32 v55, s52, v54
    ds_read_b64 v[18:19], v55
    s_cmp_ge_u32 s36, 4
    s_cbranch_scc1 p1_tsk_68
p1_tbk_69:
    s_waitcnt lgkmcnt(14)
    v_mfma_f32_16x16x32_bf16 v[84:87], v[72:75], v[132:135], v[84:87]
    v_mfma_f32_16x16x32_bf16 v[92:95], v[72:75], v[204:207], v[92:95]
    s_waitcnt lgkmcnt(12)
    v_mfma_f32_16x16x32_bf16 v[80:83], v[56:59], v[136:139], v[80:83]
    v_add_u32 v5, s90, v5
    ds_read_b64_tr_b16 v[72:73], v5 offset:4096
    ds_read_b64_tr_b16 v[74:75], v5 offset:4608
    s_add_u32 s88, s88, 24576
    s_cmp_ge_u32 s88, 147456
    s_cselect_b32 s88, 0, s88
    s_mov_b32 s90, -122880
    s_cselect_b32 s90, s90, 24576
    s_waitcnt lgkmcnt(2)
    v_add_f32 v36, v36, v44
    v_mfma_f32_16x16x32_bf16 v[88:91], v[56:59], v[208:211], v[88:91]
    v_mfma_f32_16x16x32_bf16 v[76:79], v[56:59], v[22:25], v[76:79]
    ds_read_b64_tr_b16 v[64:65], v2 offset:8192
    ds_read_b64_tr_b16 v[66:67], v2 offset:8704
    v_add_f32 v37, v37, v45
    v_mfma_f32_16x16x32_bf16 v[84:87], v[68:71], v[136:139], v[84:87]
    s_mul_i32 s52, s46, 192
    s_add_u32 s53, s45, s55
    s_add_u32 m0, s53, 1024
    s_add_u32 s52, s52, s47
    buffer_load_dwordx4 v10, s[20:23], s52 offen lds
    v_add_f32 v38, v38, v46
    v_add_f32 v39, v39, v47
    v_mfma_f32_16x16x32_bf16 v[92:95], v[68:71], v[208:211], v[92:95]
    v_add_f32 v40, v40, v48
    v_mfma_f32_16x16x32_bf16 v[80:83], v[60:63], v[140:143], v[80:83]
    ds_read_b64_tr_b16 v[68:69], v3 offset:8192
    ds_read_b64_tr_b16 v[70:71], v3 offset:8704
    v_add_f32 v41, v41, v49
    v_add_f32 v42, v42, v50
    v_mfma_f32_16x16x32_bf16 v[88:91], v[60:63], v[212:215], v[88:91]
    ds_read_b64_tr_b16 v[56:57], v4 offset:12288
    ds_read_b64_tr_b16 v[58:59], v4 offset:12800
    v_add_f32 v43, v43, v51
    s_waitcnt lgkmcnt(6)
    v_mfma_f32_16x16x32_bf16 v[84:87], v[72:75], v[140:143], v[84:87]
    v_fma_f32 v96, -v17, v36, v96
    v_fma_f32 v97, -v17, v37, v97
    v_mfma_f32_16x16x32_bf16 v[92:95], v[72:75], v[212:215], v[92:95]
    v_mul_f32 v96, v16, v96
    s_waitcnt lgkmcnt(4)
    v_mfma_f32_16x16x32_bf16 v[80:83], v[64:67], v[144:147], v[80:83]
    ds_read_b64_tr_b16 v[72:73], v5 offset:12288
    ds_read_b64_tr_b16 v[74:75], v5 offset:12800
    v_mul_f32 v97, v16, v97
    v_cvt_pk_bf16_f32 v44, v96, v97
    v_mfma_f32_16x16x32_bf16 v[88:91], v[64:67], v[216:219], v[88:91]
    v_mfma_f32_16x16x32_bf16 v[76:79], v[64:67], v[22:25], v[76:79]
    ds_read_b64_tr_b16 v[60:61], v2 offset:16384
    ds_read_b64_tr_b16 v[62:63], v2 offset:16896
    v_fma_f32 v98, -v17, v38, v98
    s_waitcnt lgkmcnt(6)
    v_mfma_f32_16x16x32_bf16 v[84:87], v[68:71], v[144:147], v[84:87]
    s_mul_i32 s52, s46, 192
    s_add_u32 s53, s45, s55
    s_add_u32 m0, s53, 2048
    s_add_u32 s52, s52, s47
    buffer_load_dwordx4 v11, s[20:23], s52 offen lds
    s_add_u32 s45, s45, 24576
    s_cmp_ge_u32 s45, 147456
    s_cselect_b32 s45, 0, s45
    v_fma_f32 v99, -v17, v39, v99
    v_mul_f32 v98, v16, v98
    v_mfma_f32_16x16x32_bf16 v[92:95], v[68:71], v[216:219], v[92:95]
    v_mul_f32 v99, v16, v99
    s_waitcnt lgkmcnt(4)
    v_mfma_f32_16x16x32_bf16 v[80:83], v[56:59], v[148:151], v[80:83]
    ds_read_b64_tr_b16 v[68:69], v3 offset:16384
    ds_read_b64_tr_b16 v[70:71], v3 offset:16896
    v_cvt_pk_bf16_f32 v46, v98, v99
    v_fma_f32 v100, -v17, v40, v100
    v_mfma_f32_16x16x32_bf16 v[88:91], v[56:59], v[220:223], v[88:91]
    ds_read_b64_tr_b16 v[64:65], v4 offset:20480
    ds_read_b64_tr_b16 v[66:67], v4 offset:20992
    v_fma_f32 v101, -v17, v41, v101
    s_waitcnt lgkmcnt(6)
    v_mfma_f32_16x16x32_bf16 v[84:87], v[72:75], v[148:151], v[84:87]
    v_mul_f32 v100, v16, v100
    v_mul_f32 v101, v16, v101
    v_mfma_f32_16x16x32_bf16 v[92:95], v[72:75], v[220:223], v[92:95]
    v_cvt_pk_bf16_f32 v48, v100, v101
    s_waitcnt lgkmcnt(4)
    v_mfma_f32_16x16x32_bf16 v[80:83], v[60:63], v[152:155], v[80:83]
    s_waitcnt vmcnt(6)
    s_barrier
    ds_read_b64_tr_b16 v[72:73], v5 offset:20480
    ds_read_b64_tr_b16 v[74:75], v5 offset:20992
    v_fma_f32 v102, -v17, v42, v102
    v_fma_f32 v103, -v17, v43, v103
    v_mfma_f32_16x16x32_bf16 v[88:91], v[60:63], v[224:227], v[88:91]
    v_mfma_f32_16x16x32_bf16 v[76:79], v[60:63], v[22:25], v[76:79]
    v_add_u32 v2, s89, v2
    ds_read_b64_tr_b16 v[56:57], v2 offset:0
    ds_read_b64_tr_b16 v[58:59], v2 offset:512
    v_mul_f32 v102, v16, v102
    s_waitcnt lgkmcnt(6)
    v_mfma_f32_16x16x32_bf16 v[84:87], v[68:71], v[152:155], v[84:87]
    s_mul_i32 s52, s46, 384
    s_add_u32 s53, s45, s55
    s_add_u32 m0, s53, 0
    s_add_u32 s52, s52, s47
    buffer_load_dwordx4 v9, s[20:23], s52 offen lds
    v_mul_f32 v103, v16, v103
    v_mfma_f32_16x16x32_bf16 v[92:95], v[68:71], v[224:227], v[92:95]
    v_cvt_pk_bf16_f32 v50, v102, v103
    v_fma_f32 v104, -v19, v36, v104
    s_waitcnt lgkmcnt(4)
    v_mfma_f32_16x16x32_bf16 v[80:83], v[64:67], v[156:159], v[80:83]
    v_add_u32 v3, s90, v3
    ds_read_b64_tr_b16 v[68:69], v3 offset:0
    ds_read_b64_tr_b16 v[70:71], v3 offset:512
    v_fma_f32 v105, -v19, v37, v105
    v_mfma_f32_16x16x32_bf16 v[88:91], v[64:67], v[228:231], v[88:91]
    v_add_u32 v4, s89, v4
    ds_read_b64_tr_b16 v[60:61], v4 offset:4096
    ds_read_b64_tr_b16 v[62:63], v4 offset:4608
    s_add_u32 s44, s44, 24576
    s_cmp_ge_u32 s44, 147456
    s_cselect_b32 s44, 0, s44
    s_mov_b32 s89, -122880
    s_cselect_b32 s89, s89, 24576
    v_mul_f32 v104, v18, v104
    v_mul_f32 v105, v18, v105
    s_waitcnt lgkmcnt(6)
    v_mfma_f32_16x16x32_bf16 v[84:87], v[72:75], v[156:159], v[84:87]
    v_cvt_pk_bf16_f32 v45, v104, v105
    v_mfma_f32_16x16x32_bf16 v[92:95], v[72:75], v[228:231], v[92:95]
    v_fma_f32 v106, -v19, v38, v106
    v_fma_f32 v107, -v19, v39, v107
    s_waitcnt lgkmcnt(4)
    v_mfma_f32_16x16x32_bf16 v[80:83], v[56:59], v[160:163], v[80:83]
    v_add_u32 v5, s90, v5
    ds_read_b64_tr_b16 v[72:73], v5 offset:4096
    ds_read_b64_tr_b16 v[74:75], v5 offset:4608
    s_add_u32 s88, s88, 24576
    s_cmp_ge_u32 s88, 147456
    s_cselect_b32 s88, 0, s88
    s_mov_b32 s90, -122880
    s_cselect_b32 s90, s90, 24576
    v_mul_f32 v106, v18, v106
    v_mfma_f32_16x16x32_bf16 v[88:91], v[56:59], v[232:235], v[88:91]
    v_mfma_f32_16x16x32_bf16 v[76:79], v[56:59], v[22:25], v[76:79]
    ds_read_b64_tr_b16 v[64:65], v2 offset:8192
    ds_read_b64_tr_b16 v[66:67], v2 offset:8704
    v_mul_f32 v107, v18, v107
    v_cvt_pk_bf16_f32 v47, v106, v107
    s_waitcnt lgkmcnt(6)
    v_mfma_f32_16x16x32_bf16 v[84:87], v[68:71], v[160:163], v[84:87]
    s_mul_i32 s52, s46, 384
    s_add_u32 s53, s45, s55
    s_add_u32 m0, s53, 1024
    s_add_u32 s52, s52, s47
    buffer_load_dwordx4 v10, s[20:23], s52 offen lds
    v_fma_f32 v108, -v19, v40, v108
    v_mfma_f32_16x16x32_bf16 v[92:95], v[68:71], v[232:235], v[92:95]
    v_fma_f32 v109, -v19, v41, v109
    v_mul_f32 v108, v18, v108
    s_waitcnt lgkmcnt(4)
    v_mfma_f32_16x16x32_bf16 v[80:83], v[60:63], v[164:167], v[80:83]
    ds_read_b64_tr_b16 v[68:69], v3 offset:8192
    ds_read_b64_tr_b16 v[70:71], v3 offset:8704
    v_mul_f32 v109, v18, v109
    v_mfma_f32_16x16x32_bf16 v[88:91], v[60:63], v[236:239], v[88:91]
    ds_read_b64_tr_b16 v[56:57], v4 offset:12288
    ds_read_b64_tr_b16 v[58:59], v4 offset:12800
    v_cvt_pk_bf16_f32 v49, v108, v109
    v_fma_f32 v110, -v19, v42, v110
    s_waitcnt lgkmcnt(6)
    v_mfma_f32_16x16x32_bf16 v[84:87], v[72:75], v[164:167], v[84:87]
    v_fma_f32 v111, -v19, v43, v111
    v_mfma_f32_16x16x32_bf16 v[92:95], v[72:75], v[236:239], v[92:95]
    v_mul_f32 v110, v18, v110
    v_mul_f32 v111, v18, v111
    s_waitcnt lgkmcnt(4)
    v_mfma_f32_16x16x32_bf16 v[80:83], v[64:67], v[168:171], v[80:83]
    ds_read_b64_tr_b16 v[72:73], v5 offset:12288
    ds_read_b64_tr_b16 v[74:75], v5 offset:12800
    v_cvt_pk_bf16_f32 v51, v110, v111
    v_mfma_f32_16x16x32_bf16 v[88:91], v[64:67], v[240:243], v[88:91]
    v_mfma_f32_16x16x32_bf16 v[76:79], v[64:67], v[22:25], v[76:79]
    ds_read_b64_tr_b16 v[60:61], v2 offset:16384
    ds_read_b64_tr_b16 v[62:63], v2 offset:16896
    s_cmp_eq_u32 s37, 0
    s_cbranch_scc1 p1_sw_70
    v_swap_b32 v44, v45
    v_swap_b32 v46, v47
    v_swap_b32 v48, v49
    v_swap_b32 v50, v51
p1_sw_70:
    s_sub_u32 s56, s49, 72
    s_lshl_b32 s56, s56, 18
    s_add_u32 s56, s56, s82
    s_add_u32 s56, s56, 0
    buffer_store_dwordx2 v[44:45], v53, s[28:31], s56 offen sc1
    s_waitcnt lgkmcnt(6)
    v_mfma_f32_16x16x32_bf16 v[84:87], v[68:71], v[168:171], v[84:87]
    s_mul_i32 s52, s46, 384
    s_add_u32 s53, s45, s55
    s_add_u32 m0, s53, 2048
    s_add_u32 s52, s52, s47
    buffer_load_dwordx4 v11, s[20:23], s52 offen lds
    s_add_u32 s45, s45, 24576
    s_cmp_ge_u32 s45, 147456
    s_cselect_b32 s45, 0, s45
    s_sub_u32 s56, s49, 72
    s_lshl_b32 s56, s56, 18
    s_add_u32 s56, s56, s82
    s_add_u32 s56, s56, 8192
    buffer_store_dwordx2 v[46:47], v53, s[28:31], s56 offen sc1
    v_mfma_f32_16x16x32_bf16 v[92:95], v[68:71], v[240:243], v[92:95]
    s_sub_u32 s56, s49, 72
    s_lshl_b32 s56, s56, 18
    s_add_u32 s56, s56, s83
    s_add_u32 s56, s56, 0
    buffer_store_dwordx2 v[48:49], v53, s[28:31], s56 offen sc1
    s_sub_u32 s56, s49, 72
    s_lshl_b32 s56, s56, 18
    s_add_u32 s56, s56, s83
    s_add_u32 s56, s56, 8192
    buffer_store_dwordx2 v[50:51], v53, s[28:31], s56 offen sc1
    s_waitcnt lgkmcnt(4)
    v_mfma_f32_16x16x32_bf16 v[80:83], v[56:59], v[172:175], v[80:83]
    ds_read_b64_tr_b16 v[68:69], v3 offset:16384
    ds_read_b64_tr_b16 v[70:71], v3 offset:16896
    v_mfma_f32_16x16x32_bf16 v[88:91], v[56:59], v[244:247], v[88:91]
    ds_read_b64_tr_b16 v[64:65], v4 offset:20480
    ds_read_b64_tr_b16 v[66:67], v4 offset:20992
    s_waitcnt lgkmcnt(6)
    v_mfma_f32_16x16x32_bf16 v[84:87], v[72:75], v[172:175], v[84:87]
    v_mfma_f32_16x16x32_bf16 v[92:95], v[72:75], v[244:247], v[92:95]
    s_waitcnt lgkmcnt(4)
    v_mfma_f32_16x16x32_bf16 v[80:83], v[60:63], v[176:179], v[80:83]
    s_waitcnt vmcnt(10)
    s_barrier
    ds_read_b64_tr_b16 v[72:73], v5 offset:20480
    ds_read_b64_tr_b16 v[74:75], v5 offset:20992
    v_mfma_f32_16x16x32_bf16 v[88:91], v[60:63], v[248:251], v[88:91]
    v_mfma_f32_16x16x32_bf16 v[76:79], v[60:63], v[22:25], v[76:79]
    v_add_u32 v2, s89, v2
    ds_read_b64_tr_b16 v[56:57], v2 offset:0
    ds_read_b64_tr_b16 v[58:59], v2 offset:512
    s_add_u32 s56, s43, 2
    s_add_u32 s47, s47, 512
    s_waitcnt lgkmcnt(6)
    v_mfma_f32_16x16x32_bf16 v[84:87], v[68:71], v[176:179], v[84:87]
    s_mul_i32 s52, s46, 0
    s_add_u32 s53, s45, s55
    s_add_u32 m0, s53, 0
    s_add_u32 s52, s52, s47
    buffer_load_dwordx4 v9, s[20:23], s52 offen lds
    v_mfma_f32_16x16x32_bf16 v[92:95], v[68:71], v[248:251], v[92:95]
    s_waitcnt lgkmcnt(4)
    v_mfma_f32_16x16x32_bf16 v[80:83], v[64:67], v[180:183], v[80:83]
    v_add_u32 v3, s90, v3
    ds_read_b64_tr_b16 v[68:69], v3 offset:0
    ds_read_b64_tr_b16 v[70:71], v3 offset:512
    v_mfma_f32_16x16x32_bf16 v[88:91], v[64:67], v[252:255], v[88:91]
    v_add_u32 v4, s89, v4
    ds_read_b64_tr_b16 v[60:61], v4 offset:4096
    ds_read_b64_tr_b16 v[62:63], v4 offset:4608
    s_add_u32 s44, s44, 24576
    s_cmp_ge_u32 s44, 147456
    s_cselect_b32 s44, 0, s44
    s_mov_b32 s89, -122880
    s_cselect_b32 s89, s89, 24576
    s_waitcnt lgkmcnt(6)
    v_mfma_f32_16x16x32_bf16 v[84:87], v[72:75], v[180:183], v[84:87]
    v_mfma_f32_16x16x32_bf16 v[92:95], v[72:75], v[252:255], v[92:95]
    ds_write_b128 v20, v[76:79]
    s_mov_b32 s49, s48
    s_add_u32 s43, s43, 1
    s_add_u32 s48, s48, 4
    s_branch p1_b0_9
p1_tsk_68:
    s_cmp_gt_u32 s36, 5
    s_cbranch_scc1 p1_pf_71
    s_cmp_gt_u32 s43, 2
    s_cbranch_scc1 p1_pf_71
    s_cmp_eq_u32 s40, 0
    s_cbranch_scc1 p1_pf_71
    s_bfe_u32 s52, s2, 0x10005
    s_add_u32 s52, s52, 1
    s_cmp_lg_u32 s52, s43
    s_cbranch_scc1 p1_pf_71
    s_lshr_b32 s52, s2, 5
    s_lshl_b32 s52, s52, 3
    s_sub_u32 s52, s2, s52
    s_sub_u32 s52, s52, 8
    s_lshl_b32 s52, s52, 1
    s_add_u32 s52, s52, s36
    s_sub_u32 s52, s52, 4
pf_go_73:
    s_getpc_b64 s[94:95]
    s_add_u32 s94, s94, tab_Tinv@rel32@lo+4
    s_addc_u32 s95, s95, tab_Tinv@rel32@hi+12
    s_lshl_b32 s53, s52, 14
    s_sub_u32 s54, s53, 5308416
    v_lshlrev_b32 v1, 8, v0
    s_cmp_lt_u32 s52, 324
    s_cselect_b32 s32, s92, s94
    s_cselect_b32 s33, s93, s95
    s_cselect_b32 s53, s53, s54
    s_mov_b32 s54, 724992
    s_cselect_b32 s34, 5308416, s54
    s_and_b32 s33, s33, 0xffff
    buffer_load_dwordx2 v[26:27], v1, s[32:35], s53 offen offset:124
p1_pf_71:
    s_cmp_lg_u32 s43, 1
    s_cbranch_scc1 p1_tq_74
    s_cmp_lt_u32 s36, 6
    s_cbranch_scc1 p1_tw_75
    s_add_u32 s56, s43, 2
    s_cmp_ge_u32 s56, s42
    s_cbranch_scc1 p1_tw_75
    s_lshl_b32 s52, s56, 2
    s_add_u32 s52, s52, s40
    s_add_u32 s53, s52, s51
    s_mul_i32 s54, s41, 18
    s_add_u32 s54, s54, s52
    s_sub_u32 s54, s54, s50
    s_cmp_lt_u32 s52, s50
    s_cselect_b32 s56, s53, s54
    s_lshl_b32 s56, s56, 7
    s_and_b32 s52, s39, 7
    s_lshl_b32 s52, s52, 1
    s_add_u32 s52, s52, s36
    s_sub_u32 s52, s52, 6
    s_mul_i32 s52, s52, 331776
    s_add_u32 s56, s56, s52
    v_min_u32 v1, 35, v0
    v_mul_u32_u24 v1, 9216, v1
    buffer_load_dword v26, v1, s[12:15], s56 offen
p1_tw_75:
    s_cmp_lt_u32 s36, 6
    s_cbranch_scc1 p1_tw_76
    s_add_u32 s56, s43, 3
    s_cmp_ge_u32 s56, s42
    s_cbranch_scc1 p1_tw_76
    s_lshl_b32 s52, s56, 2
    s_add_u32 s52, s52, s40
    s_add_u32 s53, s52, s51
    s_mul_i32 s54, s41, 18
    s_add_u32 s54, s54, s52
    s_sub_u32 s54, s54, s50
    s_cmp_lt_u32 s52, s50
    s_cselect_b32 s56, s53, s54
    s_lshl_b32 s56, s56, 7
    s_and_b32 s52, s39, 7
    s_lshl_b32 s52, s52, 1
    s_add_u32 s52, s52, s36
    s_sub_u32 s52, s52, 6
    s_mul_i32 s52, s52, 331776
    s_add_u32 s56, s56, s52
    v_min_u32 v1, 35, v0
    v_mul_u32_u24 v1, 9216, v1
    buffer_load_dword v26, v1, s[12:15], s56 offen
p1_tw_76:
    s_cmp_lt_u32 s36, 6
    s_cbranch_scc1 p1_tw_77
    s_add_u32 s56, s43, 4
    s_cmp_ge_u32 s56, s42
    s_cbranch_scc1 p1_tw_77
    s_lshl_b32 s52, s56, 2
    s_add_u32 s52, s52, s40
    s_add_u32 s53, s52, s51
    s_mul_i32 s54, s41, 18
    s_add_u32 s54, s54, s52
    s_sub_u32 s54, s54, s50
    s_cmp_lt_u32 s52, s50
    s_cselect_b32 s56, s53, s54
    s_lshl_b32 s56, s56, 7
    s_and_b32 s52, s39, 7
    s_lshl_b32 s52, s52, 1
    s_add_u32 s52, s52, s36
    s_sub_u32 s52, s52, 6
    s_mul_i32 s52, s52, 331776
    s_add_u32 s56, s56, s52
    v_min_u32 v1, 35, v0
    v_mul_u32_u24 v1, 9216, v1
    buffer_load_dword v26, v1, s[12:15], s56 offen
p1_tw_77:
p1_tq_74:
    s_branch p1_tbk_69
p1_x_12:
    s_waitcnt vmcnt(2) lgkmcnt(0)
    s_cmp_eq_u32 s40, 0
    s_cbranch_scc1 aux_part
    s_load_dwordx4 s[60:63], s[0:1], 48
    s_load_dwordx2 s[6:7], s[0:1], 64
    s_sub_u32 s40, s40, 1
    s_mov_b32 s78, s43
    s_waitcnt lgkmcnt(0)
    s_getpc_b64 s[68:69]
    s_add_u32 s68, s68, tab_Tinv@rel32@lo+4
    s_addc_u32 s69, s69, tab_Tinv@rel32@hi+12
    s_add_u32 s8, s66, 0x1000000
    s_addc_u32 s9, s67, 0
    s_and_b32 s9, s9, 0xffff
    s_mov_b32 s10, 0x1200000
    s_mov_b32 s11, 0x20000
    s_mov_b32 s12, s60
    s_mov_b32 s13, s61
    s_and_b32 s13, s13, 0xffff
    s_mov_b32 s14, 0x510000
    s_mov_b32 s15, 0x20000
    s_add_u32 s16, s66, 0x780000
    s_addc_u32 s17, s67, 0
    s_and_b32 s17, s17, 0xffff
    s_mov_b32 s18, 0x242000
    s_mov_b32 s19, 0x20000
    s_mov_b32 s20, s68
    s_mov_b32 s21, s69
    s_and_b32 s21, s21, 0xffff
    s_mov_b32 s22, 0xa2000
    s_mov_b32 s23, 0x20000
    s_add_u32 s24, s66, 0x2400000
    s_addc_u32 s25, s67, 0
    s_and_b32 s25, s25, 0xffff
    s_mov_b32 s26, 0x1200000
    s_mov_b32 s27, 0x20000
    s_mov_b32 s28, s4
    s_mov_b32 s29, s5
    s_and_b32 s29, s29, 0xffff
    s_mov_b32 s30, 0x240000
    s_mov_b32 s31, 0x20000
    s_mov_b32 s32, s6
    s_mov_b32 s33, s7
    s_and_b32 s33, s33, 0xffff
    s_mov_b32 s34, 0x240000
    s_mov_b32 s35, 0x20000
    s_mov_b32 s80, s62
    s_mov_b32 s81, s63
    s_and_b32 s81, s81, 0xffff
    s_mov_b32 s82, 0x480
    s_mov_b32 s83, 0x20000
    s_add_u32 s88, s66, 0xa40000
    s_addc_u32 s89, s67, 0
    s_and_b32 s89, s89, 0xffff
    s_mov_b32 s90, 0x4000
    s_mov_b32 s91, 0x20000
    s_mul_i32 s49, s39, 3
    s_add_u32 s49, s49, s40
    s_cmp_lt_u32 s36, 4
    s_cbranch_scc1 g2_comp_78
    s_setprio 0
    s_sub_u32 s56, s36, 4
    s_mul_i32 s53, s39, 72
    s_mul_i32 s54, s41, 18
    s_add_u32 s53, s53, s54
    s_lshl_b32 s53, s53, 14
    s_lshl_b32 s52, s56, 12
    s_add_u32 s53, s53, s52
    v_lshl_add_u32 v2, v0, 4, s53
    v_lshrrev_b32 v12, 3, v0
    v_mul_u32_u24 v12, 1152, v12
    v_bfe_u32 v13, v0, 4, 1
    v_lshlrev_b32 v13, 1, v13
    v_and_b32 v14, 7, v0
    v_xor_b32 v13, v13, v14
    v_lshl_add_u32 v14, v13, 4, v12
    v_xor_b32 v13, 4, v13
    v_lshl_add_u32 v15, v13, 4, v12
    s_mul_i32 s52, s56, 6
    s_mul_i32 s47, s40, 384
    s_add_u32 s53, s52, 0
    s_and_b32 s54, s53, 7
    s_mul_i32 s54, s54, 9216
    s_lshr_b32 s53, s53, 3
    s_lshl_b32 s53, s53, 7
    s_add_u32 s54, s54, s53
    s_add_u32 s54, s54, s47
    v_add_u32 v20, s54, v14
    s_add_u32 s53, s52, 1
    s_and_b32 s54, s53, 7
    s_mul_i32 s54, s54, 9216
    s_lshr_b32 s53, s53, 3
    s_lshl_b32 s53, s53, 7
    s_add_u32 s54, s54, s53
    s_add_u32 s54, s54, s47
    v_add_u32 v21, s54, v15
    s_add_u32 s53, s52, 2
    s_and_b32 s54, s53, 7
    s_mul_i32 s54, s54, 9216
    s_lshr_b32 s53, s53, 3
    s_lshl_b32 s53, s53, 7
    s_add_u32 s54, s54, s53
    s_add_u32 s54, s54, s47
    v_add_u32 v22, s54, v14
    s_add_u32 s53, s52, 3
    s_and_b32 s54, s53, 7
    s_mul_i32 s54, s54, 9216
    s_lshr_b32 s53, s53, 3
    s_lshl_b32 s53, s53, 7
    s_add_u32 s54, s54, s53
    s_add_u32 s54, s54, s47
    v_add_u32 v23, s54, v15
    s_add_u32 s53, s52, 4
    s_and_b32 s54, s53, 7
    s_mul_i32 s54, s54, 9216
    s_lshr_b32 s53, s53, 3
    s_lshl_b32 s53, s53, 7
    s_add_u32 s54, s54, s53
    s_add_u32 s54, s54, s47
    v_add_u32 v24, s54, v14
    s_add_u32 s53, s52, 5
    s_and_b32 s54, s53, 7
    s_mul_i32 s54, s54, 9216
    s_lshr_b32 s53, s53, 3
    s_lshl_b32 s53, s53, 7
    s_add_u32 s54, s54, s53
    s_add_u32 s54, s54, s47
    v_add_u32 v25, s54, v15
    s_lshl_b32 s53, s39, 1
    s_and_b32 s54, s41, 1
    s_add_u32 s53, s53, s54
    s_mul_i32 s53, s53, 73984
    s_lshl_b32 s43, s56, 11
    s_add_u32 s53, s53, s43
    v_lshl_add_u32 v26, v0, 4, s53
    s_lshl_b32 s53, s40, 1
    s_lshr_b32 s54, s41, 1
    s_add_u32 s53, s53, s54
    s_mul_i32 s53, s53, 110592
    s_mul_i32 s50, s56, 3072
    s_add_u32 s53, s53, s50
    v_lshl_add_u32 v27, v0, 4, s53
    s_lshl_b32 s47, s56, 12
    s_mul_i32 s48, s56, 6144
    s_mul_i32 s46, s41, 1327104
    s_add_u32 s92, s66, 0xa60000
    s_addc_u32 s93, s67, 0
    s_and_b32 s93, s93, 0xffff
    s_mov_b32 s94, 0x800
    s_mov_b32 s95, 0x20000
    v_min_u32 v38, 32, v0
    v_lshlrev_b32 v38, 2, v38
    v_add_u32 v38, 1024, v38
    v_and_b32 v29, 3, v0
    v_lshlrev_b32 v30, 2, v29
    v_lshlrev_b32 v31, 4, v0
    s_lshl_b32 s45, s39, 2
    s_add_u32 s45, s45, s41
    s_lshl_b32 s45, s45, 6
    s_lshl_b32 s52, s39, 2
    s_add_u32 s52, s52, s56
    s_mul_i32 s53, s52, 1152
    s_mul_i32 s54, s40, 384
    s_add_u32 s53, s53, s54
    s_add_u32 s53, s53, s46
    s_add_u32 s53, s53, 368640
    s_add_u32 s100, s60, s53
    s_addc_u32 s101, s61, 0
    s_min_u32 s52, s52, 60
    s_mul_i32 s52, s52, 1792
    s_lshl_b32 s53, s40, 1
    s_lshr_b32 s54, s41, 1
    s_add_u32 s53, s53, s54
    s_mul_i32 s53, s53, 110592
    s_add_u32 s53, s53, s52
    s_add_u32 s74, s68, s53
    s_addc_u32 s75, s69, 0
    s_cmp_eq_u32 s41, 0
    s_cselect_b32 s56, 3, 2
    s_mov_b32 s44, s3
    s_barrier
    s_add_u32 s54, s56, 3
    s_cmp_lt_u32 s54, s44
    s_cbranch_scc1 g2_hok_79
    s_mov_b32 s59, 0
g2_hre_80:
    buffer_load_dword v36, v30, s[96:99], s45 offen sc1
    s_waitcnt vmcnt(0)
    v_subrev_u32 v36, s57, v36
    v_cmp_gt_u32 vcc, 16, v36
    s_nop 1
    v_cndmask_b32 v36, 0, v36, vcc
    v_lshl_add_u32 v36, v36, 2, v29
    s_nop 1
    v_min_u32_dpp v36, v36, v36 quad_perm:[1,0,3,2] row_mask:0xf bank_mask:0xf
    s_nop 1
    v_min_u32_dpp v36, v36, v36 quad_perm:[2,3,0,1] row_mask:0xf bank_mask:0xf
    s_nop 0
    v_readfirstlane_b32 s52, v36
    s_nop 0
    s_max_u32 s44, s44, s52
    s_add_u32 s59, s59, 1
    s_cmp_lt_u32 s54, s44
    s_cbranch_scc1 g2_hok_79
    s_sleep 2
    s_cmp_lt_u32 s59, 20000
    s_cbranch_scc1 g2_hre_80
g2_hok_79:
    s_mov_b32 s52, 49152
    s_add_u32 s53, s46, 221184
    s_add_u32 m0, s48, 49152
    s_nop 0
    buffer_load_dwordx4 v20, s[12:15], s53 offen lds
    s_add_u32 m0, s48, 50176
    s_nop 0
    buffer_load_dwordx4 v21, s[12:15], s53 offen lds
    s_add_u32 m0, s48, 51200
    s_nop 0
    buffer_load_dwordx4 v22, s[12:15], s53 offen lds
    s_add_u32 m0, s48, 52224
    s_nop 0
    buffer_load_dwordx4 v23, s[12:15], s53 offen lds
    s_add_u32 m0, s48, 53248
    s_nop 0
    buffer_load_dwordx4 v24, s[12:15], s53 offen lds
    s_add_u32 m0, s48, 54272
    s_nop 0
    buffer_load_dwordx4 v25, s[12:15], s53 offen lds
    s_add_u32 m0, s47, 147456
    s_nop 0
    buffer_load_dwordx4 v2, s[8:11], s52 offen offset:0 lds
    buffer_load_dwordx4 v2, s[8:11], s52 offen offset:1024 lds
    buffer_load_dwordx4 v2, s[8:11], s52 offen offset:2048 lds
    buffer_load_dwordx4 v2, s[8:11], s52 offen offset:3072 lds
    s_waitcnt vmcnt(10)
    s_barrier
    s_add_u32 s54, s56, 4
    s_cmp_lt_u32 s54, s44
    s_cbranch_scc1 g2_hok_81
    s_mov_b32 s59, 0
g2_hre_82:
    buffer_load_dword v36, v30, s[96:99], s45 offen sc1
    s_waitcnt vmcnt(0)
    v_subrev_u32 v36, s57, v36
    v_cmp_gt_u32 vcc, 16, v36
    s_nop 1
    v_cndmask_b32 v36, 0, v36, vcc
    v_lshl_add_u32 v36, v36, 2, v29
    s_nop 1
    v_min_u32_dpp v36, v36, v36 quad_perm:[1,0,3,2] row_mask:0xf bank_mask:0xf
    s_nop 1
    v_min_u32_dpp v36, v36, v36 quad_perm:[2,3,0,1] row_mask:0xf bank_mask:0xf
    s_nop 0
    v_readfirstlane_b32 s52, v36
    s_nop 0
    s_max_u32 s44, s44, s52
    s_add_u32 s59, s59, 1
    s_cmp_lt_u32 s54, s44
    s_cbranch_scc1 g2_hok_81
    s_sleep 2
    s_cmp_lt_u32 s59, 20000
    s_cbranch_scc1 g2_hre_82
g2_hok_81:
    s_mov_b32 s52, 65536
    s_add_u32 s53, s46, 294912
    s_add_u32 m0, s48, 73728
    s_nop 0
    buffer_load_dwordx4 v20, s[12:15], s53 offen lds
    s_add_u32 m0, s48, 74752
    s_nop 0
    buffer_load_dwordx4 v21, s[12:15], s53 offen lds
    s_add_u32 m0, s48, 75776
    s_nop 0
    buffer_load_dwordx4 v22, s[12:15], s53 offen lds
    s_add_u32 m0, s48, 76800
    s_nop 0
    buffer_load_dwordx4 v23, s[12:15], s53 offen lds
    s_add_u32 m0, s48, 77824
    s_nop 0
    buffer_load_dwordx4 v24, s[12:15], s53 offen lds
    s_add_u32 m0, s48, 78848
    s_nop 0
    buffer_load_dwordx4 v25, s[12:15], s53 offen lds
    s_add_u32 m0, s47, 0
    s_nop 0
    buffer_load_dwordx4 v2, s[8:11], s52 offen offset:0 lds
    buffer_load_dwordx4 v2, s[8:11], s52 offen offset:1024 lds
    buffer_load_dwordx4 v2, s[8:11], s52 offen offset:2048 lds
    buffer_load_dwordx4 v2, s[8:11], s52 offen offset:3072 lds
    s_barrier
    s_add_u32 s54, s56, 5
    s_cmp_lt_u32 s54, s44
    s_cbranch_scc1 g2_hok_83
    s_mov_b32 s59, 0
g2_hre_84:
    buffer_load_dword v36, v30, s[96:99], s45 offen sc1
    s_waitcnt vmcnt(0)
    v_subrev_u32 v36, s57, v36
    v_cmp_gt_u32 vcc, 16, v36
    s_nop 1
    v_cndmask_b32 v36, 0, v36, vcc
    v_lshl_add_u32 v36, v36, 2, v29
    s_nop 1
    v_min_u32_dpp v36, v36, v36 quad_perm:[1,0,3,2] row_mask:0xf bank_mask:0xf
    s_nop 1
    v_min_u32_dpp v36, v36, v36 quad_perm:[2,3,0,1] row_mask:0xf bank_mask:0xf
    s_nop 0
    v_readfirstlane_b32 s52, v36
    s_nop 0
    s_max_u32 s44, s44, s52
    s_add_u32 s59, s59, 1
    s_cmp_lt_u32 s54, s44
    s_cbranch_scc1 g2_hok_83
    s_sleep 2
    s_cmp_lt_u32 s59, 20000
    s_cbranch_scc1 g2_hre_84
g2_hok_83:
    s_mov_b32 s52, 81920
    s_add_u32 s53, s46, 368640
    s_add_u32 m0, s48, 98304
    s_nop 0
    buffer_load_dwordx4 v20, s[12:15], s53 offen lds
    s_add_u32 m0, s48, 99328
    s_nop 0
    buffer_load_dwordx4 v21, s[12:15], s53 offen lds
    s_add_u32 m0, s48, 100352
    s_nop 0
    buffer_load_dwordx4 v22, s[12:15], s53 offen lds
    s_add_u32 m0, s48, 101376
    s_nop 0
    buffer_load_dwordx4 v23, s[12:15], s53 offen lds
    s_add_u32 m0, s48, 102400
    s_nop 0
    buffer_load_dwordx4 v24, s[12:15], s53 offen lds
    s_add_u32 m0, s48, 103424
    s_nop 0
    buffer_load_dwordx4 v25, s[12:15], s53 offen lds
    s_add_u32 m0, s47, 16384
    s_nop 0
    buffer_load_dwordx4 v2, s[8:11], s52 offen offset:0 lds
    buffer_load_dwordx4 v2, s[8:11], s52 offen offset:1024 lds
    buffer_load_dwordx4 v2, s[8:11], s52 offen offset:2048 lds
    buffer_load_dwordx4 v2, s[8:11], s52 offen offset:3072 lds
    buffer_load_dword v32, v30, s[96:99], s45 offen sc1
    s_waitcnt vmcnt(21)
    s_barrier
    s_add_u32 s54, s56, 6
    s_cmp_lt_u32 s54, s44
    s_cbranch_scc1 g2_hok_85
    s_mov_b32 s59, 0
g2_hre_86:
    buffer_load_dword v36, v30, s[96:99], s45 offen sc1
    s_waitcnt vmcnt(0)
    v_subrev_u32 v36, s57, v36
    v_cmp_gt_u32 vcc, 16, v36
    s_nop 1
    v_cndmask_b32 v36, 0, v36, vcc
    v_lshl_add_u32 v36, v36, 2, v29
    s_nop 1
    v_min_u32_dpp v36, v36, v36 quad_perm:[1,0,3,2] row_mask:0xf bank_mask:0xf
    s_nop 1
    v_min_u32_dpp v36, v36, v36 quad_perm:[2,3,0,1] row_mask:0xf bank_mask:0xf
    s_nop 0
    v_readfirstlane_b32 s52, v36
    s_nop 0
    s_max_u32 s44, s44, s52
    s_add_u32 s59, s59, 1
    s_cmp_lt_u32 s54, s44
    s_cbranch_scc1 g2_hok_85
    s_sleep 2
    s_cmp_lt_u32 s59, 20000
    s_cbranch_scc1 g2_hre_86
g2_hok_85:
    s_mov_b32 s52, 98304
    s_add_u32 s53, s46, 442368
    s_add_u32 m0, s48, 122880
    s_nop 0
    buffer_load_dwordx4 v20, s[12:15], s53 offen lds
    s_add_u32 m0, s48, 123904
    s_nop 0
    buffer_load_dwordx4 v21, s[12:15], s53 offen lds
    s_add_u32 m0, s48, 124928
    s_nop 0
    buffer_load_dwordx4 v22, s[12:15], s53 offen lds
    s_add_u32 m0, s48, 125952
    s_nop 0
    buffer_load_dwordx4 v23, s[12:15], s53 offen lds
    s_add_u32 m0, s48, 126976
    s_nop 0
    buffer_load_dwordx4 v24, s[12:15], s53 offen lds
    s_add_u32 m0, s48, 128000
    s_nop 0
    buffer_load_dwordx4 v25, s[12:15], s53 offen lds
    s_add_u32 m0, s47, 32768
    s_nop 0
    buffer_load_dwordx4 v2, s[8:11], s52 offen offset:0 lds
    buffer_load_dwordx4 v2, s[8:11], s52 offen offset:1024 lds
    buffer_load_dwordx4 v2, s[8:11], s52 offen offset:2048 lds
    buffer_load_dwordx4 v2, s[8:11], s52 offen offset:3072 lds
    s_waitcnt vmcnt(21)
    s_barrier
    s_add_u32 s54, s56, 7
    s_cmp_lt_u32 s54, s44
    s_cbranch_scc1 g2_hok_87
    s_mov_b32 s59, 0
g2_hre_88:
    buffer_load_dword v36, v30, s[96:99], s45 offen sc1
    s_waitcnt vmcnt(0)
    v_subrev_u32 v36, s57, v36
    v_cmp_gt_u32 vcc, 16, v36
    s_nop 1
    v_cndmask_b32 v36, 0, v36, vcc
    v_lshl_add_u32 v36, v36, 2, v29
    s_nop 1
    v_min_u32_dpp v36, v36, v36 quad_perm:[1,0,3,2] row_mask:0xf bank_mask:0xf
    s_nop 1
    v_min_u32_dpp v36, v36, v36 quad_perm:[2,3,0,1] row_mask:0xf bank_mask:0xf
    s_nop 0
    v_readfirstlane_b32 s52, v36
    s_nop 0
    s_max_u32 s44, s44, s52
    s_add_u32 s59, s59, 1
    s_cmp_lt_u32 s54, s44
    s_cbranch_scc1 g2_hok_87
    s_sleep 2
    s_cmp_lt_u32 s59, 20000
    s_cbranch_scc1 g2_hre_88
g2_hok_87:
    s_mov_b32 s52, 114688
    s_add_u32 s53, s46, 516096
    s_add_u32 m0, s48, 49152
    s_nop 0
    buffer_load_dwordx4 v20, s[12:15], s53 offen lds
    s_add_u32 m0, s48, 50176
    s_nop 0
    buffer_load_dwordx4 v21, s[12:15], s53 offen lds
    s_add_u32 m0, s48, 51200
    s_nop 0
    buffer_load_dwordx4 v22, s[12:15], s53 offen lds
    s_add_u32 m0, s48, 52224
    s_nop 0
    buffer_load_dwordx4 v23, s[12:15], s53 offen lds
    s_add_u32 m0, s48, 53248
    s_nop 0
    buffer_load_dwordx4 v24, s[12:15], s53 offen lds
    s_add_u32 m0, s48, 54272
    s_nop 0
    buffer_load_dwordx4 v25, s[12:15], s53 offen lds
    s_add_u32 m0, s47, 147456
    s_nop 0
    buffer_load_dwordx4 v2, s[8:11], s52 offen offset:0 lds
    buffer_load_dwordx4 v2, s[8:11], s52 offen offset:1024 lds
    buffer_load_dwordx4 v2, s[8:11], s52 offen offset:2048 lds
    buffer_load_dwordx4 v2, s[8:11], s52 offen offset:3072 lds
    s_waitcnt vmcnt(20)
    s_barrier
    v_subrev_u32 v32, s57, v32
    v_cmp_gt_u32 vcc, 16, v32
    s_nop 1
    v_cndmask_b32 v32, 0, v32, vcc
    v_lshl_add_u32 v32, v32, 2, v29
    s_nop 1
    v_min_u32_dpp v32, v32, v32 quad_perm:[1,0,3,2] row_mask:0xf bank_mask:0xf
    s_nop 1
    v_min_u32_dpp v32, v32, v32 quad_perm:[2,3,0,1] row_mask:0xf bank_mask:0xf
    s_nop 0
    v_readfirstlane_b32 s52, v32
    s_nop 0
    s_max_u32 s44, s44, s52
    s_add_u32 s54, s56, 8
    s_cmp_lt_u32 s54, s44
    s_cbranch_scc1 g2_hok_89
    s_mov_b32 s59, 0
g2_hre_90:
    buffer_load_dword v36, v30, s[96:99], s45 offen sc1
    s_waitcnt vmcnt(0)
    v_subrev_u32 v36, s57, v36
    v_cmp_gt_u32 vcc, 16, v36
    s_nop 1
    v_cndmask_b32 v36, 0, v36, vcc
    v_lshl_add_u32 v36, v36, 2, v29
    s_nop 1
    v_min_u32_dpp v36, v36, v36 quad_perm:[1,0,3,2] row_mask:0xf bank_mask:0xf
    s_nop 1
    v_min_u32_dpp v36, v36, v36 quad_perm:[2,3,0,1] row_mask:0xf bank_mask:0xf
    s_nop 0
    v_readfirstlane_b32 s52, v36
    s_nop 0
    s_max_u32 s44, s44, s52
    s_add_u32 s59, s59, 1
    s_cmp_lt_u32 s54, s44
    s_cbranch_scc1 g2_hok_89
    s_sleep 2
    s_cmp_lt_u32 s59, 20000
    s_cbranch_scc1 g2_hre_90
g2_hok_89:
    s_mov_b32 s52, 131072
    s_add_u32 s53, s46, 589824
    s_add_u32 m0, s48, 73728
    s_nop 0
    buffer_load_dwordx4 v20, s[12:15], s53 offen lds
    s_add_u32 m0, s48, 74752
    s_nop 0
    buffer_load_dwordx4 v21, s[12:15], s53 offen lds
    s_add_u32 m0, s48, 75776
    s_nop 0
    buffer_load_dwordx4 v22, s[12:15], s53 offen lds
    s_add_u32 m0, s48, 76800
    s_nop 0
    buffer_load_dwordx4 v23, s[12:15], s53 offen lds
    s_add_u32 m0, s48, 77824
    s_nop 0
    buffer_load_dwordx4 v24, s[12:15], s53 offen lds
    s_add_u32 m0, s48, 78848
    s_nop 0
    buffer_load_dwordx4 v25, s[12:15], s53 offen lds
    s_add_u32 m0, s47, 0
    s_nop 0
    buffer_load_dwordx4 v2, s[8:11], s52 offen offset:0 lds
    buffer_load_dwordx4 v2, s[8:11], s52 offen offset:1024 lds
    buffer_load_dwordx4 v2, s[8:11], s52 offen offset:2048 lds
    buffer_load_dwordx4 v2, s[8:11], s52 offen offset:3072 lds
    s_waitcnt vmcnt(20)
    s_barrier
    s_add_u32 s54, s56, 9
    s_cmp_lt_u32 s54, s44
    s_cbranch_scc1 g2_hok_91
    s_mov_b32 s59, 0
g2_hre_92:
    buffer_load_dword v36, v30, s[96:99], s45 offen sc1
    s_waitcnt vmcnt(0)
    v_subrev_u32 v36, s57, v36
    v_cmp_gt_u32 vcc, 16, v36
    s_nop 1
    v_cndmask_b32 v36, 0, v36, vcc
    v_lshl_add_u32 v36, v36, 2, v29
    s_nop 1
    v_min_u32_dpp v36, v36, v36 quad_perm:[1,0,3,2] row_mask:0xf bank_mask:0xf
    s_nop 1
    v_min_u32_dpp v36, v36, v36 quad_perm:[2,3,0,1] row_mask:0xf bank_mask:0xf
    s_nop 0
    v_readfirstlane_b32 s52, v36
    s_nop 0
    s_max_u32 s44, s44, s52
    s_add_u32 s59, s59, 1
    s_cmp_lt_u32 s54, s44
    s_cbranch_scc1 g2_hok_91
    s_sleep 2
    s_cmp_lt_u32 s59, 20000
    s_cbranch_scc1 g2_hre_92
g2_hok_91:
    s_mov_b32 s52, 147456
    s_add_u32 s53, s46, 663552
    s_add_u32 m0, s48, 98304
    s_nop 0
    buffer_load_dwordx4 v20, s[12:15], s53 offen lds
    s_add_u32 m0, s48, 99328
    s_nop 0
    buffer_load_dwordx4 v21, s[12:15], s53 offen lds
    s_add_u32 m0, s48, 100352
    s_nop 0
    buffer_load_dwordx4 v22, s[12:15], s53 offen lds
    s_add_u32 m0, s48, 101376
    s_nop 0
    buffer_load_dwordx4 v23, s[12:15], s53 offen lds
    s_add_u32 m0, s48, 102400
    s_nop 0
    buffer_load_dwordx4 v24, s[12:15], s53 offen lds
    s_add_u32 m0, s48, 103424
    s_nop 0
    buffer_load_dwordx4 v25, s[12:15], s53 offen lds
    s_add_u32 m0, s47, 16384
    s_nop 0
    buffer_load_dwordx4 v2, s[8:11], s52 offen offset:0 lds
    buffer_load_dwordx4 v2, s[8:11], s52 offen offset:1024 lds
    buffer_load_dwordx4 v2, s[8:11], s52 offen offset:2048 lds
    buffer_load_dwordx4 v2, s[8:11], s52 offen offset:3072 lds
    s_waitcnt vmcnt(20)
    s_barrier
    s_add_u32 s54, s56, 10
    s_cmp_lt_u32 s54, s44
    s_cbranch_scc1 g2_hok_93
    s_mov_b32 s59, 0
g2_hre_94:
    buffer_load_dword v36, v30, s[96:99], s45 offen sc1
    s_waitcnt vmcnt(0)
    v_subrev_u32 v36, s57, v36
    v_cmp_gt_u32 vcc, 16, v36
    s_nop 1
    v_cndmask_b32 v36, 0, v36, vcc
    v_lshl_add_u32 v36, v36, 2, v29
    s_nop 1
    v_min_u32_dpp v36, v36, v36 quad_perm:[1,0,3,2] row_mask:0xf bank_mask:0xf
    s_nop 1
    v_min_u32_dpp v36, v36, v36 quad_perm:[2,3,0,1] row_mask:0xf bank_mask:0xf
    s_nop 0
    v_readfirstlane_b32 s52, v36
    s_nop 0
    s_max_u32 s44, s44, s52
    s_add_u32 s59, s59, 1
    s_cmp_lt_u32 s54, s44
    s_cbranch_scc1 g2_hok_93
    s_sleep 2
    s_cmp_lt_u32 s59, 20000
    s_cbranch_scc1 g2_hre_94
g2_hok_93:
    s_mov_b32 s52, 163840
    s_add_u32 s53, s46, 737280
    s_add_u32 m0, s48, 122880
    s_nop 0
    buffer_load_dwordx4 v20, s[12:15], s53 offen lds
    s_add_u32 m0, s48, 123904
    s_nop 0
    buffer_load_dwordx4 v21, s[12:15], s53 offen lds
    s_add_u32 m0, s48, 124928
    s_nop 0
    buffer_load_dwordx4 v22, s[12:15], s53 offen lds
    s_add_u32 m0, s48, 125952
    s_nop 0
    buffer_load_dwordx4 v23, s[12:15], s53 offen lds
    s_add_u32 m0, s48, 126976
    s_nop 0
    buffer_load_dwordx4 v24, s[12:15], s53 offen lds
    s_add_u32 m0, s48, 128000
    s_nop 0
    buffer_load_dwordx4 v25, s[12:15], s53 offen lds
    s_add_u32 m0, s47, 32768
    s_nop 0
    buffer_load_dwordx4 v2, s[8:11], s52 offen offset:0 lds
    buffer_load_dwordx4 v2, s[8:11], s52 offen offset:1024 lds
    buffer_load_dwordx4 v2, s[8:11], s52 offen offset:2048 lds
    buffer_load_dwordx4 v2, s[8:11], s52 offen offset:3072 lds
    s_waitcnt vmcnt(20)
    s_barrier
    s_add_u32 s54, s56, 11
    s_cmp_lt_u32 s54, s44
    s_cbranch_scc1 g2_hok_95
    s_mov_b32 s59, 0
g2_hre_96:
    buffer_load_dword v36, v30, s[96:99], s45 offen sc1
    s_waitcnt vmcnt(0)
    v_subrev_u32 v36, s57, v36
    v_cmp_gt_u32 vcc, 16, v36
    s_nop 1
    v_cndmask_b32 v36, 0, v36, vcc
    v_lshl_add_u32 v36, v36, 2, v29
    s_nop 1
    v_min_u32_dpp v36, v36, v36 quad_perm:[1,0,3,2] row_mask:0xf bank_mask:0xf
    s_nop 1
    v_min_u32_dpp v36, v36, v36 quad_perm:[2,3,0,1] row_mask:0xf bank_mask:0xf
    s_nop 0
    v_readfirstlane_b32 s52, v36
    s_nop 0
    s_max_u32 s44, s44, s52
    s_add_u32 s59, s59, 1
    s_cmp_lt_u32 s54, s44
    s_cbranch_scc1 g2_hok_95
    s_sleep 2
    s_cmp_lt_u32 s59, 20000
    s_cbranch_scc1 g2_hre_96
g2_hok_95:
    s_mov_b32 s52, 180224
    s_add_u32 s53, s46, 811008
    s_add_u32 m0, s48, 49152
    s_nop 0
    buffer_load_dwordx4 v20, s[12:15], s53 offen lds
    s_add_u32 m0, s48, 50176
    s_nop 0
    buffer_load_dwordx4 v21, s[12:15], s53 offen lds
    s_add_u32 m0, s48, 51200
    s_nop 0
    buffer_load_dwordx4 v22, s[12:15], s53 offen lds
    s_add_u32 m0, s48, 52224
    s_nop 0
    buffer_load_dwordx4 v23, s[12:15], s53 offen lds
    s_add_u32 m0, s48, 53248
    s_nop 0
    buffer_load_dwordx4 v24, s[12:15], s53 offen lds
    s_add_u32 m0, s48, 54272
    s_nop 0
    buffer_load_dwordx4 v25, s[12:15], s53 offen lds
    s_add_u32 m0, s47, 147456
    s_nop 0
    buffer_load_dwordx4 v2, s[8:11], s52 offen offset:0 lds
    buffer_load_dwordx4 v2, s[8:11], s52 offen offset:1024 lds
    buffer_load_dwordx4 v2, s[8:11], s52 offen offset:2048 lds
    buffer_load_dwordx4 v2, s[8:11], s52 offen offset:3072 lds
    s_waitcnt vmcnt(20)
    s_barrier
    s_add_u32 s54, s56, 12
    s_cmp_lt_u32 s54, s44
    s_cbranch_scc1 g2_hok_97
    s_mov_b32 s59, 0
g2_hre_98:
    buffer_load_dword v36, v30, s[96:99], s45 offen sc1
    s_waitcnt vmcnt(0)
    v_subrev_u32 v36, s57, v36
    v_cmp_gt_u32 vcc, 16, v36
    s_nop 1
    v_cndmask_b32 v36, 0, v36, vcc
    v_lshl_add_u32 v36, v36, 2, v29
    s_nop 1
    v_min_u32_dpp v36, v36, v36 quad_perm:[1,0,3,2] row_mask:0xf bank_mask:0xf
    s_nop 1
    v_min_u32_dpp v36, v36, v36 quad_perm:[2,3,0,1] row_mask:0xf bank_mask:0xf
    s_nop 0
    v_readfirstlane_b32 s52, v36
    s_nop 0
    s_max_u32 s44, s44, s52
    s_add_u32 s59, s59, 1
    s_cmp_lt_u32 s54, s44
    s_cbranch_scc1 g2_hok_97
    s_sleep 2
    s_cmp_lt_u32 s59, 20000
    s_cbranch_scc1 g2_hre_98
g2_hok_97:
    s_mov_b32 s52, 196608
    s_add_u32 s53, s46, 884736
    s_add_u32 m0, s48, 73728
    s_nop 0
    buffer_load_dwordx4 v20, s[12:15], s53 offen lds
    s_add_u32 m0, s48, 74752
    s_nop 0
    buffer_load_dwordx4 v21, s[12:15], s53 offen lds
    s_add_u32 m0, s48, 75776
    s_nop 0
    buffer_load_dwordx4 v22, s[12:15], s53 offen lds
    s_add_u32 m0, s48, 76800
    s_nop 0
    buffer_load_dwordx4 v23, s[12:15], s53 offen lds
    s_add_u32 m0, s48, 77824
    s_nop 0
    buffer_load_dwordx4 v24, s[12:15], s53 offen lds
    s_add_u32 m0, s48, 78848
    s_nop 0
    buffer_load_dwordx4 v25, s[12:15], s53 offen lds
    s_add_u32 m0, s47, 0
    s_nop 0
    buffer_load_dwordx4 v2, s[8:11], s52 offen offset:0 lds
    buffer_load_dwordx4 v2, s[8:11], s52 offen offset:1024 lds
    buffer_load_dwordx4 v2, s[8:11], s52 offen offset:2048 lds
    buffer_load_dwordx4 v2, s[8:11], s52 offen offset:3072 lds
    buffer_load_dword v32, v30, s[96:99], s45 offen sc1
    s_waitcnt vmcnt(21)
    s_barrier
    s_add_u32 s54, s56, 13
    s_cmp_lt_u32 s54, s44
    s_cbranch_scc1 g2_hok_99
    s_mov_b32 s59, 0
g2_hre_100:
    buffer_load_dword v36, v30, s[96:99], s45 offen sc1
    s_waitcnt vmcnt(0)
    v_subrev_u32 v36, s57, v36
    v_cmp_gt_u32 vcc, 16, v36
    s_nop 1
    v_cndmask_b32 v36, 0, v36, vcc
    v_lshl_add_u32 v36, v36, 2, v29
    s_nop 1
    v_min_u32_dpp v36, v36, v36 quad_perm:[1,0,3,2] row_mask:0xf bank_mask:0xf
    s_nop 1
    v_min_u32_dpp v36, v36, v36 quad_perm:[2,3,0,1] row_mask:0xf bank_mask:0xf
    s_nop 0
    v_readfirstlane_b32 s52, v36
    s_nop 0
    s_max_u32 s44, s44, s52
    s_add_u32 s59, s59, 1
    s_cmp_lt_u32 s54, s44
    s_cbranch_scc1 g2_hok_99
    s_sleep 2
    s_cmp_lt_u32 s59, 20000
    s_cbranch_scc1 g2_hre_100
g2_hok_99:
    s_mov_b32 s52, 212992
    s_add_u32 s53, s46, 958464
    s_add_u32 m0, s48, 98304
    s_nop 0
    buffer_load_dwordx4 v20, s[12:15], s53 offen lds
    s_add_u32 m0, s48, 99328
    s_nop 0
    buffer_load_dwordx4 v21, s[12:15], s53 offen lds
    s_add_u32 m0, s48, 100352
    s_nop 0
    buffer_load_dwordx4 v22, s[12:15], s53 offen lds
    s_add_u32 m0, s48, 101376
    s_nop 0
    buffer_load_dwordx4 v23, s[12:15], s53 offen lds
    s_add_u32 m0, s48, 102400
    s_nop 0
    buffer_load_dwordx4 v24, s[12:15], s53 offen lds
    s_add_u32 m0, s48, 103424
    s_nop 0
    buffer_load_dwordx4 v25, s[12:15], s53 offen lds
    s_add_u32 m0, s47, 16384
    s_nop 0
    buffer_load_dwordx4 v2, s[8:11], s52 offen offset:0 lds
    buffer_load_dwordx4 v2, s[8:11], s52 offen offset:1024 lds
    buffer_load_dwordx4 v2, s[8:11], s52 offen offset:2048 lds
    buffer_load_dwordx4 v2, s[8:11], s52 offen offset:3072 lds
    s_waitcnt vmcnt(21)
    s_barrier
    s_add_u32 s54, s56, 14
    s_cmp_lt_u32 s54, s44
    s_cbranch_scc1 g2_hok_101
    s_mov_b32 s59, 0
g2_hre_102:
    buffer_load_dword v36, v30, s[96:99], s45 offen sc1
    s_waitcnt vmcnt(0)
    v_subrev_u32 v36, s57, v36
    v_cmp_gt_u32 vcc, 16, v36
    s_nop 1
    v_cndmask_b32 v36, 0, v36, vcc
    v_lshl_add_u32 v36, v36, 2, v29
    s_nop 1
    v_min_u32_dpp v36, v36, v36 quad_perm:[1,0,3,2] row_mask:0xf bank_mask:0xf
    s_nop 1
    v_min_u32_dpp v36, v36, v36 quad_perm:[2,3,0,1] row_mask:0xf bank_mask:0xf
    s_nop 0
    v_readfirstlane_b32 s52, v36
    s_nop 0
    s_max_u32 s44, s44, s52
    s_add_u32 s59, s59, 1
    s_cmp_lt_u32 s54, s44
    s_cbranch_scc1 g2_hok_101
    s_sleep 2
    s_cmp_lt_u32 s59, 20000
    s_cbranch_scc1 g2_hre_102
g2_hok_101:
    s_mov_b32 s52, 229376
    s_add_u32 s53, s46, 1032192
    s_add_u32 m0, s48, 122880
    s_nop 0
    buffer_load_dwordx4 v20, s[12:15], s53 offen lds
    s_add_u32 m0, s48, 123904
    s_nop 0
    buffer_load_dwordx4 v21, s[12:15], s53 offen lds
    s_add_u32 m0, s48, 124928
    s_nop 0
    buffer_load_dwordx4 v22, s[12:15], s53 offen lds
    s_add_u32 m0, s48, 125952
    s_nop 0
    buffer_load_dwordx4 v23, s[12:15], s53 offen lds
    s_add_u32 m0, s48, 126976
    s_nop 0
    buffer_load_dwordx4 v24, s[12:15], s53 offen lds
    s_add_u32 m0, s48, 128000
    s_nop 0
    buffer_load_dwordx4 v25, s[12:15], s53 offen lds
    s_add_u32 m0, s47, 32768
    s_nop 0
    buffer_load_dwordx4 v2, s[8:11], s52 offen offset:0 lds
    buffer_load_dwordx4 v2, s[8:11], s52 offen offset:1024 lds
    buffer_load_dwordx4 v2, s[8:11], s52 offen offset:2048 lds
    buffer_load_dwordx4 v2, s[8:11], s52 offen offset:3072 lds
    s_waitcnt vmcnt(20)
    s_barrier
    v_subrev_u32 v32, s57, v32
    v_cmp_gt_u32 vcc, 16, v32
    s_nop 1
    v_cndmask_b32 v32, 0, v32, vcc
    v_lshl_add_u32 v32, v32, 2, v29
    s_nop 1
    v_min_u32_dpp v32, v32, v32 quad_perm:[1,0,3,2] row_mask:0xf bank_mask:0xf
    s_nop 1
    v_min_u32_dpp v32, v32, v32 quad_perm:[2,3,0,1] row_mask:0xf bank_mask:0xf
    s_nop 0
    v_readfirstlane_b32 s52, v32
    s_nop 0
    s_max_u32 s44, s44, s52
    s_add_u32 s54, s56, 15
    s_cmp_lt_u32 s54, s44
    s_cbranch_scc1 g2_hok_103
    s_mov_b32 s59, 0
g2_hre_104:
    buffer_load_dword v36, v30, s[96:99], s45 offen sc1
    s_waitcnt vmcnt(0)
    v_subrev_u32 v36, s57, v36
    v_cmp_gt_u32 vcc, 16, v36
    s_nop 1
    v_cndmask_b32 v36, 0, v36, vcc
    v_lshl_add_u32 v36, v36, 2, v29
    s_nop 1
    v_min_u32_dpp v36, v36, v36 quad_perm:[1,0,3,2] row_mask:0xf bank_mask:0xf
    s_nop 1
    v_min_u32_dpp v36, v36, v36 quad_perm:[2,3,0,1] row_mask:0xf bank_mask:0xf
    s_nop 0
    v_readfirstlane_b32 s52, v36
    s_nop 0
    s_max_u32 s44, s44, s52
    s_add_u32 s59, s59, 1
    s_cmp_lt_u32 s54, s44
    s_cbranch_scc1 g2_hok_103
    s_sleep 2
    s_cmp_lt_u32 s59, 20000
    s_cbranch_scc1 g2_hre_104
g2_hok_103:
    s_mov_b32 s52, 245760
    s_add_u32 s53, s46, 1105920
    s_add_u32 m0, s48, 49152
    s_nop 0
    buffer_load_dwordx4 v20, s[12:15], s53 offen lds
    s_add_u32 m0, s48, 50176
    s_nop 0
    buffer_load_dwordx4 v21, s[12:15], s53 offen lds
    s_add_u32 m0, s48, 51200
    s_nop 0
    buffer_load_dwordx4 v22, s[12:15], s53 offen lds
    s_add_u32 m0, s48, 52224
    s_nop 0
    buffer_load_dwordx4 v23, s[12:15], s53 offen lds
    s_add_u32 m0, s48, 53248
    s_nop 0
    buffer_load_dwordx4 v24, s[12:15], s53 offen lds
    s_add_u32 m0, s48, 54272
    s_nop 0
    buffer_load_dwordx4 v25, s[12:15], s53 offen lds
    s_add_u32 m0, s47, 147456
    s_nop 0
    buffer_load_dwordx4 v2, s[8:11], s52 offen offset:0 lds
    buffer_load_dwordx4 v2, s[8:11], s52 offen offset:1024 lds
    buffer_load_dwordx4 v2, s[8:11], s52 offen offset:2048 lds
    buffer_load_dwordx4 v2, s[8:11], s52 offen offset:3072 lds
    s_waitcnt vmcnt(20)
    s_barrier
    s_add_u32 s54, s56, 16
    s_cmp_lt_u32 s54, s44
    s_cbranch_scc1 g2_hok_105
    s_mov_b32 s59, 0
g2_hre_106:
    buffer_load_dword v36, v30, s[96:99], s45 offen sc1
    s_waitcnt vmcnt(0)
    v_subrev_u32 v36, s57, v36
    v_cmp_gt_u32 vcc, 16, v36
    s_nop 1
    v_cndmask_b32 v36, 0, v36, vcc
    v_lshl_add_u32 v36, v36, 2, v29
    s_nop 1
    v_min_u32_dpp v36, v36, v36 quad_perm:[1,0,3,2] row_mask:0xf bank_mask:0xf
    s_nop 1
    v_min_u32_dpp v36, v36, v36 quad_perm:[2,3,0,1] row_mask:0xf bank_mask:0xf
    s_nop 0
    v_readfirstlane_b32 s52, v36
    s_nop 0
    s_max_u32 s44, s44, s52
    s_add_u32 s59, s59, 1
    s_cmp_lt_u32 s54, s44
    s_cbranch_scc1 g2_hok_105
    s_sleep 2
    s_cmp_lt_u32 s59, 20000
    s_cbranch_scc1 g2_hre_106
g2_hok_105:
    s_mov_b32 s52, 262144
    s_add_u32 s53, s46, 1179648
    s_add_u32 m0, s48, 73728
    s_nop 0
    buffer_load_dwordx4 v20, s[12:15], s53 offen lds
    s_add_u32 m0, s48, 74752
    s_nop 0
    buffer_load_dwordx4 v21, s[12:15], s53 offen lds
    s_add_u32 m0, s48, 75776
    s_nop 0
    buffer_load_dwordx4 v22, s[12:15], s53 offen lds
    s_add_u32 m0, s48, 76800
    s_nop 0
    buffer_load_dwordx4 v23, s[12:15], s53 offen lds
    s_add_u32 m0, s48, 77824
    s_nop 0
    buffer_load_dwordx4 v24, s[12:15], s53 offen lds
    s_add_u32 m0, s48, 78848
    s_nop 0
    buffer_load_dwordx4 v25, s[12:15], s53 offen lds
    s_add_u32 m0, s47, 0
    s_nop 0
    buffer_load_dwordx4 v2, s[8:11], s52 offen offset:0 lds
    buffer_load_dwordx4 v2, s[8:11], s52 offen offset:1024 lds
    buffer_load_dwordx4 v2, s[8:11], s52 offen offset:2048 lds
    buffer_load_dwordx4 v2, s[8:11], s52 offen offset:3072 lds
    s_waitcnt vmcnt(20)
    s_barrier
    s_add_u32 s54, s56, 17
    s_cmp_lt_u32 s54, s44
    s_cbranch_scc1 g2_hok_107
    s_mov_b32 s59, 0
g2_hre_108:
    buffer_load_dword v36, v30, s[96:99], s45 offen sc1
    s_waitcnt vmcnt(0)
    v_subrev_u32 v36, s57, v36
    v_cmp_gt_u32 vcc, 16, v36
    s_nop 1
    v_cndmask_b32 v36, 0, v36, vcc
    v_lshl_add_u32 v36, v36, 2, v29
    s_nop 1
    v_min_u32_dpp v36, v36, v36 quad_perm:[1,0,3,2] row_mask:0xf bank_mask:0xf
    s_nop 1
    v_min_u32_dpp v36, v36, v36 quad_perm:[2,3,0,1] row_mask:0xf bank_mask:0xf
    s_nop 0
    v_readfirstlane_b32 s52, v36
    s_nop 0
    s_max_u32 s44, s44, s52
    s_add_u32 s59, s59, 1
    s_cmp_lt_u32 s54, s44
    s_cbranch_scc1 g2_hok_107
    s_sleep 2
    s_cmp_lt_u32 s59, 20000
    s_cbranch_scc1 g2_hre_108
g2_hok_107:
    s_mov_b32 s52, 278528
    s_add_u32 s53, s46, 1253376
    s_add_u32 m0, s48, 98304
    s_nop 0
    buffer_load_dwordx4 v20, s[12:15], s53 offen lds
    s_add_u32 m0, s48, 99328
    s_nop 0
    buffer_load_dwordx4 v21, s[12:15], s53 offen lds
    s_add_u32 m0, s48, 100352
    s_nop 0
    buffer_load_dwordx4 v22, s[12:15], s53 offen lds
    s_add_u32 m0, s48, 101376
    s_nop 0
    buffer_load_dwordx4 v23, s[12:15], s53 offen lds
    s_add_u32 m0, s48, 102400
    s_nop 0
    buffer_load_dwordx4 v24, s[12:15], s53 offen lds
    s_add_u32 m0, s48, 103424
    s_nop 0
    buffer_load_dwordx4 v25, s[12:15], s53 offen lds
    s_add_u32 m0, s47, 16384
    s_nop 0
    buffer_load_dwordx4 v2, s[8:11], s52 offen offset:0 lds
    buffer_load_dwordx4 v2, s[8:11], s52 offen offset:1024 lds
    buffer_load_dwordx4 v2, s[8:11], s52 offen offset:2048 lds
    buffer_load_dwordx4 v2, s[8:11], s52 offen offset:3072 lds
    buffer_load_dwordx4 v[40:43], v31, s[92:95], 0 offen
    buffer_load_dword v44, v38, s[92:95], 0 offen
    s_waitcnt vmcnt(22)
    s_barrier
    s_mov_b32 s53, 0
    s_add_u32 m0, s50, 122880
    s_nop 0
    buffer_load_dwordx4 v27, s[20:23], s53 offen offset:0 lds
    buffer_load_dwordx4 v27, s[20:23], s53 offen offset:1024 lds
    buffer_load_dwordx4 v27, s[20:23], s53 offen offset:2048 lds
    s_mov_b32 s53, 12288
    s_add_u32 m0, s50, 135168
    s_nop 0
    buffer_load_dwordx4 v27, s[20:23], s53 offen offset:0 lds
    buffer_load_dwordx4 v27, s[20:23], s53 offen offset:1024 lds
    buffer_load_dwordx4 v27, s[20:23], s53 offen offset:2048 lds
    s_waitcnt vmcnt(18)
    s_barrier
    s_mov_b32 s53, 24576
    s_add_u32 m0, s50, 49152
    s_nop 0
    buffer_load_dwordx4 v27, s[20:23], s53 offen offset:0 lds
    buffer_load_dwordx4 v27, s[20:23], s53 offen offset:1024 lds
    buffer_load_dwordx4 v27, s[20:23], s53 offen offset:2048 lds
    s_mov_b32 s53, 36864
    s_add_u32 m0, s50, 61440
    s_nop 0
    buffer_load_dwordx4 v27, s[20:23], s53 offen offset:0 lds
    buffer_load_dwordx4 v27, s[20:23], s53 offen offset:1024 lds
    buffer_load_dwordx4 v27, s[20:23], s53 offen offset:2048 lds
    s_waitcnt vmcnt(12)
    s_cmp_lg_u32 s36, 4
    s_cbranch_scc1 g2_zs_109
    s_mov_b32 s59, 0
g2_zre_111:
    v_xor_b32 v40, s57, v40
    v_xor_b32 v41, s57, v41
    v_xor_b32 v42, s57, v42
    v_xor_b32 v43, s57, v43
    v_xor_b32 v44, s57, v44
    v_or3_b32 v40, v40, v41, v42
    v_or3_b32 v40, v40, v43, v44
    v_cmp_ne_u32 vcc, 0, v40
    s_add_u32 s59, s59, 1
    s_nop 3
    s_cbranch_vccz g2_zok_110
    s_sleep 8
    buffer_load_dwordx4 v[40:43], v31, s[92:95], 0 offen sc1
    buffer_load_dword v44, v38, s[92:95], 0 offen sc1
    s_waitcnt vmcnt(0)
    s_cmp_lt_u32 s59, 20000
    s_cbranch_scc1 g2_zre_111
g2_zok_110:
g2_zs_109:
    s_barrier
    s_mov_b32 s52, 0
    s_add_u32 m0, s43, 32768
    s_nop 0
    buffer_load_dwordx4 v26, s[16:19], s52 offen offset:0 lds
    buffer_load_dwordx4 v26, s[16:19], s52 offen offset:1024 lds
    s_mov_b32 s52, 8192
    s_add_u32 m0, s43, 40960
    s_nop 0
    buffer_load_dwordx4 v26, s[16:19], s52 offen offset:0 lds
    buffer_load_dwordx4 v26, s[16:19], s52 offen offset:1024 lds
    s_mov_b32 s52, 16384
    s_add_u32 m0, s43, 147456
    s_nop 0
    buffer_load_dwordx4 v26, s[16:19], s52 offen offset:0 lds
    buffer_load_dwordx4 v26, s[16:19], s52 offen offset:1024 lds
    s_mov_b32 s52, 24576
    s_add_u32 m0, s43, 155648
    s_nop 0
    buffer_load_dwordx4 v26, s[16:19], s52 offen offset:0 lds
    buffer_load_dwordx4 v26, s[16:19], s52 offen offset:1024 lds
    s_mov_b32 s52, 32768
    s_add_u32 m0, s43, 0
    s_nop 0
    buffer_load_dwordx4 v26, s[16:19], s52 offen offset:0 lds
    buffer_load_dwordx4 v26, s[16:19], s52 offen offset:1024 lds
    s_mov_b32 s52, 40960
    s_add_u32 m0, s43, 8192
    s_nop 0
    buffer_load_dwordx4 v26, s[16:19], s52 offen offset:0 lds
    buffer_load_dwordx4 v26, s[16:19], s52 offen offset:1024 lds
    s_mov_b32 s53, 49152
    s_add_u32 m0, s50, 73728
    s_nop 0
    buffer_load_dwordx4 v27, s[20:23], s53 offen offset:0 lds
    buffer_load_dwordx4 v27, s[20:23], s53 offen offset:1024 lds
    buffer_load_dwordx4 v27, s[20:23], s53 offen offset:2048 lds
    s_mov_b32 s53, 61440
    s_add_u32 m0, s50, 86016
    s_nop 0
    buffer_load_dwordx4 v27, s[20:23], s53 offen offset:0 lds
    buffer_load_dwordx4 v27, s[20:23], s53 offen offset:1024 lds
    buffer_load_dwordx4 v27, s[20:23], s53 offen offset:2048 lds
    s_waitcnt vmcnt(14)
    s_barrier
    s_waitcnt vmcnt(10)
    s_barrier
    s_mov_b32 s53, 73728
    s_add_u32 m0, s50, 122880
    s_nop 0
    buffer_load_dwordx4 v27, s[20:23], s53 offen offset:0 lds
    buffer_load_dwordx4 v27, s[20:23], s53 offen offset:1024 lds
    buffer_load_dwordx4 v27, s[20:23], s53 offen offset:2048 lds
    s_mov_b32 s53, 86016
    s_add_u32 m0, s50, 135168
    s_nop 0
    buffer_load_dwordx4 v27, s[20:23], s53 offen offset:0 lds
    buffer_load_dwordx4 v27, s[20:23], s53 offen offset:1024 lds
    buffer_load_dwordx4 v27, s[20:23], s53 offen offset:2048 lds
    s_mov_b32 s52, 49152
    s_add_u32 m0, s43, 32768
    s_nop 0
    buffer_load_dwordx4 v26, s[16:19], s52 offen offset:0 lds
    buffer_load_dwordx4 v26, s[16:19], s52 offen offset:1024 lds
    s_mov_b32 s52, 57344
    s_add_u32 m0, s43, 40960
    s_nop 0
    buffer_load_dwordx4 v26, s[16:19], s52 offen offset:0 lds
    buffer_load_dwordx4 v26, s[16:19], s52 offen offset:1024 lds
    s_sub_u32 s56, s36, 4
    s_mul_i32 s52, s56, 6144
    s_add_u32 s52, s52, 98304
    v_lshl_add_u32 v45, v0, 4, s52
    ds_read_b128 v[48:51], v45 offset:0
    ds_read_b128 v[52:55], v45 offset:1024
    ds_read_b128 v[56:59], v45 offset:2048
    ds_read_b128 v[60:63], v45 offset:3072
    ds_read_b128 v[64:67], v45 offset:4096
    ds_read_b128 v[68:71], v45 offset:5120
    s_lshl_b32 s53, s40, 1
    s_lshr_b32 s54, s41, 1
    s_add_u32 s53, s53, s54
    s_mul_i32 s53, s53, 192
    s_lshr_b32 s54, s56, 1
    s_mul_i32 s54, s54, 96
    s_add_u32 s53, s53, s54
    v_lshrrev_b32 v46, 4, v0
    v_lshl_add_u32 v46, v46, 3, s53
    buffer_load_dwordx2 v[108:109], v46, s[80:83], 0 offen offset:0
    buffer_load_dwordx2 v[110:111], v46, s[80:83], 0 offen offset:32
    buffer_load_dwordx2 v[112:113], v46, s[80:83], 0 offen offset:64
    s_lshl_b32 s52, s49, 2
    s_add_u32 s52, s52, s41
    s_lshl_b32 s52, s52, 16
    s_lshl_b32 s53, s56, 12
    s_add_u32 s47, s52, s53
    v_lshlrev_b32 v47, 4, v0
    s_waitcnt vmcnt(13)
    s_barrier
    s_mov_b32 s53, 98304
    s_add_u32 m0, s50, 49152
    s_nop 0
    buffer_load_dwordx4 v27, s[20:23], s53 offen offset:0 lds
    buffer_load_dwordx4 v27, s[20:23], s53 offen offset:1024 lds
    buffer_load_dwordx4 v27, s[20:23], s53 offen offset:2048 lds
    s_mov_b32 s52, 65536
    s_add_u32 m0, s43, 147456
    s_nop 0
    buffer_load_dwordx4 v26, s[16:19], s52 offen offset:0 lds
    buffer_load_dwordx4 v26, s[16:19], s52 offen offset:1024 lds
    s_waitcnt vmcnt(0)
    s_barrier
    s_add_u32 s53, s41, 1
    s_and_b32 s53, s53, 3
    s_lshl_b32 s53, s53, 14
    s_add_u32 s53, s53, s47
    buffer_load_dwordx4 v[144:147], v47, s[24:27], s53 offen offset:0 sc1
    buffer_load_dwordx4 v[148:151], v47, s[24:27], s53 offen offset:1024 sc1
    buffer_load_dwordx4 v[152:155], v47, s[24:27], s53 offen offset:2048 sc1
    buffer_load_dwordx4 v[156:159], v47, s[24:27], s53 offen offset:3072 sc1
    s_add_u32 s53, s41, 2
    s_and_b32 s53, s53, 3
    s_lshl_b32 s53, s53, 14
    s_add_u32 s53, s53, s47
    buffer_load_dwordx4 v[160:163], v47, s[24:27], s53 offen offset:0 sc1
    buffer_load_dwordx4 v[164:167], v47, s[24:27], s53 offen offset:1024 sc1
    buffer_load_dwordx4 v[168:171], v47, s[24:27], s53 offen offset:2048 sc1
    buffer_load_dwordx4 v[172:175], v47, s[24:27], s53 offen offset:3072 sc1
    s_add_u32 s53, s41, 3
    s_and_b32 s53, s53, 3
    s_lshl_b32 s53, s53, 14
    s_add_u32 s53, s53, s47
    buffer_load_dwordx4 v[176:179], v47, s[24:27], s53 offen offset:0 sc1
    buffer_load_dwordx4 v[180:183], v47, s[24:27], s53 offen offset:1024 sc1
    buffer_load_dwordx4 v[184:187], v47, s[24:27], s53 offen offset:2048 sc1
    buffer_load_dwordx4 v[188:191], v47, s[24:27], s53 offen offset:3072 sc1
    v_lshlrev_b32 v116, 16, v108
    v_and_b32 v117, 0xffff0000, v108
    v_lshlrev_b32 v118, 16, v109
    v_and_b32 v119, 0xffff0000, v109
    v_lshlrev_b32 v120, 16, v110
    v_and_b32 v121, 0xffff0000, v110
    v_lshlrev_b32 v122, 16, v111
    v_and_b32 v123, 0xffff0000, v111
    v_lshlrev_b32 v124, 16, v112
    v_and_b32 v125, 0xffff0000, v112
    v_lshlrev_b32 v126, 16, v113
    v_and_b32 v127, 0xffff0000, v113
    s_waitcnt lgkmcnt(0)
    v_add_f32 v48, v48, v116
    v_add_f32 v49, v49, v117
    v_add_f32 v50, v50, v118
    v_add_f32 v51, v51, v119
    v_add_f32 v52, v52, v120
    v_add_f32 v53, v53, v121
    v_add_f32 v54, v54, v122
    v_add_f32 v55, v55, v123
    v_add_f32 v56, v56, v124
    v_add_f32 v57, v57, v125
    v_add_f32 v58, v58, v126
    v_add_f32 v59, v59, v127
    v_add_f32 v60, v60, v116
    v_add_f32 v61, v61, v117
    v_add_f32 v62, v62, v118
    v_add_f32 v63, v63, v119
    v_add_f32 v64, v64, v120
    v_add_f32 v65, v65, v121
    v_add_f32 v66, v66, v122
    v_add_f32 v67, v67, v123
    v_add_f32 v68, v68, v124
    v_add_f32 v69, v69, v125
    v_add_f32 v70, v70, v126
    v_add_f32 v71, v71, v127
    s_mov_b32 s59, 0
g2_fre_113:
    s_waitcnt vmcnt(0)
    v_xor_b32 v13, s57, v147
    v_xor_b32 v14, s57, v151
    v_or_b32 v13, v13, v14
    v_xor_b32 v14, s57, v155
    v_or_b32 v13, v13, v14
    v_xor_b32 v14, s57, v159
    v_or_b32 v13, v13, v14
    v_xor_b32 v14, s57, v163
    v_or_b32 v13, v13, v14
    v_xor_b32 v14, s57, v167
    v_or_b32 v13, v13, v14
    v_xor_b32 v14, s57, v171
    v_or_b32 v13, v13, v14
    v_xor_b32 v14, s57, v175
    v_or_b32 v13, v13, v14
    v_xor_b32 v14, s57, v179
    v_or_b32 v13, v13, v14
    v_xor_b32 v14, s57, v183
    v_or_b32 v13, v13, v14
    v_xor_b32 v14, s57, v187
    v_or_b32 v13, v13, v14
    v_xor_b32 v14, s57, v191
    v_or_b32 v13, v13, v14
    v_cmp_ne_u32 vcc, 0, v13
    s_add_u32 s59, s59, 1
    s_nop 3
    s_cbranch_vccz g2_fok_112
    s_sleep 4
    s_add_u32 s53, s41, 1
    s_and_b32 s53, s53, 3
    s_lshl_b32 s53, s53, 14
    s_add_u32 s53, s53, s47
    buffer_load_dwordx4 v[144:147], v47, s[24:27], s53 offen offset:0 sc1
    buffer_load_dwordx4 v[148:151], v47, s[24:27], s53 offen offset:1024 sc1
    buffer_load_dwordx4 v[152:155], v47, s[24:27], s53 offen offset:2048 sc1
    buffer_load_dwordx4 v[156:159], v47, s[24:27], s53 offen offset:3072 sc1
    s_add_u32 s53, s41, 2
    s_and_b32 s53, s53, 3
    s_lshl_b32 s53, s53, 14
    s_add_u32 s53, s53, s47
    buffer_load_dwordx4 v[160:163], v47, s[24:27], s53 offen offset:0 sc1
    buffer_load_dwordx4 v[164:167], v47, s[24:27], s53 offen offset:1024 sc1
    buffer_load_dwordx4 v[168:171], v47, s[24:27], s53 offen offset:2048 sc1
    buffer_load_dwordx4 v[172:175], v47, s[24:27], s53 offen offset:3072 sc1
    s_add_u32 s53, s41, 3
    s_and_b32 s53, s53, 3
    s_lshl_b32 s53, s53, 14
    s_add_u32 s53, s53, s47
    buffer_load_dwordx4 v[176:179], v47, s[24:27], s53 offen offset:0 sc1
    buffer_load_dwordx4 v[180:183], v47, s[24:27], s53 offen offset:1024 sc1
    buffer_load_dwordx4 v[184:187], v47, s[24:27], s53 offen offset:2048 sc1
    buffer_load_dwordx4 v[188:191], v47, s[24:27], s53 offen offset:3072 sc1
    s_cmp_lt_u32 s59, 20000
    s_cbranch_scc1 g2_fre_113
g2_fok_112:
    v_lshlrev_b32 v132, 16, v144
    v_and_b32 v133, 0xffff0000, v144
    v_lshlrev_b32 v134, 16, v145
    v_and_b32 v135, 0xffff0000, v145
    v_add_f32 v48, v48, v132
    v_add_f32 v49, v49, v133
    v_add_f32 v50, v50, v134
    v_add_f32 v51, v51, v135
    v_lshlrev_b32 v132, 16, v160
    v_and_b32 v133, 0xffff0000, v160
    v_lshlrev_b32 v134, 16, v161
    v_and_b32 v135, 0xffff0000, v161
    v_add_f32 v48, v48, v132
    v_add_f32 v49, v49, v133
    v_add_f32 v50, v50, v134
    v_add_f32 v51, v51, v135
    v_lshlrev_b32 v132, 16, v176
    v_and_b32 v133, 0xffff0000, v176
    v_lshlrev_b32 v134, 16, v177
    v_and_b32 v135, 0xffff0000, v177
    v_add_f32 v48, v48, v132
    v_add_f32 v49, v49, v133
    v_add_f32 v50, v50, v134
    v_add_f32 v51, v51, v135
    v_cvt_pk_bf16_f32 v128, v48, v49
    v_cvt_pk_bf16_f32 v129, v50, v51
    v_lshlrev_b32 v48, 16, v128
    v_and_b32 v49, 0xffff0000, v128
    v_lshlrev_b32 v50, 16, v129
    v_and_b32 v51, 0xffff0000, v129
    v_mul_f32 v132, 0xbfb8aa3b, v48
    v_mul_f32 v133, 0xbfb8aa3b, v49
    v_mul_f32 v134, 0xbfb8aa3b, v50
    v_mul_f32 v135, 0xbfb8aa3b, v51
    v_exp_f32 v132, v132
    v_exp_f32 v133, v133
    v_exp_f32 v134, v134
    v_exp_f32 v135, v135
    v_add_f32 v132, 1.0, v132
    v_add_f32 v133, 1.0, v133
    v_add_f32 v134, 1.0, v134
    v_add_f32 v135, 1.0, v135
    v_rcp_f32 v132, v132
    v_rcp_f32 v133, v133
    v_rcp_f32 v134, v134
    v_rcp_f32 v135, v135
    v_mul_f32 v48, v48, v132
    v_mul_f32 v49, v49, v133
    v_mul_f32 v50, v50, v134
    v_mul_f32 v51, v51, v135
    v_cvt_pk_bf16_f32 v136, v48, v49
    v_cvt_pk_bf16_f32 v137, v50, v51
    v_lshlrev_b32 v132, 16, v152
    v_and_b32 v133, 0xffff0000, v152
    v_lshlrev_b32 v134, 16, v153
    v_and_b32 v135, 0xffff0000, v153
    v_add_f32 v60, v60, v132
    v_add_f32 v61, v61, v133
    v_add_f32 v62, v62, v134
    v_add_f32 v63, v63, v135
    v_lshlrev_b32 v132, 16, v168
    v_and_b32 v133, 0xffff0000, v168
    v_lshlrev_b32 v134, 16, v169
    v_and_b32 v135, 0xffff0000, v169
    v_add_f32 v60, v60, v132
    v_add_f32 v61, v61, v133
    v_add_f32 v62, v62, v134
    v_add_f32 v63, v63, v135
    v_lshlrev_b32 v132, 16, v184
    v_and_b32 v133, 0xffff0000, v184
    v_lshlrev_b32 v134, 16, v185
    v_and_b32 v135, 0xffff0000, v185
    v_add_f32 v60, v60, v132
    v_add_f32 v61, v61, v133
    v_add_f32 v62, v62, v134
    v_add_f32 v63, v63, v135
    v_cvt_pk_bf16_f32 v128, v60, v61
    v_cvt_pk_bf16_f32 v129, v62, v63
    v_lshlrev_b32 v60, 16, v128
    v_and_b32 v61, 0xffff0000, v128
    v_lshlrev_b32 v62, 16, v129
    v_and_b32 v63, 0xffff0000, v129
    v_mul_f32 v132, 0xbfb8aa3b, v60
    v_mul_f32 v133, 0xbfb8aa3b, v61
    v_mul_f32 v134, 0xbfb8aa3b, v62
    v_mul_f32 v135, 0xbfb8aa3b, v63
    v_exp_f32 v132, v132
    v_exp_f32 v133, v133
    v_exp_f32 v134, v134
    v_exp_f32 v135, v135
    v_add_f32 v132, 1.0, v132
    v_add_f32 v133, 1.0, v133
    v_add_f32 v134, 1.0, v134
    v_add_f32 v135, 1.0, v135
    v_rcp_f32 v132, v132
    v_rcp_f32 v133, v133
    v_rcp_f32 v134, v134
    v_rcp_f32 v135, v135
    v_mul_f32 v60, v60, v132
    v_mul_f32 v61, v61, v133
    v_mul_f32 v62, v62, v134
    v_mul_f32 v63, v63, v135
    v_cvt_pk_bf16_f32 v138, v60, v61
    v_cvt_pk_bf16_f32 v139, v62, v63
    ds_write_b128 v45, v[136:139] offset:0
    v_lshlrev_b32 v132, 16, v146
    v_and_b32 v133, 0xffff0000, v146
    v_lshlrev_b32 v134, 16, v148
    v_and_b32 v135, 0xffff0000, v148
    v_add_f32 v52, v52, v132
    v_add_f32 v53, v53, v133
    v_add_f32 v54, v54, v134
    v_add_f32 v55, v55, v135
    v_lshlrev_b32 v132, 16, v162
    v_and_b32 v133, 0xffff0000, v162
    v_lshlrev_b32 v134, 16, v164
    v_and_b32 v135, 0xffff0000, v164
    v_add_f32 v52, v52, v132
    v_add_f32 v53, v53, v133
    v_add_f32 v54, v54, v134
    v_add_f32 v55, v55, v135
    v_lshlrev_b32 v132, 16, v178
    v_and_b32 v133, 0xffff0000, v178
    v_lshlrev_b32 v134, 16, v180
    v_and_b32 v135, 0xffff0000, v180
    v_add_f32 v52, v52, v132
    v_add_f32 v53, v53, v133
    v_add_f32 v54, v54, v134
    v_add_f32 v55, v55, v135
    v_cvt_pk_bf16_f32 v128, v52, v53
    v_cvt_pk_bf16_f32 v129, v54, v55
    v_lshlrev_b32 v52, 16, v128
    v_and_b32 v53, 0xffff0000, v128
    v_lshlrev_b32 v54, 16, v129
    v_and_b32 v55, 0xffff0000, v129
    v_mul_f32 v132, 0xbfb8aa3b, v52
    v_mul_f32 v133, 0xbfb8aa3b, v53
    v_mul_f32 v134, 0xbfb8aa3b, v54
    v_mul_f32 v135, 0xbfb8aa3b, v55
    v_exp_f32 v132, v132
    v_exp_f32 v133, v133
    v_exp_f32 v134, v134
    v_exp_f32 v135, v135
    v_add_f32 v132, 1.0, v132
    v_add_f32 v133, 1.0, v133
    v_add_f32 v134, 1.0, v134
    v_add_f32 v135, 1.0, v135
    v_rcp_f32 v132, v132
    v_rcp_f32 v133, v133
    v_rcp_f32 v134, v134
    v_rcp_f32 v135, v135
    v_mul_f32 v52, v52, v132
    v_mul_f32 v53, v53, v133
    v_mul_f32 v54, v54, v134
    v_mul_f32 v55, v55, v135
    v_cvt_pk_bf16_f32 v136, v52, v53
    v_cvt_pk_bf16_f32 v137, v54, v55
    v_lshlrev_b32 v132, 16, v154
    v_and_b32 v133, 0xffff0000, v154
    v_lshlrev_b32 v134, 16, v156
    v_and_b32 v135, 0xffff0000, v156
    v_add_f32 v64, v64, v132
    v_add_f32 v65, v65, v133
    v_add_f32 v66, v66, v134
    v_add_f32 v67, v67, v135
    v_lshlrev_b32 v132, 16, v170
    v_and_b32 v133, 0xffff0000, v170
    v_lshlrev_b32 v134, 16, v172
    v_and_b32 v135, 0xffff0000, v172
    v_add_f32 v64, v64, v132
    v_add_f32 v65, v65, v133
    v_add_f32 v66, v66, v134
    v_add_f32 v67, v67, v135
    v_lshlrev_b32 v132, 16, v186
    v_and_b32 v133, 0xffff0000, v186
    v_lshlrev_b32 v134, 16, v188
    v_and_b32 v135, 0xffff0000, v188
    v_add_f32 v64, v64, v132
    v_add_f32 v65, v65, v133
    v_add_f32 v66, v66, v134
    v_add_f32 v67, v67, v135
    v_cvt_pk_bf16_f32 v128, v64, v65
    v_cvt_pk_bf16_f32 v129, v66, v67
    v_lshlrev_b32 v64, 16, v128
    v_and_b32 v65, 0xffff0000, v128
    v_lshlrev_b32 v66, 16, v129
    v_and_b32 v67, 0xffff0000, v129
    v_mul_f32 v132, 0xbfb8aa3b, v64
    v_mul_f32 v133, 0xbfb8aa3b, v65
    v_mul_f32 v134, 0xbfb8aa3b, v66
    v_mul_f32 v135, 0xbfb8aa3b, v67
    v_exp_f32 v132, v132
    v_exp_f32 v133, v133
    v_exp_f32 v134, v134
    v_exp_f32 v135, v135
    v_add_f32 v132, 1.0, v132
    v_add_f32 v133, 1.0, v133
    v_add_f32 v134, 1.0, v134
    v_add_f32 v135, 1.0, v135
    v_rcp_f32 v132, v132
    v_rcp_f32 v133, v133
    v_rcp_f32 v134, v134
    v_rcp_f32 v135, v135
    v_mul_f32 v64, v64, v132
    v_mul_f32 v65, v65, v133
    v_mul_f32 v66, v66, v134
    v_mul_f32 v67, v67, v135
    v_cvt_pk_bf16_f32 v138, v64, v65
    v_cvt_pk_bf16_f32 v139, v66, v67
    ds_write_b128 v45, v[136:139] offset:1024
    v_lshlrev_b32 v132, 16, v149
    v_and_b32 v133, 0xffff0000, v149
    v_lshlrev_b32 v134, 16, v150
    v_and_b32 v135, 0xffff0000, v150
    v_add_f32 v56, v56, v132
    v_add_f32 v57, v57, v133
    v_add_f32 v58, v58, v134
    v_add_f32 v59, v59, v135
    v_lshlrev_b32 v132, 16, v165
    v_and_b32 v133, 0xffff0000, v165
    v_lshlrev_b32 v134, 16, v166
    v_and_b32 v135, 0xffff0000, v166
    v_add_f32 v56, v56, v132
    v_add_f32 v57, v57, v133
    v_add_f32 v58, v58, v134
    v_add_f32 v59, v59, v135
    v_lshlrev_b32 v132, 16, v181
    v_and_b32 v133, 0xffff0000, v181
    v_lshlrev_b32 v134, 16, v182
    v_and_b32 v135, 0xffff0000, v182
    v_add_f32 v56, v56, v132
    v_add_f32 v57, v57, v133
    v_add_f32 v58, v58, v134
    v_add_f32 v59, v59, v135
    v_cvt_pk_bf16_f32 v128, v56, v57
    v_cvt_pk_bf16_f32 v129, v58, v59
    v_lshlrev_b32 v56, 16, v128
    v_and_b32 v57, 0xffff0000, v128
    v_lshlrev_b32 v58, 16, v129
    v_and_b32 v59, 0xffff0000, v129
    v_mul_f32 v132, 0xbfb8aa3b, v56
    v_mul_f32 v133, 0xbfb8aa3b, v57
    v_mul_f32 v134, 0xbfb8aa3b, v58
    v_mul_f32 v135, 0xbfb8aa3b, v59
    v_exp_f32 v132, v132
    v_exp_f32 v133, v133
    v_exp_f32 v134, v134
    v_exp_f32 v135, v135
    v_add_f32 v132, 1.0, v132
    v_add_f32 v133, 1.0, v133
    v_add_f32 v134, 1.0, v134
    v_add_f32 v135, 1.0, v135
    v_rcp_f32 v132, v132
    v_rcp_f32 v133, v133
    v_rcp_f32 v134, v134
    v_rcp_f32 v135, v135
    v_mul_f32 v56, v56, v132
    v_mul_f32 v57, v57, v133
    v_mul_f32 v58, v58, v134
    v_mul_f32 v59, v59, v135
    v_cvt_pk_bf16_f32 v136, v56, v57
    v_cvt_pk_bf16_f32 v137, v58, v59
    v_lshlrev_b32 v132, 16, v157
    v_and_b32 v133, 0xffff0000, v157
    v_lshlrev_b32 v134, 16, v158
    v_and_b32 v135, 0xffff0000, v158
    v_add_f32 v68, v68, v132
    v_add_f32 v69, v69, v133
    v_add_f32 v70, v70, v134
    v_add_f32 v71, v71, v135
    v_lshlrev_b32 v132, 16, v173
    v_and_b32 v133, 0xffff0000, v173
    v_lshlrev_b32 v134, 16, v174
    v_and_b32 v135, 0xffff0000, v174
    v_add_f32 v68, v68, v132
    v_add_f32 v69, v69, v133
    v_add_f32 v70, v70, v134
    v_add_f32 v71, v71, v135
    v_lshlrev_b32 v132, 16, v189
    v_and_b32 v133, 0xffff0000, v189
    v_lshlrev_b32 v134, 16, v190
    v_and_b32 v135, 0xffff0000, v190
    v_add_f32 v68, v68, v132
    v_add_f32 v69, v69, v133
    v_add_f32 v70, v70, v134
    v_add_f32 v71, v71, v135
    v_cvt_pk_bf16_f32 v128, v68, v69
    v_cvt_pk_bf16_f32 v129, v70, v71
    v_lshlrev_b32 v68, 16, v128
    v_and_b32 v69, 0xffff0000, v128
    v_lshlrev_b32 v70, 16, v129
    v_and_b32 v71, 0xffff0000, v129
    v_mul_f32 v132, 0xbfb8aa3b, v68
    v_mul_f32 v133, 0xbfb8aa3b, v69
    v_mul_f32 v134, 0xbfb8aa3b, v70
    v_mul_f32 v135, 0xbfb8aa3b, v71
    v_exp_f32 v132, v132
    v_exp_f32 v133, v133
    v_exp_f32 v134, v134
    v_exp_f32 v135, v135
    v_add_f32 v132, 1.0, v132
    v_add_f32 v133, 1.0, v133
    v_add_f32 v134, 1.0, v134
    v_add_f32 v135, 1.0, v135
    v_rcp_f32 v132, v132
    v_rcp_f32 v133, v133
    v_rcp_f32 v134, v134
    v_rcp_f32 v135, v135
    v_mul_f32 v68, v68, v132
    v_mul_f32 v69, v69, v133
    v_mul_f32 v70, v70, v134
    v_mul_f32 v71, v71, v135
    v_cvt_pk_bf16_f32 v138, v68, v69
    v_cvt_pk_bf16_f32 v139, v70, v71
    ds_write_b128 v45, v[136:139] offset:2048
    s_waitcnt lgkmcnt(0)
    s_barrier
    s_endpgm
g2_comp_78:
    s_and_b32 s37, s36, 1
    s_lshr_b32 s38, s36, 1
    v_and_b32 v30, 15, v0
    v_lshrrev_b32 v31, 4, v0
    v_lshrrev_b32 v12, 2, v30
    v_and_b32 v12, 2, v12
    v_xor_b32 v12, v12, v31
    s_lshl_b32 s52, s37, 12
    v_lshlrev_b32 v13, 6, v30
    v_add_u32 v13, s52, v13
    v_lshl_add_u32 v2, v12, 4, v13
    v_add_u32 v3, 8192, v2
    v_bfe_u32 v12, v0, 2, 2
    v_and_b32 v13, 3, v0
    v_lshl_add_u32 v14, v31, 3, v12
    v_lshrrev_b32 v16, 1, v13
    v_and_b32 v29, 1, v13
    v_and_b32 v17, 1, v31
    v_lshlrev_b32 v17, 1, v17
    v_mul_u32_u24 v15, 192, v14
    v_lshl_add_u32 v15, v29, 3, v15
    s_mul_i32 s52, s38, 6
    v_add3_u32 v1, v16, s52, 0
    v_xor_b32 v1, v1, v17
    v_lshl_add_u32 v18, v1, 4, v15
    v_add3_u32 v1, v16, s52, 2
    v_xor_b32 v1, v1, v17
    v_lshl_add_u32 v19, v1, 4, v15
    v_add3_u32 v1, v16, s52, 4
    v_xor_b32 v1, v1, v17
    v_lshl_add_u32 v20, v1, 4, v15
    v_lshrrev_b32 v1, 1, v12
    v_add_u32 v17, v17, v1
    v_lshlrev_b32 v17, 1, v17
    v_lshlrev_b32 v15, 7, v14
    v_lshl_add_u32 v15, v29, 3, v15
    s_mul_i32 s52, s38, 6
    s_add_u32 s53, s52, 0
    s_and_b32 s54, s53, 3
    s_lshl_b32 s54, s54, 1
    s_lshr_b32 s53, s53, 2
    s_lshl_b32 s53, s53, 13
    v_add_u32 v1, s54, v16
    v_xor_b32 v1, v1, v17
    v_lshl_add_u32 v1, v1, 4, v15
    v_add_u32 v4, s53, v1
    s_add_u32 s53, s52, 1
    s_and_b32 s54, s53, 3
    s_lshl_b32 s54, s54, 1
    s_lshr_b32 s53, s53, 2
    s_lshl_b32 s53, s53, 13
    v_add_u32 v1, s54, v16
    v_xor_b32 v1, v1, v17
    v_lshl_add_u32 v1, v1, 4, v15
    v_add_u32 v5, s53, v1
    s_add_u32 s53, s52, 2
    s_and_b32 s54, s53, 3
    s_lshl_b32 s54, s54, 1
    s_lshr_b32 s53, s53, 2
    s_lshl_b32 s53, s53, 13
    v_add_u32 v1, s54, v16
    v_xor_b32 v1, v1, v17
    v_lshl_add_u32 v1, v1, 4, v15
    v_add_u32 v6, s53, v1
    s_add_u32 s53, s52, 3
    s_and_b32 s54, s53, 3
    s_lshl_b32 s54, s54, 1
    s_lshr_b32 s53, s53, 2
    s_lshl_b32 s53, s53, 13
    v_add_u32 v1, s54, v16
    v_xor_b32 v1, v1, v17
    v_lshl_add_u32 v1, v1, 4, v15
    v_add_u32 v7, s53, v1
    s_add_u32 s53, s52, 4
    s_and_b32 s54, s53, 3
    s_lshl_b32 s54, s54, 1
    s_lshr_b32 s53, s53, 2
    s_lshl_b32 s53, s53, 13
    v_add_u32 v1, s54, v16
    v_xor_b32 v1, v1, v17
    v_lshl_add_u32 v1, v1, 4, v15
    v_add_u32 v8, s53, v1
    s_add_u32 s53, s52, 5
    s_and_b32 s54, s53, 3
    s_lshl_b32 s54, s54, 1
    s_lshr_b32 s53, s53, 2
    s_lshl_b32 s53, s53, 13
    v_add_u32 v1, s54, v16
    v_xor_b32 v1, v1, v17
    v_lshl_add_u32 v1, v1, 4, v15
    v_add_u32 v9, s53, v1
    v_lshlrev_b32 v15, 7, v14
    v_lshl_add_u32 v15, v29, 3, v15
    s_lshl_b32 s52, s37, 2
    v_add3_u32 v1, v16, s52, 0
    v_xor_b32 v1, v1, v17
    v_lshl_add_u32 v10, v1, 4, v15
    v_add3_u32 v1, v16, s52, 2
    v_xor_b32 v1, v1, v17
    v_lshl_add_u32 v11, v1, 4, v15
    s_mov_b32 s44, 0
    s_mov_b32 s47, 0
    s_mov_b32 s48, 73728
    v_add_u32 v21, s47, v2
    v_add_u32 v22, s47, v3
    v_add_u32 v23, s48, v4
    v_add_u32 v24, s48, v5
    v_add_u32 v25, s48, v6
    v_add_u32 v26, s48, v7
    v_add_u32 v27, s48, v8
    v_add_u32 v28, s48, v9
    s_add_u32 s44, s44, 1
    s_and_b32 s44, s44, 3
    s_lshl_b32 s47, s44, 14
    s_add_u32 s48, s48, 24576
    s_cmp_eq_u32 s44, 3
    s_cselect_b32 s47, 147456, s47
    s_cselect_b32 s48, 49152, s48
    s_barrier
    s_lshl_b32 s52, s39, 2
    s_and_b32 s53, s41, 1
    s_lshl_b32 s53, s53, 1
    s_add_u32 s52, s52, s53
    s_add_u32 s52, s52, s37
    s_lshl_b32 s53, s40, 1
    s_lshr_b32 s54, s41, 1
    s_add_u32 s53, s53, s54
    s_mul_i32 s53, s53, 192
    s_mul_i32 s54, s38, 96
    s_add_u32 s53, s53, s54
    v_lshlrev_b32 v16, 7, v30
    v_add_u32 v16, s52, v16
    v_mul_u32_u24 v16, 1152, v16
    v_lshl_add_u32 v17, v31, 3, s53
    v_add_u32 v16, v16, v17
    s_mov_b32 s45, 73728
    buffer_load_dwordx2 v[232:233], v16, s[28:31], 0 offen offset:0
    buffer_load_dwordx2 v[234:235], v16, s[28:31], 0 offen offset:32
    buffer_load_dwordx2 v[236:237], v16, s[28:31], 0 offen offset:64
    buffer_load_dwordx2 v[238:239], v16, s[28:31], s45 offen offset:0
    buffer_load_dwordx2 v[240:241], v16, s[28:31], s45 offen offset:32
    buffer_load_dwordx2 v[242:243], v16, s[28:31], s45 offen offset:64
    s_lshr_b32 s52, s52, 1
    s_mul_i32 s52, s52, 73984
    s_lshl_b32 s53, s37, 6
    s_add_u32 s52, s52, s53
    s_add_u32 s50, s52, 73728
    ds_read_b128 v[32:35], v21 offset:0
    ds_read_b64_tr_b16 v[48:49], v23 offset:0
    ds_read_b64_tr_b16 v[50:51], v23 offset:512
    ds_read_b64_tr_b16 v[52:53], v24 offset:0
    ds_read_b64_tr_b16 v[54:55], v24 offset:512
    ds_read_b64_tr_b16 v[56:57], v25 offset:0
    ds_read_b64_tr_b16 v[58:59], v25 offset:512
    ds_read_b64_tr_b16 v[60:61], v26 offset:0
    ds_read_b64_tr_b16 v[62:63], v26 offset:512
    ds_read_b64_tr_b16 v[64:65], v27 offset:0
    ds_read_b64_tr_b16 v[66:67], v27 offset:512
    ds_read_b64_tr_b16 v[68:69], v28 offset:0
    ds_read_b64_tr_b16 v[70:71], v28 offset:512
    ds_read_b128 v[36:39], v21 offset:1024
    ds_read_b128 v[40:43], v21 offset:2048
    ds_read_b128 v[44:47], v21 offset:3072
    s_mov_b32 s43, 0
    s_waitcnt lgkmcnt(0)
    v_mfma_f32_16x16x32_bf16 v[112:115], v[48:51], v[32:35], 0
    ds_read_b128 v[72:75], v22 offset:0
    v_mfma_f32_16x16x32_bf16 v[116:119], v[52:55], v[32:35], 0
    ds_read_b64_tr_b16 v[88:89], v23 offset:4096
    v_mfma_f32_16x16x32_bf16 v[120:123], v[56:59], v[32:35], 0
    ds_read_b64_tr_b16 v[90:91], v23 offset:4608
    v_mfma_f32_16x16x32_bf16 v[124:127], v[60:63], v[32:35], 0
    ds_read_b64_tr_b16 v[92:93], v24 offset:4096
    v_mfma_f32_16x16x32_bf16 v[128:131], v[64:67], v[32:35], 0
    ds_read_b64_tr_b16 v[94:95], v24 offset:4608
    v_mfma_f32_16x16x32_bf16 v[132:135], v[68:71], v[32:35], 0
    ds_read_b64_tr_b16 v[96:97], v25 offset:4096
    v_mfma_f32_16x16x32_bf16 v[136:139], v[48:51], v[36:39], 0
    ds_read_b64_tr_b16 v[98:99], v25 offset:4608
    v_mfma_f32_16x16x32_bf16 v[140:143], v[52:55], v[36:39], 0
    ds_read_b64_tr_b16 v[100:101], v26 offset:4096
    v_mfma_f32_16x16x32_bf16 v[144:147], v[56:59], v[36:39], 0
    ds_read_b64_tr_b16 v[102:103], v26 offset:4608
    v_mfma_f32_16x16x32_bf16 v[148:151], v[60:63], v[36:39], 0
    ds_read_b64_tr_b16 v[104:105], v27 offset:4096
    v_mfma_f32_16x16x32_bf16 v[152:155], v[64:67], v[36:39], 0
    ds_read_b64_tr_b16 v[106:107], v27 offset:4608
    v_mfma_f32_16x16x32_bf16 v[156:159], v[68:71], v[36:39], 0
    ds_read_b64_tr_b16 v[108:109], v28 offset:4096
    v_mfma_f32_16x16x32_bf16 v[160:163], v[48:51], v[40:43], 0
    ds_read_b64_tr_b16 v[110:111], v28 offset:4608
    v_mfma_f32_16x16x32_bf16 v[164:167], v[52:55], v[40:43], 0
    ds_read_b128 v[76:79], v22 offset:1024
    v_mfma_f32_16x16x32_bf16 v[168:171], v[56:59], v[40:43], 0
    ds_read_b128 v[80:83], v22 offset:2048
    v_mfma_f32_16x16x32_bf16 v[172:175], v[60:63], v[40:43], 0
    ds_read_b128 v[84:87], v22 offset:3072
    v_mfma_f32_16x16x32_bf16 v[176:179], v[64:67], v[40:43], 0
    v_mfma_f32_16x16x32_bf16 v[180:183], v[68:71], v[40:43], 0
    v_mfma_f32_16x16x32_bf16 v[184:187], v[48:51], v[44:47], 0
    v_mfma_f32_16x16x32_bf16 v[188:191], v[52:55], v[44:47], 0
    v_mfma_f32_16x16x32_bf16 v[192:195], v[56:59], v[44:47], 0
    v_mfma_f32_16x16x32_bf16 v[196:199], v[60:63], v[44:47], 0
    v_mfma_f32_16x16x32_bf16 v[200:203], v[64:67], v[44:47], 0
    v_mfma_f32_16x16x32_bf16 v[204:207], v[68:71], v[44:47], 0
    s_waitcnt lgkmcnt(0)
    v_mfma_f32_16x16x32_bf16 v[112:115], v[88:91], v[72:75], v[112:115]
    v_add_u32 v21, s47, v2
    v_add_u32 v22, s47, v3
    v_add_u32 v23, s48, v4
    v_add_u32 v24, s48, v5
    v_mfma_f32_16x16x32_bf16 v[116:119], v[92:95], v[72:75], v[116:119]
    v_add_u32 v25, s48, v6
    v_add_u32 v26, s48, v7
    v_add_u32 v27, s48, v8
    v_add_u32 v28, s48, v9
    s_add_u32 s44, s44, 1
    s_and_b32 s44, s44, 3
    s_lshl_b32 s47, s44, 14
    s_add_u32 s48, s48, 24576
    s_cmp_eq_u32 s44, 3
    s_cselect_b32 s47, 147456, s47
    s_cselect_b32 s48, 49152, s48
    s_waitcnt vmcnt(6)
    s_barrier
    v_mfma_f32_16x16x32_bf16 v[120:123], v[96:99], v[72:75], v[120:123]
    ds_read_b128 v[32:35], v21 offset:0
    v_mfma_f32_16x16x32_bf16 v[124:127], v[100:103], v[72:75], v[124:127]
    ds_read_b64_tr_b16 v[48:49], v23 offset:0
    v_mfma_f32_16x16x32_bf16 v[128:131], v[104:107], v[72:75], v[128:131]
    ds_read_b64_tr_b16 v[50:51], v23 offset:512
    v_mfma_f32_16x16x32_bf16 v[132:135], v[108:111], v[72:75], v[132:135]
    ds_read_b64_tr_b16 v[52:53], v24 offset:0
    v_mfma_f32_16x16x32_bf16 v[136:139], v[88:91], v[76:79], v[136:139]
    ds_read_b64_tr_b16 v[54:55], v24 offset:512
    v_mfma_f32_16x16x32_bf16 v[140:143], v[92:95], v[76:79], v[140:143]
    ds_read_b64_tr_b16 v[56:57], v25 offset:0
    v_mfma_f32_16x16x32_bf16 v[144:147], v[96:99], v[76:79], v[144:147]
    ds_read_b64_tr_b16 v[58:59], v25 offset:512
    v_mfma_f32_16x16x32_bf16 v[148:151], v[100:103], v[76:79], v[148:151]
    ds_read_b64_tr_b16 v[60:61], v26 offset:0
    v_mfma_f32_16x16x32_bf16 v[152:155], v[104:107], v[76:79], v[152:155]
    ds_read_b64_tr_b16 v[62:63], v26 offset:512
    v_mfma_f32_16x16x32_bf16 v[156:159], v[108:111], v[76:79], v[156:159]
    ds_read_b64_tr_b16 v[64:65], v27 offset:0
    v_mfma_f32_16x16x32_bf16 v[160:163], v[88:91], v[80:83], v[160:163]
    ds_read_b64_tr_b16 v[66:67], v27 offset:512
    v_mfma_f32_16x16x32_bf16 v[164:167], v[92:95], v[80:83], v[164:167]
    ds_read_b64_tr_b16 v[68:69], v28 offset:0
    v_mfma_f32_16x16x32_bf16 v[168:171], v[96:99], v[80:83], v[168:171]
    ds_read_b64_tr_b16 v[70:71], v28 offset:512
    v_mfma_f32_16x16x32_bf16 v[172:175], v[100:103], v[80:83], v[172:175]
    ds_read_b128 v[36:39], v21 offset:1024
    v_mfma_f32_16x16x32_bf16 v[176:179], v[104:107], v[80:83], v[176:179]
    ds_read_b128 v[40:43], v21 offset:2048
    v_mfma_f32_16x16x32_bf16 v[180:183], v[108:111], v[80:83], v[180:183]
    ds_read_b128 v[44:47], v21 offset:3072
    v_mfma_f32_16x16x32_bf16 v[184:187], v[88:91], v[84:87], v[184:187]
    v_mfma_f32_16x16x32_bf16 v[188:191], v[92:95], v[84:87], v[188:191]
    v_mfma_f32_16x16x32_bf16 v[192:195], v[96:99], v[84:87], v[192:195]
    v_mfma_f32_16x16x32_bf16 v[196:199], v[100:103], v[84:87], v[196:199]
    v_mfma_f32_16x16x32_bf16 v[200:203], v[104:107], v[84:87], v[200:203]
    v_mfma_f32_16x16x32_bf16 v[204:207], v[108:111], v[84:87], v[204:207]
    s_cmp_lg_u32 s36, 0
    s_cbranch_scc1 mg_pub_114
    s_add_u32 s52, s57, s78
    v_mov_b32 v12, s52
    v_mov_b32 v13, 0
    buffer_store_dword v12, v13, s[96:99], s79 offen sc1
mg_pub_114:
    s_mov_b32 s43, 1
g2_hl_115:
    s_waitcnt lgkmcnt(0)
    v_mfma_f32_16x16x32_bf16 v[112:115], v[48:51], v[32:35], v[112:115]
    ds_read_b128 v[72:75], v22 offset:0
    v_mfma_f32_16x16x32_bf16 v[116:119], v[52:55], v[32:35], v[116:119]
    ds_read_b64_tr_b16 v[88:89], v23 offset:4096
    v_mfma_f32_16x16x32_bf16 v[120:123], v[56:59], v[32:35], v[120:123]
    ds_read_b64_tr_b16 v[90:91], v23 offset:4608
    v_mfma_f32_16x16x32_bf16 v[124:127], v[60:63], v[32:35], v[124:127]
    ds_read_b64_tr_b16 v[92:93], v24 offset:4096
    v_mfma_f32_16x16x32_bf16 v[128:131], v[64:67], v[32:35], v[128:131]
    ds_read_b64_tr_b16 v[94:95], v24 offset:4608
    v_mfma_f32_16x16x32_bf16 v[132:135], v[68:71], v[32:35], v[132:135]
    ds_read_b64_tr_b16 v[96:97], v25 offset:4096
    v_mfma_f32_16x16x32_bf16 v[136:139], v[48:51], v[36:39], v[136:139]
    ds_read_b64_tr_b16 v[98:99], v25 offset:4608
    v_mfma_f32_16x16x32_bf16 v[140:143], v[52:55], v[36:39], v[140:143]
    ds_read_b64_tr_b16 v[100:101], v26 offset:4096
    v_mfma_f32_16x16x32_bf16 v[144:147], v[56:59], v[36:39], v[144:147]
    ds_read_b64_tr_b16 v[102:103], v26 offset:4608
    v_mfma_f32_16x16x32_bf16 v[148:151], v[60:63], v[36:39], v[148:151]
    ds_read_b64_tr_b16 v[104:105], v27 offset:4096
    v_mfma_f32_16x16x32_bf16 v[152:155], v[64:67], v[36:39], v[152:155]
    ds_read_b64_tr_b16 v[106:107], v27 offset:4608
    v_mfma_f32_16x16x32_bf16 v[156:159], v[68:71], v[36:39], v[156:159]
    ds_read_b64_tr_b16 v[108:109], v28 offset:4096
    v_mfma_f32_16x16x32_bf16 v[160:163], v[48:51], v[40:43], v[160:163]
    ds_read_b64_tr_b16 v[110:111], v28 offset:4608
    v_mfma_f32_16x16x32_bf16 v[164:167], v[52:55], v[40:43], v[164:167]
    ds_read_b128 v[76:79], v22 offset:1024
    v_mfma_f32_16x16x32_bf16 v[168:171], v[56:59], v[40:43], v[168:171]
    ds_read_b128 v[80:83], v22 offset:2048
    v_mfma_f32_16x16x32_bf16 v[172:175], v[60:63], v[40:43], v[172:175]
    ds_read_b128 v[84:87], v22 offset:3072
    v_mfma_f32_16x16x32_bf16 v[176:179], v[64:67], v[40:43], v[176:179]
    v_mfma_f32_16x16x32_bf16 v[180:183], v[68:71], v[40:43], v[180:183]
    v_mfma_f32_16x16x32_bf16 v[184:187], v[48:51], v[44:47], v[184:187]
    v_mfma_f32_16x16x32_bf16 v[188:191], v[52:55], v[44:47], v[188:191]
    v_mfma_f32_16x16x32_bf16 v[192:195], v[56:59], v[44:47], v[192:195]
    v_mfma_f32_16x16x32_bf16 v[196:199], v[60:63], v[44:47], v[196:199]
    v_mfma_f32_16x16x32_bf16 v[200:203], v[64:67], v[44:47], v[200:203]
    v_mfma_f32_16x16x32_bf16 v[204:207], v[68:71], v[44:47], v[204:207]
    s_waitcnt lgkmcnt(0)
    v_mfma_f32_16x16x32_bf16 v[112:115], v[88:91], v[72:75], v[112:115]
    v_add_u32 v21, s47, v2
    v_add_u32 v22, s47, v3
    v_add_u32 v23, s48, v4
    v_add_u32 v24, s48, v5
    v_mfma_f32_16x16x32_bf16 v[116:119], v[92:95], v[72:75], v[116:119]
    v_add_u32 v25, s48, v6
    v_add_u32 v26, s48, v7
    v_add_u32 v27, s48, v8
    v_add_u32 v28, s48, v9
    s_add_u32 s44, s44, 1
    s_and_b32 s44, s44, 3
    s_lshl_b32 s47, s44, 14
    s_add_u32 s48, s48, 24576
    s_cmp_eq_u32 s44, 3
    s_cselect_b32 s47, 147456, s47
    s_cselect_b32 s48, 49152, s48
    s_barrier
    v_mfma_f32_16x16x32_bf16 v[120:123], v[96:99], v[72:75], v[120:123]
    ds_read_b128 v[32:35], v21 offset:0
    v_mfma_f32_16x16x32_bf16 v[124:127], v[100:103], v[72:75], v[124:127]
    ds_read_b64_tr_b16 v[48:49], v23 offset:0
    v_mfma_f32_16x16x32_bf16 v[128:131], v[104:107], v[72:75], v[128:131]
    ds_read_b64_tr_b16 v[50:51], v23 offset:512
    v_mfma_f32_16x16x32_bf16 v[132:135], v[108:111], v[72:75], v[132:135]
    ds_read_b64_tr_b16 v[52:53], v24 offset:0
    v_mfma_f32_16x16x32_bf16 v[136:139], v[88:91], v[76:79], v[136:139]
    ds_read_b64_tr_b16 v[54:55], v24 offset:512
    v_mfma_f32_16x16x32_bf16 v[140:143], v[92:95], v[76:79], v[140:143]
    ds_read_b64_tr_b16 v[56:57], v25 offset:0
    v_mfma_f32_16x16x32_bf16 v[144:147], v[96:99], v[76:79], v[144:147]
    ds_read_b64_tr_b16 v[58:59], v25 offset:512
    v_mfma_f32_16x16x32_bf16 v[148:151], v[100:103], v[76:79], v[148:151]
    ds_read_b64_tr_b16 v[60:61], v26 offset:0
    v_mfma_f32_16x16x32_bf16 v[152:155], v[104:107], v[76:79], v[152:155]
    ds_read_b64_tr_b16 v[62:63], v26 offset:512
    v_mfma_f32_16x16x32_bf16 v[156:159], v[108:111], v[76:79], v[156:159]
    ds_read_b64_tr_b16 v[64:65], v27 offset:0
    v_mfma_f32_16x16x32_bf16 v[160:163], v[88:91], v[80:83], v[160:163]
    ds_read_b64_tr_b16 v[66:67], v27 offset:512
    v_mfma_f32_16x16x32_bf16 v[164:167], v[92:95], v[80:83], v[164:167]
    ds_read_b64_tr_b16 v[68:69], v28 offset:0
    v_mfma_f32_16x16x32_bf16 v[168:171], v[96:99], v[80:83], v[168:171]
    ds_read_b64_tr_b16 v[70:71], v28 offset:512
    v_mfma_f32_16x16x32_bf16 v[172:175], v[100:103], v[80:83], v[172:175]
    ds_read_b128 v[36:39], v21 offset:1024
    v_mfma_f32_16x16x32_bf16 v[176:179], v[104:107], v[80:83], v[176:179]
    ds_read_b128 v[40:43], v21 offset:2048
    v_mfma_f32_16x16x32_bf16 v[180:183], v[108:111], v[80:83], v[180:183]
    ds_read_b128 v[44:47], v21 offset:3072
    v_mfma_f32_16x16x32_bf16 v[184:187], v[88:91], v[84:87], v[184:187]
    v_mfma_f32_16x16x32_bf16 v[188:191], v[92:95], v[84:87], v[188:191]
    v_mfma_f32_16x16x32_bf16 v[192:195], v[96:99], v[84:87], v[192:195]
    v_mfma_f32_16x16x32_bf16 v[196:199], v[100:103], v[84:87], v[196:199]
    v_mfma_f32_16x16x32_bf16 v[200:203], v[104:107], v[84:87], v[200:203]
    v_mfma_f32_16x16x32_bf16 v[204:207], v[108:111], v[84:87], v[204:207]
    s_add_u32 s43, s43, 1
    s_cmp_lt_u32 s43, 17
    s_cbranch_scc1 g2_hl_115
    s_waitcnt lgkmcnt(0)
    v_mfma_f32_16x16x32_bf16 v[112:115], v[48:51], v[32:35], v[112:115]
    ds_read_b128 v[72:75], v22 offset:0
    v_mfma_f32_16x16x32_bf16 v[116:119], v[52:55], v[32:35], v[116:119]
    ds_read_b64_tr_b16 v[88:89], v23 offset:4096
    v_mfma_f32_16x16x32_bf16 v[120:123], v[56:59], v[32:35], v[120:123]
    ds_read_b64_tr_b16 v[90:91], v23 offset:4608
    v_mfma_f32_16x16x32_bf16 v[124:127], v[60:63], v[32:35], v[124:127]
    ds_read_b64_tr_b16 v[92:93], v24 offset:4096
    v_mfma_f32_16x16x32_bf16 v[128:131], v[64:67], v[32:35], v[128:131]
    ds_read_b64_tr_b16 v[94:95], v24 offset:4608
    v_mfma_f32_16x16x32_bf16 v[132:135], v[68:71], v[32:35], v[132:135]
    ds_read_b64_tr_b16 v[96:97], v25 offset:4096
    v_mfma_f32_16x16x32_bf16 v[136:139], v[48:51], v[36:39], v[136:139]
    ds_read_b64_tr_b16 v[98:99], v25 offset:4608
    v_mfma_f32_16x16x32_bf16 v[140:143], v[52:55], v[36:39], v[140:143]
    ds_read_b64_tr_b16 v[100:101], v26 offset:4096
    v_mfma_f32_16x16x32_bf16 v[144:147], v[56:59], v[36:39], v[144:147]
    ds_read_b64_tr_b16 v[102:103], v26 offset:4608
    v_mfma_f32_16x16x32_bf16 v[148:151], v[60:63], v[36:39], v[148:151]
    ds_read_b64_tr_b16 v[104:105], v27 offset:4096
    v_mfma_f32_16x16x32_bf16 v[152:155], v[64:67], v[36:39], v[152:155]
    ds_read_b64_tr_b16 v[106:107], v27 offset:4608
    v_mfma_f32_16x16x32_bf16 v[156:159], v[68:71], v[36:39], v[156:159]
    ds_read_b64_tr_b16 v[108:109], v28 offset:4096
    v_mfma_f32_16x16x32_bf16 v[160:163], v[48:51], v[40:43], v[160:163]
    ds_read_b64_tr_b16 v[110:111], v28 offset:4608
    v_mfma_f32_16x16x32_bf16 v[164:167], v[52:55], v[40:43], v[164:167]
    ds_read_b128 v[76:79], v22 offset:1024
    v_mfma_f32_16x16x32_bf16 v[168:171], v[56:59], v[40:43], v[168:171]
    ds_read_b128 v[80:83], v22 offset:2048
    v_mfma_f32_16x16x32_bf16 v[172:175], v[60:63], v[40:43], v[172:175]
    ds_read_b128 v[84:87], v22 offset:3072
    v_mfma_f32_16x16x32_bf16 v[176:179], v[64:67], v[40:43], v[176:179]
    v_mfma_f32_16x16x32_bf16 v[180:183], v[68:71], v[40:43], v[180:183]
    v_mfma_f32_16x16x32_bf16 v[184:187], v[48:51], v[44:47], v[184:187]
    v_mfma_f32_16x16x32_bf16 v[188:191], v[52:55], v[44:47], v[188:191]
    v_mfma_f32_16x16x32_bf16 v[192:195], v[56:59], v[44:47], v[192:195]
    v_mfma_f32_16x16x32_bf16 v[196:199], v[60:63], v[44:47], v[196:199]
    v_mfma_f32_16x16x32_bf16 v[200:203], v[64:67], v[44:47], v[200:203]
    v_mfma_f32_16x16x32_bf16 v[204:207], v[68:71], v[44:47], v[204:207]
    s_waitcnt lgkmcnt(0)
    v_mfma_f32_16x16x32_bf16 v[112:115], v[88:91], v[72:75], v[112:115]
    v_add_u32 v21, s47, v10
    v_add_u32 v22, s47, v11
    v_add_u32 v23, s48, v18
    v_add_u32 v24, s48, v19
    v_mfma_f32_16x16x32_bf16 v[116:119], v[92:95], v[72:75], v[116:119]
    v_add_u32 v25, s48, v20
    s_add_u32 s44, s44, 1
    s_and_b32 s44, s44, 3
    s_lshl_b32 s47, s44, 14
    s_add_u32 s48, s48, 24576
    s_cmp_eq_u32 s44, 3
    s_cselect_b32 s47, 147456, s47
    s_cselect_b32 s48, 49152, s48
    s_barrier
    v_mfma_f32_16x16x32_bf16 v[120:123], v[96:99], v[72:75], v[120:123]
    ds_read_b64_tr_b16 v[32:33], v21 offset:0
    v_mfma_f32_16x16x32_bf16 v[124:127], v[100:103], v[72:75], v[124:127]
    ds_read_b64_tr_b16 v[34:35], v21 offset:512
    v_mfma_f32_16x16x32_bf16 v[128:131], v[104:107], v[72:75], v[128:131]
    ds_read_b64_tr_b16 v[36:37], v22 offset:0
    v_mfma_f32_16x16x32_bf16 v[132:135], v[108:111], v[72:75], v[132:135]
    ds_read_b64_tr_b16 v[38:39], v22 offset:512
    v_mfma_f32_16x16x32_bf16 v[136:139], v[88:91], v[76:79], v[136:139]
    ds_read_b64_tr_b16 v[48:49], v23 offset:0
    v_mfma_f32_16x16x32_bf16 v[140:143], v[92:95], v[76:79], v[140:143]
    ds_read_b64_tr_b16 v[50:51], v23 offset:768
    v_mfma_f32_16x16x32_bf16 v[144:147], v[96:99], v[76:79], v[144:147]
    ds_read_b64_tr_b16 v[52:53], v24 offset:0
    v_mfma_f32_16x16x32_bf16 v[148:151], v[100:103], v[76:79], v[148:151]
    ds_read_b64_tr_b16 v[54:55], v24 offset:768
    v_mfma_f32_16x16x32_bf16 v[152:155], v[104:107], v[76:79], v[152:155]
    ds_read_b64_tr_b16 v[56:57], v25 offset:0
    v_mfma_f32_16x16x32_bf16 v[156:159], v[108:111], v[76:79], v[156:159]
    ds_read_b64_tr_b16 v[58:59], v25 offset:768
    v_mfma_f32_16x16x32_bf16 v[160:163], v[88:91], v[80:83], v[160:163]
    v_mfma_f32_16x16x32_bf16 v[164:167], v[92:95], v[80:83], v[164:167]
    v_mfma_f32_16x16x32_bf16 v[168:171], v[96:99], v[80:83], v[168:171]
    v_mfma_f32_16x16x32_bf16 v[172:175], v[100:103], v[80:83], v[172:175]
    v_mfma_f32_16x16x32_bf16 v[176:179], v[104:107], v[80:83], v[176:179]
    v_mfma_f32_16x16x32_bf16 v[180:183], v[108:111], v[80:83], v[180:183]
    v_mfma_f32_16x16x32_bf16 v[184:187], v[88:91], v[84:87], v[184:187]
    v_mfma_f32_16x16x32_bf16 v[188:191], v[92:95], v[84:87], v[188:191]
    v_mfma_f32_16x16x32_bf16 v[192:195], v[96:99], v[84:87], v[192:195]
    v_mfma_f32_16x16x32_bf16 v[196:199], v[100:103], v[84:87], v[196:199]
    v_mfma_f32_16x16x32_bf16 v[200:203], v[104:107], v[84:87], v[200:203]
    v_mfma_f32_16x16x32_bf16 v[204:207], v[108:111], v[84:87], v[204:207]
    v_lshlrev_b32 v29, 4, v0
    s_lshl_b32 s52, s49, 2
    s_add_u32 s52, s52, s36
    s_lshl_b32 s52, s52, 2
    s_add_u32 s46, s52, s41
    s_cmp_eq_u32 s36, s41
    s_cbranch_scc1 g2_own_116
    s_lshl_b32 s52, s46, 14
    v_mov_b32 v75, s57
    v_mov_b32 v79, s57
    v_mov_b32 v83, s57
    v_mov_b32 v87, s57
    v_cvt_pk_bf16_f32 v72, v112, v113
    v_cvt_pk_bf16_f32 v73, v114, v115
    v_cvt_pk_bf16_f32 v74, v116, v117
    v_cvt_pk_bf16_f32 v76, v118, v119
    v_cvt_pk_bf16_f32 v77, v120, v121
    v_cvt_pk_bf16_f32 v78, v122, v123
    v_cvt_pk_bf16_f32 v80, v136, v137
    v_cvt_pk_bf16_f32 v81, v138, v139
    v_cvt_pk_bf16_f32 v82, v140, v141
    v_cvt_pk_bf16_f32 v84, v142, v143
    v_cvt_pk_bf16_f32 v85, v144, v145
    v_cvt_pk_bf16_f32 v86, v146, v147
    s_add_u32 s53, s52, 0
    buffer_store_dwordx4 v[72:75], v29, s[24:27], s53 offen offset:0 sc1
    buffer_store_dwordx4 v[76:79], v29, s[24:27], s53 offen offset:1024 sc1
    buffer_store_dwordx4 v[80:83], v29, s[24:27], s53 offen offset:2048 sc1
    buffer_store_dwordx4 v[84:87], v29, s[24:27], s53 offen offset:3072 sc1
    v_mov_b32 v91, s57
    v_mov_b32 v95, s57
    v_mov_b32 v99, s57
    v_mov_b32 v103, s57
    v_cvt_pk_bf16_f32 v88, v160, v161
    v_cvt_pk_bf16_f32 v89, v162, v163
    v_cvt_pk_bf16_f32 v90, v164, v165
    v_cvt_pk_bf16_f32 v92, v166, v167
    v_cvt_pk_bf16_f32 v93, v168, v169
    v_cvt_pk_bf16_f32 v94, v170, v171
    v_cvt_pk_bf16_f32 v96, v184, v185
    v_cvt_pk_bf16_f32 v97, v186, v187
    v_cvt_pk_bf16_f32 v98, v188, v189
    v_cvt_pk_bf16_f32 v100, v190, v191
    v_cvt_pk_bf16_f32 v101, v192, v193
    v_cvt_pk_bf16_f32 v102, v194, v195
    s_add_u32 s53, s52, 4096
    buffer_store_dwordx4 v[88:91], v29, s[24:27], s53 offen offset:0 sc1
    buffer_store_dwordx4 v[92:95], v29, s[24:27], s53 offen offset:1024 sc1
    buffer_store_dwordx4 v[96:99], v29, s[24:27], s53 offen offset:2048 sc1
    buffer_store_dwordx4 v[100:103], v29, s[24:27], s53 offen offset:3072 sc1
    v_mov_b32 v75, s57
    v_mov_b32 v79, s57
    v_mov_b32 v83, s57
    v_mov_b32 v87, s57
    v_cvt_pk_bf16_f32 v72, v124, v125
    v_cvt_pk_bf16_f32 v73, v126, v127
    v_cvt_pk_bf16_f32 v74, v128, v129
    v_cvt_pk_bf16_f32 v76, v130, v131
    v_cvt_pk_bf16_f32 v77, v132, v133
    v_cvt_pk_bf16_f32 v78, v134, v135
    v_cvt_pk_bf16_f32 v80, v148, v149
    v_cvt_pk_bf16_f32 v81, v150, v151
    v_cvt_pk_bf16_f32 v82, v152, v153
    v_cvt_pk_bf16_f32 v84, v154, v155
    v_cvt_pk_bf16_f32 v85, v156, v157
    v_cvt_pk_bf16_f32 v86, v158, v159
    s_add_u32 s53, s52, 8192
    buffer_store_dwordx4 v[72:75], v29, s[24:27], s53 offen offset:0 sc1
    buffer_store_dwordx4 v[76:79], v29, s[24:27], s53 offen offset:1024 sc1
    buffer_store_dwordx4 v[80:83], v29, s[24:27], s53 offen offset:2048 sc1
    buffer_store_dwordx4 v[84:87], v29, s[24:27], s53 offen offset:3072 sc1
    v_mov_b32 v91, s57
    v_mov_b32 v95, s57
    v_mov_b32 v99, s57
    v_mov_b32 v103, s57
    v_cvt_pk_bf16_f32 v88, v172, v173
    v_cvt_pk_bf16_f32 v89, v174, v175
    v_cvt_pk_bf16_f32 v90, v176, v177
    v_cvt_pk_bf16_f32 v92, v178, v179
    v_cvt_pk_bf16_f32 v93, v180, v181
    v_cvt_pk_bf16_f32 v94, v182, v183
    v_cvt_pk_bf16_f32 v96, v196, v197
    v_cvt_pk_bf16_f32 v97, v198, v199
    v_cvt_pk_bf16_f32 v98, v200, v201
    v_cvt_pk_bf16_f32 v100, v202, v203
    v_cvt_pk_bf16_f32 v101, v204, v205
    v_cvt_pk_bf16_f32 v102, v206, v207
    s_add_u32 s53, s52, 12288
    buffer_store_dwordx4 v[88:91], v29, s[24:27], s53 offen offset:0 sc1
    buffer_store_dwordx4 v[92:95], v29, s[24:27], s53 offen offset:1024 sc1
    buffer_store_dwordx4 v[96:99], v29, s[24:27], s53 offen offset:2048 sc1
    buffer_store_dwordx4 v[100:103], v29, s[24:27], s53 offen offset:3072 sc1
    s_branch g2_j_117
g2_own_116:
    v_add_u32 v1, 98304, v29
    ds_write_b128 v1, v[112:115] offset:0
    ds_write_b128 v1, v[116:119] offset:1024
    ds_write_b128 v1, v[120:123] offset:2048
    ds_write_b128 v1, v[136:139] offset:3072
    ds_write_b128 v1, v[140:143] offset:4096
    ds_write_b128 v1, v[144:147] offset:5120
    ds_write_b128 v1, v[160:163] offset:6144
    ds_write_b128 v1, v[164:167] offset:7168
    ds_write_b128 v1, v[168:171] offset:8192
    ds_write_b128 v1, v[184:187] offset:9216
    ds_write_b128 v1, v[188:191] offset:10240
    ds_write_b128 v1, v[192:195] offset:11264
    ds_write_b128 v1, v[124:127] offset:12288
    ds_write_b128 v1, v[128:131] offset:13312
    ds_write_b128 v1, v[132:135] offset:14336
    ds_write_b128 v1, v[148:151] offset:15360
    ds_write_b128 v1, v[152:155] offset:16384
    ds_write_b128 v1, v[156:159] offset:17408
    ds_write_b128 v1, v[172:175] offset:18432
    ds_write_b128 v1, v[176:179] offset:19456
    ds_write_b128 v1, v[180:183] offset:20480
    ds_write_b128 v1, v[196:199] offset:21504
    ds_write_b128 v1, v[200:203] offset:22528
    ds_write_b128 v1, v[204:207] offset:23552
g2_j_117:
    s_waitcnt lgkmcnt(0)
    v_mfma_f32_16x16x32_bf16 v[208:211], v[48:51], v[32:35], 0
    ds_read_b64_tr_b16 v[72:73], v21 offset:4096
    ds_read_b64_tr_b16 v[74:75], v21 offset:4608
    v_mfma_f32_16x16x32_bf16 v[212:215], v[52:55], v[32:35], 0
    ds_read_b64_tr_b16 v[76:77], v22 offset:4096
    ds_read_b64_tr_b16 v[78:79], v22 offset:4608
    v_mfma_f32_16x16x32_bf16 v[216:219], v[56:59], v[32:35], 0
    ds_read_b64_tr_b16 v[88:89], v23 offset:6144
    ds_read_b64_tr_b16 v[90:91], v23 offset:6912
    v_mfma_f32_16x16x32_bf16 v[220:223], v[48:51], v[36:39], 0
    ds_read_b64_tr_b16 v[92:93], v24 offset:6144
    ds_read_b64_tr_b16 v[94:95], v24 offset:6912
    v_mfma_f32_16x16x32_bf16 v[224:227], v[52:55], v[36:39], 0
    ds_read_b64_tr_b16 v[96:97], v25 offset:6144
    ds_read_b64_tr_b16 v[98:99], v25 offset:6912
    v_mfma_f32_16x16x32_bf16 v[228:231], v[56:59], v[36:39], 0
    s_waitcnt lgkmcnt(0)
    v_mfma_f32_16x16x32_bf16 v[208:211], v[88:91], v[72:75], v[208:211]
    v_add_u32 v21, 40960, v10
    v_add_u32 v22, 40960, v11
    v_add_u32 v23, 135168, v18
    v_add_u32 v24, 135168, v19
    v_add_u32 v25, 135168, v20
    v_mfma_f32_16x16x32_bf16 v[212:215], v[92:95], v[72:75], v[212:215]
    ds_read_b64_tr_b16 v[32:33], v21 offset:0
    ds_read_b64_tr_b16 v[34:35], v21 offset:512
    v_mfma_f32_16x16x32_bf16 v[216:219], v[96:99], v[72:75], v[216:219]
    ds_read_b64_tr_b16 v[36:37], v22 offset:0
    ds_read_b64_tr_b16 v[38:39], v22 offset:512
    v_mfma_f32_16x16x32_bf16 v[220:223], v[88:91], v[76:79], v[220:223]
    ds_read_b64_tr_b16 v[48:49], v23 offset:0
    ds_read_b64_tr_b16 v[50:51], v23 offset:768
    v_mfma_f32_16x16x32_bf16 v[224:227], v[92:95], v[76:79], v[224:227]
    ds_read_b64_tr_b16 v[52:53], v24 offset:0
    ds_read_b64_tr_b16 v[54:55], v24 offset:768
    v_mfma_f32_16x16x32_bf16 v[228:231], v[96:99], v[76:79], v[228:231]
    ds_read_b64_tr_b16 v[56:57], v25 offset:0
    ds_read_b64_tr_b16 v[58:59], v25 offset:768
    s_waitcnt lgkmcnt(0)
    v_mfma_f32_16x16x32_bf16 v[208:211], v[48:51], v[32:35], v[208:211]
    ds_read_b64_tr_b16 v[72:73], v21 offset:4096
    ds_read_b64_tr_b16 v[74:75], v21 offset:4608
    v_mfma_f32_16x16x32_bf16 v[212:215], v[52:55], v[32:35], v[212:215]
    ds_read_b64_tr_b16 v[76:77], v22 offset:4096
    ds_read_b64_tr_b16 v[78:79], v22 offset:4608
    v_mfma_f32_16x16x32_bf16 v[216:219], v[56:59], v[32:35], v[216:219]
    ds_read_b64_tr_b16 v[88:89], v23 offset:6144
    ds_read_b64_tr_b16 v[90:91], v23 offset:6912
    v_mfma_f32_16x16x32_bf16 v[220:223], v[48:51], v[36:39], v[220:223]
    ds_read_b64_tr_b16 v[92:93], v24 offset:6144
    ds_read_b64_tr_b16 v[94:95], v24 offset:6912
    v_mfma_f32_16x16x32_bf16 v[224:227], v[52:55], v[36:39], v[224:227]
    ds_read_b64_tr_b16 v[96:97], v25 offset:6144
    ds_read_b64_tr_b16 v[98:99], v25 offset:6912
    v_mfma_f32_16x16x32_bf16 v[228:231], v[56:59], v[36:39], v[228:231]
    s_waitcnt lgkmcnt(0)
    v_mfma_f32_16x16x32_bf16 v[208:211], v[88:91], v[72:75], v[208:211]
    v_add_u32 v21, 147456, v10
    v_add_u32 v22, 147456, v11
    v_add_u32 v23, 49152, v18
    v_add_u32 v24, 49152, v19
    v_add_u32 v25, 49152, v20
    s_barrier
    v_mfma_f32_16x16x32_bf16 v[212:215], v[92:95], v[72:75], v[212:215]
    ds_read_b64_tr_b16 v[32:33], v21 offset:0
    ds_read_b64_tr_b16 v[34:35], v21 offset:512
    v_mfma_f32_16x16x32_bf16 v[216:219], v[96:99], v[72:75], v[216:219]
    ds_read_b64_tr_b16 v[36:37], v22 offset:0
    ds_read_b64_tr_b16 v[38:39], v22 offset:512
    v_mfma_f32_16x16x32_bf16 v[220:223], v[88:91], v[76:79], v[220:223]
    ds_read_b64_tr_b16 v[48:49], v23 offset:0
    ds_read_b64_tr_b16 v[50:51], v23 offset:768
    v_mfma_f32_16x16x32_bf16 v[224:227], v[92:95], v[76:79], v[224:227]
    ds_read_b64_tr_b16 v[52:53], v24 offset:0
    ds_read_b64_tr_b16 v[54:55], v24 offset:768
    v_mfma_f32_16x16x32_bf16 v[228:231], v[96:99], v[76:79], v[228:231]
    ds_read_b64_tr_b16 v[56:57], v25 offset:0
    ds_read_b64_tr_b16 v[58:59], v25 offset:768
    s_waitcnt lgkmcnt(0)
    v_mfma_f32_16x16x32_bf16 v[208:211], v[48:51], v[32:35], v[208:211]
    ds_read_b64_tr_b16 v[72:73], v21 offset:4096
    ds_read_b64_tr_b16 v[74:75], v21 offset:4608
    v_mfma_f32_16x16x32_bf16 v[212:215], v[52:55], v[32:35], v[212:215]
    ds_read_b64_tr_b16 v[76:77], v22 offset:4096
    ds_read_b64_tr_b16 v[78:79], v22 offset:4608
    v_mfma_f32_16x16x32_bf16 v[216:219], v[56:59], v[32:35], v[216:219]
    ds_read_b64_tr_b16 v[88:89], v23 offset:6144
    ds_read_b64_tr_b16 v[90:91], v23 offset:6912
    v_mfma_f32_16x16x32_bf16 v[220:223], v[48:51], v[36:39], v[220:223]
    ds_read_b64_tr_b16 v[92:93], v24 offset:6144
    ds_read_b64_tr_b16 v[94:95], v24 offset:6912
    v_mfma_f32_16x16x32_bf16 v[224:227], v[52:55], v[36:39], v[224:227]
    ds_read_b64_tr_b16 v[96:97], v25 offset:6144
    ds_read_b64_tr_b16 v[98:99], v25 offset:6912
    v_mfma_f32_16x16x32_bf16 v[228:231], v[56:59], v[36:39], v[228:231]
    s_waitcnt lgkmcnt(0)
    v_mfma_f32_16x16x32_bf16 v[208:211], v[88:91], v[72:75], v[208:211]
    v_add_u32 v21, 155648, v10
    v_add_u32 v22, 155648, v11
    v_add_u32 v23, 61440, v18
    v_add_u32 v24, 61440, v19
    v_add_u32 v25, 61440, v20
    v_mfma_f32_16x16x32_bf16 v[212:215], v[92:95], v[72:75], v[212:215]
    ds_read_b64_tr_b16 v[32:33], v21 offset:0
    ds_read_b64_tr_b16 v[34:35], v21 offset:512
    v_mfma_f32_16x16x32_bf16 v[216:219], v[96:99], v[72:75], v[216:219]
    ds_read_b64_tr_b16 v[36:37], v22 offset:0
    ds_read_b64_tr_b16 v[38:39], v22 offset:512
    v_mfma_f32_16x16x32_bf16 v[220:223], v[88:91], v[76:79], v[220:223]
    ds_read_b64_tr_b16 v[48:49], v23 offset:0
    ds_read_b64_tr_b16 v[50:51], v23 offset:768
    v_mfma_f32_16x16x32_bf16 v[224:227], v[92:95], v[76:79], v[224:227]
    ds_read_b64_tr_b16 v[52:53], v24 offset:0
    ds_read_b64_tr_b16 v[54:55], v24 offset:768
    v_mfma_f32_16x16x32_bf16 v[228:231], v[96:99], v[76:79], v[228:231]
    ds_read_b64_tr_b16 v[56:57], v25 offset:0
    ds_read_b64_tr_b16 v[58:59], v25 offset:768
    s_waitcnt lgkmcnt(0)
    v_mfma_f32_16x16x32_bf16 v[208:211], v[48:51], v[32:35], v[208:211]
    ds_read_b64_tr_b16 v[72:73], v21 offset:4096
    ds_read_b64_tr_b16 v[74:75], v21 offset:4608
    v_mfma_f32_16x16x32_bf16 v[212:215], v[52:55], v[32:35], v[212:215]
    ds_read_b64_tr_b16 v[76:77], v22 offset:4096
    ds_read_b64_tr_b16 v[78:79], v22 offset:4608
    v_mfma_f32_16x16x32_bf16 v[216:219], v[56:59], v[32:35], v[216:219]
    ds_read_b64_tr_b16 v[88:89], v23 offset:6144
    ds_read_b64_tr_b16 v[90:91], v23 offset:6912
    v_mfma_f32_16x16x32_bf16 v[220:223], v[48:51], v[36:39], v[220:223]
    ds_read_b64_tr_b16 v[92:93], v24 offset:6144
    ds_read_b64_tr_b16 v[94:95], v24 offset:6912
    v_mfma_f32_16x16x32_bf16 v[224:227], v[52:55], v[36:39], v[224:227]
    ds_read_b64_tr_b16 v[96:97], v25 offset:6144
    ds_read_b64_tr_b16 v[98:99], v25 offset:6912
    v_mfma_f32_16x16x32_bf16 v[228:231], v[56:59], v[36:39], v[228:231]
    s_waitcnt lgkmcnt(0)
    v_mfma_f32_16x16x32_bf16 v[208:211], v[88:91], v[72:75], v[208:211]
    v_add_u32 v21, 0, v10
    v_add_u32 v22, 0, v11
    v_add_u32 v23, 73728, v18
    v_add_u32 v24, 73728, v19
    v_add_u32 v25, 73728, v20
    s_barrier
    v_mfma_f32_16x16x32_bf16 v[212:215], v[92:95], v[72:75], v[212:215]
    ds_read_b64_tr_b16 v[32:33], v21 offset:0
    ds_read_b64_tr_b16 v[34:35], v21 offset:512
    v_mfma_f32_16x16x32_bf16 v[216:219], v[96:99], v[72:75], v[216:219]
    ds_read_b64_tr_b16 v[36:37], v22 offset:0
    ds_read_b64_tr_b16 v[38:39], v22 offset:512
    v_mfma_f32_16x16x32_bf16 v[220:223], v[88:91], v[76:79], v[220:223]
    ds_read_b64_tr_b16 v[48:49], v23 offset:0
    ds_read_b64_tr_b16 v[50:51], v23 offset:768
    v_mfma_f32_16x16x32_bf16 v[224:227], v[92:95], v[76:79], v[224:227]
    ds_read_b64_tr_b16 v[52:53], v24 offset:0
    ds_read_b64_tr_b16 v[54:55], v24 offset:768
    v_mfma_f32_16x16x32_bf16 v[228:231], v[96:99], v[76:79], v[228:231]
    ds_read_b64_tr_b16 v[56:57], v25 offset:0
    ds_read_b64_tr_b16 v[58:59], v25 offset:768
    v_lshlrev_b32 v15, 1, v30
    buffer_load_ushort v250, v15, s[16:19], s50 offen offset:0
    buffer_load_ushort v251, v15, s[16:19], s50 offen offset:32
    s_waitcnt lgkmcnt(0)
    v_mfma_f32_16x16x32_bf16 v[208:211], v[48:51], v[32:35], v[208:211]
    ds_read_b64_tr_b16 v[72:73], v21 offset:4096
    ds_read_b64_tr_b16 v[74:75], v21 offset:4608
    v_mfma_f32_16x16x32_bf16 v[212:215], v[52:55], v[32:35], v[212:215]
    ds_read_b64_tr_b16 v[76:77], v22 offset:4096
    ds_read_b64_tr_b16 v[78:79], v22 offset:4608
    v_mfma_f32_16x16x32_bf16 v[216:219], v[56:59], v[32:35], v[216:219]
    ds_read_b64_tr_b16 v[88:89], v23 offset:6144
    ds_read_b64_tr_b16 v[90:91], v23 offset:6912
    v_mfma_f32_16x16x32_bf16 v[220:223], v[48:51], v[36:39], v[220:223]
    ds_read_b64_tr_b16 v[92:93], v24 offset:6144
    ds_read_b64_tr_b16 v[94:95], v24 offset:6912
    v_mfma_f32_16x16x32_bf16 v[224:227], v[52:55], v[36:39], v[224:227]
    ds_read_b64_tr_b16 v[96:97], v25 offset:6144
    ds_read_b64_tr_b16 v[98:99], v25 offset:6912
    v_mfma_f32_16x16x32_bf16 v[228:231], v[56:59], v[36:39], v[228:231]
    s_waitcnt lgkmcnt(0)
    v_mfma_f32_16x16x32_bf16 v[208:211], v[88:91], v[72:75], v[208:211]
    v_add_u32 v21, 8192, v10
    v_add_u32 v22, 8192, v11
    v_add_u32 v23, 86016, v18
    v_add_u32 v24, 86016, v19
    v_add_u32 v25, 86016, v20
    v_mfma_f32_16x16x32_bf16 v[212:215], v[92:95], v[72:75], v[212:215]
    ds_read_b64_tr_b16 v[32:33], v21 offset:0
    ds_read_b64_tr_b16 v[34:35], v21 offset:512
    v_mfma_f32_16x16x32_bf16 v[216:219], v[96:99], v[72:75], v[216:219]
    ds_read_b64_tr_b16 v[36:37], v22 offset:0
    ds_read_b64_tr_b16 v[38:39], v22 offset:512
    v_mfma_f32_16x16x32_bf16 v[220:223], v[88:91], v[76:79], v[220:223]
    ds_read_b64_tr_b16 v[48:49], v23 offset:0
    ds_read_b64_tr_b16 v[50:51], v23 offset:768
    v_mfma_f32_16x16x32_bf16 v[224:227], v[92:95], v[76:79], v[224:227]
    ds_read_b64_tr_b16 v[52:53], v24 offset:0
    ds_read_b64_tr_b16 v[54:55], v24 offset:768
    v_mfma_f32_16x16x32_bf16 v[228:231], v[96:99], v[76:79], v[228:231]
    ds_read_b64_tr_b16 v[56:57], v25 offset:0
    ds_read_b64_tr_b16 v[58:59], v25 offset:768
    s_waitcnt lgkmcnt(0)
    v_mfma_f32_16x16x32_bf16 v[208:211], v[48:51], v[32:35], v[208:211]
    ds_read_b64_tr_b16 v[72:73], v21 offset:4096
    ds_read_b64_tr_b16 v[74:75], v21 offset:4608
    v_mfma_f32_16x16x32_bf16 v[212:215], v[52:55], v[32:35], v[212:215]
    ds_read_b64_tr_b16 v[76:77], v22 offset:4096
    ds_read_b64_tr_b16 v[78:79], v22 offset:4608
    v_mfma_f32_16x16x32_bf16 v[216:219], v[56:59], v[32:35], v[216:219]
    ds_read_b64_tr_b16 v[88:89], v23 offset:6144
    ds_read_b64_tr_b16 v[90:91], v23 offset:6912
    v_mfma_f32_16x16x32_bf16 v[220:223], v[48:51], v[36:39], v[220:223]
    ds_read_b64_tr_b16 v[92:93], v24 offset:6144
    ds_read_b64_tr_b16 v[94:95], v24 offset:6912
    v_mfma_f32_16x16x32_bf16 v[224:227], v[52:55], v[36:39], v[224:227]
    ds_read_b64_tr_b16 v[96:97], v25 offset:6144
    ds_read_b64_tr_b16 v[98:99], v25 offset:6912
    v_mfma_f32_16x16x32_bf16 v[228:231], v[56:59], v[36:39], v[228:231]
    s_waitcnt lgkmcnt(0)
    v_mfma_f32_16x16x32_bf16 v[208:211], v[88:91], v[72:75], v[208:211]
    v_add_u32 v21, 32768, v10
    v_add_u32 v22, 32768, v11
    v_add_u32 v23, 122880, v18
    v_add_u32 v24, 122880, v19
    v_add_u32 v25, 122880, v20
    s_barrier
    v_mfma_f32_16x16x32_bf16 v[212:215], v[92:95], v[72:75], v[212:215]
    ds_read_b64_tr_b16 v[32:33], v21 offset:0
    ds_read_b64_tr_b16 v[34:35], v21 offset:512
    v_mfma_f32_16x16x32_bf16 v[216:219], v[96:99], v[72:75], v[216:219]
    ds_read_b64_tr_b16 v[36:37], v22 offset:0
    ds_read_b64_tr_b16 v[38:39], v22 offset:512
    v_mfma_f32_16x16x32_bf16 v[220:223], v[88:91], v[76:79], v[220:223]
    ds_read_b64_tr_b16 v[48:49], v23 offset:0
    ds_read_b64_tr_b16 v[50:51], v23 offset:768
    v_mfma_f32_16x16x32_bf16 v[224:227], v[92:95], v[76:79], v[224:227]
    ds_read_b64_tr_b16 v[52:53], v24 offset:0
    ds_read_b64_tr_b16 v[54:55], v24 offset:768
    v_mfma_f32_16x16x32_bf16 v[228:231], v[96:99], v[76:79], v[228:231]
    ds_read_b64_tr_b16 v[56:57], v25 offset:0
    ds_read_b64_tr_b16 v[58:59], v25 offset:768
    s_waitcnt lgkmcnt(0)
    v_mfma_f32_16x16x32_bf16 v[208:211], v[48:51], v[32:35], v[208:211]
    ds_read_b64_tr_b16 v[72:73], v21 offset:4096
    ds_read_b64_tr_b16 v[74:75], v21 offset:4608
    v_mfma_f32_16x16x32_bf16 v[212:215], v[52:55], v[32:35], v[212:215]
    ds_read_b64_tr_b16 v[76:77], v22 offset:4096
    ds_read_b64_tr_b16 v[78:79], v22 offset:4608
    v_mfma_f32_16x16x32_bf16 v[216:219], v[56:59], v[32:35], v[216:219]
    ds_read_b64_tr_b16 v[88:89], v23 offset:6144
    ds_read_b64_tr_b16 v[90:91], v23 offset:6912
    v_mfma_f32_16x16x32_bf16 v[220:223], v[48:51], v[36:39], v[220:223]
    ds_read_b64_tr_b16 v[92:93], v24 offset:6144
    ds_read_b64_tr_b16 v[94:95], v24 offset:6912
    v_mfma_f32_16x16x32_bf16 v[224:227], v[52:55], v[36:39], v[224:227]
    ds_read_b64_tr_b16 v[96:97], v25 offset:6144
    ds_read_b64_tr_b16 v[98:99], v25 offset:6912
    v_mfma_f32_16x16x32_bf16 v[228:231], v[56:59], v[36:39], v[228:231]
    s_waitcnt lgkmcnt(0)
    v_mfma_f32_16x16x32_bf16 v[208:211], v[88:91], v[72:75], v[208:211]
    v_add_u32 v21, 40960, v10
    v_add_u32 v22, 40960, v11
    v_add_u32 v23, 135168, v18
    v_add_u32 v24, 135168, v19
    v_add_u32 v25, 135168, v20
    v_mfma_f32_16x16x32_bf16 v[212:215], v[92:95], v[72:75], v[212:215]
    ds_read_b64_tr_b16 v[32:33], v21 offset:0
    ds_read_b64_tr_b16 v[34:35], v21 offset:512
    v_mfma_f32_16x16x32_bf16 v[216:219], v[96:99], v[72:75], v[216:219]
    ds_read_b64_tr_b16 v[36:37], v22 offset:0
    ds_read_b64_tr_b16 v[38:39], v22 offset:512
    v_mfma_f32_16x16x32_bf16 v[220:223], v[88:91], v[76:79], v[220:223]
    ds_read_b64_tr_b16 v[48:49], v23 offset:0
    ds_read_b64_tr_b16 v[50:51], v23 offset:768
    v_mfma_f32_16x16x32_bf16 v[224:227], v[92:95], v[76:79], v[224:227]
    ds_read_b64_tr_b16 v[52:53], v24 offset:0
    ds_read_b64_tr_b16 v[54:55], v24 offset:768
    v_mfma_f32_16x16x32_bf16 v[228:231], v[96:99], v[76:79], v[228:231]
    ds_read_b64_tr_b16 v[56:57], v25 offset:0
    ds_read_b64_tr_b16 v[58:59], v25 offset:768
    s_waitcnt lgkmcnt(0)
    v_mfma_f32_16x16x32_bf16 v[208:211], v[48:51], v[32:35], v[208:211]
    ds_read_b64_tr_b16 v[72:73], v21 offset:4096
    ds_read_b64_tr_b16 v[74:75], v21 offset:4608
    v_mfma_f32_16x16x32_bf16 v[212:215], v[52:55], v[32:35], v[212:215]
    ds_read_b64_tr_b16 v[76:77], v22 offset:4096
    ds_read_b64_tr_b16 v[78:79], v22 offset:4608
    v_mfma_f32_16x16x32_bf16 v[216:219], v[56:59], v[32:35], v[216:219]
    ds_read_b64_tr_b16 v[88:89], v23 offset:6144
    ds_read_b64_tr_b16 v[90:91], v23 offset:6912
    v_mfma_f32_16x16x32_bf16 v[220:223], v[48:51], v[36:39], v[220:223]
    ds_read_b64_tr_b16 v[92:93], v24 offset:6144
    ds_read_b64_tr_b16 v[94:95], v24 offset:6912
    v_mfma_f32_16x16x32_bf16 v[224:227], v[52:55], v[36:39], v[224:227]
    ds_read_b64_tr_b16 v[96:97], v25 offset:6144
    ds_read_b64_tr_b16 v[98:99], v25 offset:6912
    v_mfma_f32_16x16x32_bf16 v[228:231], v[56:59], v[36:39], v[228:231]
    s_waitcnt lgkmcnt(0)
    v_mfma_f32_16x16x32_bf16 v[208:211], v[88:91], v[72:75], v[208:211]
    v_add_u32 v21, 147456, v10
    v_add_u32 v22, 147456, v11
    v_add_u32 v23, 49152, v18
    v_add_u32 v24, 49152, v19
    v_add_u32 v25, 49152, v20
    v_mfma_f32_16x16x32_bf16 v[212:215], v[92:95], v[72:75], v[212:215]
    ds_read_b64_tr_b16 v[32:33], v21 offset:0
    ds_read_b64_tr_b16 v[34:35], v21 offset:512
    v_mfma_f32_16x16x32_bf16 v[216:219], v[96:99], v[72:75], v[216:219]
    ds_read_b64_tr_b16 v[36:37], v22 offset:0
    ds_read_b64_tr_b16 v[38:39], v22 offset:512
    v_mfma_f32_16x16x32_bf16 v[220:223], v[88:91], v[76:79], v[220:223]
    ds_read_b64_tr_b16 v[48:49], v23 offset:0
    ds_read_b64_tr_b16 v[50:51], v23 offset:768
    v_mfma_f32_16x16x32_bf16 v[224:227], v[92:95], v[76:79], v[224:227]
    ds_read_b64_tr_b16 v[52:53], v24 offset:0
    ds_read_b64_tr_b16 v[54:55], v24 offset:768
    v_mfma_f32_16x16x32_bf16 v[228:231], v[96:99], v[76:79], v[228:231]
    ds_read_b64_tr_b16 v[56:57], v25 offset:0
    ds_read_b64_tr_b16 v[58:59], v25 offset:768
    s_waitcnt lgkmcnt(0)
    v_mfma_f32_16x16x32_bf16 v[208:211], v[48:51], v[32:35], v[208:211]
    ds_read_b64_tr_b16 v[72:73], v21 offset:4096
    ds_read_b64_tr_b16 v[74:75], v21 offset:4608
    v_mfma_f32_16x16x32_bf16 v[212:215], v[52:55], v[32:35], v[212:215]
    ds_read_b64_tr_b16 v[76:77], v22 offset:4096
    ds_read_b64_tr_b16 v[78:79], v22 offset:4608
    v_mfma_f32_16x16x32_bf16 v[216:219], v[56:59], v[32:35], v[216:219]
    ds_read_b64_tr_b16 v[88:89], v23 offset:6144
    ds_read_b64_tr_b16 v[90:91], v23 offset:6912
    v_mfma_f32_16x16x32_bf16 v[220:223], v[48:51], v[36:39], v[220:223]
    ds_read_b64_tr_b16 v[92:93], v24 offset:6144
    ds_read_b64_tr_b16 v[94:95], v24 offset:6912
    v_mfma_f32_16x16x32_bf16 v[224:227], v[52:55], v[36:39], v[224:227]
    ds_read_b64_tr_b16 v[96:97], v25 offset:6144
    ds_read_b64_tr_b16 v[98:99], v25 offset:6912
    v_mfma_f32_16x16x32_bf16 v[228:231], v[56:59], v[36:39], v[228:231]
    s_waitcnt lgkmcnt(0)
    v_mfma_f32_16x16x32_bf16 v[208:211], v[88:91], v[72:75], v[208:211]
    v_mfma_f32_16x16x32_bf16 v[212:215], v[92:95], v[72:75], v[212:215]
    v_mfma_f32_16x16x32_bf16 v[216:219], v[96:99], v[72:75], v[216:219]
    v_mfma_f32_16x16x32_bf16 v[220:223], v[88:91], v[76:79], v[220:223]
    v_mfma_f32_16x16x32_bf16 v[224:227], v[92:95], v[76:79], v[224:227]
    v_mfma_f32_16x16x32_bf16 v[228:231], v[96:99], v[76:79], v[228:231]
    s_waitcnt vmcnt(0)
    v_lshlrev_b32 v250, 16, v250
    v_lshlrev_b32 v251, 16, v251
    v_add_f32 v208, v208, v250
    v_add_f32 v209, v209, v250
    v_add_f32 v210, v210, v250
    v_add_f32 v211, v211, v250
    v_add_f32 v212, v212, v250
    v_add_f32 v213, v213, v250
    v_add_f32 v214, v214, v250
    v_add_f32 v215, v215, v250
    v_add_f32 v216, v216, v250
    v_add_f32 v217, v217, v250
    v_add_f32 v218, v218, v250
    v_add_f32 v219, v219, v250
    v_add_f32 v220, v220, v251
    v_add_f32 v221, v221, v251
    v_add_f32 v222, v222, v251
    v_add_f32 v223, v223, v251
    v_add_f32 v224, v224, v251
    v_add_f32 v225, v225, v251
    v_add_f32 v226, v226, v251
    v_add_f32 v227, v227, v251
    v_add_f32 v228, v228, v251
    v_add_f32 v229, v229, v251
    v_add_f32 v230, v230, v251
    v_add_f32 v231, v231, v251
    v_cvt_pk_bf16_f32 v32, v208, v209
    v_lshlrev_b32 v208, 16, v32
    v_and_b32 v209, 0xffff0000, v32
    v_cvt_pk_bf16_f32 v32, v210, v211
    v_lshlrev_b32 v210, 16, v32
    v_and_b32 v211, 0xffff0000, v32
    v_cvt_pk_bf16_f32 v32, v212, v213
    v_lshlrev_b32 v212, 16, v32
    v_and_b32 v213, 0xffff0000, v32
    v_cvt_pk_bf16_f32 v32, v214, v215
    v_lshlrev_b32 v214, 16, v32
    v_and_b32 v215, 0xffff0000, v32
    v_cvt_pk_bf16_f32 v32, v216, v217
    v_lshlrev_b32 v216, 16, v32
    v_and_b32 v217, 0xffff0000, v32
    v_cvt_pk_bf16_f32 v32, v218, v219
    v_lshlrev_b32 v218, 16, v32
    v_and_b32 v219, 0xffff0000, v32
    v_cvt_pk_bf16_f32 v32, v220, v221
    v_lshlrev_b32 v220, 16, v32
    v_and_b32 v221, 0xffff0000, v32
    v_cvt_pk_bf16_f32 v32, v222, v223
    v_lshlrev_b32 v222, 16, v32
    v_and_b32 v223, 0xffff0000, v32
    v_cvt_pk_bf16_f32 v32, v224, v225
    v_lshlrev_b32 v224, 16, v32
    v_and_b32 v225, 0xffff0000, v32
    v_cvt_pk_bf16_f32 v32, v226, v227
    v_lshlrev_b32 v226, 16, v32
    v_and_b32 v227, 0xffff0000, v32
    v_cvt_pk_bf16_f32 v32, v228, v229
    v_lshlrev_b32 v228, 16, v32
    v_and_b32 v229, 0xffff0000, v32
    v_cvt_pk_bf16_f32 v32, v230, v231
    v_lshlrev_b32 v230, 16, v32
    v_and_b32 v231, 0xffff0000, v32
    v_lshlrev_b32 v112, 16, v232
    v_and_b32 v113, 0xffff0000, v232
    v_lshlrev_b32 v114, 16, v233
    v_and_b32 v115, 0xffff0000, v233
    v_lshlrev_b32 v116, 16, v234
    v_and_b32 v117, 0xffff0000, v234
    v_lshlrev_b32 v118, 16, v235
    v_and_b32 v119, 0xffff0000, v235
    v_lshlrev_b32 v120, 16, v236
    v_and_b32 v121, 0xffff0000, v236
    v_lshlrev_b32 v122, 16, v237
    v_and_b32 v123, 0xffff0000, v237
    v_lshlrev_b32 v124, 16, v238
    v_and_b32 v125, 0xffff0000, v238
    v_lshlrev_b32 v126, 16, v239
    v_and_b32 v127, 0xffff0000, v239
    v_lshlrev_b32 v128, 16, v240
    v_and_b32 v129, 0xffff0000, v240
    v_lshlrev_b32 v130, 16, v241
    v_and_b32 v131, 0xffff0000, v241
    v_lshlrev_b32 v132, 16, v242
    v_and_b32 v133, 0xffff0000, v242
    v_lshlrev_b32 v134, 16, v243
    v_and_b32 v135, 0xffff0000, v243
    s_mul_i32 s52, s36, 6144
    s_add_u32 s52, s52, 98304
    v_add_u32 v1, s52, v29
    s_barrier
    ds_read_b128 v[40:43], v1 offset:0
    ds_read_b128 v[44:47], v1 offset:1024
    ds_read_b128 v[48:51], v1 offset:2048
    s_waitcnt lgkmcnt(2)
    v_lshlrev_b32 v56, 16, v40
    v_and_b32 v57, 0xffff0000, v40
    v_lshlrev_b32 v58, 16, v41
    v_and_b32 v59, 0xffff0000, v41
    v_fma_f32 v56, v56, v208, v112
    v_fma_f32 v57, v57, v209, v113
    v_fma_f32 v58, v58, v210, v114
    v_fma_f32 v59, v59, v211, v115
    v_cvt_pk_bf16_f32 v232, v56, v57
    v_cvt_pk_bf16_f32 v233, v58, v59
    buffer_store_dwordx2 v[232:233], v16, s[32:35], 0 offen offset:0
    v_lshlrev_b32 v56, 16, v42
    v_and_b32 v57, 0xffff0000, v42
    v_lshlrev_b32 v58, 16, v43
    v_and_b32 v59, 0xffff0000, v43
    v_fma_f32 v56, v56, v220, v124
    v_fma_f32 v57, v57, v221, v125
    v_fma_f32 v58, v58, v222, v126
    v_fma_f32 v59, v59, v223, v127
    v_cvt_pk_bf16_f32 v238, v56, v57
    v_cvt_pk_bf16_f32 v239, v58, v59
    buffer_store_dwordx2 v[238:239], v16, s[32:35], s45 offen offset:0
    s_waitcnt lgkmcnt(1)
    v_lshlrev_b32 v56, 16, v44
    v_and_b32 v57, 0xffff0000, v44
    v_lshlrev_b32 v58, 16, v45
    v_and_b32 v59, 0xffff0000, v45
    v_fma_f32 v56, v56, v212, v116
    v_fma_f32 v57, v57, v213, v117
    v_fma_f32 v58, v58, v214, v118
    v_fma_f32 v59, v59, v215, v119
    v_cvt_pk_bf16_f32 v234, v56, v57
    v_cvt_pk_bf16_f32 v235, v58, v59
    buffer_store_dwordx2 v[234:235], v16, s[32:35], 0 offen offset:32
    v_lshlrev_b32 v56, 16, v46
    v_and_b32 v57, 0xffff0000, v46
    v_lshlrev_b32 v58, 16, v47
    v_and_b32 v59, 0xffff0000, v47
    v_fma_f32 v56, v56, v224, v128
    v_fma_f32 v57, v57, v225, v129
    v_fma_f32 v58, v58, v226, v130
    v_fma_f32 v59, v59, v227, v131
    v_cvt_pk_bf16_f32 v240, v56, v57
    v_cvt_pk_bf16_f32 v241, v58, v59
    buffer_store_dwordx2 v[240:241], v16, s[32:35], s45 offen offset:32
    s_waitcnt lgkmcnt(0)
    v_lshlrev_b32 v56, 16, v48
    v_and_b32 v57, 0xffff0000, v48
    v_lshlrev_b32 v58, 16, v49
    v_and_b32 v59, 0xffff0000, v49
    v_fma_f32 v56, v56, v216, v120
    v_fma_f32 v57, v57, v217, v121
    v_fma_f32 v58, v58, v218, v122
    v_fma_f32 v59, v59, v219, v123
    v_cvt_pk_bf16_f32 v236, v56, v57
    v_cvt_pk_bf16_f32 v237, v58, v59
    buffer_store_dwordx2 v[236:237], v16, s[32:35], 0 offen offset:64
    v_lshlrev_b32 v56, 16, v50
    v_and_b32 v57, 0xffff0000, v50
    v_lshlrev_b32 v58, 16, v51
    v_and_b32 v59, 0xffff0000, v51
    v_fma_f32 v56, v56, v228, v132
    v_fma_f32 v57, v57, v229, v133
    v_fma_f32 v58, v58, v230, v134
    v_fma_f32 v59, v59, v231, v135
    v_cvt_pk_bf16_f32 v242, v56, v57
    v_cvt_pk_bf16_f32 v243, v58, v59
    buffer_store_dwordx2 v[242:243], v16, s[32:35], s45 offen offset:64
    s_endpgm
aux_part:
    s_add_u32 s16, s66, 0x280000
    s_addc_u32 s17, s67, 0
    s_and_b32 s17, s17, 0xffff
    s_mov_b32 s18, 0x242000
    s_mov_b32 s19, 0x20000
    s_add_u32 s20, s66, 0x780000
    s_addc_u32 s21, s67, 0
    s_and_b32 s21, s21, 0xffff
    s_mov_b32 s22, 0x242000
    s_mov_b32 s23, 0x20000
    s_add_u32 s28, s66, 0xa60000
    s_addc_u32 s29, s67, 0
    s_and_b32 s29, s29, 0xffff
    s_mov_b32 s30, 0x800
    s_mov_b32 s31, 0x20000
    s_barrier
    s_cmp_gt_u32 s91, 288
    s_cbranch_scc0 aux_work
    s_waitcnt vmcnt(0)
    s_barrier
    s_cmp_lg_u32 s36, 0
    s_cbranch_scc1 p1_pub_118
    s_add_u32 s52, s57, s43
    s_add_i32 s52, s52, 0
    v_mov_b32 v1, s52
    v_mov_b32 v54, 0
    buffer_store_dword v1, v54, s[96:99], s79 offen sc1
p1_pub_118:
    s_branch aux_done
aux_work:
    v_lshlrev_b32 v1, 4, v0
    v_and_b32 v2, 31, v0
    v_lshrrev_b32 v3, 5, v0
    v_lshlrev_b32 v4, 7, v2
    v_lshl_add_u32 v4, v3, 4, v4
    v_lshrrev_b32 v5, 1, v2
    v_mul_u32_u24 v5, 73984, v5
    v_and_b32 v2, 1, v2
    v_lshl_add_u32 v2, v2, 2, v3
    s_and_b32 s32, s91, 1
    s_lshl_b32 s32, s32, 1
    s_and_b32 s33, s91, 4
    s_or_b32 s32, s32, s33
    v_xor_b32 v2, s32, v2
    v_xor_b32 v3, 2, v2
    v_lshl_add_u32 v2, v2, 4, v5
    v_lshl_add_u32 v3, v3, 4, v5
    v_add_u32 v5, s3, v1
    s_cmp_eq_u32 s91, 288
    s_cselect_b32 s32, 0, s91
    s_lshl_b32 s32, s32, 13
    v_and_b32 v246, 31, v0
    v_lshrrev_b32 v247, 5, v0
    v_bfe_u32 v248, v0, 1, 3
    v_xor_b32 v247, v247, v248
    v_lshlrev_b32 v246, 7, v246
    v_add_u32 v246, s100, v246
    v_xor_b32 v248, 0, v247
    v_lshl_add_u32 v249, v248, 4, v246
    v_xor_b32 v248, 2, v247
    v_lshl_add_u32 v250, v248, 4, v246
    v_xor_b32 v248, 4, v247
    v_lshl_add_u32 v251, v248, 4, v246
    v_xor_b32 v248, 6, v247
    v_lshl_add_u32 v252, v248, 4, v246
    ds_read_b128 v[6:9], v249 offset:0
    ds_read_b128 v[10:13], v250 offset:0
    ds_read_b128 v[14:17], v251 offset:0
    ds_read_b128 v[18:21], v252 offset:0
    ds_read_b128 v[22:25], v249 offset:4096
    ds_read_b128 v[26:29], v250 offset:4096
    ds_read_b128 v[30:33], v251 offset:4096
    ds_read_b128 v[34:37], v252 offset:4096
    s_waitcnt lgkmcnt(0)
    ds_read_b128 v[102:105], v5 offset:0
    ds_read_b128 v[106:109], v5 offset:1024
    ds_read_b128 v[110:113], v5 offset:2048
    ds_read_b128 v[114:117], v5 offset:3072
    ds_read_b128 v[118:121], v5 offset:4096
    ds_read_b128 v[122:125], v5 offset:5120
    ds_read_b128 v[126:129], v5 offset:6144
    ds_read_b128 v[130:133], v5 offset:7168
    ds_read_b128 v[214:217], v5 offset:28672
    ds_read_b128 v[218:221], v5 offset:29696
    ds_read_b128 v[222:225], v5 offset:30720
    ds_read_b128 v[226:229], v5 offset:31744
    ds_read_b128 v[230:233], v5 offset:32768
    ds_read_b128 v[234:237], v5 offset:33792
    ds_read_b128 v[238:241], v5 offset:34816
    ds_read_b128 v[242:245], v5 offset:35840
    s_cmp_eq_u32 s91, 288
    s_cbranch_scc1 fft_d_120
    s_cmp_lg_u32 s91, 0
    s_cbranch_scc1 fft_n_119
    v_and_b32 v6, 0xffff, v6
    v_and_b32 v7, 0xffff, v7
    v_and_b32 v8, 0xffff, v8
    v_and_b32 v9, 0xffff, v9
    v_and_b32 v10, 0xffff, v10
    v_and_b32 v11, 0xffff, v11
    v_and_b32 v12, 0xffff, v12
    v_and_b32 v13, 0xffff, v13
    v_and_b32 v14, 0xffff, v14
    v_and_b32 v15, 0xffff, v15
    v_and_b32 v16, 0xffff, v16
    v_and_b32 v17, 0xffff, v17
    v_and_b32 v18, 0xffff, v18
    v_and_b32 v19, 0xffff, v19
    v_and_b32 v20, 0xffff, v20
    v_and_b32 v21, 0xffff, v21
    v_and_b32 v22, 0xffff, v22
    v_and_b32 v23, 0xffff, v23
    v_and_b32 v24, 0xffff, v24
    v_and_b32 v25, 0xffff, v25
    v_and_b32 v26, 0xffff, v26
    v_and_b32 v27, 0xffff, v27
    v_and_b32 v28, 0xffff, v28
    v_and_b32 v29, 0xffff, v29
    v_and_b32 v30, 0xffff, v30
    v_and_b32 v31, 0xffff, v31
    v_and_b32 v32, 0xffff, v32
    v_and_b32 v33, 0xffff, v33
    v_and_b32 v34, 0xffff, v34
    v_and_b32 v35, 0xffff, v35
    v_and_b32 v36, 0xffff, v36
    v_and_b32 v37, 0xffff, v37
    s_branch fft_n_119
fft_d_120:
    v_lshrrev_b32 v6, 16, v6
    v_lshrrev_b32 v7, 16, v7
    v_lshrrev_b32 v8, 16, v8
    v_lshrrev_b32 v9, 16, v9
    v_lshrrev_b32 v10, 16, v10
    v_lshrrev_b32 v11, 16, v11
    v_lshrrev_b32 v12, 16, v12
    v_lshrrev_b32 v13, 16, v13
    v_lshrrev_b32 v14, 16, v14
    v_lshrrev_b32 v15, 16, v15
    v_lshrrev_b32 v16, 16, v16
    v_lshrrev_b32 v17, 16, v17
    v_lshrrev_b32 v18, 16, v18
    v_lshrrev_b32 v19, 16, v19
    v_lshrrev_b32 v20, 16, v20
    v_lshrrev_b32 v21, 16, v21
    v_lshrrev_b32 v22, 16, v22
    v_lshrrev_b32 v23, 16, v23
    v_lshrrev_b32 v24, 16, v24
    v_lshrrev_b32 v25, 16, v25
    v_lshrrev_b32 v26, 16, v26
    v_lshrrev_b32 v27, 16, v27
    v_lshrrev_b32 v28, 16, v28
    v_lshrrev_b32 v29, 16, v29
    v_lshrrev_b32 v30, 16, v30
    v_lshrrev_b32 v31, 16, v31
    v_lshrrev_b32 v32, 16, v32
    v_lshrrev_b32 v33, 16, v33
    v_lshrrev_b32 v34, 16, v34
    v_lshrrev_b32 v35, 16, v35
    v_lshrrev_b32 v36, 16, v36
    v_lshrrev_b32 v37, 16, v37
fft_n_119:
    s_waitcnt lgkmcnt(8)
    v_mfma_f32_32x32x16_bf16 v[38:53], v[6:9], v[102:105], 0
    v_mfma_f32_32x32x16_bf16 v[70:85], v[6:9], v[118:121], 0
    v_mfma_f32_32x32x16_bf16 v[38:53], v[10:13], v[106:109], v[38:53]
    v_mfma_f32_32x32x16_bf16 v[70:85], v[10:13], v[122:125], v[70:85]
    v_mfma_f32_32x32x16_bf16 v[38:53], v[14:17], v[110:113], v[38:53]
    v_mfma_f32_32x32x16_bf16 v[70:85], v[14:17], v[126:129], v[70:85]
    v_mfma_f32_32x32x16_bf16 v[38:53], v[18:21], v[114:117], v[38:53]
    v_mfma_f32_32x32x16_bf16 v[70:85], v[18:21], v[130:133], v[70:85]
    v_mfma_f32_32x32x16_bf16 v[54:69], v[22:25], v[102:105], 0
    v_mfma_f32_32x32x16_bf16 v[86:101], v[22:25], v[118:121], 0
    v_mfma_f32_32x32x16_bf16 v[54:69], v[26:29], v[106:109], v[54:69]
    v_mfma_f32_32x32x16_bf16 v[86:101], v[26:29], v[122:125], v[86:101]
    v_mfma_f32_32x32x16_bf16 v[54:69], v[30:33], v[110:113], v[54:69]
    v_mfma_f32_32x32x16_bf16 v[86:101], v[30:33], v[126:129], v[86:101]
    v_mfma_f32_32x32x16_bf16 v[54:69], v[34:37], v[114:117], v[54:69]
    v_mfma_f32_32x32x16_bf16 v[86:101], v[34:37], v[130:133], v[86:101]
    ds_read_b128 v[150:153], v5 offset:8192
    ds_read_b128 v[154:157], v5 offset:9216
    ds_read_b128 v[158:161], v5 offset:10240
    ds_read_b128 v[162:165], v5 offset:11264
    ds_read_b128 v[166:169], v5 offset:12288
    ds_read_b128 v[170:173], v5 offset:13312
    ds_read_b128 v[174:177], v5 offset:14336
    ds_read_b128 v[178:181], v5 offset:15360
    s_waitcnt lgkmcnt(8)
    ds_read_b128 v[182:185], v5 offset:16384
    ds_read_b128 v[186:189], v5 offset:17408
    ds_read_b128 v[190:193], v5 offset:18432
    ds_read_b128 v[194:197], v5 offset:19456
    ds_read_b128 v[198:201], v5 offset:20480
    ds_read_b128 v[202:205], v5 offset:21504
    ds_read_b128 v[206:209], v5 offset:22528
    ds_read_b128 v[210:213], v5 offset:23552
    s_waitcnt vmcnt(0)
    s_barrier
    s_cmp_lg_u32 s36, 0
    s_cbranch_scc1 aux_pub_121
    s_add_u32 s52, s57, s43
    v_mov_b32 v250, s52
    v_mov_b32 v251, 0
    buffer_store_dword v250, v251, s[96:99], s79 offen sc1
aux_pub_121:
    s_lshl_b32 s32, s91, 13
    s_add_u32 s33, s32, 0
    buffer_load_dwordx4 v[6:9], v1, s[16:19], s33 offen offset:0
    buffer_load_dwordx4 v[10:13], v1, s[16:19], s33 offen offset:1024
    buffer_load_dwordx4 v[14:17], v1, s[16:19], s33 offen offset:2048
    buffer_load_dwordx4 v[18:21], v1, s[16:19], s33 offen offset:3072
    s_add_u32 s33, s32, 4096
    buffer_load_dwordx4 v[22:25], v1, s[16:19], s33 offen offset:0
    buffer_load_dwordx4 v[26:29], v1, s[16:19], s33 offen offset:1024
    buffer_load_dwordx4 v[30:33], v1, s[16:19], s33 offen offset:2048
    buffer_load_dwordx4 v[34:37], v1, s[16:19], s33 offen offset:3072
    v_pk_mul_f32 v[246:247], v[38:39], v[214:215]
    v_pk_mul_f32 v[248:249], v[38:39], v[218:219]
    v_pk_fma_f32 v[246:247], v[70:71], v[218:219], v[246:247] neg_lo:[1,0,0] neg_hi:[1,0,0]
    v_pk_fma_f32 v[248:249], v[70:71], v[214:215], v[248:249]
    v_cvt_pk_bf16_f32 v102, v246, v247
    v_cvt_pk_bf16_f32 v118, v248, v249
    v_xor_b32 v134, 0x80008000, v102
    v_pk_mul_f32 v[246:247], v[40:41], v[216:217]
    v_pk_mul_f32 v[248:249], v[40:41], v[220:221]
    v_pk_fma_f32 v[246:247], v[72:73], v[220:221], v[246:247] neg_lo:[1,0,0] neg_hi:[1,0,0]
    v_pk_fma_f32 v[248:249], v[72:73], v[216:217], v[248:249]
    v_cvt_pk_bf16_f32 v103, v246, v247
    v_cvt_pk_bf16_f32 v119, v248, v249
    v_xor_b32 v135, 0x80008000, v103
    v_pk_mul_f32 v[246:247], v[42:43], v[222:223]
    v_pk_mul_f32 v[248:249], v[42:43], v[226:227]
    v_pk_fma_f32 v[246:247], v[74:75], v[226:227], v[246:247] neg_lo:[1,0,0] neg_hi:[1,0,0]
    v_pk_fma_f32 v[248:249], v[74:75], v[222:223], v[248:249]
    v_cvt_pk_bf16_f32 v104, v246, v247
    v_cvt_pk_bf16_f32 v120, v248, v249
    v_xor_b32 v136, 0x80008000, v104
    v_pk_mul_f32 v[246:247], v[44:45], v[224:225]
    v_pk_mul_f32 v[248:249], v[44:45], v[228:229]
    v_pk_fma_f32 v[246:247], v[76:77], v[228:229], v[246:247] neg_lo:[1,0,0] neg_hi:[1,0,0]
    v_pk_fma_f32 v[248:249], v[76:77], v[224:225], v[248:249]
    v_cvt_pk_bf16_f32 v105, v246, v247
    v_cvt_pk_bf16_f32 v121, v248, v249
    v_xor_b32 v137, 0x80008000, v105
    ds_read_b128 v[214:217], v5 offset:36864
    ds_read_b128 v[218:221], v5 offset:37888
    ds_read_b128 v[222:225], v5 offset:38912
    ds_read_b128 v[226:229], v5 offset:39936
    v_pk_mul_f32 v[246:247], v[46:47], v[230:231]
    v_pk_mul_f32 v[248:249], v[46:47], v[234:235]
    v_pk_fma_f32 v[246:247], v[78:79], v[234:235], v[246:247] neg_lo:[1,0,0] neg_hi:[1,0,0]
    v_pk_fma_f32 v[248:249], v[78:79], v[230:231], v[248:249]
    v_cvt_pk_bf16_f32 v106, v246, v247
    v_cvt_pk_bf16_f32 v122, v248, v249
    v_xor_b32 v138, 0x80008000, v106
    v_pk_mul_f32 v[246:247], v[48:49], v[232:233]
    v_pk_mul_f32 v[248:249], v[48:49], v[236:237]
    v_pk_fma_f32 v[246:247], v[80:81], v[236:237], v[246:247] neg_lo:[1,0,0] neg_hi:[1,0,0]
    v_pk_fma_f32 v[248:249], v[80:81], v[232:233], v[248:249]
    v_cvt_pk_bf16_f32 v107, v246, v247
    v_cvt_pk_bf16_f32 v123, v248, v249
    v_xor_b32 v139, 0x80008000, v107
    v_pk_mul_f32 v[246:247], v[50:51], v[238:239]
    v_pk_mul_f32 v[248:249], v[50:51], v[242:243]
    v_pk_fma_f32 v[246:247], v[82:83], v[242:243], v[246:247] neg_lo:[1,0,0] neg_hi:[1,0,0]
    v_pk_fma_f32 v[248:249], v[82:83], v[238:239], v[248:249]
    v_cvt_pk_bf16_f32 v108, v246, v247
    v_cvt_pk_bf16_f32 v124, v248, v249
    v_xor_b32 v140, 0x80008000, v108
    v_pk_mul_f32 v[246:247], v[52:53], v[240:241]
    v_pk_mul_f32 v[248:249], v[52:53], v[244:245]
    v_pk_fma_f32 v[246:247], v[84:85], v[244:245], v[246:247] neg_lo:[1,0,0] neg_hi:[1,0,0]
    v_pk_fma_f32 v[248:249], v[84:85], v[240:241], v[248:249]
    v_cvt_pk_bf16_f32 v109, v246, v247
    v_cvt_pk_bf16_f32 v125, v248, v249
    v_xor_b32 v141, 0x80008000, v109
    ds_read_b128 v[230:233], v5 offset:40960
    ds_read_b128 v[234:237], v5 offset:41984
    ds_read_b128 v[238:241], v5 offset:43008
    ds_read_b128 v[242:245], v5 offset:44032
    s_waitcnt lgkmcnt(4)
    v_pk_mul_f32 v[246:247], v[54:55], v[214:215]
    v_pk_mul_f32 v[248:249], v[54:55], v[218:219]
    v_pk_fma_f32 v[246:247], v[86:87], v[218:219], v[246:247] neg_lo:[1,0,0] neg_hi:[1,0,0]
    v_pk_fma_f32 v[248:249], v[86:87], v[214:215], v[248:249]
    v_cvt_pk_bf16_f32 v110, v246, v247
    v_cvt_pk_bf16_f32 v126, v248, v249
    v_xor_b32 v142, 0x80008000, v110
    v_pk_mul_f32 v[246:247], v[56:57], v[216:217]
    v_pk_mul_f32 v[248:249], v[56:57], v[220:221]
    v_pk_fma_f32 v[246:247], v[88:89], v[220:221], v[246:247] neg_lo:[1,0,0] neg_hi:[1,0,0]
    v_pk_fma_f32 v[248:249], v[88:89], v[216:217], v[248:249]
    v_cvt_pk_bf16_f32 v111, v246, v247
    v_cvt_pk_bf16_f32 v127, v248, v249
    v_xor_b32 v143, 0x80008000, v111
    v_pk_mul_f32 v[246:247], v[58:59], v[222:223]
    v_pk_mul_f32 v[248:249], v[58:59], v[226:227]
    v_pk_fma_f32 v[246:247], v[90:91], v[226:227], v[246:247] neg_lo:[1,0,0] neg_hi:[1,0,0]
    v_pk_fma_f32 v[248:249], v[90:91], v[222:223], v[248:249]
    v_cvt_pk_bf16_f32 v112, v246, v247
    v_cvt_pk_bf16_f32 v128, v248, v249
    v_xor_b32 v144, 0x80008000, v112
    v_pk_mul_f32 v[246:247], v[60:61], v[224:225]
    v_pk_mul_f32 v[248:249], v[60:61], v[228:229]
    v_pk_fma_f32 v[246:247], v[92:93], v[228:229], v[246:247] neg_lo:[1,0,0] neg_hi:[1,0,0]
    v_pk_fma_f32 v[248:249], v[92:93], v[224:225], v[248:249]
    v_cvt_pk_bf16_f32 v113, v246, v247
    v_cvt_pk_bf16_f32 v129, v248, v249
    v_xor_b32 v145, 0x80008000, v113
    ds_read_b128 v[214:217], v5 offset:45056
    ds_read_b128 v[218:221], v5 offset:46080
    ds_read_b128 v[222:225], v5 offset:47104
    ds_read_b128 v[226:229], v5 offset:48128
    s_waitcnt lgkmcnt(4)
    v_pk_mul_f32 v[246:247], v[62:63], v[230:231]
    v_pk_mul_f32 v[248:249], v[62:63], v[234:235]
    v_pk_fma_f32 v[246:247], v[94:95], v[234:235], v[246:247] neg_lo:[1,0,0] neg_hi:[1,0,0]
    v_pk_fma_f32 v[248:249], v[94:95], v[230:231], v[248:249]
    v_cvt_pk_bf16_f32 v114, v246, v247
    v_cvt_pk_bf16_f32 v130, v248, v249
    v_xor_b32 v146, 0x80008000, v114
    v_pk_mul_f32 v[246:247], v[64:65], v[232:233]
    v_pk_mul_f32 v[248:249], v[64:65], v[236:237]
    v_pk_fma_f32 v[246:247], v[96:97], v[236:237], v[246:247] neg_lo:[1,0,0] neg_hi:[1,0,0]
    v_pk_fma_f32 v[248:249], v[96:97], v[232:233], v[248:249]
    v_cvt_pk_bf16_f32 v115, v246, v247
    v_cvt_pk_bf16_f32 v131, v248, v249
    v_xor_b32 v147, 0x80008000, v115
    v_pk_mul_f32 v[246:247], v[66:67], v[238:239]
    v_pk_mul_f32 v[248:249], v[66:67], v[242:243]
    v_pk_fma_f32 v[246:247], v[98:99], v[242:243], v[246:247] neg_lo:[1,0,0] neg_hi:[1,0,0]
    v_pk_fma_f32 v[248:249], v[98:99], v[238:239], v[248:249]
    v_cvt_pk_bf16_f32 v116, v246, v247
    v_cvt_pk_bf16_f32 v132, v248, v249
    v_xor_b32 v148, 0x80008000, v116
    v_pk_mul_f32 v[246:247], v[68:69], v[240:241]
    v_pk_mul_f32 v[248:249], v[68:69], v[244:245]
    v_pk_fma_f32 v[246:247], v[100:101], v[244:245], v[246:247] neg_lo:[1,0,0] neg_hi:[1,0,0]
    v_pk_fma_f32 v[248:249], v[100:101], v[240:241], v[248:249]
    v_cvt_pk_bf16_f32 v117, v246, v247
    v_cvt_pk_bf16_f32 v133, v248, v249
    v_xor_b32 v149, 0x80008000, v117
    ds_read_b128 v[230:233], v5 offset:49152
    ds_read_b128 v[234:237], v5 offset:50176
    ds_read_b128 v[238:241], v5 offset:51200
    ds_read_b128 v[242:245], v5 offset:52224
    v_mfma_f32_32x32x16_bf16 v[38:53], v[150:153], v[102:105], 0
    v_mfma_f32_32x32x16_bf16 v[70:85], v[150:153], v[118:121], 0
    v_mfma_f32_32x32x16_bf16 v[38:53], v[182:185], v[118:121], v[38:53]
    v_mfma_f32_32x32x16_bf16 v[70:85], v[182:185], v[134:137], v[70:85]
    v_mfma_f32_32x32x16_bf16 v[38:53], v[154:157], v[106:109], v[38:53]
    v_mfma_f32_32x32x16_bf16 v[70:85], v[154:157], v[122:125], v[70:85]
    v_mfma_f32_32x32x16_bf16 v[38:53], v[186:189], v[122:125], v[38:53]
    v_mfma_f32_32x32x16_bf16 v[70:85], v[186:189], v[138:141], v[70:85]
    v_mfma_f32_32x32x16_bf16 v[38:53], v[158:161], v[110:113], v[38:53]
    v_mfma_f32_32x32x16_bf16 v[70:85], v[158:161], v[126:129], v[70:85]
    v_mfma_f32_32x32x16_bf16 v[38:53], v[190:193], v[126:129], v[38:53]
    v_mfma_f32_32x32x16_bf16 v[70:85], v[190:193], v[142:145], v[70:85]
    v_mfma_f32_32x32x16_bf16 v[38:53], v[162:165], v[114:117], v[38:53]
    v_mfma_f32_32x32x16_bf16 v[70:85], v[162:165], v[130:133], v[70:85]
    v_mfma_f32_32x32x16_bf16 v[38:53], v[194:197], v[130:133], v[38:53]
    v_mfma_f32_32x32x16_bf16 v[70:85], v[194:197], v[146:149], v[70:85]
    v_mfma_f32_32x32x16_bf16 v[54:69], v[166:169], v[102:105], 0
    v_mfma_f32_32x32x16_bf16 v[86:101], v[166:169], v[118:121], 0
    v_mfma_f32_32x32x16_bf16 v[54:69], v[198:201], v[118:121], v[54:69]
    v_mfma_f32_32x32x16_bf16 v[86:101], v[198:201], v[134:137], v[86:101]
    v_mfma_f32_32x32x16_bf16 v[54:69], v[170:173], v[106:109], v[54:69]
    v_mfma_f32_32x32x16_bf16 v[86:101], v[170:173], v[122:125], v[86:101]
    v_mfma_f32_32x32x16_bf16 v[54:69], v[202:205], v[122:125], v[54:69]
    v_mfma_f32_32x32x16_bf16 v[86:101], v[202:205], v[138:141], v[86:101]
    v_mfma_f32_32x32x16_bf16 v[54:69], v[174:177], v[110:113], v[54:69]
    v_mfma_f32_32x32x16_bf16 v[86:101], v[174:177], v[126:129], v[86:101]
    v_mfma_f32_32x32x16_bf16 v[54:69], v[206:209], v[126:129], v[54:69]
    v_mfma_f32_32x32x16_bf16 v[86:101], v[206:209], v[142:145], v[86:101]
    v_mfma_f32_32x32x16_bf16 v[54:69], v[178:181], v[114:117], v[54:69]
    v_mfma_f32_32x32x16_bf16 v[86:101], v[178:181], v[130:133], v[86:101]
    v_mfma_f32_32x32x16_bf16 v[54:69], v[210:213], v[130:133], v[54:69]
    v_mfma_f32_32x32x16_bf16 v[86:101], v[210:213], v[146:149], v[86:101]
    s_waitcnt vmcnt(0)
    v_lshlrev_b32 v250, 16, v6
    v_and_b32 v252, 0xffff0000, v6
    v_lshlrev_b32 v251, 16, v7
    v_and_b32 v253, 0xffff0000, v7
    v_pk_mul_f32 v[246:247], v[38:39], v[250:251]
    v_pk_mul_f32 v[248:249], v[38:39], v[252:253]
    v_pk_fma_f32 v[246:247], v[70:71], v[252:253], v[246:247] neg_lo:[1,0,0] neg_hi:[1,0,0]
    v_pk_fma_f32 v[248:249], v[70:71], v[250:251], v[248:249]
    v_cvt_pk_bf16_f32 v102, v246, v247
    v_cvt_pk_bf16_f32 v118, v248, v249
    v_xor_b32 v134, 0x80008000, v118
    v_lshlrev_b32 v250, 16, v8
    v_and_b32 v252, 0xffff0000, v8
    v_lshlrev_b32 v251, 16, v9
    v_and_b32 v253, 0xffff0000, v9
    v_pk_mul_f32 v[246:247], v[40:41], v[250:251]
    v_pk_mul_f32 v[248:249], v[40:41], v[252:253]
    v_pk_fma_f32 v[246:247], v[72:73], v[252:253], v[246:247] neg_lo:[1,0,0] neg_hi:[1,0,0]
    v_pk_fma_f32 v[248:249], v[72:73], v[250:251], v[248:249]
    v_cvt_pk_bf16_f32 v103, v246, v247
    v_cvt_pk_bf16_f32 v119, v248, v249
    v_xor_b32 v135, 0x80008000, v119
    v_lshlrev_b32 v250, 16, v10
    v_and_b32 v252, 0xffff0000, v10
    v_lshlrev_b32 v251, 16, v11
    v_and_b32 v253, 0xffff0000, v11
    v_pk_mul_f32 v[246:247], v[42:43], v[250:251]
    v_pk_mul_f32 v[248:249], v[42:43], v[252:253]
    v_pk_fma_f32 v[246:247], v[74:75], v[252:253], v[246:247] neg_lo:[1,0,0] neg_hi:[1,0,0]
    v_pk_fma_f32 v[248:249], v[74:75], v[250:251], v[248:249]
    v_cvt_pk_bf16_f32 v104, v246, v247
    v_cvt_pk_bf16_f32 v120, v248, v249
    v_xor_b32 v136, 0x80008000, v120
    v_lshlrev_b32 v250, 16, v12
    v_and_b32 v252, 0xffff0000, v12
    v_lshlrev_b32 v251, 16, v13
    v_and_b32 v253, 0xffff0000, v13
    v_pk_mul_f32 v[246:247], v[44:45], v[250:251]
    v_pk_mul_f32 v[248:249], v[44:45], v[252:253]
    v_pk_fma_f32 v[246:247], v[76:77], v[252:253], v[246:247] neg_lo:[1,0,0] neg_hi:[1,0,0]
    v_pk_fma_f32 v[248:249], v[76:77], v[250:251], v[248:249]
    v_cvt_pk_bf16_f32 v105, v246, v247
    v_cvt_pk_bf16_f32 v121, v248, v249
    v_xor_b32 v137, 0x80008000, v121
    v_lshlrev_b32 v250, 16, v14
    v_and_b32 v252, 0xffff0000, v14
    v_lshlrev_b32 v251, 16, v15
    v_and_b32 v253, 0xffff0000, v15
    v_pk_mul_f32 v[246:247], v[46:47], v[250:251]
    v_pk_mul_f32 v[248:249], v[46:47], v[252:253]
    v_pk_fma_f32 v[246:247], v[78:79], v[252:253], v[246:247] neg_lo:[1,0,0] neg_hi:[1,0,0]
    v_pk_fma_f32 v[248:249], v[78:79], v[250:251], v[248:249]
    v_cvt_pk_bf16_f32 v106, v246, v247
    v_cvt_pk_bf16_f32 v122, v248, v249
    v_xor_b32 v138, 0x80008000, v122
    v_lshlrev_b32 v250, 16, v16
    v_and_b32 v252, 0xffff0000, v16
    v_lshlrev_b32 v251, 16, v17
    v_and_b32 v253, 0xffff0000, v17
    v_pk_mul_f32 v[246:247], v[48:49], v[250:251]
    v_pk_mul_f32 v[248:249], v[48:49], v[252:253]
    v_pk_fma_f32 v[246:247], v[80:81], v[252:253], v[246:247] neg_lo:[1,0,0] neg_hi:[1,0,0]
    v_pk_fma_f32 v[248:249], v[80:81], v[250:251], v[248:249]
    v_cvt_pk_bf16_f32 v107, v246, v247
    v_cvt_pk_bf16_f32 v123, v248, v249
    v_xor_b32 v139, 0x80008000, v123
    v_lshlrev_b32 v250, 16, v18
    v_and_b32 v252, 0xffff0000, v18
    v_lshlrev_b32 v251, 16, v19
    v_and_b32 v253, 0xffff0000, v19
    v_pk_mul_f32 v[246:247], v[50:51], v[250:251]
    v_pk_mul_f32 v[248:249], v[50:51], v[252:253]
    v_pk_fma_f32 v[246:247], v[82:83], v[252:253], v[246:247] neg_lo:[1,0,0] neg_hi:[1,0,0]
    v_pk_fma_f32 v[248:249], v[82:83], v[250:251], v[248:249]
    v_cvt_pk_bf16_f32 v108, v246, v247
    v_cvt_pk_bf16_f32 v124, v248, v249
    v_xor_b32 v140, 0x80008000, v124
    v_lshlrev_b32 v250, 16, v20
    v_and_b32 v252, 0xffff0000, v20
    v_lshlrev_b32 v251, 16, v21
    v_and_b32 v253, 0xffff0000, v21
    v_pk_mul_f32 v[246:247], v[52:53], v[250:251]
    v_pk_mul_f32 v[248:249], v[52:53], v[252:253]
    v_pk_fma_f32 v[246:247], v[84:85], v[252:253], v[246:247] neg_lo:[1,0,0] neg_hi:[1,0,0]
    v_pk_fma_f32 v[248:249], v[84:85], v[250:251], v[248:249]
    v_cvt_pk_bf16_f32 v109, v246, v247
    v_cvt_pk_bf16_f32 v125, v248, v249
    v_xor_b32 v141, 0x80008000, v125
    v_lshlrev_b32 v250, 16, v22
    v_and_b32 v252, 0xffff0000, v22
    v_lshlrev_b32 v251, 16, v23
    v_and_b32 v253, 0xffff0000, v23
    v_pk_mul_f32 v[246:247], v[54:55], v[250:251]
    v_pk_mul_f32 v[248:249], v[54:55], v[252:253]
    v_pk_fma_f32 v[246:247], v[86:87], v[252:253], v[246:247] neg_lo:[1,0,0] neg_hi:[1,0,0]
    v_pk_fma_f32 v[248:249], v[86:87], v[250:251], v[248:249]
    v_cvt_pk_bf16_f32 v110, v246, v247
    v_cvt_pk_bf16_f32 v126, v248, v249
    v_xor_b32 v142, 0x80008000, v126
    v_lshlrev_b32 v250, 16, v24
    v_and_b32 v252, 0xffff0000, v24
    v_lshlrev_b32 v251, 16, v25
    v_and_b32 v253, 0xffff0000, v25
    v_pk_mul_f32 v[246:247], v[56:57], v[250:251]
    v_pk_mul_f32 v[248:249], v[56:57], v[252:253]
    v_pk_fma_f32 v[246:247], v[88:89], v[252:253], v[246:247] neg_lo:[1,0,0] neg_hi:[1,0,0]
    v_pk_fma_f32 v[248:249], v[88:89], v[250:251], v[248:249]
    v_cvt_pk_bf16_f32 v111, v246, v247
    v_cvt_pk_bf16_f32 v127, v248, v249
    v_xor_b32 v143, 0x80008000, v127
    v_lshlrev_b32 v250, 16, v26
    v_and_b32 v252, 0xffff0000, v26
    v_lshlrev_b32 v251, 16, v27
    v_and_b32 v253, 0xffff0000, v27
    v_pk_mul_f32 v[246:247], v[58:59], v[250:251]
    v_pk_mul_f32 v[248:249], v[58:59], v[252:253]
    v_pk_fma_f32 v[246:247], v[90:91], v[252:253], v[246:247] neg_lo:[1,0,0] neg_hi:[1,0,0]
    v_pk_fma_f32 v[248:249], v[90:91], v[250:251], v[248:249]
    v_cvt_pk_bf16_f32 v112, v246, v247
    v_cvt_pk_bf16_f32 v128, v248, v249
    v_xor_b32 v144, 0x80008000, v128
    v_lshlrev_b32 v250, 16, v28
    v_and_b32 v252, 0xffff0000, v28
    v_lshlrev_b32 v251, 16, v29
    v_and_b32 v253, 0xffff0000, v29
    v_pk_mul_f32 v[246:247], v[60:61], v[250:251]
    v_pk_mul_f32 v[248:249], v[60:61], v[252:253]
    v_pk_fma_f32 v[246:247], v[92:93], v[252:253], v[246:247] neg_lo:[1,0,0] neg_hi:[1,0,0]
    v_pk_fma_f32 v[248:249], v[92:93], v[250:251], v[248:249]
    v_cvt_pk_bf16_f32 v113, v246, v247
    v_cvt_pk_bf16_f32 v129, v248, v249
    v_xor_b32 v145, 0x80008000, v129
    v_lshlrev_b32 v250, 16, v30
    v_and_b32 v252, 0xffff0000, v30
    v_lshlrev_b32 v251, 16, v31
    v_and_b32 v253, 0xffff0000, v31
    v_pk_mul_f32 v[246:247], v[62:63], v[250:251]
    v_pk_mul_f32 v[248:249], v[62:63], v[252:253]
    v_pk_fma_f32 v[246:247], v[94:95], v[252:253], v[246:247] neg_lo:[1,0,0] neg_hi:[1,0,0]
    v_pk_fma_f32 v[248:249], v[94:95], v[250:251], v[248:249]
    v_cvt_pk_bf16_f32 v114, v246, v247
    v_cvt_pk_bf16_f32 v130, v248, v249
    v_xor_b32 v146, 0x80008000, v130
    v_lshlrev_b32 v250, 16, v32
    v_and_b32 v252, 0xffff0000, v32
    v_lshlrev_b32 v251, 16, v33
    v_and_b32 v253, 0xffff0000, v33
    v_pk_mul_f32 v[246:247], v[64:65], v[250:251]
    v_pk_mul_f32 v[248:249], v[64:65], v[252:253]
    v_pk_fma_f32 v[246:247], v[96:97], v[252:253], v[246:247] neg_lo:[1,0,0] neg_hi:[1,0,0]
    v_pk_fma_f32 v[248:249], v[96:97], v[250:251], v[248:249]
    v_cvt_pk_bf16_f32 v115, v246, v247
    v_cvt_pk_bf16_f32 v131, v248, v249
    v_xor_b32 v147, 0x80008000, v131
    v_lshlrev_b32 v250, 16, v34
    v_and_b32 v252, 0xffff0000, v34
    v_lshlrev_b32 v251, 16, v35
    v_and_b32 v253, 0xffff0000, v35
    v_pk_mul_f32 v[246:247], v[66:67], v[250:251]
    v_pk_mul_f32 v[248:249], v[66:67], v[252:253]
    v_pk_fma_f32 v[246:247], v[98:99], v[252:253], v[246:247] neg_lo:[1,0,0] neg_hi:[1,0,0]
    v_pk_fma_f32 v[248:249], v[98:99], v[250:251], v[248:249]
    v_cvt_pk_bf16_f32 v116, v246, v247
    v_cvt_pk_bf16_f32 v132, v248, v249
    v_xor_b32 v148, 0x80008000, v132
    v_lshlrev_b32 v250, 16, v36
    v_and_b32 v252, 0xffff0000, v36
    v_lshlrev_b32 v251, 16, v37
    v_and_b32 v253, 0xffff0000, v37
    v_pk_mul_f32 v[246:247], v[68:69], v[250:251]
    v_pk_mul_f32 v[248:249], v[68:69], v[252:253]
    v_pk_fma_f32 v[246:247], v[100:101], v[252:253], v[246:247] neg_lo:[1,0,0] neg_hi:[1,0,0]
    v_pk_fma_f32 v[248:249], v[100:101], v[250:251], v[248:249]
    v_cvt_pk_bf16_f32 v117, v246, v247
    v_cvt_pk_bf16_f32 v133, v248, v249
    v_xor_b32 v149, 0x80008000, v133
    ds_read_b128 v[6:9], v5 offset:24576
    ds_read_b128 v[10:13], v5 offset:25600
    ds_read_b128 v[14:17], v5 offset:26624
    ds_read_b128 v[18:21], v5 offset:27648
    v_mfma_f32_32x32x16_bf16 v[38:53], v[102:105], v[150:153], 0
    v_mfma_f32_32x32x16_bf16 v[70:85], v[118:121], v[150:153], 0
    v_mfma_f32_32x32x16_bf16 v[38:53], v[134:137], v[182:185], v[38:53]
    v_mfma_f32_32x32x16_bf16 v[70:85], v[102:105], v[182:185], v[70:85]
    v_mfma_f32_32x32x16_bf16 v[38:53], v[106:109], v[154:157], v[38:53]
    v_mfma_f32_32x32x16_bf16 v[70:85], v[122:125], v[154:157], v[70:85]
    v_mfma_f32_32x32x16_bf16 v[38:53], v[138:141], v[186:189], v[38:53]
    v_mfma_f32_32x32x16_bf16 v[70:85], v[106:109], v[186:189], v[70:85]
    v_mfma_f32_32x32x16_bf16 v[38:53], v[110:113], v[158:161], v[38:53]
    v_mfma_f32_32x32x16_bf16 v[70:85], v[126:129], v[158:161], v[70:85]
    v_mfma_f32_32x32x16_bf16 v[38:53], v[142:145], v[190:193], v[38:53]
    v_mfma_f32_32x32x16_bf16 v[70:85], v[110:113], v[190:193], v[70:85]
    v_mfma_f32_32x32x16_bf16 v[38:53], v[114:117], v[162:165], v[38:53]
    v_mfma_f32_32x32x16_bf16 v[70:85], v[130:133], v[162:165], v[70:85]
    v_mfma_f32_32x32x16_bf16 v[38:53], v[146:149], v[194:197], v[38:53]
    v_mfma_f32_32x32x16_bf16 v[70:85], v[114:117], v[194:197], v[70:85]
    v_mfma_f32_32x32x16_bf16 v[54:69], v[102:105], v[166:169], 0
    v_mfma_f32_32x32x16_bf16 v[86:101], v[118:121], v[166:169], 0
    v_mfma_f32_32x32x16_bf16 v[54:69], v[134:137], v[198:201], v[54:69]
    v_mfma_f32_32x32x16_bf16 v[86:101], v[102:105], v[198:201], v[86:101]
    v_mfma_f32_32x32x16_bf16 v[54:69], v[106:109], v[170:173], v[54:69]
    v_mfma_f32_32x32x16_bf16 v[86:101], v[122:125], v[170:173], v[86:101]
    v_mfma_f32_32x32x16_bf16 v[54:69], v[138:141], v[202:205], v[54:69]
    v_mfma_f32_32x32x16_bf16 v[86:101], v[106:109], v[202:205], v[86:101]
    v_mfma_f32_32x32x16_bf16 v[54:69], v[110:113], v[174:177], v[54:69]
    v_mfma_f32_32x32x16_bf16 v[86:101], v[126:129], v[174:177], v[86:101]
    v_mfma_f32_32x32x16_bf16 v[54:69], v[142:145], v[206:209], v[54:69]
    v_mfma_f32_32x32x16_bf16 v[86:101], v[110:113], v[206:209], v[86:101]
    v_mfma_f32_32x32x16_bf16 v[54:69], v[114:117], v[178:181], v[54:69]
    v_mfma_f32_32x32x16_bf16 v[86:101], v[130:133], v[178:181], v[86:101]
    v_mfma_f32_32x32x16_bf16 v[54:69], v[146:149], v[210:213], v[54:69]
    v_mfma_f32_32x32x16_bf16 v[86:101], v[114:117], v[210:213], v[86:101]
    s_waitcnt lgkmcnt(8)
    v_pk_mul_f32 v[246:247], v[38:39], v[214:215]
    v_pk_mul_f32 v[248:249], v[38:39], v[218:219]
    v_pk_fma_f32 v[246:247], v[70:71], v[218:219], v[246:247] neg_lo:[1,0,0] neg_hi:[1,0,0]
    v_pk_fma_f32 v[248:249], v[70:71], v[214:215], v[248:249]
    v_cvt_pk_bf16_f32 v102, v246, v247
    v_cvt_pk_bf16_f32 v118, v248, v249
    v_xor_b32 v134, 0x80008000, v118
    v_pk_mul_f32 v[246:247], v[40:41], v[216:217]
    v_pk_mul_f32 v[248:249], v[40:41], v[220:221]
    v_pk_fma_f32 v[246:247], v[72:73], v[220:221], v[246:247] neg_lo:[1,0,0] neg_hi:[1,0,0]
    v_pk_fma_f32 v[248:249], v[72:73], v[216:217], v[248:249]
    v_cvt_pk_bf16_f32 v103, v246, v247
    v_cvt_pk_bf16_f32 v119, v248, v249
    v_xor_b32 v135, 0x80008000, v119
    v_pk_mul_f32 v[246:247], v[42:43], v[222:223]
    v_pk_mul_f32 v[248:249], v[42:43], v[226:227]
    v_pk_fma_f32 v[246:247], v[74:75], v[226:227], v[246:247] neg_lo:[1,0,0] neg_hi:[1,0,0]
    v_pk_fma_f32 v[248:249], v[74:75], v[222:223], v[248:249]
    v_cvt_pk_bf16_f32 v104, v246, v247
    v_cvt_pk_bf16_f32 v120, v248, v249
    v_xor_b32 v136, 0x80008000, v120
    v_pk_mul_f32 v[246:247], v[44:45], v[224:225]
    v_pk_mul_f32 v[248:249], v[44:45], v[228:229]
    v_pk_fma_f32 v[246:247], v[76:77], v[228:229], v[246:247] neg_lo:[1,0,0] neg_hi:[1,0,0]
    v_pk_fma_f32 v[248:249], v[76:77], v[224:225], v[248:249]
    v_cvt_pk_bf16_f32 v105, v246, v247
    v_cvt_pk_bf16_f32 v121, v248, v249
    v_xor_b32 v137, 0x80008000, v121
    ds_read_b128 v[214:217], v5 offset:53248
    ds_read_b128 v[218:221], v5 offset:54272
    ds_read_b128 v[222:225], v5 offset:55296
    ds_read_b128 v[226:229], v5 offset:56320
    s_waitcnt lgkmcnt(8)
    v_pk_mul_f32 v[246:247], v[46:47], v[230:231]
    v_pk_mul_f32 v[248:249], v[46:47], v[234:235]
    v_pk_fma_f32 v[246:247], v[78:79], v[234:235], v[246:247] neg_lo:[1,0,0] neg_hi:[1,0,0]
    v_pk_fma_f32 v[248:249], v[78:79], v[230:231], v[248:249]
    v_cvt_pk_bf16_f32 v106, v246, v247
    v_cvt_pk_bf16_f32 v122, v248, v249
    v_xor_b32 v138, 0x80008000, v122
    v_pk_mul_f32 v[246:247], v[48:49], v[232:233]
    v_pk_mul_f32 v[248:249], v[48:49], v[236:237]
    v_pk_fma_f32 v[246:247], v[80:81], v[236:237], v[246:247] neg_lo:[1,0,0] neg_hi:[1,0,0]
    v_pk_fma_f32 v[248:249], v[80:81], v[232:233], v[248:249]
    v_cvt_pk_bf16_f32 v107, v246, v247
    v_cvt_pk_bf16_f32 v123, v248, v249
    v_xor_b32 v139, 0x80008000, v123
    v_pk_mul_f32 v[246:247], v[50:51], v[238:239]
    v_pk_mul_f32 v[248:249], v[50:51], v[242:243]
    v_pk_fma_f32 v[246:247], v[82:83], v[242:243], v[246:247] neg_lo:[1,0,0] neg_hi:[1,0,0]
    v_pk_fma_f32 v[248:249], v[82:83], v[238:239], v[248:249]
    v_cvt_pk_bf16_f32 v108, v246, v247
    v_cvt_pk_bf16_f32 v124, v248, v249
    v_xor_b32 v140, 0x80008000, v124
    v_pk_mul_f32 v[246:247], v[52:53], v[240:241]
    v_pk_mul_f32 v[248:249], v[52:53], v[244:245]
    v_pk_fma_f32 v[246:247], v[84:85], v[244:245], v[246:247] neg_lo:[1,0,0] neg_hi:[1,0,0]
    v_pk_fma_f32 v[248:249], v[84:85], v[240:241], v[248:249]
    v_cvt_pk_bf16_f32 v109, v246, v247
    v_cvt_pk_bf16_f32 v125, v248, v249
    v_xor_b32 v141, 0x80008000, v125
    ds_read_b128 v[230:233], v5 offset:57344
    ds_read_b128 v[234:237], v5 offset:58368
    ds_read_b128 v[238:241], v5 offset:59392
    ds_read_b128 v[242:245], v5 offset:60416
    s_waitcnt lgkmcnt(4)
    v_pk_mul_f32 v[246:247], v[54:55], v[214:215]
    v_pk_mul_f32 v[248:249], v[54:55], v[218:219]
    v_pk_fma_f32 v[246:247], v[86:87], v[218:219], v[246:247] neg_lo:[1,0,0] neg_hi:[1,0,0]
    v_pk_fma_f32 v[248:249], v[86:87], v[214:215], v[248:249]
    v_cvt_pk_bf16_f32 v110, v246, v247
    v_cvt_pk_bf16_f32 v126, v248, v249
    v_xor_b32 v142, 0x80008000, v126
    v_pk_mul_f32 v[246:247], v[56:57], v[216:217]
    v_pk_mul_f32 v[248:249], v[56:57], v[220:221]
    v_pk_fma_f32 v[246:247], v[88:89], v[220:221], v[246:247] neg_lo:[1,0,0] neg_hi:[1,0,0]
    v_pk_fma_f32 v[248:249], v[88:89], v[216:217], v[248:249]
    v_cvt_pk_bf16_f32 v111, v246, v247
    v_cvt_pk_bf16_f32 v127, v248, v249
    v_xor_b32 v143, 0x80008000, v127
    v_pk_mul_f32 v[246:247], v[58:59], v[222:223]
    v_pk_mul_f32 v[248:249], v[58:59], v[226:227]
    v_pk_fma_f32 v[246:247], v[90:91], v[226:227], v[246:247] neg_lo:[1,0,0] neg_hi:[1,0,0]
    v_pk_fma_f32 v[248:249], v[90:91], v[222:223], v[248:249]
    v_cvt_pk_bf16_f32 v112, v246, v247
    v_cvt_pk_bf16_f32 v128, v248, v249
    v_xor_b32 v144, 0x80008000, v128
    v_pk_mul_f32 v[246:247], v[60:61], v[224:225]
    v_pk_mul_f32 v[248:249], v[60:61], v[228:229]
    v_pk_fma_f32 v[246:247], v[92:93], v[228:229], v[246:247] neg_lo:[1,0,0] neg_hi:[1,0,0]
    v_pk_fma_f32 v[248:249], v[92:93], v[224:225], v[248:249]
    v_cvt_pk_bf16_f32 v113, v246, v247
    v_cvt_pk_bf16_f32 v129, v248, v249
    v_xor_b32 v145, 0x80008000, v129
    s_waitcnt lgkmcnt(0)
    v_pk_mul_f32 v[246:247], v[62:63], v[230:231]
    v_pk_mul_f32 v[248:249], v[62:63], v[234:235]
    v_pk_fma_f32 v[246:247], v[94:95], v[234:235], v[246:247] neg_lo:[1,0,0] neg_hi:[1,0,0]
    v_pk_fma_f32 v[248:249], v[94:95], v[230:231], v[248:249]
    v_cvt_pk_bf16_f32 v114, v246, v247
    v_cvt_pk_bf16_f32 v130, v248, v249
    v_xor_b32 v146, 0x80008000, v130
    v_pk_mul_f32 v[246:247], v[64:65], v[232:233]
    v_pk_mul_f32 v[248:249], v[64:65], v[236:237]
    v_pk_fma_f32 v[246:247], v[96:97], v[236:237], v[246:247] neg_lo:[1,0,0] neg_hi:[1,0,0]
    v_pk_fma_f32 v[248:249], v[96:97], v[232:233], v[248:249]
    v_cvt_pk_bf16_f32 v115, v246, v247
    v_cvt_pk_bf16_f32 v131, v248, v249
    v_xor_b32 v147, 0x80008000, v131
    v_pk_mul_f32 v[246:247], v[66:67], v[238:239]
    v_pk_mul_f32 v[248:249], v[66:67], v[242:243]
    v_pk_fma_f32 v[246:247], v[98:99], v[242:243], v[246:247] neg_lo:[1,0,0] neg_hi:[1,0,0]
    v_pk_fma_f32 v[248:249], v[98:99], v[238:239], v[248:249]
    v_cvt_pk_bf16_f32 v116, v246, v247
    v_cvt_pk_bf16_f32 v132, v248, v249
    v_xor_b32 v148, 0x80008000, v132
    v_pk_mul_f32 v[246:247], v[68:69], v[240:241]
    v_pk_mul_f32 v[248:249], v[68:69], v[244:245]
    v_pk_fma_f32 v[246:247], v[100:101], v[244:245], v[246:247] neg_lo:[1,0,0] neg_hi:[1,0,0]
    v_pk_fma_f32 v[248:249], v[100:101], v[240:241], v[248:249]
    v_cvt_pk_bf16_f32 v117, v246, v247
    v_cvt_pk_bf16_f32 v133, v248, v249
    v_xor_b32 v149, 0x80008000, v133
    v_mfma_f32_32x32x16_bf16 v[38:53], v[6:9], v[102:105], 0
    v_mfma_f32_32x32x16_bf16 v[70:85], v[6:9], v[118:121], 0
    v_mfma_f32_32x32x16_bf16 v[38:53], v[14:17], v[134:137], v[38:53]
    v_mfma_f32_32x32x16_bf16 v[70:85], v[14:17], v[102:105], v[70:85]
    v_mfma_f32_32x32x16_bf16 v[38:53], v[10:13], v[106:109], v[38:53]
    v_mfma_f32_32x32x16_bf16 v[70:85], v[10:13], v[122:125], v[70:85]
    v_mfma_f32_32x32x16_bf16 v[38:53], v[18:21], v[138:141], v[38:53]
    v_mfma_f32_32x32x16_bf16 v[70:85], v[18:21], v[106:109], v[70:85]
    v_mfma_f32_32x32x16_bf16 v[54:69], v[6:9], v[110:113], 0
    v_mfma_f32_32x32x16_bf16 v[86:101], v[6:9], v[126:129], 0
    v_mfma_f32_32x32x16_bf16 v[54:69], v[14:17], v[142:145], v[54:69]
    v_mfma_f32_32x32x16_bf16 v[86:101], v[14:17], v[110:113], v[86:101]
    v_mfma_f32_32x32x16_bf16 v[54:69], v[10:13], v[114:117], v[54:69]
    v_mfma_f32_32x32x16_bf16 v[86:101], v[10:13], v[130:133], v[86:101]
    v_mfma_f32_32x32x16_bf16 v[54:69], v[18:21], v[146:149], v[54:69]
    v_mfma_f32_32x32x16_bf16 v[86:101], v[18:21], v[114:117], v[86:101]
    s_lshl_b32 s32, s91, 8
    v_bfe_u32 v246, v0, 1, 4
    v_mul_u32_u24 v247, 73728, v246
    v_sub_u32 v2, v2, v247
    v_sub_u32 v3, v3, v247
    v_add_u32 v2, s100, v2
    v_add_u32 v3, s100, v3
    v_cvt_pk_bf16_f32 v150, v38, v39
    v_cvt_pk_bf16_f32 v151, v40, v41
    v_cvt_pk_bf16_f32 v152, v42, v43
    v_cvt_pk_bf16_f32 v153, v44, v45
    s_nop 0
    v_permlane32_swap_b32 v150, v152
    v_permlane32_swap_b32 v151, v153
    ds_write_b128 v2, v[150:153] offset:0
    v_cvt_pk_bf16_f32 v154, v46, v47
    v_cvt_pk_bf16_f32 v155, v48, v49
    v_cvt_pk_bf16_f32 v156, v50, v51
    v_cvt_pk_bf16_f32 v157, v52, v53
    s_nop 0
    v_permlane32_swap_b32 v154, v156
    v_permlane32_swap_b32 v155, v157
    ds_write_b128 v3, v[154:157] offset:0
    v_cvt_pk_bf16_f32 v158, v70, v71
    v_cvt_pk_bf16_f32 v159, v72, v73
    v_cvt_pk_bf16_f32 v160, v74, v75
    v_cvt_pk_bf16_f32 v161, v76, v77
    s_nop 0
    v_permlane32_swap_b32 v158, v160
    v_permlane32_swap_b32 v159, v161
    ds_write_b128 v2, v[158:161] offset:128
    v_cvt_pk_bf16_f32 v162, v78, v79
    v_cvt_pk_bf16_f32 v163, v80, v81
    v_cvt_pk_bf16_f32 v164, v82, v83
    v_cvt_pk_bf16_f32 v165, v84, v85
    s_nop 0
    v_permlane32_swap_b32 v162, v164
    v_permlane32_swap_b32 v163, v165
    ds_write_b128 v3, v[162:165] offset:128
    v_cvt_pk_bf16_f32 v166, v54, v55
    v_cvt_pk_bf16_f32 v167, v56, v57
    v_cvt_pk_bf16_f32 v168, v58, v59
    v_cvt_pk_bf16_f32 v169, v60, v61
    s_nop 0
    v_permlane32_swap_b32 v166, v168
    v_permlane32_swap_b32 v167, v169
    ds_write_b128 v2, v[166:169] offset:4096
    v_cvt_pk_bf16_f32 v170, v62, v63
    v_cvt_pk_bf16_f32 v171, v64, v65
    v_cvt_pk_bf16_f32 v172, v66, v67
    v_cvt_pk_bf16_f32 v173, v68, v69
    s_nop 0
    v_permlane32_swap_b32 v170, v172
    v_permlane32_swap_b32 v171, v173
    ds_write_b128 v3, v[170:173] offset:4096
    v_cvt_pk_bf16_f32 v174, v86, v87
    v_cvt_pk_bf16_f32 v175, v88, v89
    v_cvt_pk_bf16_f32 v176, v90, v91
    v_cvt_pk_bf16_f32 v177, v92, v93
    s_nop 0
    v_permlane32_swap_b32 v174, v176
    v_permlane32_swap_b32 v175, v177
    ds_write_b128 v2, v[174:177] offset:4224
    v_cvt_pk_bf16_f32 v178, v94, v95
    v_cvt_pk_bf16_f32 v179, v96, v97
    v_cvt_pk_bf16_f32 v180, v98, v99
    v_cvt_pk_bf16_f32 v181, v100, v101
    s_nop 0
    v_permlane32_swap_b32 v178, v180
    v_permlane32_swap_b32 v179, v181
    ds_write_b128 v3, v[178:181] offset:4224
    v_add_u32 v246, s100, v1
    v_lshrrev_b32 v247, 4, v0
    v_mul_u32_u24 v247, 73984, v247
    v_and_b32 v248, 15, v0
    v_lshl_add_u32 v247, v248, 4, v247
    s_waitcnt lgkmcnt(0)
    ds_read_b128 v[38:41], v246 offset:0
    ds_read_b128 v[42:45], v246 offset:1024
    ds_read_b128 v[46:49], v246 offset:2048
    ds_read_b128 v[50:53], v246 offset:3072
    ds_read_b128 v[54:57], v246 offset:4096
    ds_read_b128 v[58:61], v246 offset:5120
    ds_read_b128 v[62:65], v246 offset:6144
    ds_read_b128 v[66:69], v246 offset:7168
    s_waitcnt lgkmcnt(7)
    s_add_u32 s33, s32, 0
    buffer_store_dwordx4 v[38:41], v247, s[20:23], s33 offen sc1
    s_waitcnt lgkmcnt(6)
    s_add_u32 s33, s32, 295936
    buffer_store_dwordx4 v[42:45], v247, s[20:23], s33 offen sc1
    s_waitcnt lgkmcnt(5)
    s_add_u32 s33, s32, 591872
    buffer_store_dwordx4 v[46:49], v247, s[20:23], s33 offen sc1
    s_waitcnt lgkmcnt(4)
    s_add_u32 s33, s32, 887808
    buffer_store_dwordx4 v[50:53], v247, s[20:23], s33 offen sc1
    s_waitcnt lgkmcnt(3)
    s_add_u32 s33, s32, 1183744
    buffer_store_dwordx4 v[54:57], v247, s[20:23], s33 offen sc1
    s_waitcnt lgkmcnt(2)
    s_add_u32 s33, s32, 1479680
    buffer_store_dwordx4 v[58:61], v247, s[20:23], s33 offen sc1
    s_waitcnt lgkmcnt(1)
    s_add_u32 s33, s32, 1775616
    buffer_store_dwordx4 v[62:65], v247, s[20:23], s33 offen sc1
    s_waitcnt lgkmcnt(0)
    s_add_u32 s33, s32, 2071552
    buffer_store_dwordx4 v[66:69], v247, s[20:23], s33 offen sc1
    s_waitcnt vmcnt(0)
    s_lshl_b32 s24, s91, 2
    v_mov_b32 v2, s57
    v_mov_b32 v3, 0
    buffer_store_dword v2, v3, s[28:31], s24 offen sc1
aux_done:
g2_exit:
    s_endpgm
code_end:
.section .rodata,"a"
.p2align 6
.amdhsa_kernel recurrent_scan__spectral_gfnet__dense_activation_squared_relu__prompt_kernel
  .amdhsa_next_free_vgpr 256
  .amdhsa_next_free_sgpr 102
  .amdhsa_accum_offset 256
  .amdhsa_group_segment_fixed_size 0
  .amdhsa_kernarg_size 88
  .amdhsa_user_sgpr_count 2
  .amdhsa_user_sgpr_kernarg_segment_ptr 1
  .amdhsa_system_sgpr_workgroup_id_x 1
  .amdhsa_float_denorm_mode_32 3
.end_amdhsa_kernel
.section .rodata,"a"
.p2align 8
.set ct_0, 0x3f80
.set ct_1, 0x3f80
.set ct_2, 0x3f80
.set ct_3, 0x3f80
.set ct_4, 0x3f80
.set ct_5, 0x3f80
.set ct_6, 0x3f7f
.set ct_7, 0x3f7f
.set ct_8, 0x3f7f
.set ct_9, 0x3f7f
.set ct_10, 0x3f7e
.set ct_11, 0x3f7e
.set ct_12, 0x3f7e
.set ct_13, 0x3f7d
.set ct_14, 0x3f7d
.set ct_15, 0x3f7d
.set ct_16, 0x3f7c
.set ct_17, 0x3f7c
.set ct_18, 0x3f7b
.set ct_19, 0x3f7b
.set ct_20, 0x3f7a
.set ct_21, 0x3f79
.set ct_22, 0x3f79
.set ct_23, 0x3f78
.set ct_24, 0x3f77
.set ct_25, 0x3f77
.set ct_26, 0x3f76
.set ct_27, 0x3f75
.set ct_28, 0x3f74
.set ct_29, 0x3f73
.set ct_30, 0x3f72
.set ct_31, 0x3f72
.set ct_32, 0x3f71
.set ct_33, 0x3f70
.set ct_34, 0x3f6f
.set ct_35, 0x3f6e
.set ct_36, 0x3f6d
.set ct_37, 0x3f6b
.set ct_38, 0x3f6a
.set ct_39, 0x3f69
.set ct_40, 0x3f68
.set ct_41, 0x3f67
.set ct_42, 0x3f66
.set ct_43, 0x3f64
.set ct_44, 0x3f63
.set ct_45, 0x3f62
.set ct_46, 0x3f60
.set ct_47, 0x3f5f
.set ct_48, 0x3f5e
.set ct_49, 0x3f5c
.set ct_50, 0x3f5b
.set ct_51, 0x3f59
.set ct_52, 0x3f58
.set ct_53, 0x3f56
.set ct_54, 0x3f55
.set ct_55, 0x3f53
.set ct_56, 0x3f52
.set ct_57, 0x3f50
.set ct_58, 0x3f4e
.set ct_59, 0x3f4d
.set ct_60, 0x3f4b
.set ct_61, 0x3f49
.set ct_62, 0x3f48
.set ct_63, 0x3f46
.set ct_64, 0x3f44
.set ct_65, 0x3f42
.set ct_66, 0x3f40
.set ct_67, 0x3f3f
.set ct_68, 0x3f3d
.set ct_69, 0x3f3b
.set ct_70, 0x3f39
.set ct_71, 0x3f37
.set ct_72, 0x3f35
.set ct_73, 0x3f33
.set ct_74, 0x3f31
.set ct_75, 0x3f2f
.set ct_76, 0x3f2d
.set ct_77, 0x3f2b
.set ct_78, 0x3f29
.set ct_79, 0x3f27
.set ct_80, 0x3f25
.set ct_81, 0x3f22
.set ct_82, 0x3f20
.set ct_83, 0x3f1e
.set ct_84, 0x3f1c
.set ct_85, 0x3f1a
.set ct_86, 0x3f17
.set ct_87, 0x3f15
.set ct_88, 0x3f13
.set ct_89, 0x3f11
.set ct_90, 0x3f0e
.set ct_91, 0x3f0c
.set ct_92, 0x3f0a
.set ct_93, 0x3f07
.set ct_94, 0x3f05
.set ct_95, 0x3f02
.set ct_96, 0x3f00
.set ct_97, 0x3efb
.set ct_98, 0x3ef6
.set ct_99, 0x3ef1
.set ct_100, 0x3eec
.set ct_101, 0x3ee7
.set ct_102, 0x3ee2
.set ct_103, 0x3edd
.set ct_104, 0x3ed8
.set ct_105, 0x3ed3
.set ct_106, 0x3ece
.set ct_107, 0x3ec9
.set ct_108, 0x3ec4
.set ct_109, 0x3ebf
.set ct_110, 0x3eba
.set ct_111, 0x3eb4
.set ct_112, 0x3eaf
.set ct_113, 0x3eaa
.set ct_114, 0x3ea5
.set ct_115, 0x3e9f
.set ct_116, 0x3e9a
.set ct_117, 0x3e95
.set ct_118, 0x3e8f
.set ct_119, 0x3e8a
.set ct_120, 0x3e85
.set ct_121, 0x3e7e
.set ct_122, 0x3e73
.set ct_123, 0x3e69
.set ct_124, 0x3e5e
.set ct_125, 0x3e53
.set ct_126, 0x3e48
.set ct_127, 0x3e3d
.set ct_128, 0x3e32
.set ct_129, 0x3e27
.set ct_130, 0x3e1c
.set ct_131, 0x3e11
.set ct_132, 0x3e06
.set ct_133, 0x3df5
.set ct_134, 0x3ddf
.set ct_135, 0x3dc9
.set ct_136, 0x3db2
.set ct_137, 0x3d9c
.set ct_138, 0x3d86
.set ct_139, 0x3d5f
.set ct_140, 0x3d33
.set ct_141, 0x3d06
.set ct_142, 0x3cb3
.set ct_143, 0x3c33
.set ct_144, 0x0000
.set ct_145, 0xbc33
.set ct_146, 0xbcb3
.set ct_147, 0xbd06
.set ct_148, 0xbd33
.set ct_149, 0xbd5f
.set ct_150, 0xbd86
.set ct_151, 0xbd9c
.set ct_152, 0xbdb2
.set ct_153, 0xbdc9
.set ct_154, 0xbddf
.set ct_155, 0xbdf5
.set ct_156, 0xbe06
.set ct_157, 0xbe11
.set ct_158, 0xbe1c
.set ct_159, 0xbe27
.set ct_160, 0xbe32
.set ct_161, 0xbe3d
.set ct_162, 0xbe48
.set ct_163, 0xbe53
.set ct_164, 0xbe5e
.set ct_165, 0xbe69
.set ct_166, 0xbe73
.set ct_167, 0xbe7e
.set ct_168, 0xbe85
.set ct_169, 0xbe8a
.set ct_170, 0xbe8f
.set ct_171, 0xbe95
.set ct_172, 0xbe9a
.set ct_173, 0xbe9f
.set ct_174, 0xbea5
.set ct_175, 0xbeaa
.set ct_176, 0xbeaf
.set ct_177, 0xbeb4
.set ct_178, 0xbeba
.set ct_179, 0xbebf
.set ct_180, 0xbec4
.set ct_181, 0xbec9
.set ct_182, 0xbece
.set ct_183, 0xbed3
.set ct_184, 0xbed8
.set ct_185, 0xbedd
.set ct_186, 0xbee2
.set ct_187, 0xbee7
.set ct_188, 0xbeec
.set ct_189, 0xbef1
.set ct_190, 0xbef6
.set ct_191, 0xbefb
.set ct_192, 0xbf00
.set ct_193, 0xbf02
.set ct_194, 0xbf05
.set ct_195, 0xbf07
.set ct_196, 0xbf0a
.set ct_197, 0xbf0c
.set ct_198, 0xbf0e
.set ct_199, 0xbf11
.set ct_200, 0xbf13
.set ct_201, 0xbf15
.set ct_202, 0xbf17
.set ct_203, 0xbf1a
.set ct_204, 0xbf1c
.set ct_205, 0xbf1e
.set ct_206, 0xbf20
.set ct_207, 0xbf22
.set ct_208, 0xbf25
.set ct_209, 0xbf27
.set ct_210, 0xbf29
.set ct_211, 0xbf2b
.set ct_212, 0xbf2d
.set ct_213, 0xbf2f
.set ct_214, 0xbf31
.set ct_215, 0xbf33
.set ct_216, 0xbf35
.set ct_217, 0xbf37
.set ct_218, 0xbf39
.set ct_219, 0xbf3b
.set ct_220, 0xbf3d
.set ct_221, 0xbf3f
.set ct_222, 0xbf40
.set ct_223, 0xbf42
.set ct_224, 0xbf44
.set ct_225, 0xbf46
.set ct_226, 0xbf48
.set ct_227, 0xbf49
.set ct_228, 0xbf4b
.set ct_229, 0xbf4d
.set ct_230, 0xbf4e
.set ct_231, 0xbf50
.set ct_232, 0xbf52
.set ct_233, 0xbf53
.set ct_234, 0xbf55
.set ct_235, 0xbf56
.set ct_236, 0xbf58
.set ct_237, 0xbf59
.set ct_238, 0xbf5b
.set ct_239, 0xbf5c
.set ct_240, 0xbf5e
.set ct_241, 0xbf5f
.set ct_242, 0xbf60
.set ct_243, 0xbf62
.set ct_244, 0xbf63
.set ct_245, 0xbf64
.set ct_246, 0xbf66
.set ct_247, 0xbf67
.set ct_248, 0xbf68
.set ct_249, 0xbf69
.set ct_250, 0xbf6a
.set ct_251, 0xbf6b
.set ct_252, 0xbf6d
.set ct_253, 0xbf6e
.set ct_254, 0xbf6f
.set ct_255, 0xbf70
.set ct_256, 0xbf71
.set ct_257, 0xbf72
.set ct_258, 0xbf72
.set ct_259, 0xbf73
.set ct_260, 0xbf74
.set ct_261, 0xbf75
.set ct_262, 0xbf76
.set ct_263, 0xbf77
.set ct_264, 0xbf77
.set ct_265, 0xbf78
.set ct_266, 0xbf79
.set ct_267, 0xbf79
.set ct_268, 0xbf7a
.set ct_269, 0xbf7b
.set ct_270, 0xbf7b
.set ct_271, 0xbf7c
.set ct_272, 0xbf7c
.set ct_273, 0xbf7d
.set ct_274, 0xbf7d
.set ct_275, 0xbf7d
.set ct_276, 0xbf7e
.set ct_277, 0xbf7e
.set ct_278, 0xbf7e
.set ct_279, 0xbf7f
.set ct_280, 0xbf7f
.set ct_281, 0xbf7f
.set ct_282, 0xbf7f
.set ct_283, 0xbf80
.set ct_284, 0xbf80
.set ct_285, 0xbf80
.set ct_286, 0xbf80
.set ct_287, 0xbf80
.set ct_288, 0xbf80
.set ct_289, 0xbf80
.set ct_290, 0xbf80
.set ct_291, 0xbf80
.set ct_292, 0xbf80
.set ct_293, 0xbf80
.set ct_294, 0xbf7f
.set ct_295, 0xbf7f
.set ct_296, 0xbf7f
.set ct_297, 0xbf7f
.set ct_298, 0xbf7e
.set ct_299, 0xbf7e
.set ct_300, 0xbf7e
.set ct_301, 0xbf7d
.set ct_302, 0xbf7d
.set ct_303, 0xbf7d
.set ct_304, 0xbf7c
.set ct_305, 0xbf7c
.set ct_306, 0xbf7b
.set ct_307, 0xbf7b
.set ct_308, 0xbf7a
.set ct_309, 0xbf79
.set ct_310, 0xbf79
.set ct_311, 0xbf78
.set ct_312, 0xbf77
.set ct_313, 0xbf77
.set ct_314, 0xbf76
.set ct_315, 0xbf75
.set ct_316, 0xbf74
.set ct_317, 0xbf73
.set ct_318, 0xbf72
.set ct_319, 0xbf72
.set ct_320, 0xbf71
.set ct_321, 0xbf70
.set ct_322, 0xbf6f
.set ct_323, 0xbf6e
.set ct_324, 0xbf6d
.set ct_325, 0xbf6b
.set ct_326, 0xbf6a
.set ct_327, 0xbf69
.set ct_328, 0xbf68
.set ct_329, 0xbf67
.set ct_330, 0xbf66
.set ct_331, 0xbf64
.set ct_332, 0xbf63
.set ct_333, 0xbf62
.set ct_334, 0xbf60
.set ct_335, 0xbf5f
.set ct_336, 0xbf5e
.set ct_337, 0xbf5c
.set ct_338, 0xbf5b
.set ct_339, 0xbf59
.set ct_340, 0xbf58
.set ct_341, 0xbf56
.set ct_342, 0xbf55
.set ct_343, 0xbf53
.set ct_344, 0xbf52
.set ct_345, 0xbf50
.set ct_346, 0xbf4e
.set ct_347, 0xbf4d
.set ct_348, 0xbf4b
.set ct_349, 0xbf49
.set ct_350, 0xbf48
.set ct_351, 0xbf46
.set ct_352, 0xbf44
.set ct_353, 0xbf42
.set ct_354, 0xbf40
.set ct_355, 0xbf3f
.set ct_356, 0xbf3d
.set ct_357, 0xbf3b
.set ct_358, 0xbf39
.set ct_359, 0xbf37
.set ct_360, 0xbf35
.set ct_361, 0xbf33
.set ct_362, 0xbf31
.set ct_363, 0xbf2f
.set ct_364, 0xbf2d
.set ct_365, 0xbf2b
.set ct_366, 0xbf29
.set ct_367, 0xbf27
.set ct_368, 0xbf25
.set ct_369, 0xbf22
.set ct_370, 0xbf20
.set ct_371, 0xbf1e
.set ct_372, 0xbf1c
.set ct_373, 0xbf1a
.set ct_374, 0xbf17
.set ct_375, 0xbf15
.set ct_376, 0xbf13
.set ct_377, 0xbf11
.set ct_378, 0xbf0e
.set ct_379, 0xbf0c
.set ct_380, 0xbf0a
.set ct_381, 0xbf07
.set ct_382, 0xbf05
.set ct_383, 0xbf02
.set ct_384, 0xbf00
.set ct_385, 0xbefb
.set ct_386, 0xbef6
.set ct_387, 0xbef1
.set ct_388, 0xbeec
.set ct_389, 0xbee7
.set ct_390, 0xbee2
.set ct_391, 0xbedd
.set ct_392, 0xbed8
.set ct_393, 0xbed3
.set ct_394, 0xbece
.set ct_395, 0xbec9
.set ct_396, 0xbec4
.set ct_397, 0xbebf
.set ct_398, 0xbeba
.set ct_399, 0xbeb4
.set ct_400, 0xbeaf
.set ct_401, 0xbeaa
.set ct_402, 0xbea5
.set ct_403, 0xbe9f
.set ct_404, 0xbe9a
.set ct_405, 0xbe95
.set ct_406, 0xbe8f
.set ct_407, 0xbe8a
.set ct_408, 0xbe85
.set ct_409, 0xbe7e
.set ct_410, 0xbe73
.set ct_411, 0xbe69
.set ct_412, 0xbe5e
.set ct_413, 0xbe53
.set ct_414, 0xbe48
.set ct_415, 0xbe3d
.set ct_416, 0xbe32
.set ct_417, 0xbe27
.set ct_418, 0xbe1c
.set ct_419, 0xbe11
.set ct_420, 0xbe06
.set ct_421, 0xbdf5
.set ct_422, 0xbddf
.set ct_423, 0xbdc9
.set ct_424, 0xbdb2
.set ct_425, 0xbd9c
.set ct_426, 0xbd86
.set ct_427, 0xbd5f
.set ct_428, 0xbd33
.set ct_429, 0xbd06
.set ct_430, 0xbcb3
.set ct_431, 0xbc33
.set ct_432, 0x0000
.set ct_433, 0x3c33
.set ct_434, 0x3cb3
.set ct_435, 0x3d06
.set ct_436, 0x3d33
.set ct_437, 0x3d5f
.set ct_438, 0x3d86
.set ct_439, 0x3d9c
.set ct_440, 0x3db2
.set ct_441, 0x3dc9
.set ct_442, 0x3ddf
.set ct_443, 0x3df5
.set ct_444, 0x3e06
.set ct_445, 0x3e11
.set ct_446, 0x3e1c
.set ct_447, 0x3e27
.set ct_448, 0x3e32
.set ct_449, 0x3e3d
.set ct_450, 0x3e48
.set ct_451, 0x3e53
.set ct_452, 0x3e5e
.set ct_453, 0x3e69
.set ct_454, 0x3e73
.set ct_455, 0x3e7e
.set ct_456, 0x3e85
.set ct_457, 0x3e8a
.set ct_458, 0x3e8f
.set ct_459, 0x3e95
.set ct_460, 0x3e9a
.set ct_461, 0x3e9f
.set ct_462, 0x3ea5
.set ct_463, 0x3eaa
.set ct_464, 0x3eaf
.set ct_465, 0x3eb4
.set ct_466, 0x3eba
.set ct_467, 0x3ebf
.set ct_468, 0x3ec4
.set ct_469, 0x3ec9
.set ct_470, 0x3ece
.set ct_471, 0x3ed3
.set ct_472, 0x3ed8
.set ct_473, 0x3edd
.set ct_474, 0x3ee2
.set ct_475, 0x3ee7
.set ct_476, 0x3eec
.set ct_477, 0x3ef1
.set ct_478, 0x3ef6
.set ct_479, 0x3efb
.set ct_480, 0x3f00
.set ct_481, 0x3f02
.set ct_482, 0x3f05
.set ct_483, 0x3f07
.set ct_484, 0x3f0a
.set ct_485, 0x3f0c
.set ct_486, 0x3f0e
.set ct_487, 0x3f11
.set ct_488, 0x3f13
.set ct_489, 0x3f15
.set ct_490, 0x3f17
.set ct_491, 0x3f1a
.set ct_492, 0x3f1c
.set ct_493, 0x3f1e
.set ct_494, 0x3f20
.set ct_495, 0x3f22
.set ct_496, 0x3f25
.set ct_497, 0x3f27
.set ct_498, 0x3f29
.set ct_499, 0x3f2b
.set ct_500, 0x3f2d
.set ct_501, 0x3f2f
.set ct_502, 0x3f31
.set ct_503, 0x3f33
.set ct_504, 0x3f35
.set ct_505, 0x3f37
.set ct_506, 0x3f39
.set ct_507, 0x3f3b
.set ct_508, 0x3f3d
.set ct_509, 0x3f3f
.set ct_510, 0x3f40
.set ct_511, 0x3f42
.set ct_512, 0x3f44
.set ct_513, 0x3f46
.set ct_514, 0x3f48
.set ct_515, 0x3f49
.set ct_516, 0x3f4b
.set ct_517, 0x3f4d
.set ct_518, 0x3f4e
.set ct_519, 0x3f50
.set ct_520, 0x3f52
.set ct_521, 0x3f53
.set ct_522, 0x3f55
.set ct_523, 0x3f56
.set ct_524, 0x3f58
.set ct_525, 0x3f59
.set ct_526, 0x3f5b
.set ct_527, 0x3f5c
.set ct_528, 0x3f5e
.set ct_529, 0x3f5f
.set ct_530, 0x3f60
.set ct_531, 0x3f62
.set ct_532, 0x3f63
.set ct_533, 0x3f64
.set ct_534, 0x3f66
.set ct_535, 0x3f67
.set ct_536, 0x3f68
.set ct_537, 0x3f69
.set ct_538, 0x3f6a
.set ct_539, 0x3f6b
.set ct_540, 0x3f6d
.set ct_541, 0x3f6e
.set ct_542, 0x3f6f
.set ct_543, 0x3f70
.set ct_544, 0x3f71
.set ct_545, 0x3f72
.set ct_546, 0x3f72
.set ct_547, 0x3f73
.set ct_548, 0x3f74
.set ct_549, 0x3f75
.set ct_550, 0x3f76
.set ct_551, 0x3f77
.set ct_552, 0x3f77
.set ct_553, 0x3f78
.set ct_554, 0x3f79
.set ct_555, 0x3f79
.set ct_556, 0x3f7a
.set ct_557, 0x3f7b
.set ct_558, 0x3f7b
.set ct_559, 0x3f7c
.set ct_560, 0x3f7c
.set ct_561, 0x3f7d
.set ct_562, 0x3f7d
.set ct_563, 0x3f7d
.set ct_564, 0x3f7e
.set ct_565, 0x3f7e
.set ct_566, 0x3f7e
.set ct_567, 0x3f7f
.set ct_568, 0x3f7f
.set ct_569, 0x3f7f
.set ct_570, 0x3f7f
.set ct_571, 0x3f80
.set ct_572, 0x3f80
.set ct_573, 0x3f80
.set ct_574, 0x3f80
.set ct_575, 0x3f80
.altmacro
.macro em2 a, b
.short ct_\a, ct_\b
.endm
tab_T:
.set dd, 0
.rept 576
  em2 %((288*dd)%576), 0
  .set pp, 1
  .rept 287
    em2 %((pp*dd)%576), %((pp*dd+144)%576)
    .set pp, pp+1
  .endr
  .set dd, dd+1
.endr
.noaltmacro
.section .rodata,"a"
.p2align 8
.set c2_0, 0x4000
.set c2_1, 0x4000
.set c2_2, 0x4000
.set c2_3, 0x4000
.set c2_4, 0x4000
.set c2_5, 0x4000
.set c2_6, 0x3fff
.set c2_7, 0x3fff
.set c2_8, 0x3fff
.set c2_9, 0x3fff
.set c2_10, 0x3ffe
.set c2_11, 0x3ffe
.set c2_12, 0x3ffe
.set c2_13, 0x3ffd
.set c2_14, 0x3ffd
.set c2_15, 0x3ffd
.set c2_16, 0x3ffc
.set c2_17, 0x3ffc
.set c2_18, 0x3ffb
.set c2_19, 0x3ffb
.set c2_20, 0x3ffa
.set c2_21, 0x3ff9
.set c2_22, 0x3ff9
.set c2_23, 0x3ff8
.set c2_24, 0x3ff7
.set c2_25, 0x3ff7
.set c2_26, 0x3ff6
.set c2_27, 0x3ff5
.set c2_28, 0x3ff4
.set c2_29, 0x3ff3
.set c2_30, 0x3ff2
.set c2_31, 0x3ff2
.set c2_32, 0x3ff1
.set c2_33, 0x3ff0
.set c2_34, 0x3fef
.set c2_35, 0x3fee
.set c2_36, 0x3fed
.set c2_37, 0x3feb
.set c2_38, 0x3fea
.set c2_39, 0x3fe9
.set c2_40, 0x3fe8
.set c2_41, 0x3fe7
.set c2_42, 0x3fe6
.set c2_43, 0x3fe4
.set c2_44, 0x3fe3
.set c2_45, 0x3fe2
.set c2_46, 0x3fe0
.set c2_47, 0x3fdf
.set c2_48, 0x3fde
.set c2_49, 0x3fdc
.set c2_50, 0x3fdb
.set c2_51, 0x3fd9
.set c2_52, 0x3fd8
.set c2_53, 0x3fd6
.set c2_54, 0x3fd5
.set c2_55, 0x3fd3
.set c2_56, 0x3fd2
.set c2_57, 0x3fd0
.set c2_58, 0x3fce
.set c2_59, 0x3fcd
.set c2_60, 0x3fcb
.set c2_61, 0x3fc9
.set c2_62, 0x3fc8
.set c2_63, 0x3fc6
.set c2_64, 0x3fc4
.set c2_65, 0x3fc2
.set c2_66, 0x3fc0
.set c2_67, 0x3fbf
.set c2_68, 0x3fbd
.set c2_69, 0x3fbb
.set c2_70, 0x3fb9
.set c2_71, 0x3fb7
.set c2_72, 0x3fb5
.set c2_73, 0x3fb3
.set c2_74, 0x3fb1
.set c2_75, 0x3faf
.set c2_76, 0x3fad
.set c2_77, 0x3fab
.set c2_78, 0x3fa9
.set c2_79, 0x3fa7
.set c2_80, 0x3fa5
.set c2_81, 0x3fa2
.set c2_82, 0x3fa0
.set c2_83, 0x3f9e
.set c2_84, 0x3f9c
.set c2_85, 0x3f9a
.set c2_86, 0x3f97
.set c2_87, 0x3f95
.set c2_88, 0x3f93
.set c2_89, 0x3f91
.set c2_90, 0x3f8e
.set c2_91, 0x3f8c
.set c2_92, 0x3f8a
.set c2_93, 0x3f87
.set c2_94, 0x3f85
.set c2_95, 0x3f82
.set c2_96, 0x3f80
.set c2_97, 0x3f7b
.set c2_98, 0x3f76
.set c2_99, 0x3f71
.set c2_100, 0x3f6c
.set c2_101, 0x3f67
.set c2_102, 0x3f62
.set c2_103, 0x3f5d
.set c2_104, 0x3f58
.set c2_105, 0x3f53
.set c2_106, 0x3f4e
.set c2_107, 0x3f49
.set c2_108, 0x3f44
.set c2_109, 0x3f3f
.set c2_110, 0x3f3a
.set c2_111, 0x3f34
.set c2_112, 0x3f2f
.set c2_113, 0x3f2a
.set c2_114, 0x3f25
.set c2_115, 0x3f1f
.set c2_116, 0x3f1a
.set c2_117, 0x3f15
.set c2_118, 0x3f0f
.set c2_119, 0x3f0a
.set c2_120, 0x3f05
.set c2_121, 0x3efe
.set c2_122, 0x3ef3
.set c2_123, 0x3ee9
.set c2_124, 0x3ede
.set c2_125, 0x3ed3
.set c2_126, 0x3ec8
.set c2_127, 0x3ebd
.set c2_128, 0x3eb2
.set c2_129, 0x3ea7
.set c2_130, 0x3e9c
.set c2_131, 0x3e91
.set c2_132, 0x3e86
.set c2_133, 0x3e75
.set c2_134, 0x3e5f
.set c2_135, 0x3e49
.set c2_136, 0x3e32
.set c2_137, 0x3e1c
.set c2_138, 0x3e06
.set c2_139, 0x3ddf
.set c2_140, 0x3db3
.set c2_141, 0x3d86
.set c2_142, 0x3d33
.set c2_143, 0x3cb3
.set c2_144, 0x0000
.set c2_145, 0xbcb3
.set c2_146, 0xbd33
.set c2_147, 0xbd86
.set c2_148, 0xbdb3
.set c2_149, 0xbddf
.set c2_150, 0xbe06
.set c2_151, 0xbe1c
.set c2_152, 0xbe32
.set c2_153, 0xbe49
.set c2_154, 0xbe5f
.set c2_155, 0xbe75
.set c2_156, 0xbe86
.set c2_157, 0xbe91
.set c2_158, 0xbe9c
.set c2_159, 0xbea7
.set c2_160, 0xbeb2
.set c2_161, 0xbebd
.set c2_162, 0xbec8
.set c2_163, 0xbed3
.set c2_164, 0xbede
.set c2_165, 0xbee9
.set c2_166, 0xbef3
.set c2_167, 0xbefe
.set c2_168, 0xbf05
.set c2_169, 0xbf0a
.set c2_170, 0xbf0f
.set c2_171, 0xbf15
.set c2_172, 0xbf1a
.set c2_173, 0xbf1f
.set c2_174, 0xbf25
.set c2_175, 0xbf2a
.set c2_176, 0xbf2f
.set c2_177, 0xbf34
.set c2_178, 0xbf3a
.set c2_179, 0xbf3f
.set c2_180, 0xbf44
.set c2_181, 0xbf49
.set c2_182, 0xbf4e
.set c2_183, 0xbf53
.set c2_184, 0xbf58
.set c2_185, 0xbf5d
.set c2_186, 0xbf62
.set c2_187, 0xbf67
.set c2_188, 0xbf6c
.set c2_189, 0xbf71
.set c2_190, 0xbf76
.set c2_191, 0xbf7b
.set c2_192, 0xbf80
.set c2_193, 0xbf82
.set c2_194, 0xbf85
.set c2_195, 0xbf87
.set c2_196, 0xbf8a
.set c2_197, 0xbf8c
.set c2_198, 0xbf8e
.set c2_199, 0xbf91
.set c2_200, 0xbf93
.set c2_201, 0xbf95
.set c2_202, 0xbf97
.set c2_203, 0xbf9a
.set c2_204, 0xbf9c
.set c2_205, 0xbf9e
.set c2_206, 0xbfa0
.set c2_207, 0xbfa2
.set c2_208, 0xbfa5
.set c2_209, 0xbfa7
.set c2_210, 0xbfa9
.set c2_211, 0xbfab
.set c2_212, 0xbfad
.set c2_213, 0xbfaf
.set c2_214, 0xbfb1
.set c2_215, 0xbfb3
.set c2_216, 0xbfb5
.set c2_217, 0xbfb7
.set c2_218, 0xbfb9
.set c2_219, 0xbfbb
.set c2_220, 0xbfbd
.set c2_221, 0xbfbf
.set c2_222, 0xbfc0
.set c2_223, 0xbfc2
.set c2_224, 0xbfc4
.set c2_225, 0xbfc6
.set c2_226, 0xbfc8
.set c2_227, 0xbfc9
.set c2_228, 0xbfcb
.set c2_229, 0xbfcd
.set c2_230, 0xbfce
.set c2_231, 0xbfd0
.set c2_232, 0xbfd2
.set c2_233, 0xbfd3
.set c2_234, 0xbfd5
.set c2_235, 0xbfd6
.set c2_236, 0xbfd8
.set c2_237, 0xbfd9
.set c2_238, 0xbfdb
.set c2_239, 0xbfdc
.set c2_240, 0xbfde
.set c2_241, 0xbfdf
.set c2_242, 0xbfe0
.set c2_243, 0xbfe2
.set c2_244, 0xbfe3
.set c2_245, 0xbfe4
.set c2_246, 0xbfe6
.set c2_247, 0xbfe7
.set c2_248, 0xbfe8
.set c2_249, 0xbfe9
.set c2_250, 0xbfea
.set c2_251, 0xbfeb
.set c2_252, 0xbfed
.set c2_253, 0xbfee
.set c2_254, 0xbfef
.set c2_255, 0xbff0
.set c2_256, 0xbff1
.set c2_257, 0xbff2
.set c2_258, 0xbff2
.set c2_259, 0xbff3
.set c2_260, 0xbff4
.set c2_261, 0xbff5
.set c2_262, 0xbff6
.set c2_263, 0xbff7
.set c2_264, 0xbff7
.set c2_265, 0xbff8
.set c2_266, 0xbff9
.set c2_267, 0xbff9
.set c2_268, 0xbffa
.set c2_269, 0xbffb
.set c2_270, 0xbffb
.set c2_271, 0xbffc
.set c2_272, 0xbffc
.set c2_273, 0xbffd
.set c2_274, 0xbffd
.set c2_275, 0xbffd
.set c2_276, 0xbffe
.set c2_277, 0xbffe
.set c2_278, 0xbffe
.set c2_279, 0xbfff
.set c2_280, 0xbfff
.set c2_281, 0xbfff
.set c2_282, 0xbfff
.set c2_283, 0xc000
.set c2_284, 0xc000
.set c2_285, 0xc000
.set c2_286, 0xc000
.set c2_287, 0xc000
.set c2_288, 0xc000
.set c2_289, 0xc000
.set c2_290, 0xc000
.set c2_291, 0xc000
.set c2_292, 0xc000
.set c2_293, 0xc000
.set c2_294, 0xbfff
.set c2_295, 0xbfff
.set c2_296, 0xbfff
.set c2_297, 0xbfff
.set c2_298, 0xbffe
.set c2_299, 0xbffe
.set c2_300, 0xbffe
.set c2_301, 0xbffd
.set c2_302, 0xbffd
.set c2_303, 0xbffd
.set c2_304, 0xbffc
.set c2_305, 0xbffc
.set c2_306, 0xbffb
.set c2_307, 0xbffb
.set c2_308, 0xbffa
.set c2_309, 0xbff9
.set c2_310, 0xbff9
.set c2_311, 0xbff8
.set c2_312, 0xbff7
.set c2_313, 0xbff7
.set c2_314, 0xbff6
.set c2_315, 0xbff5
.set c2_316, 0xbff4
.set c2_317, 0xbff3
.set c2_318, 0xbff2
.set c2_319, 0xbff2
.set c2_320, 0xbff1
.set c2_321, 0xbff0
.set c2_322, 0xbfef
.set c2_323, 0xbfee
.set c2_324, 0xbfed
.set c2_325, 0xbfeb
.set c2_326, 0xbfea
.set c2_327, 0xbfe9
.set c2_328, 0xbfe8
.set c2_329, 0xbfe7
.set c2_330, 0xbfe6
.set c2_331, 0xbfe4
.set c2_332, 0xbfe3
.set c2_333, 0xbfe2
.set c2_334, 0xbfe0
.set c2_335, 0xbfdf
.set c2_336, 0xbfde
.set c2_337, 0xbfdc
.set c2_338, 0xbfdb
.set c2_339, 0xbfd9
.set c2_340, 0xbfd8
.set c2_341, 0xbfd6
.set c2_342, 0xbfd5
.set c2_343, 0xbfd3
.set c2_344, 0xbfd2
.set c2_345, 0xbfd0
.set c2_346, 0xbfce
.set c2_347, 0xbfcd
.set c2_348, 0xbfcb
.set c2_349, 0xbfc9
.set c2_350, 0xbfc8
.set c2_351, 0xbfc6
.set c2_352, 0xbfc4
.set c2_353, 0xbfc2
.set c2_354, 0xbfc0
.set c2_355, 0xbfbf
.set c2_356, 0xbfbd
.set c2_357, 0xbfbb
.set c2_358, 0xbfb9
.set c2_359, 0xbfb7
.set c2_360, 0xbfb5
.set c2_361, 0xbfb3
.set c2_362, 0xbfb1
.set c2_363, 0xbfaf
.set c2_364, 0xbfad
.set c2_365, 0xbfab
.set c2_366, 0xbfa9
.set c2_367, 0xbfa7
.set c2_368, 0xbfa5
.set c2_369, 0xbfa2
.set c2_370, 0xbfa0
.set c2_371, 0xbf9e
.set c2_372, 0xbf9c
.set c2_373, 0xbf9a
.set c2_374, 0xbf97
.set c2_375, 0xbf95
.set c2_376, 0xbf93
.set c2_377, 0xbf91
.set c2_378, 0xbf8e
.set c2_379, 0xbf8c
.set c2_380, 0xbf8a
.set c2_381, 0xbf87
.set c2_382, 0xbf85
.set c2_383, 0xbf82
.set c2_384, 0xbf80
.set c2_385, 0xbf7b
.set c2_386, 0xbf76
.set c2_387, 0xbf71
.set c2_388, 0xbf6c
.set c2_389, 0xbf67
.set c2_390, 0xbf62
.set c2_391, 0xbf5d
.set c2_392, 0xbf58
.set c2_393, 0xbf53
.set c2_394, 0xbf4e
.set c2_395, 0xbf49
.set c2_396, 0xbf44
.set c2_397, 0xbf3f
.set c2_398, 0xbf3a
.set c2_399, 0xbf34
.set c2_400, 0xbf2f
.set c2_401, 0xbf2a
.set c2_402, 0xbf25
.set c2_403, 0xbf1f
.set c2_404, 0xbf1a
.set c2_405, 0xbf15
.set c2_406, 0xbf0f
.set c2_407, 0xbf0a
.set c2_408, 0xbf05
.set c2_409, 0xbefe
.set c2_410, 0xbef3
.set c2_411, 0xbee9
.set c2_412, 0xbede
.set c2_413, 0xbed3
.set c2_414, 0xbec8
.set c2_415, 0xbebd
.set c2_416, 0xbeb2
.set c2_417, 0xbea7
.set c2_418, 0xbe9c
.set c2_419, 0xbe91
.set c2_420, 0xbe86
.set c2_421, 0xbe75
.set c2_422, 0xbe5f
.set c2_423, 0xbe49
.set c2_424, 0xbe32
.set c2_425, 0xbe1c
.set c2_426, 0xbe06
.set c2_427, 0xbddf
.set c2_428, 0xbdb3
.set c2_429, 0xbd86
.set c2_430, 0xbd33
.set c2_431, 0xbcb3
.set c2_432, 0x0000
.set c2_433, 0x3cb3
.set c2_434, 0x3d33
.set c2_435, 0x3d86
.set c2_436, 0x3db3
.set c2_437, 0x3ddf
.set c2_438, 0x3e06
.set c2_439, 0x3e1c
.set c2_440, 0x3e32
.set c2_441, 0x3e49
.set c2_442, 0x3e5f
.set c2_443, 0x3e75
.set c2_444, 0x3e86
.set c2_445, 0x3e91
.set c2_446, 0x3e9c
.set c2_447, 0x3ea7
.set c2_448, 0x3eb2
.set c2_449, 0x3ebd
.set c2_450, 0x3ec8
.set c2_451, 0x3ed3
.set c2_452, 0x3ede
.set c2_453, 0x3ee9
.set c2_454, 0x3ef3
.set c2_455, 0x3efe
.set c2_456, 0x3f05
.set c2_457, 0x3f0a
.set c2_458, 0x3f0f
.set c2_459, 0x3f15
.set c2_460, 0x3f1a
.set c2_461, 0x3f1f
.set c2_462, 0x3f25
.set c2_463, 0x3f2a
.set c2_464, 0x3f2f
.set c2_465, 0x3f34
.set c2_466, 0x3f3a
.set c2_467, 0x3f3f
.set c2_468, 0x3f44
.set c2_469, 0x3f49
.set c2_470, 0x3f4e
.set c2_471, 0x3f53
.set c2_472, 0x3f58
.set c2_473, 0x3f5d
.set c2_474, 0x3f62
.set c2_475, 0x3f67
.set c2_476, 0x3f6c
.set c2_477, 0x3f71
.set c2_478, 0x3f76
.set c2_479, 0x3f7b
.set c2_480, 0x3f80
.set c2_481, 0x3f82
.set c2_482, 0x3f85
.set c2_483, 0x3f87
.set c2_484, 0x3f8a
.set c2_485, 0x3f8c
.set c2_486, 0x3f8e
.set c2_487, 0x3f91
.set c2_488, 0x3f93
.set c2_489, 0x3f95
.set c2_490, 0x3f97
.set c2_491, 0x3f9a
.set c2_492, 0x3f9c
.set c2_493, 0x3f9e
.set c2_494, 0x3fa0
.set c2_495, 0x3fa2
.set c2_496, 0x3fa5
.set c2_497, 0x3fa7
.set c2_498, 0x3fa9
.set c2_499, 0x3fab
.set c2_500, 0x3fad
.set c2_501, 0x3faf
.set c2_502, 0x3fb1
.set c2_503, 0x3fb3
.set c2_504, 0x3fb5
.set c2_505, 0x3fb7
.set c2_506, 0x3fb9
.set c2_507, 0x3fbb
.set c2_508, 0x3fbd
.set c2_509, 0x3fbf
.set c2_510, 0x3fc0
.set c2_511, 0x3fc2
.set c2_512, 0x3fc4
.set c2_513, 0x3fc6
.set c2_514, 0x3fc8
.set c2_515, 0x3fc9
.set c2_516, 0x3fcb
.set c2_517, 0x3fcd
.set c2_518, 0x3fce
.set c2_519, 0x3fd0
.set c2_520, 0x3fd2
.set c2_521, 0x3fd3
.set c2_522, 0x3fd5
.set c2_523, 0x3fd6
.set c2_524, 0x3fd8
.set c2_525, 0x3fd9
.set c2_526, 0x3fdb
.set c2_527, 0x3fdc
.set c2_528, 0x3fde
.set c2_529, 0x3fdf
.set c2_530, 0x3fe0
.set c2_531, 0x3fe2
.set c2_532, 0x3fe3
.set c2_533, 0x3fe4
.set c2_534, 0x3fe6
.set c2_535, 0x3fe7
.set c2_536, 0x3fe8
.set c2_537, 0x3fe9
.set c2_538, 0x3fea
.set c2_539, 0x3feb
.set c2_540, 0x3fed
.set c2_541, 0x3fee
.set c2_542, 0x3fef
.set c2_543, 0x3ff0
.set c2_544, 0x3ff1
.set c2_545, 0x3ff2
.set c2_546, 0x3ff2
.set c2_547, 0x3ff3
.set c2_548, 0x3ff4
.set c2_549, 0x3ff5
.set c2_550, 0x3ff6
.set c2_551, 0x3ff7
.set c2_552, 0x3ff7
.set c2_553, 0x3ff8
.set c2_554, 0x3ff9
.set c2_555, 0x3ff9
.set c2_556, 0x3ffa
.set c2_557, 0x3ffb
.set c2_558, 0x3ffb
.set c2_559, 0x3ffc
.set c2_560, 0x3ffc
.set c2_561, 0x3ffd
.set c2_562, 0x3ffd
.set c2_563, 0x3ffd
.set c2_564, 0x3ffe
.set c2_565, 0x3ffe
.set c2_566, 0x3ffe
.set c2_567, 0x3fff
.set c2_568, 0x3fff
.set c2_569, 0x3fff
.set c2_570, 0x3fff
.set c2_571, 0x4000
.set c2_572, 0x4000
.set c2_573, 0x4000
.set c2_574, 0x4000
.set c2_575, 0x4000
.altmacro
.macro em4 a, b, c, d
.short c2_\a, c2_\b, c2_\c, c2_\d
.endm
tab_Tinv:
.set nn, 0
.rept 6
  .rept 48
    .short 0x3f80, 0xbf80
  .endr
  .rept 96
    .short 0
  .endr
  .set kk, 2
  .rept 574
    .set pp, kk>>1
    .set ph, (kk&1)*144
    .set jj, 0
    .rept 12
      .set dd, nn*96 + ((jj ^ ((kk>>2)&2))*8)
      em4 %((pp*dd+ph)%576), %((pp*(dd+1)+ph)%576), %((pp*(dd+2)+ph)%576), %((pp*(dd+3)+ph)%576)
      em4 %((pp*(dd+4)+ph)%576), %((pp*(dd+5)+ph)%576), %((pp*(dd+6)+ph)%576), %((pp*(dd+7)+ph)%576)
      .set jj, jj+1
    .endr
    .set kk, kk+1
  .endr
  .set nn, nn+1
.endr
.noaltmacro
.section .rodata,"a"
.p2align 8
tab_F:
.long 0x3f80,0x3f80,0x3f80,0x3f80,0x3f80,0x3e483f7b,0x3ec43f6d,0x3f0e3f55
.long 0x3f80,0x3ec43f6d,0x3f353f35,0x3f6d3ec4,0x3f80,0x3f0e3f55,0x3f6d3ec4,0x3f7bbe48
.long 0x3f80,0x3f353f35,0x3f800000,0x3f35bf35,0x3f80,0x3f553f0e,0x3f6dbec4,0x3e48bf7b
.long 0x3f80,0x3f6d3ec4,0x3f35bf35,0xbec4bf6d,0x3f80,0x3f7b3e48,0x3ec4bf6d,0xbf55bf0e
.long 0x3f80,0x3f800000,0xbf80,0xbf800000,0x3f80,0x3f7bbe48,0xbec4bf6d,0xbf553f0e
.long 0x3f80,0x3f6dbec4,0xbf35bf35,0xbec43f6d,0x3f80,0x3f55bf0e,0xbf6dbec4,0x3e483f7b
.long 0x3f80,0x3f35bf35,0xbf800000,0x3f353f35,0x3f80,0x3f0ebf55,0xbf6d3ec4,0x3f7b3e48
.long 0x3f80,0x3ec4bf6d,0xbf353f35,0x3f6dbec4,0x3f80,0x3e48bf7b,0xbec43f6d,0x3f0ebf55
.long 0x3f80,0xbec4bf6d,0x3f353f35,0xbf6dbec4,0x3f80,0xbf0ebf55,0x3f6d3ec4,0xbf7b3e48
.long 0x3f80,0xbf80,0x3f80,0xbf80,0x3f80,0xbe48bf7b,0x3ec43f6d,0xbf0ebf55
.long 0x3f80,0xbf6dbec4,0x3f35bf35,0x3ec43f6d,0x3f80,0xbf7bbe48,0x3ec4bf6d,0x3f553f0e
.long 0x3f80,0xbf35bf35,0x3f800000,0xbf353f35,0x3f80,0xbf55bf0e,0x3f6dbec4,0xbe483f7b
.long 0x3f80,0xbf6d3ec4,0xbf35bf35,0x3ec4bf6d,0x3f80,0xbf553f0e,0xbf6dbec4,0xbe48bf7b
.long 0x3f80,0xbf800000,0xbf80,0x3f800000,0x3f80,0xbf7b3e48,0xbec4bf6d,0x3f55bf0e
.long 0x3f80,0xbec43f6d,0xbf353f35,0xbf6d3ec4,0x3f80,0xbe483f7b,0xbec43f6d,0xbf0e3f55
.long 0x3f80,0xbf353f35,0xbf800000,0xbf35bf35,0x3f80,0xbf0e3f55,0xbf6d3ec4,0xbf7bbe48
.long 0x3f80,0x3f80,0x3f80,0x3f80,0x3f353f35,0x3f553f0e,0x3f6d3ec4,0x3f7b3e48
.long 0x3f800000,0x3f6dbec4,0x3f35bf35,0x3ec4bf6d,0x3f35bf35,0x3e48bf7b,0xbec4bf6d,0xbf55bf0e
.long 0xbf80,0xbf35bf35,0xbf800000,0xbf353f35,0xbf35bf35,0xbf7b3e48,0xbec43f6d,0x3f0e3f55
.long 0xbf800000,0xbec43f6d,0x3f353f35,0x3f6dbec4,0xbf353f35,0x3f0e3f55,0x3f6dbec4,0xbe48bf7b
.long 0x3f80,0x3f800000,0xbf80,0xbf800000,0x3f353f35,0x3f0ebf55,0xbf6dbec4,0xbe483f7b
.long 0x3f800000,0xbec4bf6d,0xbf353f35,0x3f6d3ec4,0x3f35bf35,0xbf7bbe48,0x3ec43f6d,0x3f0ebf55
.long 0xbf80,0xbf353f35,0x3f800000,0xbf35bf35,0xbf35bf35,0x3e483f7b,0x3ec4bf6d,0xbf553f0e
.long 0xbf800000,0x3f6d3ec4,0xbf35bf35,0x3ec43f6d,0xbf353f35,0x3f55bf0e,0xbf6d3ec4,0x3f7bbe48
.long 0x3f800000,0xbf6d3ec4,0x3f35bf35,0xbec43f6d,0x3f35bf35,0xbe483f7b,0xbec4bf6d,0x3f553f0e
.long 0x3f80,0xbf80,0x3f80,0xbf80,0x3f353f35,0xbf55bf0e,0x3f6d3ec4,0xbf7bbe48
.long 0xbf800000,0x3ec4bf6d,0x3f353f35,0xbf6d3ec4,0xbf353f35,0xbf0ebf55,0x3f6dbec4,0x3e483f7b
.long 0xbf80,0x3f353f35,0xbf800000,0x3f35bf35,0xbf35bf35,0x3f7bbe48,0xbec43f6d,0xbf0ebf55
.long 0x3f800000,0x3ec43f6d,0xbf353f35,0xbf6dbec4,0x3f35bf35,0x3f7b3e48,0x3ec43f6d,0xbf0e3f55
.long 0x3f80,0xbf800000,0xbf80,0x3f800000,0x3f353f35,0xbf0e3f55,0xbf6dbec4,0x3e48bf7b
.long 0xbf800000,0xbf6dbec4,0xbf35bf35,0xbec4bf6d,0xbf353f35,0xbf553f0e,0xbf6d3ec4,0xbf7b3e48
.long 0xbf80,0x3f35bf35,0x3f800000,0x3f353f35,0xbf35bf35,0xbe48bf7b,0x3ec4bf6d,0x3f55bf0e
.long 0x3f80,0x3f353f35,0x3f800000,0x3f35bf35,0x3f800000,0x3f0ebf55,0xbec4bf6d,0xbf7bbe48
.long 0xbf80,0xbf6dbec4,0xbf353f35,0x3ec43f6d,0xbf800000,0xbe483f7b,0x3f6d3ec4,0x3f0ebf55
.long 0x3f80,0x3f80,0x3f80,0x3f80,0x3f800000,0x3f7bbe48,0x3f6dbec4,0x3f55bf0e
.long 0xbf80,0xbec4bf6d,0xbf35bf35,0xbf6dbec4,0xbf800000,0xbf553f0e,0xbec43f6d,0x3e483f7b
.long 0x3f80,0x3f35bf35,0xbf800000,0x3f353f35,0x3f800000,0xbf55bf0e,0x3ec43f6d,0x3e48bf7b
.long 0xbf80,0xbec43f6d,0x3f35bf35,0xbf6d3ec4,0xbf800000,0x3f7b3e48,0xbf6dbec4,0x3f553f0e
.long 0x3f80,0x3f800000,0xbf80,0xbf800000,0x3f800000,0xbe48bf7b,0xbf6d3ec4,0x3f0e3f55
.long 0xbf80,0xbf6d3ec4,0x3f353f35,0x3ec4bf6d,0xbf800000,0x3f0e3f55,0x3ec4bf6d,0xbf7b3e48
.long 0xbf80,0x3f6d3ec4,0xbf353f35,0xbec4bf6d,0xbf800000,0x3e48bf7b,0x3f6d3ec4,0xbf0e3f55
.long 0x3f80,0xbf35bf35,0x3f800000,0xbf353f35,0x3f800000,0xbf0e3f55,0xbec4bf6d,0x3f7b3e48
.long 0xbf80,0x3ec43f6d,0xbf35bf35,0x3f6d3ec4,0xbf800000,0x3f55bf0e,0xbec43f6d,0xbe48bf7b
.long 0x3f80,0xbf80,0x3f80,0xbf80,0x3f800000,0xbf7b3e48,0x3f6dbec4,0xbf553f0e
.long 0xbf80,0x3ec4bf6d,0x3f35bf35,0x3f6dbec4,0xbf800000,0xbf7bbe48,0xbf6dbec4,0xbf55bf0e
.long 0x3f80,0xbf353f35,0xbf800000,0xbf35bf35,0x3f800000,0x3f553f0e,0x3ec43f6d,0xbe483f7b
.long 0xbf80,0x3f6dbec4,0x3f353f35,0xbec43f6d,0xbf800000,0xbf0ebf55,0x3ec4bf6d,0x3f7bbe48
.long 0x3f80,0xbf800000,0xbf80,0x3f800000,0x3f800000,0x3e483f7b,0xbf6d3ec4,0xbf0ebf55
.long 0xbf80,0xbf35bf35,0xbf800000,0xbf353f35,0xbf353f35,0x3e483f7b,0x3f6d3ec4,0x3f55bf0e
.long 0x3f800000,0x3ec4bf6d,0xbf35bf35,0xbf6d3ec4,0xbf35bf35,0xbf553f0e,0x3ec43f6d,0x3f7bbe48
.long 0x3f80,0x3f80,0x3f80,0x3f80,0x3f35bf35,0x3f0ebf55,0x3ec4bf6d,0x3e48bf7b
.long 0xbf800000,0xbf6d3ec4,0xbf353f35,0xbec43f6d,0x3f353f35,0x3f7b3e48,0x3f6dbec4,0x3f0ebf55
.long 0xbf80,0xbf353f35,0x3f800000,0xbf35bf35,0xbf353f35,0x3f7bbe48,0xbf6dbec4,0x3f0e3f55
.long 0x3f800000,0xbf6dbec4,0x3f353f35,0xbec4bf6d,0xbf35bf35,0x3f0e3f55,0xbec4bf6d,0x3e483f7b
.long 0x3f80,0x3f800000,0xbf80,0xbf800000,0x3f35bf35,0xbf55bf0e,0xbec43f6d,0x3f7b3e48
.long 0xbf800000,0x3ec43f6d,0x3f35bf35,0xbf6dbec4,0x3f353f35,0x3e48bf7b,0xbf6d3ec4,0x3f553f0e
.long 0x3f800000,0xbec43f6d,0xbf35bf35,0x3f6dbec4,0xbf35bf35,0x3f55bf0e,0x3ec43f6d,0xbf7b3e48
.long 0xbf80,0x3f353f35,0xbf800000,0x3f35bf35,0xbf353f35,0xbe48bf7b,0x3f6d3ec4,0xbf553f0e
.long 0xbf800000,0x3f6dbec4,0xbf353f35,0x3ec4bf6d,0x3f353f35,0xbf7bbe48,0x3f6dbec4,0xbf0e3f55
.long 0x3f80,0xbf80,0x3f80,0xbf80,0x3f35bf35,0xbf0e3f55,0x3ec4bf6d,0xbe483f7b
.long 0x3f800000,0x3f6d3ec4,0x3f353f35,0x3ec43f6d,0xbf35bf35,0xbf0ebf55,0xbec4bf6d,0xbe48bf7b
.long 0xbf80,0x3f35bf35,0x3f800000,0x3f353f35,0xbf353f35,0xbf7b3e48,0xbf6dbec4,0xbf0ebf55
.long 0xbf800000,0xbec4bf6d,0x3f35bf35,0x3f6d3ec4,0x3f353f35,0xbe483f7b,0xbf6d3ec4,0xbf55bf0e
.long 0x3f80,0xbf800000,0xbf80,0x3f800000,0x3f35bf35,0x3f553f0e,0xbec43f6d,0xbf7bbe48
.long 0x3f80,0x3f80,0x3f80,0x3f80,0xbf80,0xbe48bf7b,0xbec4bf6d,0xbf0ebf55
.long 0x3f80,0x3ec43f6d,0x3f353f35,0x3f6d3ec4,0xbf80,0xbf0ebf55,0xbf6dbec4,0xbf7b3e48
.long 0x3f80,0x3f353f35,0x3f800000,0x3f35bf35,0xbf80,0xbf55bf0e,0xbf6d3ec4,0xbe483f7b
.long 0x3f80,0x3f6d3ec4,0x3f35bf35,0xbec4bf6d,0xbf80,0xbf7bbe48,0xbec43f6d,0x3f553f0e
.long 0x3f80,0x3f800000,0xbf80,0xbf800000,0xbf80,0xbf7b3e48,0x3ec43f6d,0x3f55bf0e
.long 0x3f80,0x3f6dbec4,0xbf35bf35,0xbec43f6d,0xbf80,0xbf553f0e,0x3f6d3ec4,0xbe48bf7b
.long 0x3f80,0x3f35bf35,0xbf800000,0x3f353f35,0xbf80,0xbf0e3f55,0x3f6dbec4,0xbf7bbe48
.long 0x3f80,0x3ec4bf6d,0xbf353f35,0x3f6dbec4,0xbf80,0xbe483f7b,0x3ec4bf6d,0xbf0e3f55
.long 0x3f80,0xbec4bf6d,0x3f353f35,0xbf6dbec4,0xbf80,0x3f0e3f55,0xbf6dbec4,0x3f7bbe48
.long 0x3f80,0xbf80,0x3f80,0xbf80,0xbf80,0x3e483f7b,0xbec4bf6d,0x3f0e3f55
.long 0x3f80,0xbf6dbec4,0x3f35bf35,0x3ec43f6d,0xbf80,0x3f7b3e48,0xbec43f6d,0xbf55bf0e
.long 0x3f80,0xbf35bf35,0x3f800000,0xbf353f35,0xbf80,0x3f553f0e,0xbf6d3ec4,0x3e48bf7b
.long 0x3f80,0xbf6d3ec4,0xbf35bf35,0x3ec4bf6d,0xbf80,0x3f55bf0e,0x3f6d3ec4,0x3e483f7b
.long 0x3f80,0xbf800000,0xbf80,0x3f800000,0xbf80,0x3f7bbe48,0x3ec43f6d,0xbf553f0e
.long 0x3f80,0xbec43f6d,0xbf353f35,0xbf6d3ec4,0xbf80,0x3e48bf7b,0x3ec4bf6d,0x3f0ebf55
.long 0x3f80,0xbf353f35,0xbf800000,0xbf35bf35,0xbf80,0x3f0ebf55,0x3f6dbec4,0x3f7b3e48
.long 0x3f80,0x3f80,0x3f80,0x3f80,0xbf35bf35,0xbf55bf0e,0xbf6dbec4,0xbf7bbe48
.long 0x3f800000,0x3f6dbec4,0x3f35bf35,0x3ec4bf6d,0xbf353f35,0xbe483f7b,0x3ec43f6d,0x3f553f0e
.long 0xbf80,0xbf35bf35,0xbf800000,0xbf353f35,0x3f353f35,0x3f7bbe48,0x3ec4bf6d,0xbf0ebf55
.long 0xbf800000,0xbec43f6d,0x3f353f35,0x3f6dbec4,0x3f35bf35,0xbf0ebf55,0xbf6d3ec4,0x3e483f7b
.long 0x3f80,0x3f800000,0xbf80,0xbf800000,0xbf35bf35,0xbf0e3f55,0x3f6d3ec4,0x3e48bf7b
.long 0x3f800000,0xbec4bf6d,0xbf353f35,0x3f6d3ec4,0xbf353f35,0x3f7b3e48,0xbec4bf6d,0xbf0e3f55
.long 0xbf80,0xbf353f35,0x3f800000,0xbf35bf35,0x3f353f35,0xbe48bf7b,0xbec43f6d,0x3f55bf0e
.long 0xbf800000,0x3f6d3ec4,0xbf35bf35,0x3ec43f6d,0x3f35bf35,0xbf553f0e,0x3f6dbec4,0xbf7b3e48
.long 0x3f800000,0xbf6d3ec4,0x3f35bf35,0xbec43f6d,0xbf353f35,0x3e48bf7b,0x3ec43f6d,0xbf55bf0e
.long 0x3f80,0xbf80,0x3f80,0xbf80,0xbf35bf35,0x3f553f0e,0xbf6dbec4,0x3f7b3e48
.long 0xbf800000,0x3ec4bf6d,0x3f353f35,0xbf6d3ec4,0x3f35bf35,0x3f0e3f55,0xbf6d3ec4,0xbe48bf7b
.long 0xbf80,0x3f353f35,0xbf800000,0x3f35bf35,0x3f353f35,0xbf7b3e48,0x3ec4bf6d,0x3f0e3f55
.long 0x3f800000,0x3ec43f6d,0xbf353f35,0xbf6dbec4,0xbf353f35,0xbf7bbe48,0xbec4bf6d,0x3f0ebf55
.long 0x3f80,0xbf800000,0xbf80,0x3f800000,0xbf35bf35,0x3f0ebf55,0x3f6d3ec4,0xbe483f7b
.long 0xbf800000,0xbf6dbec4,0xbf35bf35,0xbec4bf6d,0x3f35bf35,0x3f55bf0e,0x3f6dbec4,0x3f7bbe48
.long 0xbf80,0x3f35bf35,0x3f800000,0x3f353f35,0x3f353f35,0x3e483f7b,0xbec43f6d,0xbf553f0e
.long 0x3f80,0x3f353f35,0x3f800000,0x3f35bf35,0xbf800000,0xbf0e3f55,0x3ec43f6d,0x3f7b3e48
.long 0xbf80,0xbf6dbec4,0xbf353f35,0x3ec43f6d,0x3f800000,0x3e48bf7b,0xbf6dbec4,0xbf0e3f55
.long 0x3f80,0x3f80,0x3f80,0x3f80,0xbf800000,0xbf7b3e48,0xbf6d3ec4,0xbf553f0e
.long 0xbf80,0xbec4bf6d,0xbf35bf35,0xbf6dbec4,0x3f800000,0x3f55bf0e,0x3ec4bf6d,0xbe48bf7b
.long 0x3f80,0x3f35bf35,0xbf800000,0x3f353f35,0xbf800000,0x3f553f0e,0xbec4bf6d,0xbe483f7b
.long 0xbf80,0xbec43f6d,0x3f35bf35,0xbf6d3ec4,0x3f800000,0xbf7bbe48,0x3f6d3ec4,0xbf55bf0e
.long 0x3f80,0x3f800000,0xbf80,0xbf800000,0xbf800000,0x3e483f7b,0x3f6dbec4,0xbf0ebf55
.long 0xbf80,0xbf6d3ec4,0x3f353f35,0x3ec4bf6d,0x3f800000,0xbf0ebf55,0xbec43f6d,0x3f7bbe48
.long 0xbf80,0x3f6d3ec4,0xbf353f35,0xbec4bf6d,0x3f800000,0xbe483f7b,0xbf6dbec4,0x3f0ebf55
.long 0x3f80,0xbf35bf35,0x3f800000,0xbf353f35,0xbf800000,0x3f0ebf55,0x3ec43f6d,0xbf7bbe48
.long 0xbf80,0x3ec43f6d,0xbf35bf35,0x3f6d3ec4,0x3f800000,0xbf553f0e,0x3ec4bf6d,0x3e483f7b
.long 0x3f80,0xbf80,0x3f80,0xbf80,0xbf800000,0x3f7bbe48,0xbf6d3ec4,0x3f55bf0e
.long 0xbf80,0x3ec4bf6d,0x3f35bf35,0x3f6dbec4,0x3f800000,0x3f7b3e48,0x3f6d3ec4,0x3f553f0e
.long 0x3f80,0xbf353f35,0xbf800000,0xbf35bf35,0xbf800000,0xbf55bf0e,0xbec4bf6d,0x3e48bf7b
.long 0xbf80,0x3f6dbec4,0x3f353f35,0xbec43f6d,0x3f800000,0x3f0e3f55,0xbec43f6d,0xbf7b3e48
.long 0x3f80,0xbf800000,0xbf80,0x3f800000,0xbf800000,0xbe48bf7b,0x3f6dbec4,0x3f0e3f55
.long 0xbf80,0xbf35bf35,0xbf800000,0xbf353f35,0x3f35bf35,0xbe48bf7b,0xbf6dbec4,0xbf553f0e
.long 0x3f800000,0x3ec4bf6d,0xbf35bf35,0xbf6d3ec4,0x3f353f35,0x3f55bf0e,0xbec4bf6d,0xbf7b3e48
.long 0x3f80,0x3f80,0x3f80,0x3f80,0xbf353f35,0xbf0e3f55,0xbec43f6d,0xbe483f7b
.long 0xbf800000,0xbf6d3ec4,0xbf353f35,0xbec43f6d,0xbf35bf35,0xbf7bbe48,0xbf6d3ec4,0xbf0e3f55
.long 0xbf80,0xbf353f35,0x3f800000,0xbf35bf35,0x3f35bf35,0xbf7b3e48,0x3f6d3ec4,0xbf0ebf55
.long 0x3f800000,0xbf6dbec4,0x3f353f35,0xbec4bf6d,0x3f353f35,0xbf0ebf55,0x3ec43f6d,0xbe48bf7b
.long 0x3f80,0x3f800000,0xbf80,0xbf800000,0xbf353f35,0x3f553f0e,0x3ec4bf6d,0xbf7bbe48
.long 0xbf800000,0x3ec43f6d,0x3f35bf35,0xbf6dbec4,0xbf35bf35,0xbe483f7b,0x3f6dbec4,0xbf55bf0e
.long 0x3f800000,0xbec43f6d,0xbf35bf35,0x3f6dbec4,0x3f353f35,0xbf553f0e,0xbec4bf6d,0x3f7bbe48
.long 0xbf80,0x3f353f35,0xbf800000,0x3f35bf35,0x3f35bf35,0x3e483f7b,0xbf6dbec4,0x3f55bf0e
.long 0xbf800000,0x3f6dbec4,0xbf353f35,0x3ec4bf6d,0xbf35bf35,0x3f7b3e48,0xbf6d3ec4,0x3f0ebf55
.long 0x3f80,0xbf80,0x3f80,0xbf80,0xbf353f35,0x3f0ebf55,0xbec43f6d,0x3e48bf7b
.long 0x3f800000,0x3f6d3ec4,0x3f353f35,0x3ec43f6d,0x3f353f35,0x3f0e3f55,0x3ec43f6d,0x3e483f7b
.long 0xbf80,0x3f35bf35,0x3f800000,0x3f353f35,0x3f35bf35,0x3f7bbe48,0x3f6d3ec4,0x3f0e3f55
.long 0xbf800000,0xbec4bf6d,0x3f35bf35,0x3f6d3ec4,0xbf35bf35,0x3e48bf7b,0x3f6dbec4,0x3f553f0e
.long 0x3f80,0xbf800000,0xbf80,0x3f800000,0xbf353f35,0xbf55bf0e,0x3ec4bf6d,0x3f7b3e48
.long 0x3f808000,0x3f808000,0x3f808000,0x3f808000,0x3f808000,0x3f7bbe48,0x3f6dbec4,0x3f55bf0e
.long 0x3f808000,0x3f6dbec4,0x3f35bf35,0x3ec4bf6d,0x3f808000,0x3f55bf0e,0x3ec4bf6d,0xbe48bf7b
.long 0x3f808000,0x3f35bf35,0xbf80,0xbf35bf35,0x3f808000,0x3f0ebf55,0xbec4bf6d,0xbf7bbe48
.long 0x3f808000,0x3ec4bf6d,0xbf35bf35,0xbf6d3ec4,0x3f808000,0x3e48bf7b,0xbf6dbec4,0xbf0e3f55
.long 0x3f808000,0xbf80,0xbf808000,0x3f80,0x3f808000,0xbe48bf7b,0xbf6d3ec4,0x3f0e3f55
.long 0x3f808000,0xbec4bf6d,0xbf353f35,0x3f6d3ec4,0x3f808000,0xbf0ebf55,0xbec43f6d,0x3f7bbe48
.long 0x3f808000,0xbf35bf35,0x3f80,0x3f35bf35,0x3f808000,0xbf55bf0e,0x3ec43f6d,0x3e48bf7b
.long 0x3f808000,0xbf6dbec4,0x3f353f35,0xbec4bf6d,0x3f808000,0xbf7bbe48,0x3f6d3ec4,0xbf55bf0e
.long 0x3f808000,0xbf6d3ec4,0x3f35bf35,0xbec43f6d,0x3f808000,0xbf553f0e,0x3ec4bf6d,0x3e483f7b
.long 0x3f808000,0xbf808000,0x3f808000,0xbf808000,0x3f808000,0xbf7b3e48,0x3f6dbec4,0xbf553f0e
.long 0x3f808000,0xbec43f6d,0xbf35bf35,0x3f6dbec4,0x3f808000,0xbe483f7b,0xbf6dbec4,0x3f0ebf55
.long 0x3f808000,0xbf353f35,0xbf80,0x3f353f35,0x3f808000,0xbf0e3f55,0xbec4bf6d,0x3f7b3e48
.long 0x3f808000,0x3ec43f6d,0xbf353f35,0xbf6dbec4,0x3f808000,0x3f0e3f55,0xbec43f6d,0xbf7b3e48
.long 0x3f808000,0x3f80,0xbf808000,0xbf80,0x3f808000,0x3e483f7b,0xbf6d3ec4,0xbf0ebf55
.long 0x3f808000,0x3f6d3ec4,0x3f353f35,0x3ec43f6d,0x3f808000,0x3f7b3e48,0x3f6d3ec4,0x3f553f0e
.long 0x3f808000,0x3f353f35,0x3f80,0xbf353f35,0x3f808000,0x3f553f0e,0x3ec43f6d,0xbe483f7b
.long 0x3f808000,0x3f808000,0x3f808000,0x3f808000,0x3f35bf35,0x3f0ebf55,0x3ec4bf6d,0x3e48bf7b
.long 0xbf80,0xbec4bf6d,0xbf35bf35,0xbf6dbec4,0xbf35bf35,0xbf7bbe48,0xbf6d3ec4,0xbf0e3f55
.long 0xbf808000,0xbf353f35,0x3f80,0x3f353f35,0xbf353f35,0x3e483f7b,0x3f6d3ec4,0x3f55bf0e
.long 0x3f80,0x3f6d3ec4,0x3f35bf35,0xbec4bf6d,0x3f353f35,0x3f55bf0e,0xbec4bf6d,0xbf7b3e48
.long 0x3f808000,0xbf80,0xbf808000,0x3f80,0x3f35bf35,0xbf55bf0e,0xbec43f6d,0x3f7b3e48
.long 0xbf80,0xbf6d3ec4,0x3f353f35,0x3ec4bf6d,0xbf35bf35,0xbe483f7b,0x3f6dbec4,0xbf55bf0e
.long 0xbf808000,0x3f353f35,0xbf80,0xbf353f35,0xbf353f35,0x3f7bbe48,0xbf6dbec4,0x3f0e3f55
.long 0x3f80,0x3ec4bf6d,0xbf353f35,0x3f6dbec4,0x3f353f35,0xbf0ebf55,0x3ec43f6d,0xbe48bf7b
.long 0xbf80,0x3ec43f6d,0xbf35bf35,0x3f6d3ec4,0xbf35bf35,0x3f7b3e48,0xbf6d3ec4,0x3f0ebf55
.long 0x3f808000,0xbf808000,0x3f808000,0xbf808000,0x3f35bf35,0xbf0e3f55,0x3ec4bf6d,0xbe483f7b
.long 0x3f80,0xbf6dbec4,0x3f35bf35,0x3ec43f6d,0x3f353f35,0xbf553f0e,0xbec4bf6d,0x3f7bbe48
.long 0xbf808000,0x3f35bf35,0x3f80,0xbf35bf35,0xbf353f35,0xbe48bf7b,0x3f6d3ec4,0xbf553f0e
.long 0xbf80,0x3f6dbec4,0x3f353f35,0xbec43f6d,0xbf35bf35,0x3e48bf7b,0x3f6dbec4,0x3f553f0e
.long 0x3f808000,0x3f80,0xbf808000,0xbf80,0x3f35bf35,0x3f553f0e,0xbec43f6d,0xbf7bbe48
.long 0x3f80,0xbec43f6d,0xbf353f35,0xbf6d3ec4,0x3f353f35,0x3f0e3f55,0x3ec43f6d,0x3e483f7b
.long 0xbf808000,0xbf35bf35,0xbf80,0x3f35bf35,0xbf353f35,0xbf7b3e48,0xbf6dbec4,0xbf0ebf55
.long 0x3f808000,0x3f35bf35,0xbf80,0xbf35bf35,0xbf80,0xbf55bf0e,0xbf6d3ec4,0xbe483f7b
.long 0xbf808000,0xbec43f6d,0x3f353f35,0x3f6dbec4,0x3f80,0x3f7b3e48,0x3ec4bf6d,0xbf55bf0e
.long 0x3f808000,0x3f808000,0x3f808000,0x3f808000,0xbf80,0xbe48bf7b,0xbec4bf6d,0xbf0ebf55
.long 0xbf808000,0xbf6d3ec4,0xbf353f35,0xbec43f6d,0x3f80,0x3f0e3f55,0x3f6d3ec4,0x3f7bbe48
.long 0x3f808000,0xbf35bf35,0x3f80,0x3f35bf35,0xbf80,0xbf0e3f55,0x3f6dbec4,0xbf7bbe48
.long 0xbf808000,0x3f6d3ec4,0xbf35bf35,0x3ec43f6d,0x3f80,0x3e48bf7b,0xbec43f6d,0x3f0ebf55
.long 0x3f808000,0xbf80,0xbf808000,0x3f80,0xbf80,0xbf7b3e48,0x3ec43f6d,0x3f55bf0e
.long 0xbf808000,0x3ec43f6d,0x3f35bf35,0xbf6dbec4,0x3f80,0x3f55bf0e,0xbf6dbec4,0x3e483f7b
.long 0xbf808000,0x3ec4bf6d,0x3f353f35,0xbf6d3ec4,0x3f80,0xbf7bbe48,0x3ec4bf6d,0x3f553f0e
.long 0x3f808000,0xbf353f35,0xbf80,0x3f353f35,0xbf80,0x3f553f0e,0xbf6d3ec4,0x3e48bf7b
.long 0xbf808000,0x3f6dbec4,0xbf353f35,0x3ec4bf6d,0x3f80,0xbf0ebf55,0x3f6d3ec4,0xbf7b3e48
.long 0x3f808000,0xbf808000,0x3f808000,0xbf808000,0xbf80,0x3e483f7b,0xbec4bf6d,0x3f0e3f55
.long 0xbf808000,0xbf6dbec4,0xbf35bf35,0xbec4bf6d,0x3f80,0xbe483f7b,0xbec43f6d,0xbf0e3f55
.long 0x3f808000,0x3f353f35,0x3f80,0xbf353f35,0xbf80,0x3f0ebf55,0x3f6dbec4,0x3f7b3e48
.long 0xbf808000,0xbec4bf6d,0x3f35bf35,0x3f6d3ec4,0x3f80,0xbf553f0e,0xbf6dbec4,0xbe48bf7b
.long 0x3f808000,0x3f80,0xbf808000,0xbf80,0xbf80,0x3f7bbe48,0x3ec43f6d,0xbf553f0e
.long 0xbf808000,0xbf353f35,0x3f80,0x3f353f35,0x3f353f35,0x3f7bbe48,0x3ec4bf6d,0xbf0ebf55
.long 0xbf80,0xbf6dbec4,0xbf353f35,0x3ec43f6d,0xbf353f35,0x3f0e3f55,0x3f6dbec4,0xbe48bf7b
.long 0x3f808000,0x3f808000,0x3f808000,0x3f808000,0xbf35bf35,0xbf55bf0e,0xbf6dbec4,0xbf7bbe48
.long 0x3f80,0x3ec43f6d,0x3f353f35,0x3f6d3ec4,0x3f35bf35,0x3e48bf7b,0xbec4bf6d,0xbf55bf0e
.long 0xbf808000,0x3f353f35,0xbf80,0xbf353f35,0x3f353f35,0xbe48bf7b,0xbec43f6d,0x3f55bf0e
.long 0xbf80,0xbec43f6d,0x3f35bf35,0xbf6d3ec4,0xbf353f35,0x3f55bf0e,0xbf6d3ec4,0x3f7bbe48
.long 0x3f808000,0xbf80,0xbf808000,0x3f80,0xbf35bf35,0xbf0e3f55,0x3f6d3ec4,0x3e48bf7b
.long 0x3f80,0x3f6dbec4,0xbf35bf35,0xbec43f6d,0x3f35bf35,0xbf7bbe48,0x3ec43f6d,0x3f0ebf55
.long 0xbf80,0x3f6d3ec4,0xbf353f35,0xbec4bf6d,0xbf353f35,0xbf0ebf55,0x3f6dbec4,0x3e483f7b
.long 0xbf808000,0x3f35bf35,0x3f80,0xbf35bf35,0x3f353f35,0xbf7b3e48,0x3ec4bf6d,0x3f0e3f55
.long 0x3f80,0xbec4bf6d,0x3f353f35,0xbf6dbec4,0x3f35bf35,0xbe483f7b,0xbec4bf6d,0x3f553f0e
.long 0x3f808000,0xbf808000,0x3f808000,0xbf808000,0xbf35bf35,0x3f553f0e,0xbf6dbec4,0x3f7b3e48
.long 0xbf80,0x3ec4bf6d,0x3f35bf35,0x3f6dbec4,0xbf353f35,0xbf553f0e,0xbf6d3ec4,0xbf7b3e48
.long 0xbf808000,0xbf35bf35,0xbf80,0x3f35bf35,0x3f353f35,0x3e483f7b,0xbec43f6d,0xbf553f0e
.long 0x3f80,0xbf6d3ec4,0xbf35bf35,0x3ec4bf6d,0x3f35bf35,0x3f7b3e48,0x3ec43f6d,0xbf0e3f55
.long 0x3f808000,0x3f80,0xbf808000,0xbf80,0xbf35bf35,0x3f0ebf55,0x3f6d3ec4,0xbe483f7b
.long 0x3f808000,0x3f808000,0x3f808000,0x3f808000,0xbf808000,0xbf7b3e48,0xbf6d3ec4,0xbf553f0e
.long 0x3f808000,0x3f6dbec4,0x3f35bf35,0x3ec4bf6d,0xbf808000,0xbf553f0e,0xbec43f6d,0x3e483f7b
.long 0x3f808000,0x3f35bf35,0xbf80,0xbf35bf35,0xbf808000,0xbf0e3f55,0x3ec43f6d,0x3f7b3e48
.long 0x3f808000,0x3ec4bf6d,0xbf35bf35,0xbf6d3ec4,0xbf808000,0xbe483f7b,0x3f6d3ec4,0x3f0ebf55
.long 0x3f808000,0xbf80,0xbf808000,0x3f80,0xbf808000,0x3e483f7b,0x3f6dbec4,0xbf0ebf55
.long 0x3f808000,0xbec4bf6d,0xbf353f35,0x3f6d3ec4,0xbf808000,0x3f0e3f55,0x3ec4bf6d,0xbf7b3e48
.long 0x3f808000,0xbf35bf35,0x3f80,0x3f35bf35,0xbf808000,0x3f553f0e,0xbec4bf6d,0xbe483f7b
.long 0x3f808000,0xbf6dbec4,0x3f353f35,0xbec4bf6d,0xbf808000,0x3f7b3e48,0xbf6dbec4,0x3f553f0e
.long 0x3f808000,0xbf6d3ec4,0x3f35bf35,0xbec43f6d,0xbf808000,0x3f55bf0e,0xbec43f6d,0xbe48bf7b
.long 0x3f808000,0xbf808000,0x3f808000,0xbf808000,0xbf808000,0x3f7bbe48,0xbf6d3ec4,0x3f55bf0e
.long 0x3f808000,0xbec43f6d,0xbf35bf35,0x3f6dbec4,0xbf808000,0x3e48bf7b,0x3f6d3ec4,0xbf0e3f55
.long 0x3f808000,0xbf353f35,0xbf80,0x3f353f35,0xbf808000,0x3f0ebf55,0x3ec43f6d,0xbf7bbe48
.long 0x3f808000,0x3ec43f6d,0xbf353f35,0xbf6dbec4,0xbf808000,0xbf0ebf55,0x3ec4bf6d,0x3f7bbe48
.long 0x3f808000,0x3f80,0xbf808000,0xbf80,0xbf808000,0xbe48bf7b,0x3f6dbec4,0x3f0e3f55
.long 0x3f808000,0x3f6d3ec4,0x3f353f35,0x3ec43f6d,0xbf808000,0xbf7bbe48,0xbf6dbec4,0xbf55bf0e
.long 0x3f808000,0x3f353f35,0x3f80,0xbf353f35,0xbf808000,0xbf55bf0e,0xbec4bf6d,0x3e48bf7b
.long 0x3f808000,0x3f808000,0x3f808000,0x3f808000,0xbf353f35,0xbf0e3f55,0xbec43f6d,0xbe483f7b
.long 0xbf80,0xbec4bf6d,0xbf35bf35,0xbf6dbec4,0x3f353f35,0x3f7b3e48,0x3f6dbec4,0x3f0ebf55
.long 0xbf808000,0xbf353f35,0x3f80,0x3f353f35,0x3f35bf35,0xbe48bf7b,0xbf6dbec4,0xbf553f0e
.long 0x3f80,0x3f6d3ec4,0x3f35bf35,0xbec4bf6d,0xbf35bf35,0xbf553f0e,0x3ec43f6d,0x3f7bbe48
.long 0x3f808000,0xbf80,0xbf808000,0x3f80,0xbf353f35,0x3f553f0e,0x3ec4bf6d,0xbf7bbe48
.long 0xbf80,0xbf6d3ec4,0x3f353f35,0x3ec4bf6d,0x3f353f35,0x3e48bf7b,0xbf6d3ec4,0x3f553f0e
.long 0xbf808000,0x3f353f35,0xbf80,0xbf353f35,0x3f35bf35,0xbf7b3e48,0x3f6d3ec4,0xbf0ebf55
.long 0x3f80,0x3ec4bf6d,0xbf353f35,0x3f6dbec4,0xbf35bf35,0x3f0e3f55,0xbec4bf6d,0x3e483f7b
.long 0xbf80,0x3ec43f6d,0xbf35bf35,0x3f6d3ec4,0x3f353f35,0xbf7bbe48,0x3f6dbec4,0xbf0e3f55
.long 0x3f808000,0xbf808000,0x3f808000,0xbf808000,0xbf353f35,0x3f0ebf55,0xbec43f6d,0x3e48bf7b
.long 0x3f80,0xbf6dbec4,0x3f35bf35,0x3ec43f6d,0xbf35bf35,0x3f55bf0e,0x3ec43f6d,0xbf7b3e48
.long 0xbf808000,0x3f35bf35,0x3f80,0xbf35bf35,0x3f35bf35,0x3e483f7b,0xbf6dbec4,0x3f55bf0e
.long 0xbf80,0x3f6dbec4,0x3f353f35,0xbec43f6d,0x3f353f35,0xbe483f7b,0xbf6d3ec4,0xbf55bf0e
.long 0x3f808000,0x3f80,0xbf808000,0xbf80,0xbf353f35,0xbf55bf0e,0x3ec4bf6d,0x3f7b3e48
.long 0x3f80,0xbec43f6d,0xbf353f35,0xbf6d3ec4,0xbf35bf35,0xbf0ebf55,0xbec4bf6d,0xbe48bf7b
.long 0xbf808000,0xbf35bf35,0xbf80,0x3f35bf35,0x3f35bf35,0x3f7bbe48,0x3f6d3ec4,0x3f0e3f55
.long 0x3f808000,0x3f35bf35,0xbf80,0xbf35bf35,0x3f80,0x3f553f0e,0x3f6dbec4,0x3e48bf7b
.long 0xbf808000,0xbec43f6d,0x3f353f35,0x3f6dbec4,0xbf80,0xbf7bbe48,0xbec43f6d,0x3f553f0e
.long 0x3f808000,0x3f808000,0x3f808000,0x3f808000,0x3f80,0x3e483f7b,0x3ec43f6d,0x3f0e3f55
.long 0xbf808000,0xbf6d3ec4,0xbf353f35,0xbec43f6d,0xbf80,0xbf0ebf55,0xbf6dbec4,0xbf7b3e48
.long 0x3f808000,0xbf35bf35,0x3f80,0x3f35bf35,0x3f80,0x3f0ebf55,0xbf6d3ec4,0x3f7b3e48
.long 0xbf808000,0x3f6d3ec4,0xbf35bf35,0x3ec43f6d,0xbf80,0xbe483f7b,0x3ec4bf6d,0xbf0e3f55
.long 0x3f808000,0xbf80,0xbf808000,0x3f80,0x3f80,0x3f7bbe48,0xbec4bf6d,0xbf553f0e
.long 0xbf808000,0x3ec43f6d,0x3f35bf35,0xbf6dbec4,0xbf80,0xbf553f0e,0x3f6d3ec4,0xbe48bf7b
.long 0xbf808000,0x3ec4bf6d,0x3f353f35,0xbf6d3ec4,0xbf80,0x3f7b3e48,0xbec43f6d,0xbf55bf0e
.long 0x3f808000,0xbf353f35,0xbf80,0x3f353f35,0x3f80,0xbf55bf0e,0x3f6dbec4,0xbe483f7b
.long 0xbf808000,0x3f6dbec4,0xbf353f35,0x3ec4bf6d,0xbf80,0x3f0e3f55,0xbf6dbec4,0x3f7bbe48
.long 0x3f808000,0xbf808000,0x3f808000,0xbf808000,0x3f80,0xbe48bf7b,0x3ec43f6d,0xbf0ebf55
.long 0xbf808000,0xbf6dbec4,0xbf35bf35,0xbec4bf6d,0xbf80,0x3e48bf7b,0x3ec4bf6d,0x3f0ebf55
.long 0x3f808000,0x3f353f35,0x3f80,0xbf353f35,0x3f80,0xbf0e3f55,0xbf6d3ec4,0xbf7bbe48
.long 0xbf808000,0xbec4bf6d,0x3f35bf35,0x3f6d3ec4,0xbf80,0x3f55bf0e,0x3f6d3ec4,0x3e483f7b
.long 0x3f808000,0x3f80,0xbf808000,0xbf80,0x3f80,0xbf7b3e48,0xbec4bf6d,0x3f55bf0e
.long 0xbf808000,0xbf353f35,0x3f80,0x3f353f35,0xbf35bf35,0xbf7b3e48,0xbec43f6d,0x3f0e3f55
.long 0xbf80,0xbf6dbec4,0xbf353f35,0x3ec43f6d,0x3f35bf35,0xbf0ebf55,0xbf6d3ec4,0x3e483f7b
.long 0x3f808000,0x3f808000,0x3f808000,0x3f808000,0x3f353f35,0x3f553f0e,0x3f6d3ec4,0x3f7b3e48
.long 0x3f80,0x3ec43f6d,0x3f353f35,0x3f6d3ec4,0xbf353f35,0xbe483f7b,0x3ec43f6d,0x3f553f0e
.long 0xbf808000,0x3f353f35,0xbf80,0xbf353f35,0xbf35bf35,0x3e483f7b,0x3ec4bf6d,0xbf553f0e
.long 0xbf80,0xbec43f6d,0x3f35bf35,0xbf6d3ec4,0x3f35bf35,0xbf553f0e,0x3f6dbec4,0xbf7b3e48
.long 0x3f808000,0xbf80,0xbf808000,0x3f80,0x3f353f35,0x3f0ebf55,0xbf6dbec4,0xbe483f7b
.long 0x3f80,0x3f6dbec4,0xbf35bf35,0xbec43f6d,0xbf353f35,0x3f7b3e48,0xbec4bf6d,0xbf0e3f55
.long 0xbf80,0x3f6d3ec4,0xbf353f35,0xbec4bf6d,0x3f35bf35,0x3f0e3f55,0xbf6d3ec4,0xbe48bf7b
.long 0xbf808000,0x3f35bf35,0x3f80,0xbf35bf35,0xbf35bf35,0x3f7bbe48,0xbec43f6d,0xbf0ebf55
.long 0x3f80,0xbec4bf6d,0x3f353f35,0xbf6dbec4,0xbf353f35,0x3e48bf7b,0x3ec43f6d,0xbf55bf0e
.long 0x3f808000,0xbf808000,0x3f808000,0xbf808000,0x3f353f35,0xbf55bf0e,0x3f6d3ec4,0xbf7bbe48
.long 0xbf80,0x3ec4bf6d,0x3f35bf35,0x3f6dbec4,0x3f35bf35,0x3f55bf0e,0x3f6dbec4,0x3f7bbe48
.long 0xbf808000,0xbf35bf35,0xbf80,0x3f35bf35,0xbf35bf35,0xbe48bf7b,0x3ec4bf6d,0x3f55bf0e
.long 0x3f80,0xbf6d3ec4,0xbf35bf35,0x3ec4bf6d,0xbf353f35,0xbf7bbe48,0xbec4bf6d,0x3f0ebf55
.long 0x3f808000,0x3f80,0xbf808000,0xbf80,0x3f353f35,0xbf0e3f55,0xbf6dbec4,0x3e48bf7b
.long 0x3f803f80,0x3f803f80,0x3f803f80,0x3f803f80,0x3f7f3f80,0x3f753f7b,0x3f223f35,0x3ef13f0e
.long 0x3f7b3f80,0x3f553f6d,0xbe480000,0xbf0ebec4,0x3f753f80,0x3f223f55,0xbf62bf35,0xbf7fbf7b
.long 0x3f6d3f80,0x3ec43f35,0xbf6dbf80,0xbec4bf35,0x3f623f80,0x3dc93f0e,0xbe95bf35,0x3f223e48
.long 0x3f553f80,0xbe483ec4,0x3f0e0000,0x3f7b3f6d,0x3f463f80,0xbef13e48,0x3f7f3f35,0x3e953f55
.long 0x3f353f80,0xbf350000,0x3f353f80,0xbf350000,0x3f223f80,0xbf62be48,0xbdc93f35,0xbf75bf55
.long 0x3f0e3f80,0xbf7bbec4,0xbf550000,0xbe48bf6d,0x3ef13f80,0xbf7fbf0e,0xbf75bf35,0x3f46be48
.long 0x3ec43f80,0xbf6dbf35,0xbec4bf80,0x3f6d3f35,0x3e953f80,0xbf46bf55,0x3ef1bf35,0x3dc93f7b
.long 0x3e483f80,0xbf0ebf6d,0x3f7b0000,0xbf553ec4,0x3dc93f80,0xbe95bf7b,0x3f463f35,0xbf62bf0e
.long 0xbe483f80,0x3f0ebf6d,0xbf7b0000,0x3f553ec4,0xbe953f80,0x3f46bf55,0xbef1bf35,0xbdc93f7b
.long 0x3f80,0xbf80,0x3f80,0xbf80,0xbdc93f80,0x3e95bf7b,0xbf463f35,0x3f62bf0e
.long 0xbf0e3f80,0x3f7bbec4,0x3f550000,0x3e48bf6d,0xbf223f80,0x3f62be48,0x3dc93f35,0x3f75bf55
.long 0xbec43f80,0x3f6dbf35,0x3ec4bf80,0xbf6d3f35,0xbef13f80,0x3f7fbf0e,0x3f75bf35,0xbf46be48
.long 0xbf553f80,0x3e483ec4,0xbf0e0000,0xbf7b3f6d,0xbf623f80,0xbdc93f0e,0x3e95bf35,0xbf223e48
.long 0xbf353f80,0x3f350000,0xbf353f80,0x3f350000,0xbf463f80,0x3ef13e48,0xbf7f3f35,0xbe953f55
.long 0xbf7b3f80,0xbf553f6d,0x3e480000,0x3f0ebec4,0xbf7f3f80,0xbf753f7b,0xbf223f35,0xbef13f0e
.long 0xbf6d3f80,0xbec43f35,0x3f6dbf80,0x3ec4bf35,0xbf753f80,0xbf223f55,0x3f62bf35,0x3f7fbf7b
.long 0x3f803f80,0x3f803f80,0x3f803f80,0x3f803f80,0x3f623f6d,0x3f463f55,0x3e953ec4,0x3dc93e48
.long 0x3f0e3f35,0x3e483ec4,0xbf55bf35,0xbf7bbf6d,0x3dc93ec4,0xbef1be48,0xbf46bf6d,0xbe95bf0e
.long 0xbec40000,0xbf6dbf35,0x3ec40000,0x3f6d3f35,0xbf46bec4,0xbf75bf7b,0x3f7f3f6d,0x3ef13f55
.long 0xbf7bbf35,0xbf0ebf6d,0x3e483f35,0xbf55bec4,0xbf75bf6d,0x3dc9bf0e,0xbf62bec4,0xbf22bf7b
.long 0xbf35bf80,0x3f350000,0xbf35bf80,0x3f350000,0xbe95bf6d,0x3f7f3f0e,0x3ef1bec4,0x3f463f7b
.long 0x3e48bf35,0x3f553f6d,0x3f7b3f35,0xbf0e3ec4,0x3f22bec4,0x3e953f7b,0x3dc93f6d,0xbf62bf55
.long 0x3f6d0000,0xbec43f35,0xbf6d0000,0x3ec4bf35,0x3f7f3ec4,0xbf623e48,0xbf22bf6d,0x3f753f0e
.long 0x3f553f35,0xbf7bbec4,0x3f0ebf35,0xbe483f6d,0x3ef13f6d,0xbf22bf55,0x3f753ec4,0xbf7fbe48
.long 0xbf553f35,0x3f7bbec4,0xbf0ebf35,0x3e483f6d,0xbf7f3ec4,0x3f623e48,0x3f22bf6d,0xbf753f0e
.long 0x3f80,0xbf80,0x3f80,0xbf80,0xbef13f6d,0x3f22bf55,0xbf753ec4,0x3f7fbe48
.long 0xbe48bf35,0xbf553f6d,0xbf7b3f35,0x3f0e3ec4,0x3e95bf6d,0xbf7f3f0e,0xbef1bec4,0xbf463f7b
.long 0xbf6d0000,0x3ec43f35,0x3f6d0000,0xbec4bf35,0xbf22bec4,0xbe953f7b,0xbdc93f6d,0x3f62bf55
.long 0x3f7bbf35,0x3f0ebf6d,0xbe483f35,0x3f55bec4,0x3f46bec4,0x3f75bf7b,0xbf7f3f6d,0xbef13f55
.long 0x3f35bf80,0xbf350000,0x3f35bf80,0xbf350000,0x3f75bf6d,0xbdc9bf0e,0x3f62bec4,0x3f22bf7b
.long 0xbf0e3f35,0xbe483ec4,0x3f55bf35,0x3f7bbf6d,0xbf623f6d,0xbf463f55,0xbe953ec4,0xbdc93e48
.long 0x3ec40000,0x3f6dbf35,0xbec40000,0xbf6d3f35,0xbdc93ec4,0x3ef1be48,0x3f46bf6d,0x3e95bf0e
.long 0x3f6d3f80,0x3ec43f35,0xbf6dbf80,0xbec4bf35,0xbef10000,0xbf7fbf55,0x3f753f35,0x3f463f7b
.long 0xbf55bf80,0x3e48bec4,0xbf0e0000,0xbf7bbf6d,0x3f220000,0x3f623f7b,0xbdc9bf35,0x3f753f0e
.long 0x3f803f80,0x3f803f80,0x3f803f80,0x3f803f80,0xbdc90000,0xbe95be48,0xbf46bf35,0xbf62bf55
.long 0xbf7bbf80,0xbf55bf6d,0x3e480000,0x3f0e3ec4,0x3e950000,0x3f463f0e,0x3ef13f35,0xbdc93e48
.long 0x3ec43f80,0xbf6dbf35,0xbec4bf80,0x3f6d3f35,0xbf750000,0x3f22bf0e,0x3f623f35,0xbf7fbe48
.long 0xbe48bf80,0x3f0e3f6d,0xbf7b0000,0x3f55bec4,0x3f7f0000,0xbf753e48,0x3f22bf35,0xbef13f55
.long 0x3f353f80,0xbf350000,0x3f353f80,0xbf350000,0xbf460000,0xbef1bf7b,0xbf7fbf35,0x3e95bf0e
.long 0xbf0ebf80,0x3f7b3ec4,0x3f550000,0x3e483f6d,0x3f620000,0xbdc93f55,0xbe953f35,0xbf22bf7b
.long 0x3f0ebf80,0xbf7b3ec4,0xbf550000,0xbe483f6d,0x3f460000,0x3ef1bf7b,0x3f7fbf35,0xbe95bf0e
.long 0xbec43f80,0x3f6dbf35,0x3ec4bf80,0xbf6d3f35,0xbf620000,0x3dc93f55,0x3e953f35,0x3f22bf7b
.long 0x3e48bf80,0xbf0e3f6d,0x3f7b0000,0xbf55bec4,0x3f750000,0xbf22bf0e,0xbf623f35,0x3f7fbe48
.long 0x3f80,0xbf80,0x3f80,0xbf80,0xbf7f0000,0x3f753e48,0xbf22bf35,0x3ef13f55
.long 0x3f7bbf80,0x3f55bf6d,0xbe480000,0xbf0e3ec4,0x3dc90000,0x3e95be48,0x3f46bf35,0x3f62bf55
.long 0xbf6d3f80,0xbec43f35,0x3f6dbf80,0x3ec4bf35,0xbe950000,0xbf463f0e,0xbef13f35,0x3dc93e48
.long 0x3f55bf80,0xbe48bec4,0x3f0e0000,0x3f7bbf6d,0x3ef10000,0x3f7fbf55,0xbf753f35,0xbf463f7b
.long 0xbf353f80,0x3f350000,0xbf353f80,0x3f350000,0xbf220000,0xbf623f7b,0x3dc9bf35,0xbf753f0e
.long 0xbec40000,0xbf6dbf35,0x3ec40000,0x3f6d3f35,0xbf22bf6d,0x3e95be48,0xbdc93ec4,0xbf62bf0e
.long 0x3f7b3f35,0x3f0e3f6d,0xbe48bf35,0x3f553ec4,0xbe953ec4,0xbf7fbf55,0x3ef13f6d,0xbf46be48
.long 0x3f803f80,0x3f803f80,0x3f803f80,0x3f803f80,0xbef1bec4,0xbf22bf0e,0xbf75bf6d,0xbf7fbf7b
.long 0xbf0ebf35,0xbe48bec4,0x3f553f35,0x3f7b3f6d,0x3f7f3f6d,0x3f623f7b,0xbf22bec4,0xbf75bf55
.long 0x3f6d0000,0xbec43f35,0xbf6d0000,0x3ec4bf35,0xbdc93f6d,0xbef1bf7b,0x3f46bec4,0xbe953f55
.long 0xbf55bf35,0x3f7b3ec4,0xbf0e3f35,0x3e48bf6d,0x3f62bec4,0xbf463f0e,0x3e95bf6d,0xbdc93f7b
.long 0xbf35bf80,0x3f350000,0xbf35bf80,0x3f350000,0x3f753ec4,0x3dc93f55,0x3f623f6d,0xbf223e48
.long 0xbe483f35,0xbf55bf6d,0xbf7bbf35,0x3f0ebec4,0xbf46bf6d,0x3f753e48,0x3f7f3ec4,0xbef13f0e
.long 0x3e483f35,0x3f55bf6d,0x3f7bbf35,0xbf0ebec4,0xbf753ec4,0xbdc93f55,0xbf623f6d,0x3f223e48
.long 0xbf6d0000,0x3ec43f35,0x3f6d0000,0xbec4bf35,0x3f46bf6d,0xbf753e48,0xbf7f3ec4,0x3ef13f0e
.long 0x3f55bf35,0xbf7b3ec4,0x3f0e3f35,0xbe48bf6d,0x3dc93f6d,0x3ef1bf7b,0xbf46bec4,0x3e953f55
.long 0x3f80,0xbf80,0x3f80,0xbf80,0xbf62bec4,0x3f463f0e,0xbe95bf6d,0x3dc93f7b
.long 0x3f0ebf35,0x3e48bec4,0xbf553f35,0xbf7b3f6d,0x3ef1bec4,0x3f22bf0e,0x3f75bf6d,0x3f7fbf7b
.long 0x3ec40000,0x3f6dbf35,0xbec40000,0xbf6d3f35,0xbf7f3f6d,0xbf623f7b,0x3f22bec4,0x3f75bf55
.long 0xbf7b3f35,0xbf0e3f6d,0x3e48bf35,0xbf553ec4,0x3f22bf6d,0xbe95be48,0x3dc93ec4,0x3f62bf0e
.long 0x3f35bf80,0xbf350000,0x3f35bf80,0xbf350000,0x3e953ec4,0x3f7fbf55,0xbef13f6d,0x3f46be48
.long 0x3f803f80,0x3f803f80,0x3f803f80,0x3f803f80,0xbf7fbf80,0xbf75bf7b,0xbf22bf35,0xbef1bf0e
.long 0x3f7b3f80,0x3f553f6d,0xbe480000,0xbf0ebec4,0xbf75bf80,0xbf22bf55,0x3f623f35,0x3f7f3f7b
.long 0x3f6d3f80,0x3ec43f35,0xbf6dbf80,0xbec4bf35,0xbf62bf80,0xbdc9bf0e,0x3e953f35,0xbf22be48
.long 0x3f553f80,0xbe483ec4,0x3f0e0000,0x3f7b3f6d,0xbf46bf80,0x3ef1be48,0xbf7fbf35,0xbe95bf55
.long 0x3f353f80,0xbf350000,0x3f353f80,0xbf350000,0xbf22bf80,0x3f623e48,0x3dc9bf35,0x3f753f55
.long 0x3f0e3f80,0xbf7bbec4,0xbf550000,0xbe48bf6d,0xbef1bf80,0x3f7f3f0e,0x3f753f35,0xbf463e48
.long 0x3ec43f80,0xbf6dbf35,0xbec4bf80,0x3f6d3f35,0xbe95bf80,0x3f463f55,0xbef13f35,0xbdc9bf7b
.long 0x3e483f80,0xbf0ebf6d,0x3f7b0000,0xbf553ec4,0xbdc9bf80,0x3e953f7b,0xbf46bf35,0x3f623f0e
.long 0xbe483f80,0x3f0ebf6d,0xbf7b0000,0x3f553ec4,0x3e95bf80,0xbf463f55,0x3ef13f35,0x3dc9bf7b
.long 0x3f80,0xbf80,0x3f80,0xbf80,0x3dc9bf80,0xbe953f7b,0x3f46bf35,0xbf623f0e
.long 0xbf0e3f80,0x3f7bbec4,0x3f550000,0x3e48bf6d,0x3f22bf80,0xbf623e48,0xbdc9bf35,0xbf753f55
.long 0xbec43f80,0x3f6dbf35,0x3ec4bf80,0xbf6d3f35,0x3ef1bf80,0xbf7f3f0e,0xbf753f35,0x3f463e48
.long 0xbf553f80,0x3e483ec4,0xbf0e0000,0xbf7b3f6d,0x3f62bf80,0x3dc9bf0e,0xbe953f35,0x3f22be48
.long 0xbf353f80,0x3f350000,0xbf353f80,0x3f350000,0x3f46bf80,0xbef1be48,0x3f7fbf35,0x3e95bf55
.long 0xbf7b3f80,0xbf553f6d,0x3e480000,0x3f0ebec4,0x3f7fbf80,0x3f75bf7b,0x3f22bf35,0x3ef1bf0e
.long 0xbf6d3f80,0xbec43f35,0x3f6dbf80,0x3ec4bf35,0x3f75bf80,0x3f22bf55,0xbf623f35,0xbf7f3f7b
.long 0x3f803f80,0x3f803f80,0x3f803f80,0x3f803f80,0xbf62bf6d,0xbf46bf55,0xbe95bec4,0xbdc9be48
.long 0x3f0e3f35,0x3e483ec4,0xbf55bf35,0xbf7bbf6d,0xbdc9bec4,0x3ef13e48,0x3f463f6d,0x3e953f0e
.long 0xbec40000,0xbf6dbf35,0x3ec40000,0x3f6d3f35,0x3f463ec4,0x3f753f7b,0xbf7fbf6d,0xbef1bf55
.long 0xbf7bbf35,0xbf0ebf6d,0x3e483f35,0xbf55bec4,0x3f753f6d,0xbdc93f0e,0x3f623ec4,0x3f223f7b
.long 0xbf35bf80,0x3f350000,0xbf35bf80,0x3f350000,0x3e953f6d,0xbf7fbf0e,0xbef13ec4,0xbf46bf7b
.long 0x3e48bf35,0x3f553f6d,0x3f7b3f35,0xbf0e3ec4,0xbf223ec4,0xbe95bf7b,0xbdc9bf6d,0x3f623f55
.long 0x3f6d0000,0xbec43f35,0xbf6d0000,0x3ec4bf35,0xbf7fbec4,0x3f62be48,0x3f223f6d,0xbf75bf0e
.long 0x3f553f35,0xbf7bbec4,0x3f0ebf35,0xbe483f6d,0xbef1bf6d,0x3f223f55,0xbf75bec4,0x3f7f3e48
.long 0xbf553f35,0x3f7bbec4,0xbf0ebf35,0x3e483f6d,0x3f7fbec4,0xbf62be48,0xbf223f6d,0x3f75bf0e
.long 0x3f80,0xbf80,0x3f80,0xbf80,0x3ef1bf6d,0xbf223f55,0x3f75bec4,0xbf7f3e48
.long 0xbe48bf35,0xbf553f6d,0xbf7b3f35,0x3f0e3ec4,0xbe953f6d,0x3f7fbf0e,0x3ef13ec4,0x3f46bf7b
.long 0xbf6d0000,0x3ec43f35,0x3f6d0000,0xbec4bf35,0x3f223ec4,0x3e95bf7b,0x3dc9bf6d,0xbf623f55
.long 0x3f7bbf35,0x3f0ebf6d,0xbe483f35,0x3f55bec4,0xbf463ec4,0xbf753f7b,0x3f7fbf6d,0x3ef1bf55
.long 0x3f35bf80,0xbf350000,0x3f35bf80,0xbf350000,0xbf753f6d,0x3dc93f0e,0xbf623ec4,0xbf223f7b
.long 0xbf0e3f35,0xbe483ec4,0x3f55bf35,0x3f7bbf6d,0x3f62bf6d,0x3f46bf55,0x3e95bec4,0x3dc9be48
.long 0x3ec40000,0x3f6dbf35,0xbec40000,0xbf6d3f35,0x3dc9bec4,0xbef13e48,0xbf463f6d,0xbe953f0e
.long 0x3f6d3f80,0x3ec43f35,0xbf6dbf80,0xbec4bf35,0x3ef10000,0x3f7f3f55,0xbf75bf35,0xbf46bf7b
.long 0xbf55bf80,0x3e48bec4,0xbf0e0000,0xbf7bbf6d,0xbf220000,0xbf62bf7b,0x3dc93f35,0xbf75bf0e
.long 0x3f803f80,0x3f803f80,0x3f803f80,0x3f803f80,0x3dc90000,0x3e953e48,0x3f463f35,0x3f623f55
.long 0xbf7bbf80,0xbf55bf6d,0x3e480000,0x3f0e3ec4,0xbe950000,0xbf46bf0e,0xbef1bf35,0x3dc9be48
.long 0x3ec43f80,0xbf6dbf35,0xbec4bf80,0x3f6d3f35,0x3f750000,0xbf223f0e,0xbf62bf35,0x3f7f3e48
.long 0xbe48bf80,0x3f0e3f6d,0xbf7b0000,0x3f55bec4,0xbf7f0000,0x3f75be48,0xbf223f35,0x3ef1bf55
.long 0x3f353f80,0xbf350000,0x3f353f80,0xbf350000,0x3f460000,0x3ef13f7b,0x3f7f3f35,0xbe953f0e
.long 0xbf0ebf80,0x3f7b3ec4,0x3f550000,0x3e483f6d,0xbf620000,0x3dc9bf55,0x3e95bf35,0x3f223f7b
.long 0x3f0ebf80,0xbf7b3ec4,0xbf550000,0xbe483f6d,0xbf460000,0xbef13f7b,0xbf7f3f35,0x3e953f0e
.long 0xbec43f80,0x3f6dbf35,0x3ec4bf80,0xbf6d3f35,0x3f620000,0xbdc9bf55,0xbe95bf35,0xbf223f7b
.long 0x3e48bf80,0xbf0e3f6d,0x3f7b0000,0xbf55bec4,0xbf750000,0x3f223f0e,0x3f62bf35,0xbf7f3e48
.long 0x3f80,0xbf80,0x3f80,0xbf80,0x3f7f0000,0xbf75be48,0x3f223f35,0xbef1bf55
.long 0x3f7bbf80,0x3f55bf6d,0xbe480000,0xbf0e3ec4,0xbdc90000,0xbe953e48,0xbf463f35,0xbf623f55
.long 0xbf6d3f80,0xbec43f35,0x3f6dbf80,0x3ec4bf35,0x3e950000,0x3f46bf0e,0x3ef1bf35,0xbdc9be48
.long 0x3f55bf80,0xbe48bec4,0x3f0e0000,0x3f7bbf6d,0xbef10000,0xbf7f3f55,0x3f75bf35,0x3f46bf7b
.long 0xbf353f80,0x3f350000,0xbf353f80,0x3f350000,0x3f220000,0x3f62bf7b,0xbdc93f35,0x3f75bf0e
.long 0xbec40000,0xbf6dbf35,0x3ec40000,0x3f6d3f35,0x3f223f6d,0xbe953e48,0x3dc9bec4,0x3f623f0e
.long 0x3f7b3f35,0x3f0e3f6d,0xbe48bf35,0x3f553ec4,0x3e95bec4,0x3f7f3f55,0xbef1bf6d,0x3f463e48
.long 0x3f803f80,0x3f803f80,0x3f803f80,0x3f803f80,0x3ef13ec4,0x3f223f0e,0x3f753f6d,0x3f7f3f7b
.long 0xbf0ebf35,0xbe48bec4,0x3f553f35,0x3f7b3f6d,0xbf7fbf6d,0xbf62bf7b,0x3f223ec4,0x3f753f55
.long 0x3f6d0000,0xbec43f35,0xbf6d0000,0x3ec4bf35,0x3dc9bf6d,0x3ef13f7b,0xbf463ec4,0x3e95bf55
.long 0xbf55bf35,0x3f7b3ec4,0xbf0e3f35,0x3e48bf6d,0xbf623ec4,0x3f46bf0e,0xbe953f6d,0x3dc9bf7b
.long 0xbf35bf80,0x3f350000,0xbf35bf80,0x3f350000,0xbf75bec4,0xbdc9bf55,0xbf62bf6d,0x3f22be48
.long 0xbe483f35,0xbf55bf6d,0xbf7bbf35,0x3f0ebec4,0x3f463f6d,0xbf75be48,0xbf7fbec4,0x3ef1bf0e
.long 0x3e483f35,0x3f55bf6d,0x3f7bbf35,0xbf0ebec4,0x3f75bec4,0x3dc9bf55,0x3f62bf6d,0xbf22be48
.long 0xbf6d0000,0x3ec43f35,0x3f6d0000,0xbec4bf35,0xbf463f6d,0x3f75be48,0x3f7fbec4,0xbef1bf0e
.long 0x3f55bf35,0xbf7b3ec4,0x3f0e3f35,0xbe48bf6d,0xbdc9bf6d,0xbef13f7b,0x3f463ec4,0xbe95bf55
.long 0x3f80,0xbf80,0x3f80,0xbf80,0x3f623ec4,0xbf46bf0e,0x3e953f6d,0xbdc9bf7b
.long 0x3f0ebf35,0x3e48bec4,0xbf553f35,0xbf7b3f6d,0xbef13ec4,0xbf223f0e,0xbf753f6d,0xbf7f3f7b
.long 0x3ec40000,0x3f6dbf35,0xbec40000,0xbf6d3f35,0x3f7fbf6d,0x3f62bf7b,0xbf223ec4,0xbf753f55
.long 0xbf7b3f35,0xbf0e3f6d,0x3e48bf35,0xbf553ec4,0xbf223f6d,0x3e953e48,0xbdc9bec4,0xbf623f0e
.long 0x3f35bf80,0xbf350000,0x3f35bf80,0xbf350000,0xbe95bec4,0xbf7f3f55,0x3ef1bf6d,0xbf463e48
.long 0xbf803f80,0xbf803f80,0xbf803f80,0xbf803f80,0xbf7f3f80,0xbf753f7b,0xbf223f35,0xbef13f0e
.long 0xbf7b3f80,0xbf553f6d,0x3e480000,0x3f0ebec4,0xbf753f80,0xbf223f55,0x3f62bf35,0x3f7fbf7b
.long 0xbf6d3f80,0xbec43f35,0x3f6dbf80,0x3ec4bf35,0xbf623f80,0xbdc93f0e,0x3e95bf35,0xbf223e48
.long 0xbf553f80,0x3e483ec4,0xbf0e0000,0xbf7b3f6d,0xbf463f80,0x3ef13e48,0xbf7f3f35,0xbe953f55
.long 0xbf353f80,0x3f350000,0xbf353f80,0x3f350000,0xbf223f80,0x3f62be48,0x3dc93f35,0x3f75bf55
.long 0xbf0e3f80,0x3f7bbec4,0x3f550000,0x3e48bf6d,0xbef13f80,0x3f7fbf0e,0x3f75bf35,0xbf46be48
.long 0xbec43f80,0x3f6dbf35,0x3ec4bf80,0xbf6d3f35,0xbe953f80,0x3f46bf55,0xbef1bf35,0xbdc93f7b
.long 0xbe483f80,0x3f0ebf6d,0xbf7b0000,0x3f553ec4,0xbdc93f80,0x3e95bf7b,0xbf463f35,0x3f62bf0e
.long 0x3e483f80,0xbf0ebf6d,0x3f7b0000,0xbf553ec4,0x3e953f80,0xbf46bf55,0x3ef1bf35,0x3dc93f7b
.long 0x3f80,0xbf80,0x3f80,0xbf80,0x3dc93f80,0xbe95bf7b,0x3f463f35,0xbf62bf0e
.long 0x3f0e3f80,0xbf7bbec4,0xbf550000,0xbe48bf6d,0x3f223f80,0xbf62be48,0xbdc93f35,0xbf75bf55
.long 0x3ec43f80,0xbf6dbf35,0xbec4bf80,0x3f6d3f35,0x3ef13f80,0xbf7fbf0e,0xbf75bf35,0x3f46be48
.long 0x3f553f80,0xbe483ec4,0x3f0e0000,0x3f7b3f6d,0x3f623f80,0x3dc93f0e,0xbe95bf35,0x3f223e48
.long 0x3f353f80,0xbf350000,0x3f353f80,0xbf350000,0x3f463f80,0xbef13e48,0x3f7f3f35,0x3e953f55
.long 0x3f7b3f80,0x3f553f6d,0xbe480000,0xbf0ebec4,0x3f7f3f80,0x3f753f7b,0x3f223f35,0x3ef13f0e
.long 0x3f6d3f80,0x3ec43f35,0xbf6dbf80,0xbec4bf35,0x3f753f80,0x3f223f55,0xbf62bf35,0xbf7fbf7b
.long 0xbf803f80,0xbf803f80,0xbf803f80,0xbf803f80,0xbf623f6d,0xbf463f55,0xbe953ec4,0xbdc93e48
.long 0xbf0e3f35,0xbe483ec4,0x3f55bf35,0x3f7bbf6d,0xbdc93ec4,0x3ef1be48,0x3f46bf6d,0x3e95bf0e
.long 0x3ec40000,0x3f6dbf35,0xbec40000,0xbf6d3f35,0x3f46bec4,0x3f75bf7b,0xbf7f3f6d,0xbef13f55
.long 0x3f7bbf35,0x3f0ebf6d,0xbe483f35,0x3f55bec4,0x3f75bf6d,0xbdc9bf0e,0x3f62bec4,0x3f22bf7b
.long 0x3f35bf80,0xbf350000,0x3f35bf80,0xbf350000,0x3e95bf6d,0xbf7f3f0e,0xbef1bec4,0xbf463f7b
.long 0xbe48bf35,0xbf553f6d,0xbf7b3f35,0x3f0e3ec4,0xbf22bec4,0xbe953f7b,0xbdc93f6d,0x3f62bf55
.long 0xbf6d0000,0x3ec43f35,0x3f6d0000,0xbec4bf35,0xbf7f3ec4,0x3f623e48,0x3f22bf6d,0xbf753f0e
.long 0xbf553f35,0x3f7bbec4,0xbf0ebf35,0x3e483f6d,0xbef13f6d,0x3f22bf55,0xbf753ec4,0x3f7fbe48
.long 0x3f553f35,0xbf7bbec4,0x3f0ebf35,0xbe483f6d,0x3f7f3ec4,0xbf623e48,0xbf22bf6d,0x3f753f0e
.long 0x3f80,0xbf80,0x3f80,0xbf80,0x3ef13f6d,0xbf22bf55,0x3f753ec4,0xbf7fbe48
.long 0x3e48bf35,0x3f553f6d,0x3f7b3f35,0xbf0e3ec4,0xbe95bf6d,0x3f7f3f0e,0x3ef1bec4,0x3f463f7b
.long 0x3f6d0000,0xbec43f35,0xbf6d0000,0x3ec4bf35,0x3f22bec4,0x3e953f7b,0x3dc93f6d,0xbf62bf55
.long 0xbf7bbf35,0xbf0ebf6d,0x3e483f35,0xbf55bec4,0xbf46bec4,0xbf75bf7b,0x3f7f3f6d,0x3ef13f55
.long 0xbf35bf80,0x3f350000,0xbf35bf80,0x3f350000,0xbf75bf6d,0x3dc9bf0e,0xbf62bec4,0xbf22bf7b
.long 0x3f0e3f35,0x3e483ec4,0xbf55bf35,0xbf7bbf6d,0x3f623f6d,0x3f463f55,0x3e953ec4,0x3dc93e48
.long 0xbec40000,0xbf6dbf35,0x3ec40000,0x3f6d3f35,0x3dc93ec4,0xbef1be48,0xbf46bf6d,0xbe95bf0e
.long 0xbf6d3f80,0xbec43f35,0x3f6dbf80,0x3ec4bf35,0x3ef10000,0x3f7fbf55,0xbf753f35,0xbf463f7b
.long 0x3f55bf80,0xbe48bec4,0x3f0e0000,0x3f7bbf6d,0xbf220000,0xbf623f7b,0x3dc9bf35,0xbf753f0e
.long 0xbf803f80,0xbf803f80,0xbf803f80,0xbf803f80,0x3dc90000,0x3e95be48,0x3f46bf35,0x3f62bf55
.long 0x3f7bbf80,0x3f55bf6d,0xbe480000,0xbf0e3ec4,0xbe950000,0xbf463f0e,0xbef13f35,0x3dc93e48
.long 0xbec43f80,0x3f6dbf35,0x3ec4bf80,0xbf6d3f35,0x3f750000,0xbf22bf0e,0xbf623f35,0x3f7fbe48
.long 0x3e48bf80,0xbf0e3f6d,0x3f7b0000,0xbf55bec4,0xbf7f0000,0x3f753e48,0xbf22bf35,0x3ef13f55
.long 0xbf353f80,0x3f350000,0xbf353f80,0x3f350000,0x3f460000,0x3ef1bf7b,0x3f7fbf35,0xbe95bf0e
.long 0x3f0ebf80,0xbf7b3ec4,0xbf550000,0xbe483f6d,0xbf620000,0x3dc93f55,0x3e953f35,0x3f22bf7b
.long 0xbf0ebf80,0x3f7b3ec4,0x3f550000,0x3e483f6d,0xbf460000,0xbef1bf7b,0xbf7fbf35,0x3e95bf0e
.long 0x3ec43f80,0xbf6dbf35,0xbec4bf80,0x3f6d3f35,0x3f620000,0xbdc93f55,0xbe953f35,0xbf22bf7b
.long 0xbe48bf80,0x3f0e3f6d,0xbf7b0000,0x3f55bec4,0xbf750000,0x3f22bf0e,0x3f623f35,0xbf7fbe48
.long 0x3f80,0xbf80,0x3f80,0xbf80,0x3f7f0000,0xbf753e48,0x3f22bf35,0xbef13f55
.long 0xbf7bbf80,0xbf55bf6d,0x3e480000,0x3f0e3ec4,0xbdc90000,0xbe95be48,0xbf46bf35,0xbf62bf55
.long 0x3f6d3f80,0x3ec43f35,0xbf6dbf80,0xbec4bf35,0x3e950000,0x3f463f0e,0x3ef13f35,0xbdc93e48
.long 0xbf55bf80,0x3e48bec4,0xbf0e0000,0xbf7bbf6d,0xbef10000,0xbf7fbf55,0x3f753f35,0x3f463f7b
.long 0x3f353f80,0xbf350000,0x3f353f80,0xbf350000,0x3f220000,0x3f623f7b,0xbdc9bf35,0x3f753f0e
.long 0x3ec40000,0x3f6dbf35,0xbec40000,0xbf6d3f35,0x3f22bf6d,0xbe95be48,0x3dc93ec4,0x3f62bf0e
.long 0xbf7b3f35,0xbf0e3f6d,0x3e48bf35,0xbf553ec4,0x3e953ec4,0x3f7fbf55,0xbef13f6d,0x3f46be48
.long 0xbf803f80,0xbf803f80,0xbf803f80,0xbf803f80,0x3ef1bec4,0x3f22bf0e,0x3f75bf6d,0x3f7fbf7b
.long 0x3f0ebf35,0x3e48bec4,0xbf553f35,0xbf7b3f6d,0xbf7f3f6d,0xbf623f7b,0x3f22bec4,0x3f75bf55
.long 0xbf6d0000,0x3ec43f35,0x3f6d0000,0xbec4bf35,0x3dc93f6d,0x3ef1bf7b,0xbf46bec4,0x3e953f55
.long 0x3f55bf35,0xbf7b3ec4,0x3f0e3f35,0xbe48bf6d,0xbf62bec4,0x3f463f0e,0xbe95bf6d,0x3dc93f7b
.long 0x3f35bf80,0xbf350000,0x3f35bf80,0xbf350000,0xbf753ec4,0xbdc93f55,0xbf623f6d,0x3f223e48
.long 0x3e483f35,0x3f55bf6d,0x3f7bbf35,0xbf0ebec4,0x3f46bf6d,0xbf753e48,0xbf7f3ec4,0x3ef13f0e
.long 0xbe483f35,0xbf55bf6d,0xbf7bbf35,0x3f0ebec4,0x3f753ec4,0x3dc93f55,0x3f623f6d,0xbf223e48
.long 0x3f6d0000,0xbec43f35,0xbf6d0000,0x3ec4bf35,0xbf46bf6d,0x3f753e48,0x3f7f3ec4,0xbef13f0e
.long 0xbf55bf35,0x3f7b3ec4,0xbf0e3f35,0x3e48bf6d,0xbdc93f6d,0xbef1bf7b,0x3f46bec4,0xbe953f55
.long 0x3f80,0xbf80,0x3f80,0xbf80,0x3f62bec4,0xbf463f0e,0x3e95bf6d,0xbdc93f7b
.long 0xbf0ebf35,0xbe48bec4,0x3f553f35,0x3f7b3f6d,0xbef1bec4,0xbf22bf0e,0xbf75bf6d,0xbf7fbf7b
.long 0xbec40000,0xbf6dbf35,0x3ec40000,0x3f6d3f35,0x3f7f3f6d,0x3f623f7b,0xbf22bec4,0xbf75bf55
.long 0x3f7b3f35,0x3f0e3f6d,0xbe48bf35,0x3f553ec4,0xbf22bf6d,0x3e95be48,0xbdc93ec4,0xbf62bf0e
.long 0xbf35bf80,0x3f350000,0xbf35bf80,0x3f350000,0xbe953ec4,0xbf7fbf55,0x3ef13f6d,0xbf46be48
.long 0xbf803f80,0xbf803f80,0xbf803f80,0xbf803f80,0x3f7fbf80,0x3f75bf7b,0x3f22bf35,0x3ef1bf0e
.long 0xbf7b3f80,0xbf553f6d,0x3e480000,0x3f0ebec4,0x3f75bf80,0x3f22bf55,0xbf623f35,0xbf7f3f7b
.long 0xbf6d3f80,0xbec43f35,0x3f6dbf80,0x3ec4bf35,0x3f62bf80,0x3dc9bf0e,0xbe953f35,0x3f22be48
.long 0xbf553f80,0x3e483ec4,0xbf0e0000,0xbf7b3f6d,0x3f46bf80,0xbef1be48,0x3f7fbf35,0x3e95bf55
.long 0xbf353f80,0x3f350000,0xbf353f80,0x3f350000,0x3f22bf80,0xbf623e48,0xbdc9bf35,0xbf753f55
.long 0xbf0e3f80,0x3f7bbec4,0x3f550000,0x3e48bf6d,0x3ef1bf80,0xbf7f3f0e,0xbf753f35,0x3f463e48
.long 0xbec43f80,0x3f6dbf35,0x3ec4bf80,0xbf6d3f35,0x3e95bf80,0xbf463f55,0x3ef13f35,0x3dc9bf7b
.long 0xbe483f80,0x3f0ebf6d,0xbf7b0000,0x3f553ec4,0x3dc9bf80,0xbe953f7b,0x3f46bf35,0xbf623f0e
.long 0x3e483f80,0xbf0ebf6d,0x3f7b0000,0xbf553ec4,0xbe95bf80,0x3f463f55,0xbef13f35,0xbdc9bf7b
.long 0x3f80,0xbf80,0x3f80,0xbf80,0xbdc9bf80,0x3e953f7b,0xbf46bf35,0x3f623f0e
.long 0x3f0e3f80,0xbf7bbec4,0xbf550000,0xbe48bf6d,0xbf22bf80,0x3f623e48,0x3dc9bf35,0x3f753f55
.long 0x3ec43f80,0xbf6dbf35,0xbec4bf80,0x3f6d3f35,0xbef1bf80,0x3f7f3f0e,0x3f753f35,0xbf463e48
.long 0x3f553f80,0xbe483ec4,0x3f0e0000,0x3f7b3f6d,0xbf62bf80,0xbdc9bf0e,0x3e953f35,0xbf22be48
.long 0x3f353f80,0xbf350000,0x3f353f80,0xbf350000,0xbf46bf80,0x3ef1be48,0xbf7fbf35,0xbe95bf55
.long 0x3f7b3f80,0x3f553f6d,0xbe480000,0xbf0ebec4,0xbf7fbf80,0xbf75bf7b,0xbf22bf35,0xbef1bf0e
.long 0x3f6d3f80,0x3ec43f35,0xbf6dbf80,0xbec4bf35,0xbf75bf80,0xbf22bf55,0x3f623f35,0x3f7f3f7b
.long 0xbf803f80,0xbf803f80,0xbf803f80,0xbf803f80,0x3f62bf6d,0x3f46bf55,0x3e95bec4,0x3dc9be48
.long 0xbf0e3f35,0xbe483ec4,0x3f55bf35,0x3f7bbf6d,0x3dc9bec4,0xbef13e48,0xbf463f6d,0xbe953f0e
.long 0x3ec40000,0x3f6dbf35,0xbec40000,0xbf6d3f35,0xbf463ec4,0xbf753f7b,0x3f7fbf6d,0x3ef1bf55
.long 0x3f7bbf35,0x3f0ebf6d,0xbe483f35,0x3f55bec4,0xbf753f6d,0x3dc93f0e,0xbf623ec4,0xbf223f7b
.long 0x3f35bf80,0xbf350000,0x3f35bf80,0xbf350000,0xbe953f6d,0x3f7fbf0e,0x3ef13ec4,0x3f46bf7b
.long 0xbe48bf35,0xbf553f6d,0xbf7b3f35,0x3f0e3ec4,0x3f223ec4,0x3e95bf7b,0x3dc9bf6d,0xbf623f55
.long 0xbf6d0000,0x3ec43f35,0x3f6d0000,0xbec4bf35,0x3f7fbec4,0xbf62be48,0xbf223f6d,0x3f75bf0e
.long 0xbf553f35,0x3f7bbec4,0xbf0ebf35,0x3e483f6d,0x3ef1bf6d,0xbf223f55,0x3f75bec4,0xbf7f3e48
.long 0x3f553f35,0xbf7bbec4,0x3f0ebf35,0xbe483f6d,0xbf7fbec4,0x3f62be48,0x3f223f6d,0xbf75bf0e
.long 0x3f80,0xbf80,0x3f80,0xbf80,0xbef1bf6d,0x3f223f55,0xbf75bec4,0x3f7f3e48
.long 0x3e48bf35,0x3f553f6d,0x3f7b3f35,0xbf0e3ec4,0x3e953f6d,0xbf7fbf0e,0xbef13ec4,0xbf46bf7b
.long 0x3f6d0000,0xbec43f35,0xbf6d0000,0x3ec4bf35,0xbf223ec4,0xbe95bf7b,0xbdc9bf6d,0x3f623f55
.long 0xbf7bbf35,0xbf0ebf6d,0x3e483f35,0xbf55bec4,0x3f463ec4,0x3f753f7b,0xbf7fbf6d,0xbef1bf55
.long 0xbf35bf80,0x3f350000,0xbf35bf80,0x3f350000,0x3f753f6d,0xbdc93f0e,0x3f623ec4,0x3f223f7b
.long 0x3f0e3f35,0x3e483ec4,0xbf55bf35,0xbf7bbf6d,0xbf62bf6d,0xbf46bf55,0xbe95bec4,0xbdc9be48
.long 0xbec40000,0xbf6dbf35,0x3ec40000,0x3f6d3f35,0xbdc9bec4,0x3ef13e48,0x3f463f6d,0x3e953f0e
.long 0xbf6d3f80,0xbec43f35,0x3f6dbf80,0x3ec4bf35,0xbef10000,0xbf7f3f55,0x3f75bf35,0x3f46bf7b
.long 0x3f55bf80,0xbe48bec4,0x3f0e0000,0x3f7bbf6d,0x3f220000,0x3f62bf7b,0xbdc93f35,0x3f75bf0e
.long 0xbf803f80,0xbf803f80,0xbf803f80,0xbf803f80,0xbdc90000,0xbe953e48,0xbf463f35,0xbf623f55
.long 0x3f7bbf80,0x3f55bf6d,0xbe480000,0xbf0e3ec4,0x3e950000,0x3f46bf0e,0x3ef1bf35,0xbdc9be48
.long 0xbec43f80,0x3f6dbf35,0x3ec4bf80,0xbf6d3f35,0xbf750000,0x3f223f0e,0x3f62bf35,0xbf7f3e48
.long 0x3e48bf80,0xbf0e3f6d,0x3f7b0000,0xbf55bec4,0x3f7f0000,0xbf75be48,0x3f223f35,0xbef1bf55
.long 0xbf353f80,0x3f350000,0xbf353f80,0x3f350000,0xbf460000,0xbef13f7b,0xbf7f3f35,0x3e953f0e
.long 0x3f0ebf80,0xbf7b3ec4,0xbf550000,0xbe483f6d,0x3f620000,0xbdc9bf55,0xbe95bf35,0xbf223f7b
.long 0xbf0ebf80,0x3f7b3ec4,0x3f550000,0x3e483f6d,0x3f460000,0x3ef13f7b,0x3f7f3f35,0xbe953f0e
.long 0x3ec43f80,0xbf6dbf35,0xbec4bf80,0x3f6d3f35,0xbf620000,0x3dc9bf55,0x3e95bf35,0x3f223f7b
.long 0xbe48bf80,0x3f0e3f6d,0xbf7b0000,0x3f55bec4,0x3f750000,0xbf223f0e,0xbf62bf35,0x3f7f3e48
.long 0x3f80,0xbf80,0x3f80,0xbf80,0xbf7f0000,0x3f75be48,0xbf223f35,0x3ef1bf55
.long 0xbf7bbf80,0xbf55bf6d,0x3e480000,0x3f0e3ec4,0x3dc90000,0x3e953e48,0x3f463f35,0x3f623f55
.long 0x3f6d3f80,0x3ec43f35,0xbf6dbf80,0xbec4bf35,0xbe950000,0xbf46bf0e,0xbef1bf35,0x3dc9be48
.long 0xbf55bf80,0x3e48bec4,0xbf0e0000,0xbf7bbf6d,0x3ef10000,0x3f7f3f55,0xbf75bf35,0xbf46bf7b
.long 0x3f353f80,0xbf350000,0x3f353f80,0xbf350000,0xbf220000,0xbf62bf7b,0x3dc93f35,0xbf75bf0e
.long 0x3ec40000,0x3f6dbf35,0xbec40000,0xbf6d3f35,0xbf223f6d,0x3e953e48,0xbdc9bec4,0xbf623f0e
.long 0xbf7b3f35,0xbf0e3f6d,0x3e48bf35,0xbf553ec4,0xbe95bec4,0xbf7f3f55,0x3ef1bf6d,0xbf463e48
.long 0xbf803f80,0xbf803f80,0xbf803f80,0xbf803f80,0xbef13ec4,0xbf223f0e,0xbf753f6d,0xbf7f3f7b
.long 0x3f0ebf35,0x3e48bec4,0xbf553f35,0xbf7b3f6d,0x3f7fbf6d,0x3f62bf7b,0xbf223ec4,0xbf753f55
.long 0xbf6d0000,0x3ec43f35,0x3f6d0000,0xbec4bf35,0xbdc9bf6d,0xbef13f7b,0x3f463ec4,0xbe95bf55
.long 0x3f55bf35,0xbf7b3ec4,0x3f0e3f35,0xbe48bf6d,0x3f623ec4,0xbf46bf0e,0x3e953f6d,0xbdc9bf7b
.long 0x3f35bf80,0xbf350000,0x3f35bf80,0xbf350000,0x3f75bec4,0x3dc9bf55,0x3f62bf6d,0xbf22be48
.long 0x3e483f35,0x3f55bf6d,0x3f7bbf35,0xbf0ebec4,0xbf463f6d,0x3f75be48,0x3f7fbec4,0xbef1bf0e
.long 0xbe483f35,0xbf55bf6d,0xbf7bbf35,0x3f0ebec4,0xbf75bec4,0xbdc9bf55,0xbf62bf6d,0x3f22be48
.long 0x3f6d0000,0xbec43f35,0xbf6d0000,0x3ec4bf35,0x3f463f6d,0xbf75be48,0xbf7fbec4,0x3ef1bf0e
.long 0xbf55bf35,0x3f7b3ec4,0xbf0e3f35,0x3e48bf6d,0x3dc9bf6d,0x3ef13f7b,0xbf463ec4,0x3e95bf55
.long 0x3f80,0xbf80,0x3f80,0xbf80,0xbf623ec4,0x3f46bf0e,0xbe953f6d,0x3dc9bf7b
.long 0xbf0ebf35,0xbe48bec4,0x3f553f35,0x3f7b3f6d,0x3ef13ec4,0x3f223f0e,0x3f753f6d,0x3f7f3f7b
.long 0xbec40000,0xbf6dbf35,0x3ec40000,0x3f6d3f35,0xbf7fbf6d,0xbf62bf7b,0x3f223ec4,0x3f753f55
.long 0x3f7b3f35,0x3f0e3f6d,0xbe48bf35,0x3f553ec4,0x3f223f6d,0xbe953e48,0x3dc9bec4,0x3f623f0e
.long 0xbf35bf80,0x3f350000,0xbf35bf80,0x3f350000,0x3e95bec4,0x3f7f3f55,0xbef1bf6d,0x3f463e48
.long 0x0,0x0,0x0,0x0,0x3dc90000,0x3e953e48,0x3f463f35,0x3f623f55
.long 0x3e480000,0x3f0e3ec4,0x3f7b3f80,0x3f553f6d,0x3e950000,0x3f463f0e,0x3ef13f35,0xbdc93e48
.long 0x3ec40000,0x3f6d3f35,0xbec40000,0xbf6dbf35,0x3ef10000,0x3f7f3f55,0xbf75bf35,0xbf46bf7b
.long 0x3f0e0000,0x3f7b3f6d,0xbf55bf80,0x3e48bec4,0x3f220000,0x3f623f7b,0xbdc9bf35,0x3f753f0e
.long 0x3f350000,0x3f353f80,0x3f350000,0x3f353f80,0x3f460000,0x3ef13f7b,0x3f7f3f35,0xbe953f0e
.long 0x3f550000,0x3e483f6d,0x3f0e3f80,0xbf7bbec4,0x3f620000,0xbdc93f55,0xbe953f35,0xbf22bf7b
.long 0x3f6d0000,0xbec43f35,0xbf6d0000,0x3ec4bf35,0x3f750000,0xbf223f0e,0xbf62bf35,0x3f7f3e48
.long 0x3f7b0000,0xbf553ec4,0xbe48bf80,0x3f0e3f6d,0x3f7f0000,0xbf753e48,0x3f22bf35,0xbef13f55
.long 0x3f7b0000,0xbf55bec4,0xbe483f80,0x3f0ebf6d,0x3f750000,0xbf22bf0e,0xbf623f35,0x3f7fbe48
.long 0x3f800000,0xbf800000,0x3f800000,0xbf800000,0x3f7f0000,0xbf75be48,0x3f223f35,0xbef1bf55
.long 0x3f550000,0x3e48bf6d,0x3f0ebf80,0xbf7b3ec4,0x3f460000,0x3ef1bf7b,0x3f7fbf35,0xbe95bf0e
.long 0x3f6d0000,0xbec4bf35,0xbf6d0000,0x3ec43f35,0x3f620000,0xbdc9bf55,0xbe95bf35,0xbf223f7b
.long 0x3f0e0000,0x3f7bbf6d,0xbf553f80,0x3e483ec4,0x3ef10000,0x3f7fbf55,0xbf753f35,0xbf463f7b
.long 0x3f350000,0x3f35bf80,0x3f350000,0x3f35bf80,0x3f220000,0x3f62bf7b,0xbdc93f35,0x3f75bf0e
.long 0x3e480000,0x3f0ebec4,0x3f7bbf80,0x3f55bf6d,0x3dc90000,0x3e95be48,0x3f46bf35,0x3f62bf55
.long 0x3ec40000,0x3f6dbf35,0xbec40000,0xbf6d3f35,0x3e950000,0x3f46bf0e,0x3ef1bf35,0xbdc9be48
.long 0x0,0x0,0x0,0x0,0x3ef13ec4,0x3f223f0e,0x3f753f6d,0x3f7f3f7b
.long 0x3f553f35,0x3f7b3f6d,0x3f0e3f35,0x3e483ec4,0x3f7f3f6d,0x3f623f7b,0xbf22bec4,0xbf75bf55
.long 0x3f6d3f80,0x3ec43f35,0xbf6dbf80,0xbec4bf35,0x3f223f6d,0xbe953e48,0x3dc9bec4,0x3f623f0e
.long 0x3e483f35,0xbf55bec4,0x3f7b3f35,0x3f0e3f6d,0xbe953ec4,0xbf7fbf55,0x3ef13f6d,0xbf46be48
.long 0xbf350000,0xbf35bf80,0xbf350000,0xbf35bf80,0xbf75bec4,0xbdc9bf55,0xbf62bf6d,0x3f22be48
.long 0xbf7bbf35,0x3f0ebec4,0x3e48bf35,0x3f553f6d,0xbf46bf6d,0x3f753e48,0x3f7f3ec4,0xbef13f0e
.long 0xbec4bf80,0x3f6d3f35,0x3ec43f80,0xbf6dbf35,0x3dc9bf6d,0x3ef13f7b,0xbf463ec4,0x3e95bf55
.long 0x3f0ebf35,0xbe483f6d,0xbf55bf35,0x3f7b3ec4,0x3f62bec4,0xbf463f0e,0x3e95bf6d,0xbdc93f7b
.long 0x3f0e3f35,0xbe48bf6d,0xbf553f35,0x3f7bbec4,0x3dc93f6d,0x3ef1bf7b,0xbf46bec4,0x3e953f55
.long 0x3f800000,0xbf800000,0x3f800000,0xbf800000,0x3f623ec4,0xbf46bf0e,0x3e953f6d,0xbdc9bf7b
.long 0xbf7b3f35,0x3f0e3ec4,0x3e483f35,0x3f55bf6d,0xbf753ec4,0xbdc93f55,0xbf623f6d,0x3f223e48
.long 0xbec43f80,0x3f6dbf35,0x3ec4bf80,0xbf6d3f35,0xbf463f6d,0x3f75be48,0x3f7fbec4,0xbef1bf0e
.long 0x3e48bf35,0xbf553ec4,0x3f7bbf35,0x3f0ebf6d,0x3f22bf6d,0xbe95be48,0x3dc93ec4,0x3f62bf0e
.long 0xbf350000,0xbf353f80,0xbf350000,0xbf353f80,0xbe95bec4,0xbf7f3f55,0x3ef1bf6d,0xbf463e48
.long 0x3f55bf35,0x3f7bbf6d,0x3f0ebf35,0x3e48bec4,0x3ef1bec4,0x3f22bf0e,0x3f75bf6d,0x3f7fbf7b
.long 0x3f6dbf80,0x3ec4bf35,0xbf6d3f80,0xbec43f35,0x3f7fbf6d,0x3f62bf7b,0xbf223ec4,0xbf753f55
.long 0x3ec40000,0x3f6d3f35,0xbec40000,0xbf6dbf35,0x3f623f80,0x3dc93f0e,0xbe95bf35,0x3f223e48
.long 0xbf0e0000,0xbf7bbf6d,0x3f553f80,0xbe483ec4,0xbf46bf80,0x3ef1be48,0xbf7fbf35,0xbe95bf55
.long 0x0,0x0,0x0,0x0,0x3f7f3f80,0x3f753f7b,0x3f223f35,0x3ef13f0e
.long 0xbe480000,0xbf0ebec4,0xbf7bbf80,0xbf55bf6d,0xbf75bf80,0xbf22bf55,0x3f623f35,0x3f7f3f7b
.long 0x3f6d0000,0xbec43f35,0xbf6d0000,0x3ec4bf35,0x3e953f80,0xbf46bf55,0x3ef1bf35,0x3dc93f7b
.long 0xbf7b0000,0x3f55bec4,0x3e483f80,0xbf0ebf6d,0xbdc9bf80,0x3e953f7b,0xbf46bf35,0x3f623f0e
.long 0x3f350000,0x3f353f80,0x3f350000,0x3f353f80,0x3f223f80,0xbf62be48,0xbdc93f35,0xbf75bf55
.long 0xbf550000,0xbe48bf6d,0xbf0ebf80,0x3f7b3ec4,0xbef1bf80,0x3f7f3f0e,0x3f753f35,0xbf463e48
.long 0xbf550000,0xbe483f6d,0xbf0e3f80,0x3f7bbec4,0x3f22bf80,0xbf623e48,0xbdc9bf35,0xbf753f55
.long 0x3f6d0000,0xbec4bf35,0xbf6d0000,0x3ec43f35,0xbef13f80,0x3f7fbf0e,0x3f75bf35,0xbf46be48
.long 0xbf7b0000,0x3f553ec4,0x3e48bf80,0xbf0e3f6d,0x3e95bf80,0xbf463f55,0x3ef13f35,0x3dc9bf7b
.long 0x3f800000,0xbf800000,0x3f800000,0xbf800000,0xbdc93f80,0x3e95bf7b,0xbf463f35,0x3f62bf0e
.long 0xbe480000,0xbf0e3ec4,0xbf7b3f80,0xbf553f6d,0x3f7fbf80,0x3f75bf7b,0x3f22bf35,0x3ef1bf0e
.long 0x3ec40000,0x3f6dbf35,0xbec40000,0xbf6d3f35,0xbf753f80,0xbf223f55,0x3f62bf35,0x3f7fbf7b
.long 0xbf0e0000,0xbf7b3f6d,0x3f55bf80,0xbe48bec4,0x3f62bf80,0x3dc9bf0e,0xbe953f35,0x3f22be48
.long 0x3f350000,0x3f35bf80,0x3f350000,0x3f35bf80,0xbf463f80,0x3ef13e48,0xbf7f3f35,0xbe953f55
.long 0x3f6d3f80,0x3ec43f35,0xbf6dbf80,0xbec4bf35,0xbf46bec4,0xbf75bf7b,0x3f7f3f6d,0x3ef13f55
.long 0xbe48bf35,0x3f553ec4,0xbf7bbf35,0xbf0ebf6d,0x3f753f6d,0xbdc93f0e,0x3f623ec4,0x3f223f7b
.long 0x0,0x0,0x0,0x0,0x3f623f6d,0x3f463f55,0x3e953ec4,0x3dc93e48
.long 0xbf55bf35,0xbf7bbf6d,0xbf0ebf35,0xbe48bec4,0xbdc9bec4,0x3ef13e48,0x3f463f6d,0x3e953f0e
.long 0xbec4bf80,0x3f6d3f35,0x3ec43f80,0xbf6dbf35,0x3f7f3ec4,0xbf623e48,0xbf22bf6d,0x3f753f0e
.long 0xbf0e3f35,0x3e48bf6d,0x3f553f35,0xbf7bbec4,0xbef1bf6d,0x3f223f55,0xbf75bec4,0x3f7f3e48
.long 0xbf350000,0xbf35bf80,0xbf350000,0xbf35bf80,0xbe95bf6d,0x3f7f3f0e,0x3ef1bec4,0x3f463f7b
.long 0x3f7b3f35,0xbf0e3ec4,0xbe483f35,0xbf55bf6d,0xbf223ec4,0xbe95bf7b,0xbdc9bf6d,0x3f623f55
.long 0x3f7bbf35,0xbf0ebec4,0xbe48bf35,0xbf553f6d,0xbe953f6d,0x3f7fbf0e,0x3ef13ec4,0x3f46bf7b
.long 0xbec43f80,0x3f6dbf35,0x3ec4bf80,0xbf6d3f35,0xbf22bec4,0xbe953f7b,0xbdc93f6d,0x3f62bf55
.long 0xbf0ebf35,0x3e483f6d,0x3f55bf35,0xbf7b3ec4,0x3f7fbec4,0xbf62be48,0xbf223f6d,0x3f75bf0e
.long 0x3f800000,0xbf800000,0x3f800000,0xbf800000,0xbef13f6d,0x3f22bf55,0xbf753ec4,0x3f7fbe48
.long 0xbf553f35,0xbf7b3f6d,0xbf0e3f35,0xbe483ec4,0x3f62bf6d,0x3f46bf55,0x3e95bec4,0x3dc9be48
.long 0x3f6dbf80,0x3ec4bf35,0xbf6d3f80,0xbec43f35,0xbdc93ec4,0x3ef1be48,0x3f46bf6d,0x3e95bf0e
.long 0xbe483f35,0x3f55bec4,0xbf7b3f35,0xbf0e3f6d,0xbf463ec4,0xbf753f7b,0x3f7fbf6d,0x3ef1bf55
.long 0xbf350000,0xbf353f80,0xbf350000,0xbf353f80,0x3f75bf6d,0xbdc9bf0e,0x3f62bec4,0x3f22bf7b
.long 0x0,0x0,0x0,0x0,0xbdc90000,0xbe95be48,0xbf46bf35,0xbf62bf55
.long 0x3e480000,0x3f0e3ec4,0x3f7b3f80,0x3f553f6d,0xbe950000,0xbf46bf0e,0xbef1bf35,0x3dc9be48
.long 0x3ec40000,0x3f6d3f35,0xbec40000,0xbf6dbf35,0xbef10000,0xbf7fbf55,0x3f753f35,0x3f463f7b
.long 0x3f0e0000,0x3f7b3f6d,0xbf55bf80,0x3e48bec4,0xbf220000,0xbf62bf7b,0x3dc93f35,0xbf75bf0e
.long 0x3f350000,0x3f353f80,0x3f350000,0x3f353f80,0xbf460000,0xbef1bf7b,0xbf7fbf35,0x3e95bf0e
.long 0x3f550000,0x3e483f6d,0x3f0e3f80,0xbf7bbec4,0xbf620000,0x3dc9bf55,0x3e95bf35,0x3f223f7b
.long 0x3f6d0000,0xbec43f35,0xbf6d0000,0x3ec4bf35,0xbf750000,0x3f22bf0e,0x3f623f35,0xbf7fbe48
.long 0x3f7b0000,0xbf553ec4,0xbe48bf80,0x3f0e3f6d,0xbf7f0000,0x3f75be48,0xbf223f35,0x3ef1bf55
.long 0x3f7b0000,0xbf55bec4,0xbe483f80,0x3f0ebf6d,0xbf750000,0x3f223f0e,0x3f62bf35,0xbf7f3e48
.long 0x3f800000,0xbf800000,0x3f800000,0xbf800000,0xbf7f0000,0x3f753e48,0xbf22bf35,0x3ef13f55
.long 0x3f550000,0x3e48bf6d,0x3f0ebf80,0xbf7b3ec4,0xbf460000,0xbef13f7b,0xbf7f3f35,0x3e953f0e
.long 0x3f6d0000,0xbec4bf35,0xbf6d0000,0x3ec43f35,0xbf620000,0x3dc93f55,0x3e953f35,0x3f22bf7b
.long 0x3f0e0000,0x3f7bbf6d,0xbf553f80,0x3e483ec4,0xbef10000,0xbf7f3f55,0x3f75bf35,0x3f46bf7b
.long 0x3f350000,0x3f35bf80,0x3f350000,0x3f35bf80,0xbf220000,0xbf623f7b,0x3dc9bf35,0xbf753f0e
.long 0x3e480000,0x3f0ebec4,0x3f7bbf80,0x3f55bf6d,0xbdc90000,0xbe953e48,0xbf463f35,0xbf623f55
.long 0x3ec40000,0x3f6dbf35,0xbec40000,0xbf6d3f35,0xbe950000,0xbf463f0e,0xbef13f35,0x3dc93e48
.long 0x0,0x0,0x0,0x0,0xbef1bec4,0xbf22bf0e,0xbf75bf6d,0xbf7fbf7b
.long 0x3f553f35,0x3f7b3f6d,0x3f0e3f35,0x3e483ec4,0xbf7fbf6d,0xbf62bf7b,0x3f223ec4,0x3f753f55
.long 0x3f6d3f80,0x3ec43f35,0xbf6dbf80,0xbec4bf35,0xbf22bf6d,0x3e95be48,0xbdc93ec4,0xbf62bf0e
.long 0x3e483f35,0xbf55bec4,0x3f7b3f35,0x3f0e3f6d,0x3e95bec4,0x3f7f3f55,0xbef1bf6d,0x3f463e48
.long 0xbf350000,0xbf35bf80,0xbf350000,0xbf35bf80,0x3f753ec4,0x3dc93f55,0x3f623f6d,0xbf223e48
.long 0xbf7bbf35,0x3f0ebec4,0x3e48bf35,0x3f553f6d,0x3f463f6d,0xbf75be48,0xbf7fbec4,0x3ef1bf0e
.long 0xbec4bf80,0x3f6d3f35,0x3ec43f80,0xbf6dbf35,0xbdc93f6d,0xbef1bf7b,0x3f46bec4,0xbe953f55
.long 0x3f0ebf35,0xbe483f6d,0xbf55bf35,0x3f7b3ec4,0xbf623ec4,0x3f46bf0e,0xbe953f6d,0x3dc9bf7b
.long 0x3f0e3f35,0xbe48bf6d,0xbf553f35,0x3f7bbec4,0xbdc9bf6d,0xbef13f7b,0x3f463ec4,0xbe95bf55
.long 0x3f800000,0xbf800000,0x3f800000,0xbf800000,0xbf62bec4,0x3f463f0e,0xbe95bf6d,0x3dc93f7b
.long 0xbf7b3f35,0x3f0e3ec4,0x3e483f35,0x3f55bf6d,0x3f75bec4,0x3dc9bf55,0x3f62bf6d,0xbf22be48
.long 0xbec43f80,0x3f6dbf35,0x3ec4bf80,0xbf6d3f35,0x3f46bf6d,0xbf753e48,0xbf7f3ec4,0x3ef13f0e
.long 0x3e48bf35,0xbf553ec4,0x3f7bbf35,0x3f0ebf6d,0xbf223f6d,0x3e953e48,0xbdc9bec4,0xbf623f0e
.long 0xbf350000,0xbf353f80,0xbf350000,0xbf353f80,0x3e953ec4,0x3f7fbf55,0xbef13f6d,0x3f46be48
.long 0x3f55bf35,0x3f7bbf6d,0x3f0ebf35,0x3e48bec4,0xbef13ec4,0xbf223f0e,0xbf753f6d,0xbf7f3f7b
.long 0x3f6dbf80,0x3ec4bf35,0xbf6d3f80,0xbec43f35,0xbf7f3f6d,0xbf623f7b,0x3f22bec4,0x3f75bf55
.long 0x3ec40000,0x3f6d3f35,0xbec40000,0xbf6dbf35,0xbf62bf80,0xbdc9bf0e,0x3e953f35,0xbf22be48
.long 0xbf0e0000,0xbf7bbf6d,0x3f553f80,0xbe483ec4,0x3f463f80,0xbef13e48,0x3f7f3f35,0x3e953f55
.long 0x0,0x0,0x0,0x0,0xbf7fbf80,0xbf75bf7b,0xbf22bf35,0xbef1bf0e
.long 0xbe480000,0xbf0ebec4,0xbf7bbf80,0xbf55bf6d,0x3f753f80,0x3f223f55,0xbf62bf35,0xbf7fbf7b
.long 0x3f6d0000,0xbec43f35,0xbf6d0000,0x3ec4bf35,0xbe95bf80,0x3f463f55,0xbef13f35,0xbdc9bf7b
.long 0xbf7b0000,0x3f55bec4,0x3e483f80,0xbf0ebf6d,0x3dc93f80,0xbe95bf7b,0x3f463f35,0xbf62bf0e
.long 0x3f350000,0x3f353f80,0x3f350000,0x3f353f80,0xbf22bf80,0x3f623e48,0x3dc9bf35,0x3f753f55
.long 0xbf550000,0xbe48bf6d,0xbf0ebf80,0x3f7b3ec4,0x3ef13f80,0xbf7fbf0e,0xbf75bf35,0x3f46be48
.long 0xbf550000,0xbe483f6d,0xbf0e3f80,0x3f7bbec4,0xbf223f80,0x3f62be48,0x3dc93f35,0x3f75bf55
.long 0x3f6d0000,0xbec4bf35,0xbf6d0000,0x3ec43f35,0x3ef1bf80,0xbf7f3f0e,0xbf753f35,0x3f463e48
.long 0xbf7b0000,0x3f553ec4,0x3e48bf80,0xbf0e3f6d,0xbe953f80,0x3f46bf55,0xbef1bf35,0xbdc93f7b
.long 0x3f800000,0xbf800000,0x3f800000,0xbf800000,0x3dc9bf80,0xbe953f7b,0x3f46bf35,0xbf623f0e
.long 0xbe480000,0xbf0e3ec4,0xbf7b3f80,0xbf553f6d,0xbf7f3f80,0xbf753f7b,0xbf223f35,0xbef13f0e
.long 0x3ec40000,0x3f6dbf35,0xbec40000,0xbf6d3f35,0x3f75bf80,0x3f22bf55,0xbf623f35,0xbf7f3f7b
.long 0xbf0e0000,0xbf7b3f6d,0x3f55bf80,0xbe48bec4,0xbf623f80,0xbdc93f0e,0x3e95bf35,0xbf223e48
.long 0x3f350000,0x3f35bf80,0x3f350000,0x3f35bf80,0x3f46bf80,0xbef1be48,0x3f7fbf35,0x3e95bf55
.long 0x3f6d3f80,0x3ec43f35,0xbf6dbf80,0xbec4bf35,0x3f463ec4,0x3f753f7b,0xbf7fbf6d,0xbef1bf55
.long 0xbe48bf35,0x3f553ec4,0xbf7bbf35,0xbf0ebf6d,0xbf75bf6d,0x3dc9bf0e,0xbf62bec4,0xbf22bf7b
.long 0x0,0x0,0x0,0x0,0xbf62bf6d,0xbf46bf55,0xbe95bec4,0xbdc9be48
.long 0xbf55bf35,0xbf7bbf6d,0xbf0ebf35,0xbe48bec4,0x3dc93ec4,0xbef1be48,0xbf46bf6d,0xbe95bf0e
.long 0xbec4bf80,0x3f6d3f35,0x3ec43f80,0xbf6dbf35,0xbf7fbec4,0x3f62be48,0x3f223f6d,0xbf75bf0e
.long 0xbf0e3f35,0x3e48bf6d,0x3f553f35,0xbf7bbec4,0x3ef13f6d,0xbf22bf55,0x3f753ec4,0xbf7fbe48
.long 0xbf350000,0xbf35bf80,0xbf350000,0xbf35bf80,0x3e953f6d,0xbf7fbf0e,0xbef13ec4,0xbf46bf7b
.long 0x3f7b3f35,0xbf0e3ec4,0xbe483f35,0xbf55bf6d,0x3f22bec4,0x3e953f7b,0x3dc93f6d,0xbf62bf55
.long 0x3f7bbf35,0xbf0ebec4,0xbe48bf35,0xbf553f6d,0x3e95bf6d,0xbf7f3f0e,0xbef1bec4,0xbf463f7b
.long 0xbec43f80,0x3f6dbf35,0x3ec4bf80,0xbf6d3f35,0x3f223ec4,0x3e95bf7b,0x3dc9bf6d,0xbf623f55
.long 0xbf0ebf35,0x3e483f6d,0x3f55bf35,0xbf7b3ec4,0xbf7f3ec4,0x3f623e48,0x3f22bf6d,0xbf753f0e
.long 0x3f800000,0xbf800000,0x3f800000,0xbf800000,0x3ef1bf6d,0xbf223f55,0x3f75bec4,0xbf7f3e48
.long 0xbf553f35,0xbf7b3f6d,0xbf0e3f35,0xbe483ec4,0xbf623f6d,0xbf463f55,0xbe953ec4,0xbdc93e48
.long 0x3f6dbf80,0x3ec4bf35,0xbf6d3f80,0xbec43f35,0x3dc9bec4,0xbef13e48,0xbf463f6d,0xbe953f0e
.long 0xbe483f35,0x3f55bec4,0xbf7b3f35,0xbf0e3f6d,0x3f46bec4,0x3f75bf7b,0xbf7f3f6d,0xbef13f55
.long 0xbf350000,0xbf353f80,0xbf350000,0xbf353f80,0xbf753f6d,0x3dc93f0e,0xbf623ec4,0xbf223f7b
.long 0x0,0x0,0x0,0x0,0xbdc90000,0xbe953e48,0xbf463f35,0xbf623f55
.long 0xbe480000,0xbf0e3ec4,0xbf7b3f80,0xbf553f6d,0xbe950000,0xbf463f0e,0xbef13f35,0x3dc93e48
.long 0xbec40000,0xbf6d3f35,0x3ec40000,0x3f6dbf35,0xbef10000,0xbf7f3f55,0x3f75bf35,0x3f46bf7b
.long 0xbf0e0000,0xbf7b3f6d,0x3f55bf80,0xbe48bec4,0xbf220000,0xbf623f7b,0x3dc9bf35,0xbf753f0e
.long 0xbf350000,0xbf353f80,0xbf350000,0xbf353f80,0xbf460000,0xbef13f7b,0xbf7f3f35,0x3e953f0e
.long 0xbf550000,0xbe483f6d,0xbf0e3f80,0x3f7bbec4,0xbf620000,0x3dc93f55,0x3e953f35,0x3f22bf7b
.long 0xbf6d0000,0x3ec43f35,0x3f6d0000,0xbec4bf35,0xbf750000,0x3f223f0e,0x3f62bf35,0xbf7f3e48
.long 0xbf7b0000,0x3f553ec4,0x3e48bf80,0xbf0e3f6d,0xbf7f0000,0x3f753e48,0xbf22bf35,0x3ef13f55
.long 0xbf7b0000,0x3f55bec4,0x3e483f80,0xbf0ebf6d,0xbf750000,0x3f22bf0e,0x3f623f35,0xbf7fbe48
.long 0xbf800000,0x3f800000,0xbf800000,0x3f800000,0xbf7f0000,0x3f75be48,0xbf223f35,0x3ef1bf55
.long 0xbf550000,0xbe48bf6d,0xbf0ebf80,0x3f7b3ec4,0xbf460000,0xbef1bf7b,0xbf7fbf35,0x3e95bf0e
.long 0xbf6d0000,0x3ec4bf35,0x3f6d0000,0xbec43f35,0xbf620000,0x3dc9bf55,0x3e95bf35,0x3f223f7b
.long 0xbf0e0000,0xbf7bbf6d,0x3f553f80,0xbe483ec4,0xbef10000,0xbf7fbf55,0x3f753f35,0x3f463f7b
.long 0xbf350000,0xbf35bf80,0xbf350000,0xbf35bf80,0xbf220000,0xbf62bf7b,0x3dc93f35,0xbf75bf0e
.long 0xbe480000,0xbf0ebec4,0xbf7bbf80,0xbf55bf6d,0xbdc90000,0xbe95be48,0xbf46bf35,0xbf62bf55
.long 0xbec40000,0xbf6dbf35,0x3ec40000,0x3f6d3f35,0xbe950000,0xbf46bf0e,0xbef1bf35,0x3dc9be48
.long 0x0,0x0,0x0,0x0,0xbef13ec4,0xbf223f0e,0xbf753f6d,0xbf7f3f7b
.long 0xbf553f35,0xbf7b3f6d,0xbf0e3f35,0xbe483ec4,0xbf7f3f6d,0xbf623f7b,0x3f22bec4,0x3f75bf55
.long 0xbf6d3f80,0xbec43f35,0x3f6dbf80,0x3ec4bf35,0xbf223f6d,0x3e953e48,0xbdc9bec4,0xbf623f0e
.long 0xbe483f35,0x3f55bec4,0xbf7b3f35,0xbf0e3f6d,0x3e953ec4,0x3f7fbf55,0xbef13f6d,0x3f46be48
.long 0x3f350000,0x3f35bf80,0x3f350000,0x3f35bf80,0x3f75bec4,0x3dc9bf55,0x3f62bf6d,0xbf22be48
.long 0x3f7bbf35,0xbf0ebec4,0xbe48bf35,0xbf553f6d,0x3f46bf6d,0xbf753e48,0xbf7f3ec4,0x3ef13f0e
.long 0x3ec4bf80,0xbf6d3f35,0xbec43f80,0x3f6dbf35,0xbdc9bf6d,0xbef13f7b,0x3f463ec4,0xbe95bf55
.long 0xbf0ebf35,0x3e483f6d,0x3f55bf35,0xbf7b3ec4,0xbf62bec4,0x3f463f0e,0xbe95bf6d,0x3dc93f7b
.long 0xbf0e3f35,0x3e48bf6d,0x3f553f35,0xbf7bbec4,0xbdc93f6d,0xbef1bf7b,0x3f46bec4,0xbe953f55
.long 0xbf800000,0x3f800000,0xbf800000,0x3f800000,0xbf623ec4,0x3f46bf0e,0xbe953f6d,0x3dc9bf7b
.long 0x3f7b3f35,0xbf0e3ec4,0xbe483f35,0xbf55bf6d,0x3f753ec4,0x3dc93f55,0x3f623f6d,0xbf223e48
.long 0x3ec43f80,0xbf6dbf35,0xbec4bf80,0x3f6d3f35,0x3f463f6d,0xbf75be48,0xbf7fbec4,0x3ef1bf0e
.long 0xbe48bf35,0x3f553ec4,0xbf7bbf35,0xbf0ebf6d,0xbf22bf6d,0x3e95be48,0xbdc93ec4,0xbf62bf0e
.long 0x3f350000,0x3f353f80,0x3f350000,0x3f353f80,0x3e95bec4,0x3f7f3f55,0xbef1bf6d,0x3f463e48
.long 0xbf55bf35,0xbf7bbf6d,0xbf0ebf35,0xbe48bec4,0xbef1bec4,0xbf22bf0e,0xbf75bf6d,0xbf7fbf7b
.long 0xbf6dbf80,0xbec4bf35,0x3f6d3f80,0x3ec43f35,0xbf7fbf6d,0xbf62bf7b,0x3f223ec4,0x3f753f55
.long 0xbec40000,0xbf6d3f35,0x3ec40000,0x3f6dbf35,0xbf623f80,0xbdc93f0e,0x3e95bf35,0xbf223e48
.long 0x3f0e0000,0x3f7bbf6d,0xbf553f80,0x3e483ec4,0x3f46bf80,0xbef1be48,0x3f7fbf35,0x3e95bf55
.long 0x0,0x0,0x0,0x0,0xbf7f3f80,0xbf753f7b,0xbf223f35,0xbef13f0e
.long 0x3e480000,0x3f0ebec4,0x3f7bbf80,0x3f55bf6d,0x3f75bf80,0x3f22bf55,0xbf623f35,0xbf7f3f7b
.long 0xbf6d0000,0x3ec43f35,0x3f6d0000,0xbec4bf35,0xbe953f80,0x3f46bf55,0xbef1bf35,0xbdc93f7b
.long 0x3f7b0000,0xbf55bec4,0xbe483f80,0x3f0ebf6d,0x3dc9bf80,0xbe953f7b,0x3f46bf35,0xbf623f0e
.long 0xbf350000,0xbf353f80,0xbf350000,0xbf353f80,0xbf223f80,0x3f62be48,0x3dc93f35,0x3f75bf55
.long 0x3f550000,0x3e48bf6d,0x3f0ebf80,0xbf7b3ec4,0x3ef1bf80,0xbf7f3f0e,0xbf753f35,0x3f463e48
.long 0x3f550000,0x3e483f6d,0x3f0e3f80,0xbf7bbec4,0xbf22bf80,0x3f623e48,0x3dc9bf35,0x3f753f55
.long 0xbf6d0000,0x3ec4bf35,0x3f6d0000,0xbec43f35,0x3ef13f80,0xbf7fbf0e,0xbf75bf35,0x3f46be48
.long 0x3f7b0000,0xbf553ec4,0xbe48bf80,0x3f0e3f6d,0xbe95bf80,0x3f463f55,0xbef13f35,0xbdc9bf7b
.long 0xbf800000,0x3f800000,0xbf800000,0x3f800000,0x3dc93f80,0xbe95bf7b,0x3f463f35,0xbf62bf0e
.long 0x3e480000,0x3f0e3ec4,0x3f7b3f80,0x3f553f6d,0xbf7fbf80,0xbf75bf7b,0xbf22bf35,0xbef1bf0e
.long 0xbec40000,0xbf6dbf35,0x3ec40000,0x3f6d3f35,0x3f753f80,0x3f223f55,0xbf62bf35,0xbf7fbf7b
.long 0x3f0e0000,0x3f7b3f6d,0xbf55bf80,0x3e48bec4,0xbf62bf80,0xbdc9bf0e,0x3e953f35,0xbf22be48
.long 0xbf350000,0xbf35bf80,0xbf350000,0xbf35bf80,0x3f463f80,0xbef13e48,0x3f7f3f35,0x3e953f55
.long 0xbf6d3f80,0xbec43f35,0x3f6dbf80,0x3ec4bf35,0x3f46bec4,0x3f75bf7b,0xbf7f3f6d,0xbef13f55
.long 0x3e48bf35,0xbf553ec4,0x3f7bbf35,0x3f0ebf6d,0xbf753f6d,0x3dc93f0e,0xbf623ec4,0xbf223f7b
.long 0x0,0x0,0x0,0x0,0xbf623f6d,0xbf463f55,0xbe953ec4,0xbdc93e48
.long 0x3f55bf35,0x3f7bbf6d,0x3f0ebf35,0x3e48bec4,0x3dc9bec4,0xbef13e48,0xbf463f6d,0xbe953f0e
.long 0x3ec4bf80,0xbf6d3f35,0xbec43f80,0x3f6dbf35,0xbf7f3ec4,0x3f623e48,0x3f22bf6d,0xbf753f0e
.long 0x3f0e3f35,0xbe48bf6d,0xbf553f35,0x3f7bbec4,0x3ef1bf6d,0xbf223f55,0x3f75bec4,0xbf7f3e48
.long 0x3f350000,0x3f35bf80,0x3f350000,0x3f35bf80,0x3e95bf6d,0xbf7f3f0e,0xbef1bec4,0xbf463f7b
.long 0xbf7b3f35,0x3f0e3ec4,0x3e483f35,0x3f55bf6d,0x3f223ec4,0x3e95bf7b,0x3dc9bf6d,0xbf623f55
.long 0xbf7bbf35,0x3f0ebec4,0x3e48bf35,0x3f553f6d,0x3e953f6d,0xbf7fbf0e,0xbef13ec4,0xbf46bf7b
.long 0x3ec43f80,0xbf6dbf35,0xbec4bf80,0x3f6d3f35,0x3f22bec4,0x3e953f7b,0x3dc93f6d,0xbf62bf55
.long 0x3f0ebf35,0xbe483f6d,0xbf55bf35,0x3f7b3ec4,0xbf7fbec4,0x3f62be48,0x3f223f6d,0xbf75bf0e
.long 0xbf800000,0x3f800000,0xbf800000,0x3f800000,0x3ef13f6d,0xbf22bf55,0x3f753ec4,0xbf7fbe48
.long 0x3f553f35,0x3f7b3f6d,0x3f0e3f35,0x3e483ec4,0xbf62bf6d,0xbf46bf55,0xbe95bec4,0xbdc9be48
.long 0xbf6dbf80,0xbec4bf35,0x3f6d3f80,0x3ec43f35,0x3dc93ec4,0xbef1be48,0xbf46bf6d,0xbe95bf0e
.long 0x3e483f35,0xbf55bec4,0x3f7b3f35,0x3f0e3f6d,0x3f463ec4,0x3f753f7b,0xbf7fbf6d,0xbef1bf55
.long 0x3f350000,0x3f353f80,0x3f350000,0x3f353f80,0xbf75bf6d,0x3dc9bf0e,0xbf62bec4,0xbf22bf7b
.long 0x0,0x0,0x0,0x0,0x3dc90000,0x3e95be48,0x3f46bf35,0x3f62bf55
.long 0xbe480000,0xbf0e3ec4,0xbf7b3f80,0xbf553f6d,0x3e950000,0x3f46bf0e,0x3ef1bf35,0xbdc9be48
.long 0xbec40000,0xbf6d3f35,0x3ec40000,0x3f6dbf35,0x3ef10000,0x3f7fbf55,0xbf753f35,0xbf463f7b
.long 0xbf0e0000,0xbf7b3f6d,0x3f55bf80,0xbe48bec4,0x3f220000,0x3f62bf7b,0xbdc93f35,0x3f75bf0e
.long 0xbf350000,0xbf353f80,0xbf350000,0xbf353f80,0x3f460000,0x3ef1bf7b,0x3f7fbf35,0xbe95bf0e
.long 0xbf550000,0xbe483f6d,0xbf0e3f80,0x3f7bbec4,0x3f620000,0xbdc9bf55,0xbe95bf35,0xbf223f7b
.long 0xbf6d0000,0x3ec43f35,0x3f6d0000,0xbec4bf35,0x3f750000,0xbf22bf0e,0xbf623f35,0x3f7fbe48
.long 0xbf7b0000,0x3f553ec4,0x3e48bf80,0xbf0e3f6d,0x3f7f0000,0xbf75be48,0x3f223f35,0xbef1bf55
.long 0xbf7b0000,0x3f55bec4,0x3e483f80,0xbf0ebf6d,0x3f750000,0xbf223f0e,0xbf62bf35,0x3f7f3e48
.long 0xbf800000,0x3f800000,0xbf800000,0x3f800000,0x3f7f0000,0xbf753e48,0x3f22bf35,0xbef13f55
.long 0xbf550000,0xbe48bf6d,0xbf0ebf80,0x3f7b3ec4,0x3f460000,0x3ef13f7b,0x3f7f3f35,0xbe953f0e
.long 0xbf6d0000,0x3ec4bf35,0x3f6d0000,0xbec43f35,0x3f620000,0xbdc93f55,0xbe953f35,0xbf22bf7b
.long 0xbf0e0000,0xbf7bbf6d,0x3f553f80,0xbe483ec4,0x3ef10000,0x3f7f3f55,0xbf75bf35,0xbf46bf7b
.long 0xbf350000,0xbf35bf80,0xbf350000,0xbf35bf80,0x3f220000,0x3f623f7b,0xbdc9bf35,0x3f753f0e
.long 0xbe480000,0xbf0ebec4,0xbf7bbf80,0xbf55bf6d,0x3dc90000,0x3e953e48,0x3f463f35,0x3f623f55
.long 0xbec40000,0xbf6dbf35,0x3ec40000,0x3f6d3f35,0x3e950000,0x3f463f0e,0x3ef13f35,0xbdc93e48
.long 0x0,0x0,0x0,0x0,0x3ef1bec4,0x3f22bf0e,0x3f75bf6d,0x3f7fbf7b
.long 0xbf553f35,0xbf7b3f6d,0xbf0e3f35,0xbe483ec4,0x3f7fbf6d,0x3f62bf7b,0xbf223ec4,0xbf753f55
.long 0xbf6d3f80,0xbec43f35,0x3f6dbf80,0x3ec4bf35,0x3f22bf6d,0xbe95be48,0x3dc93ec4,0x3f62bf0e
.long 0xbe483f35,0x3f55bec4,0xbf7b3f35,0xbf0e3f6d,0xbe95bec4,0xbf7f3f55,0x3ef1bf6d,0xbf463e48
.long 0x3f350000,0x3f35bf80,0x3f350000,0x3f35bf80,0xbf753ec4,0xbdc93f55,0xbf623f6d,0x3f223e48
.long 0x3f7bbf35,0xbf0ebec4,0xbe48bf35,0xbf553f6d,0xbf463f6d,0x3f75be48,0x3f7fbec4,0xbef1bf0e
.long 0x3ec4bf80,0xbf6d3f35,0xbec43f80,0x3f6dbf35,0x3dc93f6d,0x3ef1bf7b,0xbf46bec4,0x3e953f55
.long 0xbf0ebf35,0x3e483f6d,0x3f55bf35,0xbf7b3ec4,0x3f623ec4,0xbf46bf0e,0x3e953f6d,0xbdc9bf7b
.long 0xbf0e3f35,0x3e48bf6d,0x3f553f35,0xbf7bbec4,0x3dc9bf6d,0x3ef13f7b,0xbf463ec4,0x3e95bf55
.long 0xbf800000,0x3f800000,0xbf800000,0x3f800000,0x3f62bec4,0xbf463f0e,0x3e95bf6d,0xbdc93f7b
.long 0x3f7b3f35,0xbf0e3ec4,0xbe483f35,0xbf55bf6d,0xbf75bec4,0xbdc9bf55,0xbf62bf6d,0x3f22be48
.long 0x3ec43f80,0xbf6dbf35,0xbec4bf80,0x3f6d3f35,0xbf46bf6d,0x3f753e48,0x3f7f3ec4,0xbef13f0e
.long 0xbe48bf35,0x3f553ec4,0xbf7bbf35,0xbf0ebf6d,0x3f223f6d,0xbe953e48,0x3dc9bec4,0x3f623f0e
.long 0x3f350000,0x3f353f80,0x3f350000,0x3f353f80,0xbe953ec4,0xbf7fbf55,0x3ef13f6d,0xbf46be48
.long 0xbf55bf35,0xbf7bbf6d,0xbf0ebf35,0xbe48bec4,0x3ef13ec4,0x3f223f0e,0x3f753f6d,0x3f7f3f7b
.long 0xbf6dbf80,0xbec4bf35,0x3f6d3f80,0x3ec43f35,0x3f7f3f6d,0x3f623f7b,0xbf22bec4,0xbf75bf55
.long 0xbec40000,0xbf6d3f35,0x3ec40000,0x3f6dbf35,0x3f62bf80,0x3dc9bf0e,0xbe953f35,0x3f22be48
.long 0x3f0e0000,0x3f7bbf6d,0xbf553f80,0x3e483ec4,0xbf463f80,0x3ef13e48,0xbf7f3f35,0xbe953f55
.long 0x0,0x0,0x0,0x0,0x3f7fbf80,0x3f75bf7b,0x3f22bf35,0x3ef1bf0e
.long 0x3e480000,0x3f0ebec4,0x3f7bbf80,0x3f55bf6d,0xbf753f80,0xbf223f55,0x3f62bf35,0x3f7fbf7b
.long 0xbf6d0000,0x3ec43f35,0x3f6d0000,0xbec4bf35,0x3e95bf80,0xbf463f55,0x3ef13f35,0x3dc9bf7b
.long 0x3f7b0000,0xbf55bec4,0xbe483f80,0x3f0ebf6d,0xbdc93f80,0x3e95bf7b,0xbf463f35,0x3f62bf0e
.long 0xbf350000,0xbf353f80,0xbf350000,0xbf353f80,0x3f22bf80,0xbf623e48,0xbdc9bf35,0xbf753f55
.long 0x3f550000,0x3e48bf6d,0x3f0ebf80,0xbf7b3ec4,0xbef13f80,0x3f7fbf0e,0x3f75bf35,0xbf46be48
.long 0x3f550000,0x3e483f6d,0x3f0e3f80,0xbf7bbec4,0x3f223f80,0xbf62be48,0xbdc93f35,0xbf75bf55
.long 0xbf6d0000,0x3ec4bf35,0x3f6d0000,0xbec43f35,0xbef1bf80,0x3f7f3f0e,0x3f753f35,0xbf463e48
.long 0x3f7b0000,0xbf553ec4,0xbe48bf80,0x3f0e3f6d,0x3e953f80,0xbf46bf55,0x3ef1bf35,0x3dc93f7b
.long 0xbf800000,0x3f800000,0xbf800000,0x3f800000,0xbdc9bf80,0x3e953f7b,0xbf46bf35,0x3f623f0e
.long 0x3e480000,0x3f0e3ec4,0x3f7b3f80,0x3f553f6d,0x3f7f3f80,0x3f753f7b,0x3f223f35,0x3ef13f0e
.long 0xbec40000,0xbf6dbf35,0x3ec40000,0x3f6d3f35,0xbf75bf80,0xbf22bf55,0x3f623f35,0x3f7f3f7b
.long 0x3f0e0000,0x3f7b3f6d,0xbf55bf80,0x3e48bec4,0x3f623f80,0x3dc93f0e,0xbe95bf35,0x3f223e48
.long 0xbf350000,0xbf35bf80,0xbf350000,0xbf35bf80,0xbf46bf80,0x3ef1be48,0xbf7fbf35,0xbe95bf55
.long 0xbf6d3f80,0xbec43f35,0x3f6dbf80,0x3ec4bf35,0xbf463ec4,0xbf753f7b,0x3f7fbf6d,0x3ef1bf55
.long 0x3e48bf35,0xbf553ec4,0x3f7bbf35,0x3f0ebf6d,0x3f75bf6d,0xbdc9bf0e,0x3f62bec4,0x3f22bf7b
.long 0x0,0x0,0x0,0x0,0x3f62bf6d,0x3f46bf55,0x3e95bec4,0x3dc9be48
.long 0x3f55bf35,0x3f7bbf6d,0x3f0ebf35,0x3e48bec4,0xbdc93ec4,0x3ef1be48,0x3f46bf6d,0x3e95bf0e
.long 0x3ec4bf80,0xbf6d3f35,0xbec43f80,0x3f6dbf35,0x3f7fbec4,0xbf62be48,0xbf223f6d,0x3f75bf0e
.long 0x3f0e3f35,0xbe48bf6d,0xbf553f35,0x3f7bbec4,0xbef13f6d,0x3f22bf55,0xbf753ec4,0x3f7fbe48
.long 0x3f350000,0x3f35bf80,0x3f350000,0x3f35bf80,0xbe953f6d,0x3f7fbf0e,0x3ef13ec4,0x3f46bf7b
.long 0xbf7b3f35,0x3f0e3ec4,0x3e483f35,0x3f55bf6d,0xbf22bec4,0xbe953f7b,0xbdc93f6d,0x3f62bf55
.long 0xbf7bbf35,0x3f0ebec4,0x3e48bf35,0x3f553f6d,0xbe95bf6d,0x3f7f3f0e,0x3ef1bec4,0x3f463f7b
.long 0x3ec43f80,0xbf6dbf35,0xbec4bf80,0x3f6d3f35,0xbf223ec4,0xbe95bf7b,0xbdc9bf6d,0x3f623f55
.long 0x3f0ebf35,0xbe483f6d,0xbf55bf35,0x3f7b3ec4,0x3f7f3ec4,0xbf623e48,0xbf22bf6d,0x3f753f0e
.long 0xbf800000,0x3f800000,0xbf800000,0x3f800000,0xbef1bf6d,0x3f223f55,0xbf75bec4,0x3f7f3e48
.long 0x3f553f35,0x3f7b3f6d,0x3f0e3f35,0x3e483ec4,0x3f623f6d,0x3f463f55,0x3e953ec4,0x3dc93e48
.long 0xbf6dbf80,0xbec4bf35,0x3f6d3f80,0x3ec43f35,0xbdc9bec4,0x3ef13e48,0x3f463f6d,0x3e953f0e
.long 0x3e483f35,0xbf55bec4,0x3f7b3f35,0x3f0e3f6d,0xbf46bec4,0xbf75bf7b,0x3f7f3f6d,0x3ef13f55
.long 0x3f350000,0x3f353f80,0x3f350000,0x3f353f80,0x3f753f6d,0xbdc93f0e,0x3f623ec4,0x3f223f7b
.long 0x3f803f80,0x3f803f80,0x3f803f80,0x3f803f80,0x3f6d3f80,0x3ec43f35,0xbf6dbf80,0xbec4bf35
.long 0x3f353f80,0xbf350000,0x3f353f80,0xbf350000,0x3ec43f80,0xbf6dbf35,0xbec4bf80,0x3f6d3f35
.long 0x3f80,0xbf80,0x3f80,0xbf80,0xbec43f80,0x3f6dbf35,0x3ec4bf80,0xbf6d3f35
.long 0xbf353f80,0x3f350000,0xbf353f80,0x3f350000,0xbf6d3f80,0xbec43f35,0x3f6dbf80,0x3ec4bf35
.long 0xbf803f80,0xbf803f80,0xbf803f80,0xbf803f80,0xbf6d3f80,0xbec43f35,0x3f6dbf80,0x3ec4bf35
.long 0xbf353f80,0x3f350000,0xbf353f80,0x3f350000,0xbec43f80,0x3f6dbf35,0x3ec4bf80,0xbf6d3f35
.long 0x3f80,0xbf80,0x3f80,0xbf80,0x3ec43f80,0xbf6dbf35,0xbec4bf80,0x3f6d3f35
.long 0x3f353f80,0xbf350000,0x3f353f80,0xbf350000,0x3f6d3f80,0x3ec43f35,0xbf6dbf80,0xbec4bf35
.long 0x3f0e3f80,0xbf7bbec4,0xbf550000,0xbe48bf6d,0x3e483f80,0xbf0ebf6d,0x3f7b0000,0xbf553ec4
.long 0x3f7b3f80,0x3f553f6d,0xbe480000,0xbf0ebec4,0x3f553f80,0xbe483ec4,0x3f0e0000,0x3f7b3f6d
.long 0xbf553f80,0x3e483ec4,0xbf0e0000,0xbf7b3f6d,0xbf7b3f80,0xbf553f6d,0x3e480000,0x3f0ebec4
.long 0xbe483f80,0x3f0ebf6d,0xbf7b0000,0x3f553ec4,0xbf0e3f80,0x3f7bbec4,0x3f550000,0x3e48bf6d
.long 0xbf0e3f80,0x3f7bbec4,0x3f550000,0x3e48bf6d,0xbe483f80,0x3f0ebf6d,0xbf7b0000,0x3f553ec4
.long 0xbf7b3f80,0xbf553f6d,0x3e480000,0x3f0ebec4,0xbf553f80,0x3e483ec4,0xbf0e0000,0xbf7b3f6d
.long 0x3f553f80,0xbe483ec4,0x3f0e0000,0x3f7b3f6d,0x3f7b3f80,0x3f553f6d,0xbe480000,0xbf0ebec4
.long 0x3e483f80,0xbf0ebf6d,0x3f7b0000,0xbf553ec4,0x3f0e3f80,0xbf7bbec4,0xbf550000,0xbe48bf6d
.long 0x3f803f80,0x3f803f80,0x3f803f80,0x3f803f80,0xbec40000,0xbf6dbf35,0x3ec40000,0x3f6d3f35
.long 0xbf35bf80,0x3f350000,0xbf35bf80,0x3f350000,0x3f6d0000,0xbec43f35,0xbf6d0000,0x3ec4bf35
.long 0x3f80,0xbf80,0x3f80,0xbf80,0xbf6d0000,0x3ec43f35,0x3f6d0000,0xbec4bf35
.long 0x3f35bf80,0xbf350000,0x3f35bf80,0xbf350000,0x3ec40000,0x3f6dbf35,0xbec40000,0xbf6d3f35
.long 0xbf803f80,0xbf803f80,0xbf803f80,0xbf803f80,0x3ec40000,0x3f6dbf35,0xbec40000,0xbf6d3f35
.long 0x3f35bf80,0xbf350000,0x3f35bf80,0xbf350000,0xbf6d0000,0x3ec43f35,0x3f6d0000,0xbec4bf35
.long 0x3f80,0xbf80,0x3f80,0xbf80,0x3f6d0000,0xbec43f35,0xbf6d0000,0x3ec4bf35
.long 0xbf35bf80,0x3f350000,0xbf35bf80,0x3f350000,0xbec40000,0xbf6dbf35,0x3ec40000,0x3f6d3f35
.long 0x3e48bf35,0x3f553f6d,0x3f7b3f35,0xbf0e3ec4,0x3f553f35,0xbf7bbec4,0x3f0ebf35,0xbe483f6d
.long 0x3f0e3f35,0x3e483ec4,0xbf55bf35,0xbf7bbf6d,0xbf7bbf35,0xbf0ebf6d,0x3e483f35,0xbf55bec4
.long 0x3f7bbf35,0x3f0ebf6d,0xbe483f35,0x3f55bec4,0xbf0e3f35,0xbe483ec4,0x3f55bf35,0x3f7bbf6d
.long 0xbf553f35,0x3f7bbec4,0xbf0ebf35,0x3e483f6d,0xbe48bf35,0xbf553f6d,0xbf7b3f35,0x3f0e3ec4
.long 0xbe48bf35,0xbf553f6d,0xbf7b3f35,0x3f0e3ec4,0xbf553f35,0x3f7bbec4,0xbf0ebf35,0x3e483f6d
.long 0xbf0e3f35,0xbe483ec4,0x3f55bf35,0x3f7bbf6d,0x3f7bbf35,0x3f0ebf6d,0xbe483f35,0x3f55bec4
.long 0xbf7bbf35,0xbf0ebf6d,0x3e483f35,0xbf55bec4,0x3f0e3f35,0x3e483ec4,0xbf55bf35,0xbf7bbf6d
.long 0x3f553f35,0xbf7bbec4,0x3f0ebf35,0xbe483f6d,0x3e48bf35,0x3f553f6d,0x3f7b3f35,0xbf0e3ec4
.long 0x3f80,0xbf80,0x3f80,0xbf80,0xbec43f80,0x3f6dbf35,0x3ec4bf80,0xbf6d3f35
.long 0xbf353f80,0x3f350000,0xbf353f80,0x3f350000,0xbf6d3f80,0xbec43f35,0x3f6dbf80,0x3ec4bf35
.long 0x3f803f80,0x3f803f80,0x3f803f80,0x3f803f80,0x3f6d3f80,0x3ec43f35,0xbf6dbf80,0xbec4bf35
.long 0x3f353f80,0xbf350000,0x3f353f80,0xbf350000,0x3ec43f80,0xbf6dbf35,0xbec4bf80,0x3f6d3f35
.long 0x3f80,0xbf80,0x3f80,0xbf80,0x3ec43f80,0xbf6dbf35,0xbec4bf80,0x3f6d3f35
.long 0x3f353f80,0xbf350000,0x3f353f80,0xbf350000,0x3f6d3f80,0x3ec43f35,0xbf6dbf80,0xbec4bf35
.long 0xbf803f80,0xbf803f80,0xbf803f80,0xbf803f80,0xbf6d3f80,0xbec43f35,0x3f6dbf80,0x3ec4bf35
.long 0xbf353f80,0x3f350000,0xbf353f80,0x3f350000,0xbec43f80,0x3f6dbf35,0x3ec4bf80,0xbf6d3f35
.long 0x3f55bf80,0xbe48bec4,0x3f0e0000,0x3f7bbf6d,0x3f7bbf80,0x3f55bf6d,0xbe480000,0xbf0e3ec4
.long 0x3e48bf80,0xbf0e3f6d,0x3f7b0000,0xbf55bec4,0x3f0ebf80,0xbf7b3ec4,0xbf550000,0xbe483f6d
.long 0xbf0ebf80,0x3f7b3ec4,0x3f550000,0x3e483f6d,0xbe48bf80,0x3f0e3f6d,0xbf7b0000,0x3f55bec4
.long 0xbf7bbf80,0xbf55bf6d,0x3e480000,0x3f0e3ec4,0xbf55bf80,0x3e48bec4,0xbf0e0000,0xbf7bbf6d
.long 0xbf55bf80,0x3e48bec4,0xbf0e0000,0xbf7bbf6d,0xbf7bbf80,0xbf55bf6d,0x3e480000,0x3f0e3ec4
.long 0xbe48bf80,0x3f0e3f6d,0xbf7b0000,0x3f55bec4,0xbf0ebf80,0x3f7b3ec4,0x3f550000,0x3e483f6d
.long 0x3f0ebf80,0xbf7b3ec4,0xbf550000,0xbe483f6d,0x3e48bf80,0xbf0e3f6d,0x3f7b0000,0xbf55bec4
.long 0x3f7bbf80,0x3f55bf6d,0xbe480000,0xbf0e3ec4,0x3f55bf80,0xbe48bec4,0x3f0e0000,0x3f7bbf6d
.long 0x3f80,0xbf80,0x3f80,0xbf80,0xbf6d0000,0x3ec43f35,0x3f6d0000,0xbec4bf35
.long 0x3f35bf80,0xbf350000,0x3f35bf80,0xbf350000,0x3ec40000,0x3f6dbf35,0xbec40000,0xbf6d3f35
.long 0x3f803f80,0x3f803f80,0x3f803f80,0x3f803f80,0xbec40000,0xbf6dbf35,0x3ec40000,0x3f6d3f35
.long 0xbf35bf80,0x3f350000,0xbf35bf80,0x3f350000,0x3f6d0000,0xbec43f35,0xbf6d0000,0x3ec4bf35
.long 0x3f80,0xbf80,0x3f80,0xbf80,0x3f6d0000,0xbec43f35,0xbf6d0000,0x3ec4bf35
.long 0xbf35bf80,0x3f350000,0xbf35bf80,0x3f350000,0xbec40000,0xbf6dbf35,0x3ec40000,0x3f6d3f35
.long 0xbf803f80,0xbf803f80,0xbf803f80,0xbf803f80,0x3ec40000,0x3f6dbf35,0xbec40000,0xbf6d3f35
.long 0x3f35bf80,0xbf350000,0x3f35bf80,0xbf350000,0xbf6d0000,0x3ec43f35,0x3f6d0000,0xbec4bf35
.long 0xbf7b3f35,0xbf0e3f6d,0x3e48bf35,0xbf553ec4,0x3f0ebf35,0x3e48bec4,0xbf553f35,0xbf7b3f6d
.long 0x3f55bf35,0xbf7b3ec4,0x3f0e3f35,0xbe48bf6d,0x3e483f35,0x3f55bf6d,0x3f7bbf35,0xbf0ebec4
.long 0xbe483f35,0xbf55bf6d,0xbf7bbf35,0x3f0ebec4,0xbf55bf35,0x3f7b3ec4,0xbf0e3f35,0x3e48bf6d
.long 0xbf0ebf35,0xbe48bec4,0x3f553f35,0x3f7b3f6d,0x3f7b3f35,0x3f0e3f6d,0xbe48bf35,0x3f553ec4
.long 0x3f7b3f35,0x3f0e3f6d,0xbe48bf35,0x3f553ec4,0xbf0ebf35,0xbe48bec4,0x3f553f35,0x3f7b3f6d
.long 0xbf55bf35,0x3f7b3ec4,0xbf0e3f35,0x3e48bf6d,0xbe483f35,0xbf55bf6d,0xbf7bbf35,0x3f0ebec4
.long 0x3e483f35,0x3f55bf6d,0x3f7bbf35,0xbf0ebec4,0x3f55bf35,0xbf7b3ec4,0x3f0e3f35,0xbe48bf6d
.long 0x3f0ebf35,0x3e48bec4,0xbf553f35,0xbf7b3f6d,0xbf7b3f35,0xbf0e3f6d,0x3e48bf35,0xbf553ec4
.long 0x0,0x0,0x0,0x0,0x3ec40000,0x3f6d3f35,0xbec40000,0xbf6dbf35
.long 0x3f350000,0x3f353f80,0x3f350000,0x3f353f80,0x3f6d0000,0xbec43f35,0xbf6d0000,0x3ec4bf35
.long 0x3f800000,0xbf800000,0x3f800000,0xbf800000,0x3f6d0000,0xbec4bf35,0xbf6d0000,0x3ec43f35
.long 0x3f350000,0x3f35bf80,0x3f350000,0x3f35bf80,0x3ec40000,0x3f6dbf35,0xbec40000,0xbf6d3f35
.long 0x0,0x0,0x0,0x0,0xbec40000,0xbf6d3f35,0x3ec40000,0x3f6dbf35
.long 0xbf350000,0xbf353f80,0xbf350000,0xbf353f80,0xbf6d0000,0x3ec43f35,0x3f6d0000,0xbec4bf35
.long 0xbf800000,0x3f800000,0xbf800000,0x3f800000,0xbf6d0000,0x3ec4bf35,0x3f6d0000,0xbec43f35
.long 0xbf350000,0xbf35bf80,0xbf350000,0xbf35bf80,0xbec40000,0xbf6dbf35,0x3ec40000,0x3f6d3f35
.long 0x3f550000,0x3e483f6d,0x3f0e3f80,0xbf7bbec4,0x3f7b0000,0xbf553ec4,0xbe48bf80,0x3f0e3f6d
.long 0x3e480000,0x3f0e3ec4,0x3f7b3f80,0x3f553f6d,0x3f0e0000,0x3f7b3f6d,0xbf55bf80,0x3e48bec4
.long 0x3f0e0000,0x3f7bbf6d,0xbf553f80,0x3e483ec4,0x3e480000,0x3f0ebec4,0x3f7bbf80,0x3f55bf6d
.long 0x3f7b0000,0xbf55bec4,0xbe483f80,0x3f0ebf6d,0x3f550000,0x3e48bf6d,0x3f0ebf80,0xbf7b3ec4
.long 0xbf550000,0xbe483f6d,0xbf0e3f80,0x3f7bbec4,0xbf7b0000,0x3f553ec4,0x3e48bf80,0xbf0e3f6d
.long 0xbe480000,0xbf0e3ec4,0xbf7b3f80,0xbf553f6d,0xbf0e0000,0xbf7b3f6d,0x3f55bf80,0xbe48bec4
.long 0xbf0e0000,0xbf7bbf6d,0x3f553f80,0xbe483ec4,0xbe480000,0xbf0ebec4,0xbf7bbf80,0xbf55bf6d
.long 0xbf7b0000,0x3f55bec4,0x3e483f80,0xbf0ebf6d,0xbf550000,0xbe48bf6d,0xbf0ebf80,0x3f7b3ec4
.long 0x0,0x0,0x0,0x0,0x3f6d3f80,0x3ec43f35,0xbf6dbf80,0xbec4bf35
.long 0xbf350000,0xbf35bf80,0xbf350000,0xbf35bf80,0xbec4bf80,0x3f6d3f35,0x3ec43f80,0xbf6dbf35
.long 0x3f800000,0xbf800000,0x3f800000,0xbf800000,0xbec43f80,0x3f6dbf35,0x3ec4bf80,0xbf6d3f35
.long 0xbf350000,0xbf353f80,0xbf350000,0xbf353f80,0x3f6dbf80,0x3ec4bf35,0xbf6d3f80,0xbec43f35
.long 0x0,0x0,0x0,0x0,0xbf6d3f80,0xbec43f35,0x3f6dbf80,0x3ec4bf35
.long 0x3f350000,0x3f35bf80,0x3f350000,0x3f35bf80,0x3ec4bf80,0xbf6d3f35,0xbec43f80,0x3f6dbf35
.long 0xbf800000,0x3f800000,0xbf800000,0x3f800000,0x3ec43f80,0xbf6dbf35,0xbec4bf80,0x3f6d3f35
.long 0x3f350000,0x3f353f80,0x3f350000,0x3f353f80,0xbf6dbf80,0xbec4bf35,0x3f6d3f80,0x3ec43f35
.long 0xbf7bbf35,0x3f0ebec4,0x3e48bf35,0x3f553f6d,0x3f0ebf35,0xbe483f6d,0xbf55bf35,0x3f7b3ec4
.long 0x3f553f35,0x3f7b3f6d,0x3f0e3f35,0x3e483ec4,0x3e483f35,0xbf55bec4,0x3f7b3f35,0x3f0e3f6d
.long 0x3e48bf35,0xbf553ec4,0x3f7bbf35,0x3f0ebf6d,0x3f55bf35,0x3f7bbf6d,0x3f0ebf35,0x3e48bec4
.long 0x3f0e3f35,0xbe48bf6d,0xbf553f35,0x3f7bbec4,0xbf7b3f35,0x3f0e3ec4,0x3e483f35,0x3f55bf6d
.long 0x3f7bbf35,0xbf0ebec4,0xbe48bf35,0xbf553f6d,0xbf0ebf35,0x3e483f6d,0x3f55bf35,0xbf7b3ec4
.long 0xbf553f35,0xbf7b3f6d,0xbf0e3f35,0xbe483ec4,0xbe483f35,0x3f55bec4,0xbf7b3f35,0xbf0e3f6d
.long 0xbe48bf35,0x3f553ec4,0xbf7bbf35,0xbf0ebf6d,0xbf55bf35,0xbf7bbf6d,0xbf0ebf35,0xbe48bec4
.long 0xbf0e3f35,0x3e48bf6d,0x3f553f35,0xbf7bbec4,0x3f7b3f35,0xbf0e3ec4,0xbe483f35,0xbf55bf6d
.long 0x3f800000,0xbf800000,0x3f800000,0xbf800000,0x3f6d0000,0xbec4bf35,0xbf6d0000,0x3ec43f35
.long 0x3f350000,0x3f35bf80,0x3f350000,0x3f35bf80,0x3ec40000,0x3f6dbf35,0xbec40000,0xbf6d3f35
.long 0x0,0x0,0x0,0x0,0x3ec40000,0x3f6d3f35,0xbec40000,0xbf6dbf35
.long 0x3f350000,0x3f353f80,0x3f350000,0x3f353f80,0x3f6d0000,0xbec43f35,0xbf6d0000,0x3ec4bf35
.long 0xbf800000,0x3f800000,0xbf800000,0x3f800000,0xbf6d0000,0x3ec4bf35,0x3f6d0000,0xbec43f35
.long 0xbf350000,0xbf35bf80,0xbf350000,0xbf35bf80,0xbec40000,0xbf6dbf35,0x3ec40000,0x3f6d3f35
.long 0x0,0x0,0x0,0x0,0xbec40000,0xbf6d3f35,0x3ec40000,0x3f6dbf35
.long 0xbf350000,0xbf353f80,0xbf350000,0xbf353f80,0xbf6d0000,0x3ec43f35,0x3f6d0000,0xbec4bf35
.long 0xbf0e0000,0xbf7b3f6d,0x3f55bf80,0xbe48bec4,0xbe480000,0xbf0e3ec4,0xbf7b3f80,0xbf553f6d
.long 0xbf7b0000,0x3f553ec4,0x3e48bf80,0xbf0e3f6d,0xbf550000,0xbe483f6d,0xbf0e3f80,0x3f7bbec4
.long 0xbf550000,0xbe48bf6d,0xbf0ebf80,0x3f7b3ec4,0xbf7b0000,0x3f55bec4,0x3e483f80,0xbf0ebf6d
.long 0xbe480000,0xbf0ebec4,0xbf7bbf80,0xbf55bf6d,0xbf0e0000,0xbf7bbf6d,0x3f553f80,0xbe483ec4
.long 0x3f0e0000,0x3f7b3f6d,0xbf55bf80,0x3e48bec4,0x3e480000,0x3f0e3ec4,0x3f7b3f80,0x3f553f6d
.long 0x3f7b0000,0xbf553ec4,0xbe48bf80,0x3f0e3f6d,0x3f550000,0x3e483f6d,0x3f0e3f80,0xbf7bbec4
.long 0x3f550000,0x3e48bf6d,0x3f0ebf80,0xbf7b3ec4,0x3f7b0000,0xbf55bec4,0xbe483f80,0x3f0ebf6d
.long 0x3e480000,0x3f0ebec4,0x3f7bbf80,0x3f55bf6d,0x3f0e0000,0x3f7bbf6d,0xbf553f80,0x3e483ec4
.long 0x3f800000,0xbf800000,0x3f800000,0xbf800000,0xbec43f80,0x3f6dbf35,0x3ec4bf80,0xbf6d3f35
.long 0xbf350000,0xbf353f80,0xbf350000,0xbf353f80,0x3f6dbf80,0x3ec4bf35,0xbf6d3f80,0xbec43f35
.long 0x0,0x0,0x0,0x0,0x3f6d3f80,0x3ec43f35,0xbf6dbf80,0xbec4bf35
.long 0xbf350000,0xbf35bf80,0xbf350000,0xbf35bf80,0xbec4bf80,0x3f6d3f35,0x3ec43f80,0xbf6dbf35
.long 0xbf800000,0x3f800000,0xbf800000,0x3f800000,0x3ec43f80,0xbf6dbf35,0xbec4bf80,0x3f6d3f35
.long 0x3f350000,0x3f353f80,0x3f350000,0x3f353f80,0xbf6dbf80,0xbec4bf35,0x3f6d3f80,0x3ec43f35
.long 0x0,0x0,0x0,0x0,0xbf6d3f80,0xbec43f35,0x3f6dbf80,0x3ec4bf35
.long 0x3f350000,0x3f35bf80,0x3f350000,0x3f35bf80,0x3ec4bf80,0xbf6d3f35,0xbec43f80,0x3f6dbf35
.long 0xbe483f35,0x3f55bec4,0xbf7b3f35,0xbf0e3f6d,0xbf553f35,0xbf7b3f6d,0xbf0e3f35,0xbe483ec4
.long 0xbf0ebf35,0x3e483f6d,0x3f55bf35,0xbf7b3ec4,0x3f7bbf35,0xbf0ebec4,0xbe48bf35,0xbf553f6d
.long 0x3f7b3f35,0xbf0e3ec4,0xbe483f35,0xbf55bf6d,0xbf0e3f35,0x3e48bf6d,0x3f553f35,0xbf7bbec4
.long 0xbf55bf35,0xbf7bbf6d,0xbf0ebf35,0xbe48bec4,0xbe48bf35,0x3f553ec4,0xbf7bbf35,0xbf0ebf6d
.long 0x3e483f35,0xbf55bec4,0x3f7b3f35,0x3f0e3f6d,0x3f553f35,0x3f7b3f6d,0x3f0e3f35,0x3e483ec4
.long 0x3f0ebf35,0xbe483f6d,0xbf55bf35,0x3f7b3ec4,0xbf7bbf35,0x3f0ebec4,0x3e48bf35,0x3f553f6d
.long 0xbf7b3f35,0x3f0e3ec4,0x3e483f35,0x3f55bf6d,0x3f0e3f35,0xbe48bf6d,0xbf553f35,0x3f7bbec4
.long 0x3f55bf35,0x3f7bbf6d,0x3f0ebf35,0x3e48bec4,0x3e48bf35,0xbf553ec4,0x3f7bbf35,0x3f0ebf6d
.long 0x3f800000,0x3f800000,0x3f800000,0x3f800000,0x3f800000,0x3f7fffb1,0x3f7ffec4,0x3f7ffd39
.long 0x3f800000,0x3f7ffec4,0x3f7ffb11,0x3f7ff4e6,0x3f800000,0x3f7ffd39,0x3f7ff4e6,0x3f7fe705
.long 0x3f800000,0x3f7ffb11,0x3f7fec43,0x3f7fd397,0x3f800000,0x3f7ff84a,0x3f7fe129,0x3f7fba9e
.long 0x3f800000,0x3f7ff4e6,0x3f7fd397,0x3f7f9c18,0x3f800000,0x3f7ff0e3,0x3f7fc38f,0x3f7f7808
.long 0x3f800000,0x3f7fec43,0x3f7fb10f,0x3f7f4e6d,0x3f800000,0x3f7fe705,0x3f7f9c18,0x3f7f1f49
.long 0x3f800000,0x3f7fe129,0x3f7f84ab,0x3f7eea9d,0x3f800000,0x3f7fdaaf,0x3f7f6ac7,0x3f7eb069
.long 0x3f800000,0x3f7fd397,0x3f7f4e6d,0x3f7e70b0,0x3f800000,0x3f7fcbe2,0x3f7f2f9d,0x3f7e2b72
.long 0x3f800000,0x3f7fc38f,0x3f7f0e58,0x3f7de0b1,0x3f800000,0x3f7fba9e,0x3f7eea9d,0x3f7d906e
.long 0x3f800000,0x3f7f9c18,0x3f7e70b0,0x3f7c7eb0,0x3f800000,0x3f7f90b1,0x3f7e4323,0x3f7c187a
.long 0x3f800000,0x3f7fb10f,0x3f7ec46d,0x3f7d3aac,0x3f800000,0x3f7fa6e3,0x3f7e9bc9,0x3f7cdf6c
.long 0x3f800000,0x3f7f6ac7,0x3f7dabcc,0x3f7ac516,0x3f800000,0x3f7f5ce9,0x3f7d7474,0x3f7a4910
.long 0x3f800000,0x3f7f84ab,0x3f7e1324,0x3f7baccd,0x3f800000,0x3f7f7808,0x3f7de0b1,0x3f7b3bab
.long 0x3f800000,0x3f7f2f9d,0x3f7cbfc9,0x3f78b47b,0x3f800000,0x3f7f1f49,0x3f7c7eb0,0x3f7822d1
.long 0x3f800000,0x3f7f4e6d,0x3f7d3aac,0x3f79c79d,0x3f800000,0x3f7f3f54,0x3f7cfe73,0x3f7940c0
.long 0x3f800000,0x3f7eea9d,0x3f7baccd,0x3f764d97,0x3f800000,0x3f7ed7d4,0x3f7b61fc,0x3f75a67b
.long 0x3f800000,0x3f7f0e58,0x3f7c3b28,0x3f778bc5,0x3f800000,0x3f7efcc9,0x3f7bf531,0x3f76ef5b
.long 0x3f800000,0x3f800000,0x3f800000,0x3f800000,0x3f7ffb11,0x3f7ff84a,0x3f7ff4e6,0x3f7ff0e3
.long 0x3f7fec43,0x3f7fe129,0x3f7fd397,0x3f7fc38f,0x3f7fd397,0x3f7fba9e,0x3f7f9c18,0x3f7f7808
.long 0x3f7fb10f,0x3f7f84ab,0x3f7f4e6d,0x3f7f0e58,0x3f7f84ab,0x3f7f3f54,0x3f7eea9d,0x3f7e868b
.long 0x3f7f4e6d,0x3f7eea9d,0x3f7e70b0,0x3f7de0b1,0x3f7f0e58,0x3f7e868b,0x3f7de0b1,0x3f7d1cdd
.long 0x3f7ec46d,0x3f7e1324,0x3f7d3aac,0x3f7c3b28,0x3f7e70b0,0x3f7d906e,0x3f7c7eb0,0x3f7b3bab
.long 0x3f7e1324,0x3f7cfe73,0x3f7baccd,0x3f7a1e84,0x3f7dabcc,0x3f7c5d3a,0x3f7ac516,0x3f78e3d6
.long 0x3f7d3aac,0x3f7baccd,0x3f79c79d,0x3f778bc5,0x3f7cbfc9,0x3f7aed37,0x3f78b47b,0x3f76167a
.long 0x3f7c3b28,0x3f7a1e84,0x3f778bc5,0x3f748422,0x3f7baccd,0x3f7940c0,0x3f764d97,0x3f72d4eb
.long 0x3f79c79d,0x3f764d97,0x3f721352,0x3f6d1c1d,0x3f791298,0x3f75341d,0x3f708066,0x3f6afb8c
.long 0x3f7b14be,0x3f7853f8,0x3f74fa0b,0x3f710908,0x3f7a7302,0x3f77583a,0x3f73913f,0x3f6f20b0
.long 0x3f76ba07,0x3f718f57,0x3f6b4b0c,0x3f63f473,0x3f75dec6,0x3f703b37,0x3f696591,0x3f61668a
.long 0x3f7853f8,0x3f740bdd,0x3f6ed89e,0x3f68bf3c,0x3f778bc5,0x3f72d4eb,0x3f6d1c1d,0x3f666771
.long 0x3f731447,0x3f6be858,0x3f633c5a,0x3f591e6a,0x3f721352,0x3f6a5ad9,0x3f6106f2,0x3f5627fe
.long 0x3f74fa0b,0x3f6ed89e,0x3f676bd8,0x3f5ebe05,0x3f740bdd,0x3f6d67a1,0x3f655e0b,0x3f5bfb34
.long 0x3f6ed89e,0x3f655e0b,0x3f59f26a,0x3f4cae79,0x3f6db293,0x3f6398ac,0x3f577026,0x3f495521
.long 0x3f710908,0x3f68bf3c,0x3f5ebe05,0x3f531849,0x3f6ff573,0x3f671599,0x3f5c61c7,0x3f4fefa8
.long 0x80000000,0xbc490e90,0xbcc90ab0,0xbd16c32c,0x80000000,0xbc7b514b,0xbcfb49ba,0xbd3c6dd5
.long 0x80000000,0xbc96c9b6,0xbd16c32c,0xbd621469,0x80000000,0xbcafea69,0xbd2fe007,0xbd83db0a
.long 0x80000000,0x80000000,0x80000000,0x80000000,0x80000000,0xbb490fc6,0xbbc90f88,0xbc16cb58
.long 0x80000000,0xbbc90f88,0xbc490e90,0xbc96c9b6,0x80000000,0xbc16cb58,0xbc96c9b6,0xbce22a7a
.long 0x80000000,0xbd16c32c,0xbd96a905,0xbde1bc2e,0x80000000,0xbd2351cb,0xbda3308c,0xbdf475c0
.long 0x80000000,0xbd2fe007,0xbdafb680,0xbe039502,0x80000000,0xbd3c6dd5,0xbdbc3ac3,0xbe0cec4a
.long 0x80000000,0xbcc90ab0,0xbd48fb30,0xbd96a905,0x80000000,0xbce22a7a,0xbd621469,0xbda973ba
.long 0x80000000,0xbcfb49ba,0xbd7b2b74,0xbdbc3ac3,0x80000000,0xbd0a342f,0xbd8a200a,0xbdcefdb7
.long 0x80000000,0xbd8a200a,0xbe09cf86,0xbe4dee60,0x80000000,0xbd9064b4,0xbe1008b7,0xbe57278f
.long 0x80000000,0xbd7b2b74,0xbdfab273,0xbe3b6ecf,0x80000000,0xbd83db0a,0xbe039502,0xbe44b0b9
.long 0x80000000,0xbd621469,0xbde1bc2e,0xbe28defc,0x80000000,0xbd6ea038,0xbdee3876,0xbe3228d4
.long 0x80000000,0xbd48fb30,0xbdc8bd36,0xbe164083,0x80000000,0xbd55880e,0xbdd53db9,0xbe1f917b
.long 0x80000000,0xbdbc3ac3,0xbe3b6ecf,0xbe8b9507,0x80000000,0xbdc27c39,0xbe419b37,0xbe901c2c
.long 0x80000000,0xbdafb680,0xbe2f10a2,0xbe827dc0,0x80000000,0xbdb5f8da,0xbe354098,0xbe870ada
.long 0x80000000,0xbda3308c,0xbe22abb6,0xbe72b651,0x80000000,0xbda973ba,0xbe28defc,0xbe7bdba4
.long 0x80000000,0xbd96a905,0xbe164083,0xbe605c13,0x80000000,0xbd9cecf9,0xbe1c76de,0xbe698bba
.long 0xbd48fb30,0xbd7b2b74,0xbd96a905,0xbdafb680,0xbd7b2b74,0xbd9cecf9,0xbdbc3ac3,0xbddb7d37
.long 0xbd96a905,0xbdbc3ac3,0xbde1bc2e,0xbe039502,0xbdafb680,0xbddb7d37,0xbe039502,0xbe195be0
.long 0x80000000,0x80000000,0x80000000,0x80000000,0xbc490e90,0xbc7b514b,0xbc96c9b6,0xbcafea69
.long 0xbcc90ab0,0xbcfb49ba,0xbd16c32c,0xbd2fe007,0xbd16c32c,0xbd3c6dd5,0xbd621469,0xbd83db0a
.long 0xbe164083,0xbe3b6ecf,0xbe605c13,0xbe827dc0,0xbe22abb6,0xbe4ada4f,0xbe72b651,0xbe8d17c0
.long 0xbe2f10a2,0xbe5a3997,0xbe827dc0,0xbe97a117,0xbe3b6ecf,0xbe698bba,0xbe8b9507,0xbea21887
.long 0xbdc8bd36,0xbdfab273,0xbe164083,0xbe2f10a2,0xbde1bc2e,0xbe0cec4a,0xbe28defc,0xbe44b0b9
.long 0xbdfab273,0xbe1c76de,0xbe3b6ecf,0xbe5a3997,0xbe09cf86,0xbe2bf804,0xbe4dee60,0xbe6fa8b2
.long 0xbe888e93,0xbea986c4,0xbec9b953,0xbee900b7,0xbe8e9a22,0xbeb0eacb,0xbed25a09,0xbef2bd43
.long 0xbe78cfcc,0xbe9aa086,0xbeb8442a,0xbed53641,0xbe827dc0,0xbea21887,0xbec1071e,0xbedf28a9
.long 0xbe605c13,0xbe8b9507,0xbea68f12,0xbec1071e,0xbe6c9a7f,0xbe931f35,0xbeaf713a,0xbecb2aae
.long 0xbe47c5c2,0xbe78cfcc,0xbe94a031,0xbeac7cd4,0xbe541501,0xbe840270,0xbe9d9e78,0xbeb6ccc3
.long 0xbeb8442a,0xbee363fa,0xbf064b82,0xbf19c200,0xbebe1d4a,0xbeea6681,0xbf0a48ad,0xbf1e1e22
.long 0xbeac7cd4,0xbed53641,0xbefc5d27,0xbf10d3cd,0xbeb263ef,0xbedc53c1,0xbf0242b1,0xbf1553b7
.long 0xbea09ae5,0xbec6d529,0xbeebcbbb,0xbf07a136,0xbea68f12,0xbece0bea,0xbef41f07,0xbf0c42c9
.long 0xbe94a031,0xbeb8442a,0xbedae880,0xbefc5d27,0xbe9aa086,0xbebf926f,0xbee363fa,0xbf02ef9f
.long 0x3f800000,0x3f800000,0x3f800000,0x3f800000,0x3f7fec43,0x3f7fe705,0x3f7fe129,0x3f7fdaaf
.long 0x3f7fb10f,0x3f7f9c18,0x3f7f84ab,0x3f7f6ac7,0x3f7f4e6d,0x3f7f1f49,0x3f7eea9d,0x3f7eb069
.long 0x3f7ec46d,0x3f7e70b0,0x3f7e1324,0x3f7dabcc,0x3f7e1324,0x3f7d906e,0x3f7cfe73,0x3f7c5d3a
.long 0x3f7d3aac,0x3f7c7eb0,0x3f7baccd,0x3f7ac516,0x3f7c3b28,0x3f7b3bab,0x3f7a1e84,0x3f78e3d6
.long 0x3f7b14be,0x3f79c79d,0x3f7853f8,0x3f76ba07,0x3f79c79d,0x3f7822d1,0x3f764d97,0x3f74484b
.long 0x3f7853f8,0x3f764d97,0x3f740bdd,0x3f718f57,0x3f76ba07,0x3f74484b,0x3f718f57,0x3f6e8ff8
.long 0x3f74fa0b,0x3f721352,0x3f6ed89e,0x3f6b4b0c,0x3f731447,0x3f6faf1b,0x3f6be858,0x3f67c187
.long 0x3f710908,0x3f6d1c1d,0x3f68bf3c,0x3f63f473,0x3f6ed89e,0x3f6a5ad9,0x3f655e0b,0x3f5fe4e9
.long 0x3f676bd8,0x3f6106f2,0x3f59f26a,0x3f5233c6,0x3f64aa59,0x3f5d924d,0x3f55b993,0x3f4d26fd
.long 0x3f6c835e,0x3f676bd8,0x3f61c598,0x3f5b941a,0x3f6a09a7,0x3f644fac,0x3f5df6be,0x3f570348
.long 0x3f5b941a,0x3f5233c6,0x3f47de65,0x3f3ca003,0x3f584853,0x3f4e1689,0x3f42de29,0x3f36ad7f
.long 0x3f61c598,0x3f59f26a,0x3f514d3d,0x3f47de65,0x3f5ebe05,0x3f5627fe,0x3f4cae79,0x3f425b89
.long 0x3f4d9f02,0x3f40d0da,0x3f32c8c9,0x3f239da9,0x3f49d112,0x3f3c17d9,0x3f2d1469,0x3f1ce11f
.long 0x3f54db31,0x3f49d112,0x3f3daef9,0x3f3085bb,0x3f514d3d,0x3f456439,0x3f385216,0x3f2a2a80
.long 0x3f3daef9,0x3f2d1469,0x3f1b02c6,0x3f07a136,0x3f396842,0x3f27ce61,0x3f14b039,0x3f003a06
.long 0x3f45e403,0x3f373a23,0x3f273656,0x3f15f6d9,0x3f41d870,0x3f3238aa,0x3f212ff9,0x3f0ee0db
.long 0x3f800000,0x3f800000,0x3f800000,0x3f800000,0x3f7fd397,0x3f7fcbe2,0x3f7fc38f,0x3f7fba9e
.long 0x3f7f4e6d,0x3f7f2f9d,0x3f7f0e58,0x3f7eea9d,0x3f7e70b0,0x3f7e2b72,0x3f7de0b1,0x3f7d906e
.long 0x3f7d3aac,0x3f7cbfc9,0x3f7c3b28,0x3f7baccd,0x3f7baccd,0x3f7aed37,0x3f7a1e84,0x3f7940c0
.long 0x3f79c79d,0x3f78b47b,0x3f778bc5,0x3f764d97,0x3f778bc5,0x3f76167a,0x3f748422,0x3f72d4eb
.long 0x3f74fa0b,0x3f731447,0x3f710908,0x3f6ed89e,0x3f721352,0x3f6faf1b,0x3f6d1c1d,0x3f6a5ad9
.long 0x3f6ed89e,0x3f6be858,0x3f68bf3c,0x3f655e0b,0x3f6b4b0c,0x3f67c187,0x3f63f473,0x3f5fe4e9
.long 0x3f676bd8,0x3f633c5a,0x3f5ebe05,0x3f59f26a,0x3f633c5a,0x3f5e5aa6,0x3f591e6a,0x3f5389c7
.long 0x3f5ebe05,0x3f591e6a,0x3f531849,0x3f4cae79,0x3f59f26a,0x3f5389c7,0x3f4cae79,0x3f456439
.long 0x3f49d112,0x3f40d0da,0x3f373a23,0x3f2d1469,0x3f43e200,0x3f39f2ac,0x3f2f61a5,0x3f24381a
.long 0x3f54db31,0x3f4d9f02,0x3f45e403,0x3f3daef9,0x3f4f7a1f,0x3f476085,0x3f3ebc1b,0x3f3592e7
.long 0x3f3085bb,0x3f239da9,0x3f15f6d9,0x3f07a136,0x3f299415,0x3f1ba299,0x3f0cead0,0x3efafef7
.long 0x3f3daef9,0x3f32c8c9,0x3f273656,0x3f1b02c6,0x3f373a23,0x3f2b561b,0x3f1ebc12,0x3f11796b
.long 0x3f13682a,0x3f0242b1,0x3ee0924f,0x3ebb31a0,0x3f0b9a6b,0x3ef2bd43,0x3ecc9b8b,0x3ea5129f
.long 0x3f226799,0x3f13682a,0x3f039c3d,0x3ee63375,0x3f1b02c6,0x3f0af1b7,0x3ef41f07,0x3ed0eb2a
.long 0x3ee63375,0x3ebb31a0,0x3e8e9a22,0x3e419b37,0x3ed53641,0x3ea80b1f,0x3e72b651,0x3e1324ca
.long 0x3f039c3d,0x3ee0924f,0x3eb8442a,0x3e8e9a22,0x3ef6e0cb,0x3ece0bea,0x3ea395c5,0x3e6fa8b2
.long 0xbdc8bd36,0xbde1bc2e,0xbdfab273,0xbe09cf86,0xbdfab273,0xbe0cec4a,0xbe1c76de,0xbe2bf804
.long 0xbe164083,0xbe28defc,0xbe3b6ecf,0xbe4dee60,0xbe2f10a2,0xbe44b0b9,0xbe5a3997,0xbe6fa8b2
.long 0x80000000,0x80000000,0x80000000,0x80000000,0xbcc90ab0,0xbce22a7a,0xbcfb49ba,0xbd0a342f
.long 0xbd48fb30,0xbd621469,0xbd7b2b74,0xbd8a200a,0xbd96a905,0xbda973ba,0xbdbc3ac3,0xbdcefdb7
.long 0xbe94a031,0xbea68f12,0xbeb8442a,0xbec9b953,0xbea09ae5,0xbeb3dca5,0xbec6d529,0xbed97cb9
.long 0xbeac7cd4,0xbec1071e,0xbed53641,0xbee900b7,0xbeb8442a,0xbece0bea,0xbee363fa,0xbef840c8
.long 0xbe47c5c2,0xbe605c13,0xbe78cfcc,0xbe888e93,0xbe605c13,0xbe7bdba4,0xbe8b9507,0xbe9920fe
.long 0xbe78cfcc,0xbe8b9507,0xbe9aa086,0xbea986c4,0xbe888e93,0xbe9920fe,0xbea986c4,0xbeb9bb1e
.long 0xbf039c3d,0xbf121eb0,0xbf1ff6cb,0xbf2d1469,0xbf08f59b,0xbf17de12,0xbf26050a,0xbf33587a
.long 0xbef15aea,0xbf064b82,0xbf13682a,0xbf1ff6cb,0xbefc5d27,0xbf0c42c9,0xbf19c200,0xbf269de3
.long 0xbedae880,0xbef41f07,0xbf064b82,0xbf121eb0,0xbee63375,0xbf003a06,0xbf0cead0,0xbf19210f
.long 0xbec3ef15,0xbedae880,0xbef15aea,0xbf039c3d,0xbecf7bca,0xbee79a5d,0xbeff17b2,0xbf0af1b7
.long 0xbf2beb4a,0xbf3ca003,0xbf4bbbf8,0xbf591e6a,0xbf3085bb,0xbf4154e1,0xbf5064af,0xbf5d924d
.long 0xbf226799,0xbf32c8c9,0xbf41d870,0xbf4f7a1f,0xbf273656,0xbf37c655,0xbf46e22a,0xbf546b3b
.long 0xbf187fc0,0xbf286605,0xbf373a23,0xbf44e3f5,0xbf1d7fd1,0xbf2da859,0xbf3ca003,0xbf4a4c87
.long 0xbf0e39da,0xbf1d7fd1,0xbf2beb4a,0xbf396842,0xbf13682a,0xbf2302d3,0xbf31a81d,0xbf3f41fc
.long 0xbe164083,0xbe22abb6,0xbe2f10a2,0xbe3b6ecf,0xbe3b6ecf,0xbe4ada4f,0xbe5a3997,0xbe698bba
.long 0xbe605c13,0xbe72b651,0xbe827dc0,0xbe8b9507,0xbe827dc0,0xbe8d17c0,0xbe97a117,0xbea21887
.long 0x80000000,0x80000000,0x80000000,0x80000000,0xbd16c32c,0xbd2351cb,0xbd2fe007,0xbd3c6dd5
.long 0xbd96a905,0xbda3308c,0xbdafb680,0xbdbc3ac3,0xbde1bc2e,0xbdf475c0,0xbe039502,0xbe0cec4a
.long 0xbedae880,0xbeebcbbb,0xbefc5d27,0xbf064b82,0xbeebcbbb,0xbefdbabb,0xbf07a136,0xbf102dd5
.long 0xbefc5d27,0xbf07a136,0xbf10d3cd,0xbf19c200,0xbf064b82,0xbf102dd5,0xbf19c200,0xbf2302d3
.long 0xbe94a031,0xbea09ae5,0xbeac7cd4,0xbeb8442a,0xbea68f12,0xbeb3dca5,0xbec1071e,0xbece0bea
.long 0xbeb8442a,0xbec6d529,0xbed53641,0xbee363fa,0xbec9b953,0xbed97cb9,0xbee900b7,0xbef840c8
.long 0xbf396842,0xbf44e3f5,0xbf4f7a1f,0xbf591e6a,0xbf3fc767,0xbf4b41fa,0xbf55b993,0xbf5f20db
.long 0xbf2beb4a,0xbf373a23,0xbf41d870,0xbf4bbbf8,0xbf32c8c9,0xbf3e35c5,0xbf48d8b3,0xbf52a649
.long 0xbf1d7fd1,0xbf286605,0xbf32c8c9,0xbf3ca003,0xbf24d225,0xbf2ff3e6,0xbf3a7ca4,0xbf446337
.long 0xbf0e39da,0xbf187fc0,0xbf226799,0xbf2beb4a,0xbf15f6d9,0xbf209393,0xbf2ac082,0xbf34768f
.long 0xbf64aa59,0xbf6e46be,0xbf75dec6,0xbf7b61fc,0xbf68bf3c,0xbf71d19f,0xbf78b47b,0xbf7d57de
.long 0xbf5b941a,0xbf660f88,0xbf6ed89e,0xbf75dec6,0xbf604621,0xbf6a5ad9,0xbf7294f8,0xbf78e3d6
.long 0xbf514d3d,0xbf5c61c7,0xbf660f88,0xbf6e46be,0xbf5695e5,0xbf61668a,0xbf6aab7b,0xbf725470
.long 0xbf45e403,0xbf514d3d,0xbf5b941a,0xbf64aa59,0xbf4bbbf8,0xbf570348,0xbf6106f2,0xbf69b7e4
.long 0x3f800000,0x3f800000,0x3f800000,0x3f800000,0x3f7fb10f,0x3f7fa6e3,0x3f7f9c18,0x3f7f90b1
.long 0x3f7ec46d,0x3f7e9bc9,0x3f7e70b0,0x3f7e4323,0x3f7d3aac,0x3f7cdf6c,0x3f7c7eb0,0x3f7c187a
.long 0x3f7b14be,0x3f7a7302,0x3f79c79d,0x3f791298,0x3f7853f8,0x3f77583a,0x3f764d97,0x3f75341d
.long 0x3f74fa0b,0x3f73913f,0x3f721352,0x3f708066,0x3f710908,0x3f6f20b0,0x3f6d1c1d,0x3f6afb8c
.long 0x3f6c835e,0x3f6a09a7,0x3f676bd8,0x3f64aa59,0x3f676bd8,0x3f644fac,0x3f6106f2,0x3f5d924d
.long 0x3f61c598,0x3f5df6be,0x3f59f26a,0x3f55b993,0x3f5b941a,0x3f570348,0x3f5233c6,0x3f4d26fd
.long 0x3f54db31,0x3f4f7a1f,0x3f49d112,0x3f43e200,0x3f4d9f02,0x3f476085,0x3f40d0da,0x3f39f2ac
.long 0x3f45e403,0x3f3ebc1b,0x3f373a23,0x3f2f61a5,0x3f3daef9,0x3f3592e7,0x3f2d1469,0x3f24381a
.long 0x3f226799,0x3f173c07,0x3f0b9a6b,0x3eff17b2,0x3f187fc0,0x3f0c42c9,0x3eff17b2,0x3ee4cbfe
.long 0x3f3504f3,0x3f2beb4a,0x3f226799,0x3f187fc0,0x3f2beb4a,0x3f21cbfb,0x3f173c07,0x3f0c42c9
.long 0x3ef15aea,0x3ed25a09,0x3eb263ef,0x3e919ddd,0x3edae880,0x3eb9bb1e,0x3e97a117,0x3e698bba
.long 0x3f0e39da,0x3f00e7e4,0x3ee63375,0x3ec9b953,0x3f039c3d,0x3eea6681,0x3ecc9b8b,0x3eadf73c
.long 0x3e94a031,0x3e5a3997,0x3e09cf86,0x3d621469,0x3e78cfcc,0x3e25c58c,0x3da3308c,0xbb490fc6
.long 0x3ec3ef15,0x3ea09ae5,0x3e78cfcc,0x3e2f10a2,0x3eac7cd4,0x3e870ada,0x3e419b37,0x3de7fa9a
.long 0x3dc8bd36,0x3bc90f88,0xbdafb680,0xbe354098,0x3d48fb30,0xbd3c6dd5,0xbe1008b7,0xbe6fa8b2
.long 0x3e47c5c2,0x3de1bc2e,0x3cc90ab0,0xbd7b2b74,0x3e164083,0x3d6ea038,0xbcfb49ba,0xbdf475c0
.long 0x3f800000,0x3f800000,0x3f800000,0x3f800000,0x3f7f84ab,0x3f7f7808,0x3f7f6ac7,0x3f7f5ce9
.long 0x3f7e1324,0x3f7de0b1,0x3f7dabcc,0x3f7d7474,0x3f7baccd,0x3f7b3bab,0x3f7ac516,0x3f7a4910
.long 0x3f7853f8,0x3f778bc5,0x3f76ba07,0x3f75dec6,0x3f740bdd,0x3f72d4eb,0x3f718f57,0x3f703b37
.long 0x3f6ed89e,0x3f6d1c1d,0x3f6b4b0c,0x3f696591,0x3f68bf3c,0x3f666771,0x3f63f473,0x3f61668a
.long 0x3f61c598,0x3f5ebe05,0x3f5b941a,0x3f584853,0x3f59f26a,0x3f5627fe,0x3f5233c6,0x3f4e1689
.long 0x3f514d3d,0x3f4cae79,0x3f47de65,0x3f42de29,0x3f47de65,0x3f425b89,0x3f3ca003,0x3f36ad7f
.long 0x3f3daef9,0x3f373a23,0x3f3085bb,0x3f299415,0x3f32c8c9,0x3f2b561b,0x3f239da9,0x3f1ba299
.long 0x3f273656,0x3f1ebc12,0x3f15f6d9,0x3f0cead0,0x3f1b02c6,0x3f11796b,0x3f07a136,0x3efafef7
.long 0x3ee63375,0x3ecc9b8b,0x3eb263ef,0x3e97a117,0x3ec9b953,0x3eadf73c,0x3e919ddd,0x3e698bba
.long 0x3f0e39da,0x3f039c3d,0x3ef15aea,0x3edae880,0x3f00e7e4,0x3eea6681,0x3ed25a09,0x3eb9bb1e
.long 0x3e605c13,0x3e1c76de,0x3dafb680,0x3c96c9b6,0x3e22abb6,0x3db5f8da,0x3c96c9b6,0xbd55880e
.long 0x3eac7cd4,0x3e8e9a22,0x3e605c13,0x3e22abb6,0x3e8e9a22,0x3e5d4b1a,0x3e1c76de,0x3db5f8da
.long 0xbcc90ab0,0xbdd53db9,0xbe3b6ecf,0xbe8586ce,0xbdafb680,0xbe2bf804,0xbe7ee6e1,0xbea80b1f
.long 0x3dc8bd36,0x3cc90ab0,0xbd48fb30,0xbdfab273,0x3d16c32c,0xbd2351cb,0xbdee3876,0xbe44b0b9
.long 0xbe888e93,0xbeb554ec,0xbee0924f,0xbf04f484,0xbea68f12,0xbed3c867,0xbeff17b2,0xbf140c5f
.long 0xbe164083,0xbe6c9a7f,0xbea09ae5,0xbec9b953,0xbe541501,0xbe9620d2,0xbec1071e,0xbeea6681
.long 0xbe47c5c2,0xbe541501,0xbe605c13,0xbe6c9a7f,0xbe78cfcc,0xbe840270,0xbe8b9507,0xbe931f35
.long 0xbe94a031,0xbe9d9e78,0xbea68f12,0xbeaf713a,0xbeac7cd4,0xbeb6ccc3,0xbec1071e,0xbecb2aae
.long 0x80000000,0x80000000,0x80000000,0x80000000,0xbd48fb30,0xbd55880e,0xbd621469,0xbd6ea038
.long 0xbdc8bd36,0xbdd53db9,0xbde1bc2e,0xbdee3876,0xbe164083,0xbe1f917b,0xbe28defc,0xbe3228d4
.long 0xbf0e39da,0xbf15f6d9,0xbf1d7fd1,0xbf24d225,0xbf187fc0,0xbf209393,0xbf286605,0xbf2ff3e6
.long 0xbf226799,0xbf2ac082,0xbf32c8c9,0xbf3a7ca4,0xbf2beb4a,0xbf34768f,0xbf3ca003,0xbf446337
.long 0xbec3ef15,0xbecf7bca,0xbedae880,0xbee63375,0xbedae880,0xbee79a5d,0xbef41f07,0xbf003a06
.long 0xbef15aea,0xbeff17b2,0xbf064b82,0xbf0cead0,0xbf039c3d,0xbf0af1b7,0xbf121eb0,0xbf19210f
.long 0xbf61c598,0xbf696591,0xbf6ff573,0xbf756d97,0xbf676bd8,0xbf6e8ff8,0xbf748422,0xbf7940c0
.long 0xbf54db31,0xbf5d2d53,0xbf64aa59,0xbf6b4b0c,0xbf5b941a,0xbf6398ac,0xbf6aab7b,0xbf70c501
.long 0xbf45e403,0xbf4e8d90,0xbf5695e5,0xbf5df6be,0xbf4d9f02,0xbf5627fe,0xbf5df6be,0xbf650479
.long 0xbf3504f3,0xbf3daef9,0xbf45e403,0xbf4d9f02,0xbf3daef9,0xbf466354,0xbf4e8d90,0xbf5627fe
.long 0xbf7ec46d,0xbf7ffec4,0xbf7f0e58,0xbf7bf531,0xbf7fb10f,0xbf7fba9e,0xbf7d7474,0xbf78e3d6
.long 0xbf7b14be,0xbf7e70b0,0xbf7fec43,0xbf7f84ab,0xbf7d3aac,0xbf7f90b1,0xbf7fe129,0xbf7e2b72
.long 0xbf74fa0b,0xbf7a1e84,0xbf7dabcc,0xbf7f9c18,0xbf7853f8,0xbf7c9f8a,0xbf7f2f9d,0xbf7fffb1
.long 0xbf6c835e,0xbf731447,0xbf7853f8,0xbf7c3b28,0xbf710908,0xbf76ef5b,0xbf7b61fc,0xbf7e5a38
.long 0xbe78cfcc,0xbe827dc0,0xbe888e93,0xbe8e9a22,0xbe9aa086,0xbea21887,0xbea986c4,0xbeb0eacb
.long 0xbeb8442a,0xbec1071e,0xbec9b953,0xbed25a09,0xbed53641,0xbedf28a9,0xbee900b7,0xbef2bd43
.long 0x80000000,0x80000000,0x80000000,0x80000000,0xbd7b2b74,0xbd83db0a,0xbd8a200a,0xbd9064b4
.long 0xbdfab273,0xbe039502,0xbe09cf86,0xbe1008b7,0xbe3b6ecf,0xbe44b0b9,0xbe4dee60,0xbe57278f
.long 0xbf2beb4a,0xbf32c8c9,0xbf396842,0xbf3fc767,0xbf373a23,0xbf3e35c5,0xbf44e3f5,0xbf4b41fa
.long 0xbf41d870,0xbf48d8b3,0xbf4f7a1f,0xbf55b993,0xbf4bbbf8,0xbf52a649,0xbf591e6a,0xbf5f20db
.long 0xbef15aea,0xbefc5d27,0xbf039c3d,0xbf08f59b,0xbf064b82,0xbf0c42c9,0xbf121eb0,0xbf17de12
.long 0xbf13682a,0xbf19c200,0xbf1ff6cb,0xbf26050a,0xbf1ff6cb,0xbf269de3,0xbf2d1469,0xbf33587a
.long 0xbf79c79d,0xbf7cfe73,0xbf7f0e58,0xbf7ff4e6,0xbf7cbfc9,0xbf7efcc9,0xbf7ff4e6,0xbf7fa6e3
.long 0xbf710908,0xbf75dec6,0xbf79c79d,0xbf7cbfc9,0xbf75dec6,0xbf79f35e,0xbf7cfe73,0xbf7efcc9
.long 0xbf64aa59,0xbf6aab7b,0xbf6ff573,0xbf748422,0xbf6b4b0c,0xbf70c501,0xbf756d97,0xbf7940c0
.long 0xbf54db31,0xbf5b941a,0xbf61c598,0xbf676bd8,0xbf5d2d53,0xbf6398ac,0xbf696591,0xbf6e8ff8
.long 0xbf76ba07,0xbf6f6830,0xbf660f88,0xbf5ac450,0xbf721352,0xbf6912ae,0xbf5df6be,0xbf50d937
.long 0xbf7d3aac,0xbf791298,0xbf731447,0xbf6b4b0c,0xbf7a7302,0xbf74bf62,0xbf6d1c1d,0xbf6398ac
.long 0xbf7fec43,0xbf7e9bc9,0xbf7baccd,0xbf772417,0xbf7f0e58,0xbf7c5d3a,0xbf77f110,0xbf71d19f
.long 0xbf7ec46d,0xbf7fec43,0xbf7fb10f,0xbf7e1324,0xbf7fd397,0xbf7fcbe2,0xbf7e4323,0xbf7b3bab
.long 0x3f800000,0x3f800000,0x3f800000,0x3f800000,0x3f7f4e6d,0x3f7f3f54,0x3f7f2f9d,0x3f7f1f49
.long 0x3f7d3aac,0x3f7cfe73,0x3f7cbfc9,0x3f7c7eb0,0x3f79c79d,0x3f7940c0,0x3f78b47b,0x3f7822d1
.long 0x3f74fa0b,0x3f740bdd,0x3f731447,0x3f721352,0x3f6ed89e,0x3f6d67a1,0x3f6be858,0x3f6a5ad9
.long 0x3f676bd8,0x3f655e0b,0x3f633c5a,0x3f6106f2,0x3f5ebe05,0x3f5bfb34,0x3f591e6a,0x3f5627fe
.long 0x3f54db31,0x3f514d3d,0x3f4d9f02,0x3f49d112,0x3f49d112,0x3f456439,0x3f40d0da,0x3f3c17d9
.long 0x3f3daef9,0x3f385216,0x3f32c8c9,0x3f2d1469,0x3f3085bb,0x3f2a2a80,0x3f239da9,0x3f1ce11f
.long 0x3f226799,0x3f1b02c6,0x3f13682a,0x3f0b9a6b,0x3f13682a,0x3f0af1b7,0x3f0242b1,0x3ef2bd43
.long 0x3f039c3d,0x3ef41f07,0x3ee0924f,0x3ecc9b8b,0x3ee63375,0x3ed0eb2a,0x3ebb31a0,0x3ea5129f
.long 0x3e78cfcc,0x3e419b37,0x3e09cf86,0x3da3308c,0x3e2f10a2,0x3de7fa9a,0x3d621469,0xbb490fc6
.long 0x3ec3ef15,0x3eac7cd4,0x3e94a031,0x3e78cfcc,0x3ea09ae5,0x3e870ada,0x3e5a3997,0x3e25c58c
.long 0xbd48fb30,0xbdee3876,0xbe3b6ecf,0xbe7ee6e1,0xbdfab273,0xbe44b0b9,0xbe8586ce,0xbea80b1f
.long 0x3dc8bd36,0x3d16c32c,0xbcc90ab0,0xbdafb680,0x3cc90ab0,0xbd2351cb,0xbdd53db9,0xbe2bf804
.long 0xbeac7cd4,0xbed25a09,0xbef6e0cb,0xbf0cead0,0xbecf7bca,0xbef58035,0xbf0cead0,0xbf1e1e22
.long 0xbe47c5c2,0xbe888e93,0xbeac7cd4,0xbecf7bca,0xbe888e93,0xbeadf73c,0xbed25a09,0xbef58035
.long 0xbf187fc0,0xbf2ac082,0xbf3b8f3b,0xbf4ac77f,0xbf273656,0xbf38dd65,0xbf48d8b3,0xbf570348
.long 0xbef15aea,0xbf0b9a6b,0xbf1d7fd1,0xbf2e3bde,0xbf08f59b,0xbf1ba299,0xbf2d1469,0xbf3d27b8
.long 0x3f800000,0x3f800000,0x3f800000,0x3f800000,0x3f7f0e58,0x3f7efcc9,0x3f7eea9d,0x3f7ed7d4
.long 0x3f7c3b28,0x3f7bf531,0x3f7baccd,0x3f7b61fc,0x3f778bc5,0x3f76ef5b,0x3f764d97,0x3f75a67b
.long 0x3f710908,0x3f6ff573,0x3f6ed89e,0x3f6db293,0x3f68bf3c,0x3f671599,0x3f655e0b,0x3f6398ac
.long 0x3f5ebe05,0x3f5c61c7,0x3f59f26a,0x3f577026,0x3f531849,0x3f4fefa8,0x3f4cae79,0x3f495521
.long 0x3f45e403,0x3f41d870,0x3f3daef9,0x3f396842,0x3f373a23,0x3f3238aa,0x3f2d1469,0x3f27ce61
.long 0x3f273656,0x3f212ff9,0x3f1b02c6,0x3f14b039,0x3f15f6d9,0x3f0ee0db,0x3f07a136,0x3f003a06
.long 0x3f039c3d,0x3ef6e0cb,0x3ee63375,0x3ed53641,0x3ee0924f,0x3ece0bea,0x3ebb31a0,0x3ea80b1f
.long 0x3eb8442a,0x3ea395c5,0x3e8e9a22,0x3e72b651,0x3e8e9a22,0x3e6fa8b2,0x3e419b37,0x3e1324ca
.long 0x3cc90ab0,0xbcfb49ba,0xbdafb680,0xbe1008b7,0xbd7b2b74,0xbdf475c0,0xbe354098,0xbe6fa8b2
.long 0x3e47c5c2,0x3e164083,0x3dc8bd36,0x3d48fb30,0x3de1bc2e,0x3d6ea038,0x3bc90f88,0xbd3c6dd5
.long 0xbea09ae5,0xbec1071e,0xbee0924f,0xbeff17b2,0xbec9b953,0xbeea6681,0xbf04f484,0xbf140c5f
.long 0xbe164083,0xbe541501,0xbe888e93,0xbea68f12,0xbe6c9a7f,0xbe9620d2,0xbeb554ec,0xbed3c867
.long 0xbf1d7fd1,0xbf2d1469,0xbf3b8f3b,0xbf48d8b3,0xbf2e3bde,0xbf3d27b8,0xbf4ac77f,0xbf570348
.long 0xbef15aea,0xbf08f59b,0xbf187fc0,0xbf273656,0xbf0b9a6b,0xbf1ba299,0xbf2ac082,0xbf38dd65
.long 0xbf584853,0xbf63f473,0xbf6db293,0xbf756d97,0xbf633c5a,0xbf6d67a1,0xbf756d97,0xbf7b3bab
.long 0xbf3daef9,0xbf4bbbf8,0xbf584853,0xbf633c5a,0xbf4bbbf8,0xbf58b3a1,0xbf63f473,0xbf6d67a1
.long 0xbe94a031,0xbe9aa086,0xbea09ae5,0xbea68f12,0xbeb8442a,0xbebf926f,0xbec6d529,0xbece0bea
.long 0xbedae880,0xbee363fa,0xbeebcbbb,0xbef41f07,0xbefc5d27,0xbf02ef9f,0xbf07a136,0xbf0c42c9
.long 0x80000000,0x80000000,0x80000000,0x80000000,0xbd96a905,0xbd9cecf9,0xbda3308c,0xbda973ba
.long 0xbe164083,0xbe1c76de,0xbe22abb6,0xbe28defc,0xbe605c13,0xbe698bba,0xbe72b651,0xbe7bdba4
.long 0xbf45e403,0xbf4bbbf8,0xbf514d3d,0xbf5695e5,0xbf514d3d,0xbf570348,0xbf5c61c7,0xbf61668a
.long 0xbf5b941a,0xbf6106f2,0xbf660f88,0xbf6aab7b,0xbf64aa59,0xbf69b7e4,0xbf6e46be,0xbf725470
.long 0xbf0e39da,0xbf13682a,0xbf187fc0,0xbf1d7fd1,0xbf1d7fd1,0xbf2302d3,0xbf286605,0xbf2da859
.long 0xbf2beb4a,0xbf31a81d,0xbf373a23,0xbf3ca003,0xbf396842,0xbf3f41fc,0xbf44e3f5,0xbf4a4c87
.long 0xbf7fb10f,0xbf7e4323,0xbf7baccd,0xbf77f110,0xbf7e1324,0xbf7b3bab,0xbf772417,0xbf71d19f
.long 0xbf7ec46d,0xbf7fd397,0xbf7fec43,0xbf7f0e58,0xbf7fec43,0xbf7fcbe2,0xbf7e9bc9,0xbf7c5d3a
.long 0xbf7853f8,0xbf7b61fc,0xbf7dabcc,0xbf7f2f9d,0xbf7c3b28,0xbf7e5a38,0xbf7f9c18,0xbf7fffb1
.long 0xbf6c835e,0xbf710908,0xbf74fa0b,0xbf7853f8,0xbf731447,0xbf76ef5b,0xbf7a1e84,0xbf7c9f8a
.long 0xbf4d9f02,0xbf3ebc1b,0xbf2e3bde,0xbf1c420c,0xbf41d870,0xbf311722,0xbf1ebc12,0xbf0af1b7
.long 0xbf61c598,0xbf5695e5,0xbf49d112,0xbf3b8f3b,0xbf584853,0xbf4b41fa,0xbf3ca003,0xbf2c800f
.long 0xbf710908,0xbf696591,0xbf604621,0xbf55b993,0xbf6a09a7,0xbf60a6cf,0xbf55b993,0xbf495521
.long 0xbf7b14be,0xbf76ba07,0xbf710908,0xbf6a09a7,0xbf76ba07,0xbf70c501,0xbf696591,0xbf60a6cf
.long 0xbeac7cd4,0xbeb263ef,0xbeb8442a,0xbebe1d4a,0xbed53641,0xbedc53c1,0xbee363fa,0xbeea6681
.long 0xbefc5d27,0xbf0242b1,0xbf064b82,0xbf0a48ad,0xbf10d3cd,0xbf1553b7,0xbf19c200,0xbf1e1e22
.long 0x80000000,0x80000000,0x80000000,0x80000000,0xbdafb680,0xbdb5f8da,0xbdbc3ac3,0xbdc27c39
.long 0xbe2f10a2,0xbe354098,0xbe3b6ecf,0xbe419b37,0xbe827dc0,0xbe870ada,0xbe8b9507,0xbe901c2c
.long 0xbf5b941a,0xbf604621,0xbf64aa59,0xbf68bf3c,0xbf660f88,0xbf6a5ad9,0xbf6e46be,0xbf71d19f
.long 0xbf6ed89e,0xbf7294f8,0xbf75dec6,0xbf78b47b,0xbf75dec6,0xbf78e3d6,0xbf7b61fc,0xbf7d57de
.long 0xbf226799,0xbf273656,0xbf2beb4a,0xbf3085bb,0xbf32c8c9,0xbf37c655,0xbf3ca003,0xbf4154e1
.long 0xbf41d870,0xbf46e22a,0xbf4bbbf8,0xbf5064af,0xbf4f7a1f,0xbf546b3b,0xbf591e6a,0xbf5d924d
.long 0xbf731447,0xbf6d1c1d,0xbf660f88,0xbf5df6be,0xbf6b4b0c,0xbf6398ac,0xbf5ac450,0xbf50d937
.long 0xbf7d3aac,0xbf7a7302,0xbf76ba07,0xbf721352,0xbf791298,0xbf74bf62,0xbf6f6830,0xbf6912ae
.long 0xbf7fec43,0xbf7fe129,0xbf7f0e58,0xbf7d7474,0xbf7f84ab,0xbf7e2b72,0xbf7bf531,0xbf78e3d6
.long 0xbf7b14be,0xbf7d3aac,0xbf7ec46d,0xbf7fb10f,0xbf7e70b0,0xbf7f90b1,0xbf7ffec4,0xbf7fba9e
.long 0xbf08f59b,0xbee900b7,0xbebe1d4a,0xbe919ddd,0xbeebcbbb,0xbebf926f,0xbe919ddd,0xbe44b0b9
.long 0xbf2beb4a,0xbf1b02c6,0xbf08f59b,0xbeebcbbb,0xbf1b02c6,0xbf084b92,0xbee900b7,0xbebf926f
.long 0xbf49d112,0xbf3ca003,0xbf2e3bde,0xbf1ebc12,0xbf3b8f3b,0xbf2c800f,0xbf1c420c,0xbf0af1b7
.long 0xbf61c598,0xbf584853,0xbf4d9f02,0xbf41d870,0xbf5695e5,0xbf4b41fa,0xbf3ebc1b,0xbf311722
.long 0x3f800000,0x3f800000,0x3f800000,0x3f800000,0x3f7ec46d,0x3f7eb069,0x3f7e9bc9,0x3f7e868b
.long 0x3f7b14be,0x3f7ac516,0x3f7a7302,0x3f7a1e84,0x3f74fa0b,0x3f74484b,0x3f73913f,0x3f72d4eb
.long 0x3f6c835e,0x3f6b4b0c,0x3f6a09a7,0x3f68bf3c,0x3f61c598,0x3f5fe4e9,0x3f5df6be,0x3f5bfb34
.long 0x3f54db31,0x3f5233c6,0x3f4f7a1f,0x3f4cae79,0x3f45e403,0x3f425b89,0x3f3ebc1b,0x3f3b0629
.long 0x3f3504f3,0x3f3085bb,0x3f2beb4a,0x3f273656,0x3f226799,0x3f1ce11f,0x3f173c07,0x3f11796b
.long 0x3f0e39da,0x3f07a136,0x3f00e7e4,0x3ef41f07,0x3ef15aea,0x3ee1fb6a,0x3ed25a09,0x3ec27b55
.long 0x3ec3ef15,0x3eb263ef,0x3ea09ae5,0x3e8e9a22,0x3e94a031,0x3e80f8c0,0x3e5a3997,0x3e3228d4
.long 0x3e47c5c2,0x3e1c76de,0x3de1bc2e,0x3d8a200a,0x3dc8bd36,0x3d55880e,0x3bc90f88,0xbd2351cb
.long 0xbe47c5c2,0xbe7ee6e1,0xbe9aa086,0xbeb554ec,0xbe94a031,0xbeb0eacb,0xbecc9b8b,0xbee79a5d
.long 0x0,0xbd48fb30,0xbdc8bd36,0xbe164083,0xbdc8bd36,0xbe195be0,0xbe4dee60,0xbe80f8c0
.long 0xbf0e39da,0xbf1c420c,0xbf299415,0xbf36206c,0xbf226799,0xbf2ff3e6,0xbf3ca003,0xbf485bca
.long 0xbec3ef15,0xbee0924f,0xbefc5d27,0xbf0b9a6b,0xbef15aea,0xbf06f686,0xbf14b039,0xbf21cbfb
.long 0xbf54db31,0xbf5f8327,0xbf68bf3c,0xbf708066,0xbf61c598,0xbf6afb8c,0xbf7294f8,0xbf788486
.long 0xbf3504f3,0xbf41d870,0xbf4d9f02,0xbf584853,0xbf45e403,0xbf51c0c2,0xbf5c61c7,0xbf65b710
.long 0xbf7b14be,0xbf7e9bc9,0xbf7ffb11,0xbf7f2f9d,0xbf7ec46d,0xbf7fffb1,0xbf7eea9d,0xbf7b87b2
.long 0xbf6c835e,0xbf740bdd,0xbf79c79d,0xbf7dabcc,0xbf74fa0b,0xbf7a9c59,0xbf7e4323,0xbf7fe705
.long 0x3f800000,0x3f800000,0x3f800000,0x3f800000,0x3f7e70b0,0x3f7e5a38,0x3f7e4323,0x3f7e2b72
.long 0x3f79c79d,0x3f796e4e,0x3f791298,0x3f78b47b,0x3f721352,0x3f714c7a,0x3f708066,0x3f6faf1b
.long 0x3f676bd8,0x3f660f88,0x3f64aa59,0x3f633c5a,0x3f59f26a,0x3f57dc7f,0x3f55b993,0x3f5389c7
.long 0x3f49d112,0x3f46e22a,0x3f43e200,0x3f40d0da,0x3f373a23,0x3f33587a,0x3f2f61a5,0x3f2b561b
.long 0x3f226799,0x3f1d7fd1,0x3f187fc0,0x3f13682a,0x3f0b9a6b,0x3f05a02c,0x3eff17b2,0x3ef2bd43
.long 0x3ee63375,0x3ed8106b,0x3ec9b953,0x3ebb31a0,0x3eb263ef,0x3ea21887,0x3e919ddd,0x3e80f8c0
.long 0x3e78cfcc,0x3e541501,0x3e2f10a2,0x3e09cf86,0x3e09cf86,0x3dc27c39,0x3d621469,0x3c7b514b
.long 0x3cc90ab0,0xbc96c9b6,0xbd7b2b74,0xbdd53db9,0xbdafb680,0xbe06b26e,0xbe354098,0xbe636c83
.long 0xbecf7bca,0xbee900b7,0xbf00e7e4,0xbf0cead0,0xbf00e7e4,0xbf0d9281,0xbf19c200,0xbf256bcb
.long 0xbe47c5c2,0xbe78cfcc,0xbe94a031,0xbeac7cd4,0xbe9aa086,0xbeb3dca5,0xbecc9b8b,0xbee4cbfe
.long 0xbf41d870,0xbf4cae79,0xbf5695e5,0xbf5f8327,0xbf531849,0xbf5cc7d1,0xbf655e0b,0xbf6cd007
.long 0xbf187fc0,0xbf24d225,0xbf3085bb,0xbf3b8f3b,0xbf2e3bde,0xbf39f2ac,0xbf44e3f5,0xbf4f0417
.long 0xbf76ba07,0xbf7b61fc,0xbf7e70b0,0xbf7fe129,0xbf7cbfc9,0xbf7f3f54,0xbf7ffec4,0xbf7efcc9
.long 0xbf61c598,0xbf6a09a7,0xbf710908,0xbf76ba07,0xbf6db293,0xbf74484b,0xbf796e4e,0xbf7d1cdd
.long 0xbf7c3b28,0xbf772417,0xbf6ff573,0xbf66becc,0xbf75dec6,0xbf6dfcf2,0xbf63f473,0xbf57dc7f
.long 0xbf7fb10f,0xbf7fd397,0xbf7e1324,0xbf7a7302,0xbf7f84ab,0xbf7d1cdd,0xbf78b47b,0xbf725470
.long 0xbec3ef15,0xbec9b953,0xbecf7bca,0xbed53641,0xbef15aea,0xbef840c8,0xbeff17b2,0xbf02ef9f
.long 0xbf0e39da,0xbf121eb0,0xbf15f6d9,0xbf19c200,0xbf226799,0xbf269de3,0xbf2ac082,0xbf2ecef7
.long 0x80000000,0x80000000,0x80000000,0x80000000,0xbdc8bd36,0xbdcefdb7,0xbdd53db9,0xbddb7d37
.long 0xbe47c5c2,0xbe4dee60,0xbe541501,0xbe5a3997,0xbe94a031,0xbe9920fe,0xbe9d9e78,0xbea21887
.long 0xbf6c835e,0xbf6ff573,0xbf731447,0xbf75dec6,0xbf74fa0b,0xbf77beb7,0xbf7a1e84,0xbf7c187a
.long 0xbf7b14be,0xbf7cfe73,0xbf7e70b0,0xbf7f6ac7,0xbf7ec46d,0xbf7fa6e3,0xbf7ffec4,0xbf7fcbe2
.long 0xbf3504f3,0xbf396842,0xbf3daef9,0xbf41d870,0xbf45e403,0xbf4a4c87,0xbf4e8d90,0xbf52a649
.long 0xbf54db31,0xbf591e6a,0xbf5d2d53,0xbf6106f2,0xbf61c598,0xbf65b710,0xbf696591,0xbf6cd007
.long 0xbf54db31,0xbf4ac77f,0xbf3fc767,0xbf33e7bc,0xbf45e403,0xbf39f2ac,0xbf2d1469,0xbf1f599f
.long 0xbf6c835e,0xbf660f88,0xbf5ebe05,0xbf5695e5,0xbf61c598,0xbf5988ad,0xbf5064af,0xbf466354
.long 0xbf7b14be,0xbf77f110,0xbf740bdd,0xbf6f6830,0xbf74fa0b,0xbf703b37,0xbf6aab7b,0xbf644fac
.long 0xbf800000,0xbf7fb10f,0xbf7ec46d,0xbf7d3aac,0xbf7ec46d,0xbf7d1cdd,0xbf7ac516,0xbf77beb7
.long 0xbe47c5c2,0xbdd53db9,0xbc490e90,0x3da3308c,0xbdc8bd36,0xbb490fc6,0x3dbc3ac3,0x3e3e853e
.long 0xbec3ef15,0xbe9aa086,0xbe605c13,0xbe09cf86,0xbe94a031,0xbe5101f1,0xbdee3876,0xbce22a7a
.long 0xbf0e39da,0xbef9a02d,0xbed53641,0xbeaf713a,0xbef15aea,0xbecb2aae,0xbea395c5,0xbe75c35a
.long 0xbf3504f3,0xbf273656,0xbf187fc0,0xbf08f59b,0xbf226799,0xbf12c39a,0xbf0242b1,0xbee1fb6a
.long 0xbedae880,0xbee0924f,0xbee63375,0xbeebcbbb,0xbf064b82,0xbf099f4e,0xbf0cead0,0xbf102dd5
.long 0xbf1d7fd1,0xbf212ff9,0xbf24d225,0xbf286605,0xbf32c8c9,0xbf36ad7f,0xbf3a7ca4,0xbf3e35c5
.long 0x80000000,0x80000000,0x80000000,0x80000000,0xbde1bc2e,0xbde7fa9a,0xbdee3876,0xbdf475c0
.long 0xbe605c13,0xbe667c66,0xbe6c9a7f,0xbe72b651,0xbea68f12,0xbeab0201,0xbeaf713a,0xbeb3dca5
.long 0xbf7853f8,0xbf7a7302,0xbf7c3b28,0xbf7dabcc,0xbf7dabcc,0xbf7ed7d4,0xbf7f9c18,0xbf7ff84a
.long 0xbf7fec43,0xbf7ff4e6,0xbf7f84ab,0xbf7e9bc9,0xbf7f0e58,0xbf7dc68c,0xbf7bf531,0xbf799b43
.long 0xbf45e403,0xbf49d112,0xbf4d9f02,0xbf514d3d,0xbf5695e5,0xbf5a5ba0,0xbf5df6be,0xbf61668a
.long 0xbf64aa59,0xbf6816a8,0xbf6b4b0c,0xbf6e46be,0xbf6ff573,0xbf72d4eb,0xbf756d97,0xbf77beb7
.long 0xbf273656,0xbf19c200,0xbf0b9a6b,0xbef9a02d,0xbf10d3cd,0xbf019573,0xbee363fa,0xbec27b55
.long 0xbf4d9f02,0xbf43e200,0xbf396842,0xbf2e3bde,0xbf3b8f3b,0xbf2ff3e6,0xbf239da9,0xbf16999f
.long 0xbf6a09a7,0xbf63f473,0xbf5d2d53,0xbf55b993,0xbf5d2d53,0xbf554aa4,0xbf4cae79,0xbf436051
.long 0xbf7b14be,0xbf7853f8,0xbf74fa0b,0xbf710908,0xbf740bdd,0xbf6faf1b,0xbf6aab7b,0xbf650479
.long 0x3e2f10a2,0x3e8586ce,0x3eb263ef,0x3eddbe79,0x3e8e9a22,0x3ebca7af,0x3ee900b7,0x3f099f4e
.long 0xbd48fb30,0x3d16c32c,0x3dfab273,0x3e541501,0x3d7b2b74,0x3e195be0,0x3e72b651,0x3ea5129f
.long 0xbe888e93,0xbe419b37,0xbde1bc2e,0xbcfb49ba,0xbe22abb6,0xbd9cecf9,0x3bc90f88,0x3db5f8da
.long 0xbef15aea,0xbecf7bca,0xbeac7cd4,0xbe888e93,0xbebe1d4a,0xbe9920fe,0xbe667c66,0xbe195be0
.long 0x3f800000,0x3f800000,0x3f800000,0x3f800000,0x3f7e1324,0x3f7dfa38,0x3f7de0b1,0x3f7dc68c
.long 0x3f7853f8,0x3f77f110,0x3f778bc5,0x3f772417,0x3f6ed89e,0x3f6dfcf2,0x3f6d1c1d,0x3f6c3624
.long 0x3f61c598,0x3f604621,0x3f5ebe05,0x3f5d2d53,0x3f514d3d,0x3f4f0417,0x3f4cae79,0x3f4a4c87
.long 0x3f3daef9,0x3f3a7ca4,0x3f373a23,0x3f33e7bc,0x3f273656,0x3f2302d3,0x3f1ebc12,0x3f1a6293
.long 0x3f0e39da,0x3f08f59b,0x3f039c3d,0x3efc5d27,0x3ee63375,0x3ed97cb9,0x3ecc9b8b,0x3ebf926f
.long 0x3eac7cd4,0x3e9d9e78,0x3e8e9a22,0x3e7ee6e1,0x3e605c13,0x3e3e853e,0x3e1c76de,0x3df475c0
.long 0x3dc8bd36,0x3d7b2b74,0x3cc90ab0,0xbc490e90,0xbcc90ab0,0xbd83db0a,0xbdd53db9,0xbe1324ca
.long 0xbe164083,0xbe419b37,0xbe6c9a7f,0xbe8b9507,0xbe888e93,0xbe9f1cdf,0xbeb554ec,0xbecb2aae
.long 0xbf187fc0,0xbf239da9,0xbf2e3bde,0xbf385216,0xbf3085bb,0xbf3b0629,0xbf44e3f5,0xbf4e1689
.long 0xbec3ef15,0xbedae880,0xbef15aea,0xbf039c3d,0xbefc5d27,0xbf099f4e,0xbf14b039,0xbf1f599f
.long 0xbf676bd8,0xbf6e46be,0xbf740bdd,0xbf78b47b,0xbf731447,0xbf7822d1,0xbf7bf531,0xbf7e868b
.long 0xbf45e403,0xbf4f7a1f,0xbf584853,0xbf604621,0xbf584853,0xbf60a6cf,0xbf6816a8,0xbf6e8ff8
.long 0xbf7fb10f,0xbf7de0b1,0xbf7a7302,0xbf756d97,0xbf7c3b28,0xbf77beb7,0xbf718f57,0xbf69b7e4
.long 0xbf7b14be,0xbf7e1324,0xbf7fb10f,0xbf7fec43,0xbf7f4e6d,0xbf7fffb1,0xbf7f2f9d,0xbf7cdf6c
.long 0xbf5b941a,0xbf4e8d90,0xbf3fc767,0xbf2f61a5,0xbf49d112,0xbf39f2ac,0xbf286605,0xbf1553b7
.long 0xbf74fa0b,0xbf6db293,0xbf64aa59,0xbf59f26a,0xbf6a09a7,0xbf5fe4e9,0xbf53fac3,0xbf466354
.long 0x3f800000,0x3f800000,0x3f800000,0x3f800000,0x3f7dabcc,0x3f7d906e,0x3f7d7474,0x3f7d57de
.long 0x3f76ba07,0x3f764d97,0x3f75dec6,0x3f756d97,0x3f6b4b0c,0x3f6a5ad9,0x3f696591,0x3f686b39
.long 0x3f5b941a,0x3f59f26a,0x3f584853,0x3f5695e5,0x3f47de65,0x3f456439,0x3f42de29,0x3f404c5c
.long 0x3f3085bb,0x3f2d1469,0x3f299415,0x3f26050a,0x3f15f6d9,0x3f11796b,0x3f0cead0,0x3f084b92
.long 0x3ef15aea,0x3ee63375,0x3edae880,0x3ecf7bca,0x3eb263ef,0x3ea5129f,0x3e97a117,0x3e8a11f7
.long 0x3e605c13,0x3e419b37,0x3e22abb6,0x3e039502,0x3dafb680,0x3d55880e,0x3c96c9b6,0xbc7b514b
.long 0xbd48fb30,0xbdafb680,0xbdfab273,0xbe22abb6,0xbe3b6ecf,0xbe636c83,0xbe8586ce,0xbe9920fe
.long 0xbea09ae5,0xbeb554ec,0xbec9b953,0xbeddbe79,0xbee0924f,0xbef58035,0xbf04f484,0xbf0ee0db
.long 0xbf41d870,0xbf4ac77f,0xbf531849,0xbf5ac450,0xbf5695e5,0xbf5e5aa6,0xbf655e0b,0xbf6b99fb
.long 0xbf0e39da,0xbf187fc0,0xbf226799,0xbf2beb4a,0xbf299415,0xbf33587a,0xbf3ca003,0xbf456439
.long 0xbf7c3b28,0xbf7e9bc9,0xbf7fd397,0xbf7fe129,0xbf7fd397,0xbf7fdaaf,0xbf7e9bc9,0xbf7c187a
.long 0xbf676bd8,0xbf6db293,0xbf731447,0xbf778bc5,0xbf740bdd,0xbf788486,0xbf7bf531,0xbf7e5a38
.long 0xbf6ed89e,0xbf66becc,0xbf5d2d53,0xbf5233c6,0xbf604621,0xbf554aa4,0xbf48d8b3,0xbf3b0629
.long 0xbf7ec46d,0xbf7c3b28,0xbf7853f8,0xbf731447,0xbf791298,0xbf73ced9,0xbf6d1c1d,0xbf650479
.long 0xbf1d7fd1,0xbf0a48ad,0xbeebcbbb,0xbec1071e,0xbf00e7e4,0xbed6a399,0xbea986c4,0xbe75c35a
.long 0xbf4d9f02,0xbf3fc767,0xbf3085bb,0xbf1ff6cb,0xbf373a23,0xbf269de3,0xbf14b039,0xbf019573
.long 0xbef15aea,0xbef6e0cb,0xbefc5d27,0xbf00e7e4,0xbf13682a,0xbf16999f,0xbf19c200,0xbf1ce11f
.long 0xbf2beb4a,0xbf2f61a5,0xbf32c8c9,0xbf36206c,0xbf41d870,0xbf456439,0xbf48d8b3,0xbf4c3578
.long 0x80000000,0x80000000,0x80000000,0x80000000,0xbdfab273,0xbe007745,0xbe039502,0xbe06b26e
.long 0xbe78cfcc,0xbe7ee6e1,0xbe827dc0,0xbe8586ce,0xbeb8442a,0xbebca7af,0xbec1071e,0xbec5625c
.long 0xbf7ec46d,0xbf7f84ab,0xbf7fec43,0xbf7ffb11,0xbf7fec43,0xbf7f7808,0xbf7e9bc9,0xbf7d57de
.long 0xbf7d3aac,0xbf7b61fc,0xbf791298,0xbf764d97,0xbf76ba07,0xbf73530e,0xbf6f6830,0xbf6afb8c
.long 0xbf54db31,0xbf584853,0xbf5b941a,0xbf5ebe05,0xbf64aa59,0xbf67c187,0xbf6aab7b,0xbf6d67a1
.long 0xbf710908,0xbf73913f,0xbf75dec6,0xbf77f110,0xbf79c79d,0xbf7b87b2,0xbf7cfe73,0xbf7e2b72
.long 0xbedae880,0xbebb31a0,0xbe9aa086,0xbe72b651,0xbea09ae5,0xbe7bdba4,0xbe354098,0xbddb7d37
.long 0xbf226799,0xbf15f6d9,0xbf08f59b,0xbef6e0cb,0xbf08f59b,0xbef58035,0xbed8106b,0xbeb9bb1e
.long 0xbf4d9f02,0xbf44e3f5,0xbf3b8f3b,0xbf31a81d,0xbf396842,0xbf2ecef7,0xbf239da9,0xbf17de12
.long 0xbf6c835e,0xbf676bd8,0xbf61c598,0xbf5b941a,0xbf5ebe05,0xbf57dc7f,0xbf5064af,0xbf485bca
.long 0x3f039c3d,0x3f173c07,0x3f299415,0x3f3a7ca4,0x3f1d7fd1,0x3f2ff3e6,0x3f40d0da,0x3f4fefa8
.long 0x3e94a031,0x3ebe1d4a,0x3ee63375,0x3f064b82,0x3ecf7bca,0x3ef840c8,0x3f0f8784,0x3f21cbfb
.long 0x3d48fb30,0x3e039502,0x3e541501,0x3e919ddd,0x3e2f10a2,0x3e80f8c0,0x3ea986c4,0x3ed0eb2a
.long 0xbe47c5c2,0xbdfab273,0xbd48fb30,0x3cc90ab0,0xbd96a905,0x3b490fc6,0x3da3308c,0x3e1f917b
.long 0xbf039c3d,0xbf064b82,0xbf08f59b,0xbf0b9a6b,0xbf1ff6cb,0xbf2302d3,0xbf26050a,0xbf28fd41
.long 0xbf396842,0xbf3ca003,0xbf3fc767,0xbf42de29,0xbf4f7a1f,0xbf52a649,0xbf55b993,0xbf58b3a1
.long 0x80000000,0x80000000,0x80000000,0x80000000,0xbe09cf86,0xbe0cec4a,0xbe1008b7,0xbe1324ca
.long 0xbe888e93,0xbe8b9507,0xbe8e9a22,0xbe919ddd,0xbec9b953,0xbece0bea,0xbed25a09,0xbed6a399
.long 0xbf7fb10f,0xbf7f0e58,0xbf7e1324,0xbf7cbfc9,0xbf7baccd,0xbf799b43,0xbf772417,0xbf74484b
.long 0xbf731447,0xbf6f6830,0xbf6b4b0c,0xbf66becc,0xbf660f88,0xbf60a6cf,0xbf5ac450,0xbf546b3b
.long 0xbf61c598,0xbf64aa59,0xbf676bd8,0xbf6a09a7,0xbf6ff573,0xbf725470,0xbf748422,0xbf76841b
.long 0xbf79c79d,0xbf7b61fc,0xbf7cbfc9,0xbf7de0b1,0xbf7f0e58,0xbf7fa6e3,0xbf7ff4e6,0xbf7ff84a
.long 0xbe2f10a2,0xbdd53db9,0xbd16c32c,0x3cfb49ba,0xbd16c32c,0x3d0a342f,0x3dd53db9,0x3e3228d4
.long 0xbedae880,0xbebe1d4a,0xbea09ae5,0xbe827dc0,0xbe9aa086,0xbe75c35a,0xbe354098,0xbde7fa9a
.long 0xbf273656,0xbf1c420c,0xbf10d3cd,0xbf04f484,0xbf0b9a6b,0xbefdbabb,0xbee363fa,0xbec8477c
.long 0xbf54db31,0xbf4d9f02,0xbf45e403,0xbf3daef9,0xbf3fc767,0xbf36ad7f,0xbf2d1469,0xbf2302d3
.long 0x3f49d112,0x3f577026,0x3f633c5a,0x3f6d1c1d,0x3f5d2d53,0x3f686b39,0x3f718f57,0x3f788486
.long 0x3f187fc0,0x3f299415,0x3f396842,0x3f47de65,0x3f32c8c9,0x3f425b89,0x3f5064af,0x3f5cc7d1
.long 0x3eb8442a,0x3eddbe79,0x3f00e7e4,0x3f121eb0,0x3ef6e0cb,0x3f0d9281,0x3f1ebc12,0x3f2ecef7
.long 0x3dc8bd36,0x3e2f10a2,0x3e78cfcc,0x3ea09ae5,0x3e6c9a7f,0x3e9c1faf,0x3ec1071e,0x3ee4cbfe
.long 0x3f800000,0x3f800000,0x3f800000,0x3f800000,0x3f7d3aac,0x3f7d1cdd,0x3f7cfe73,0x3f7cdf6c
.long 0x3f74fa0b,0x3f748422,0x3f740bdd,0x3f73913f,0x3f676bd8,0x3f666771,0x3f655e0b,0x3f644fac
.long 0x3f54db31,0x3f531849,0x3f514d3d,0x3f4f7a1f,0x3f3daef9,0x3f3b0629,0x3f385216,0x3f3592e7
.long 0x3f226799,0x3f1ebc12,0x3f1b02c6,0x3f173c07,0x3f039c3d,0x3efdbabb,0x3ef41f07,0x3eea6681
.long 0x3ec3ef15,0x3eb8442a,0x3eac7cd4,0x3ea09ae5,0x3e78cfcc,0x3e5d4b1a,0x3e419b37,0x3e25c58c
.long 0x3dc8bd36,0x3d8a200a,0x3d16c32c,0x3bc90f88,0xbd48fb30,0xbda973ba,0xbdee3876,0xbe195be0
.long 0xbe47c5c2,0xbe6c9a7f,0xbe888e93,0xbe9aa086,0xbeac7cd4,0xbebf926f,0xbed25a09,0xbee4cbfe
.long 0xbef15aea,0xbf0242b1,0xbf0b9a6b,0xbf14b039,0xbf187fc0,0xbf21cbfb,0xbf2ac082,0xbf33587a
.long 0xbf61c598,0xbf6816a8,0xbf6db293,0xbf7294f8,0xbf710908,0xbf75a67b,0xbf796e4e,0xbf7c5d3a
.long 0xbf3504f3,0xbf3daef9,0xbf45e403,0xbf4d9f02,0xbf4d9f02,0xbf554aa4,0xbf5c61c7,0xbf62df7b
.long 0xbf7ec46d,0xbf7c7eb0,0xbf791298,0xbf748422,0xbf7853f8,0xbf73530e,0xbf6d1c1d,0xbf65b710
.long 0xbf7b14be,0xbf7dabcc,0xbf7f4e6d,0xbf7ffb11,0xbf7fb10f,0xbf7ff84a,0xbf7f2f9d,0xbf7d57de
.long 0xbf45e403,0xbf385216,0xbf299415,0xbf19c200,0xbf2beb4a,0xbf1ba299,0xbf0a48ad,0xbeeff7fb
.long 0xbf6c835e,0xbf64aa59,0xbf5b941a,0xbf514d3d,0xbf5b941a,0xbf50d937,0xbf44e3f5,0xbf37c655
.long 0xbe94a031,0xbe4dee60,0xbde1bc2e,0xbc96c9b6,0xbe164083,0xbd55880e,0x3d2fe007,0x3e0cec4a
.long 0xbf0e39da,0xbef6e0cb,0xbecf7bca,0xbea68f12,0xbedae880,0xbeb0eacb,0xbe8586ce,0xbe3228d4
.long 0x3f800000,0x3f800000,0x3f800000,0x3f800000,0x3f7cbfc9,0x3f7c9f8a,0x3f7c7eb0,0x3f7c5d3a
.long 0x3f731447,0x3f7294f8,0x3f721352,0x3f718f57,0x3f633c5a,0x3f62241a,0x3f6106f2,0x3f5fe4e9
.long 0x3f4d9f02,0x3f4bbbf8,0x3f49d112,0x3f47de65,0x3f32c8c9,0x3f2ff3e6,0x3f2d1469,0x3f2a2a80
.long 0x3f13682a,0x3f0f8784,0x3f0b9a6b,0x3f07a136,0x3ee0924f,0x3ed6a399,0x3ecc9b8b,0x3ec27b55
.long 0x3e94a031,0x3e888e93,0x3e78cfcc,0x3e605c13,0x3e09cf86,0x3ddb7d37,0x3da3308c,0x3d55880e
.long 0xbcc90ab0,0xbd621469,0xbdafb680,0xbdee3876,0xbe3b6ecf,0xbe5d4b1a,0xbe7ee6e1,0xbe901c2c
.long 0xbeac7cd4,0xbebe1d4a,0xbecf7bca,0xbee0924f,0xbef6e0cb,0xbf044889,0xbf0cead0,0xbf1553b7
.long 0xbf1d7fd1,0xbf26050a,0xbf2e3bde,0xbf36206c,0xbf3b8f3b,0xbf436051,0xbf4ac77f,0xbf51c0c2
.long 0xbf76ba07,0xbf7a1e84,0xbf7cbfc9,0xbf7e9bc9,0xbf7e70b0,0xbf7fa6e3,0xbf7ffec4,0xbf7f7808
.long 0xbf54db31,0xbf5b941a,0xbf61c598,0xbf676bd8,0xbf68bf3c,0xbf6dfcf2,0xbf7294f8,0xbf76841b
.long 0xbf6ed89e,0xbf6816a8,0xbf604621,0xbf577026,0xbf5d2d53,0xbf5389c7,0xbf48d8b3,0xbf3d27b8
.long 0xbf7fb10f,0xbf7e70b0,0xbf7c3b28,0xbf791298,0xbf7a7302,0xbf76841b,0xbf718f57,0xbf6b99fb
.long 0xbf08f59b,0xbeee9479,0xbec9b953,0xbea395c5,0xbec9b953,0xbea21887,0xbe72b651,0xbe1f917b
.long 0xbf45e403,0xbf396842,0xbf2beb4a,0xbf1d7fd1,0xbf299415,0xbf1a6293,0xbf0a48ad,0xbef2bd43
.long 0x3d96a905,0x3e28defc,0x3e827dc0,0x3eaf713a,0x3e6c9a7f,0x3ea5129f,0x3ed25a09,0x3efdbabb
.long 0xbe78cfcc,0xbe22abb6,0xbd96a905,0x3c490e90,0xbdafb680,0x3b490fc6,0x3dbc3ac3,0x3e3857ec
.long 0xbf0e39da,0xbf10d3cd,0xbf13682a,0xbf15f6d9,0xbf2beb4a,0xbf2ecef7,0xbf31a81d,0xbf34768f
.long 0xbf45e403,0xbf48d8b3,0xbf4bbbf8,0xbf4e8d90,0xbf5b941a,0xbf5e5aa6,0xbf6106f2,0xbf6398ac
.long 0x80000000,0x80000000,0x80000000,0x80000000,0xbe164083,0xbe195be0,0xbe1c76de,0xbe1f917b
.long 0xbe94a031,0xbe97a117,0xbe9aa086,0xbe9d9e78,0xbedae880,0xbedf28a9,0xbee363fa,0xbee79a5d
.long 0xbf7b14be,0xbf791298,0xbf76ba07,0xbf740bdd,0xbf710908,0xbf6d67a1,0xbf696591,0xbf650479
.long 0xbf61c598,0xbf5c61c7,0xbf5695e5,0xbf5064af,0xbf4d9f02,0xbf466354,0xbf3ebc1b,0xbf36ad7f
.long 0xbf6c835e,0xbf6ed89e,0xbf710908,0xbf731447,0xbf7853f8,0xbf79f35e,0xbf7b61fc,0xbf7c9f8a
.long 0xbf7ec46d,0xbf7f6ac7,0xbf7fd397,0xbf7ffec4,0xbf7fb10f,0xbf7f1f49,0xbf7e4323,0xbf7d1cdd
.long 0x3dc8bd36,0x3e28defc,0x3e6c9a7f,0x3e97a117,0x3e78cfcc,0x3e9f1cdf,0x3ec1071e,0x3ee1fb6a
.long 0xbe47c5c2,0xbe09cf86,0xbd96a905,0xbc490e90,0xbd48fb30,0x3c7b514b,0x3da3308c,0x3e1324ca
.long 0xbef15aea,0xbed8106b,0xbebe1d4a,0xbea395c5,0xbeac7cd4,0xbe901c2c,0xbe667c66,0xbe2bf804
.long 0xbf3504f3,0xbf2beb4a,0xbf226799,0xbf187fc0,0xbf187fc0,0xbf0d9281,0xbf0242b1,0xbeed3063
.long 0x3f74fa0b,0x3f7ac516,0x3f7e70b0,0x3f7ff4e6,0x3f7d3aac,0x3f7fa6e3,0x3f7fc38f,0x3f7d906e
.long 0x3f54db31,0x3f604621,0x3f6a09a7,0x3f721352,0x3f676bd8,0x3f703b37,0x3f772417,0x3f7c187a
.long 0x3f226799,0x3f31a81d,0x3f3fc767,0x3f4cae79,0x3f3daef9,0x3f4b41fa,0x3f577026,0x3f62241a
.long 0x3ec3ef15,0x3ee63375,0x3f039c3d,0x3f13682a,0x3f039c3d,0x3f140c5f,0x3f239da9,0x3f3238aa
.long 0xbf187fc0,0xbf1b02c6,0xbf1d7fd1,0xbf1ff6cb,0xbf373a23,0xbf39f2ac,0xbf3ca003,0xbf3f41fc
.long 0xbf514d3d,0xbf53fac3,0xbf5695e5,0xbf591e6a,0xbf660f88,0xbf686b39,0xbf6aab7b,0xbf6cd007
.long 0x80000000,0x80000000,0x80000000,0x80000000,0xbe22abb6,0xbe25c58c,0xbe28defc,0xbe2bf804
.long 0xbea09ae5,0xbea395c5,0xbea68f12,0xbea986c4,0xbeebcbbb,0xbeeff7fb,0xbef41f07,0xbef840c8
.long 0xbf710908,0xbf6db293,0xbf6a09a7,0xbf660f88,0xbf604621,0xbf5b2c79,0xbf55b993,0xbf4fefa8
.long 0xbf49d112,0xbf42de29,0xbf3b8f3b,0xbf33e7bc,0xbf2e3bde,0xbf256bcb,0xbf1c420c,0xbf12c39a
.long 0xbf74fa0b,0xbf76ba07,0xbf7853f8,0xbf79c79d,0xbf7dabcc,0xbf7e868b,0xbf7f2f9d,0xbf7fa6e3
.long 0xbf7fec43,0xbf7f9c18,0xbf7f0e58,0xbf7e4323,0xbf7baccd,0xbf79f35e,0xbf77f110,0xbf75a67b
.long 0x3eb8442a,0x3ed8106b,0x3ef6e0cb,0x3f0a48ad,0x3f00e7e4,0x3f102dd5,0x3f1ebc12,0x3f2c800f
.long 0x3d48fb30,0x3de1bc2e,0x3e2f10a2,0x3e6c9a7f,0x3e541501,0x3e8a11f7,0x3ea986c4,0x3ec8477c
.long 0xbe888e93,0xbe5a3997,0xbe22abb6,0xbdd53db9,0xbde1bc2e,0xbd55880e,0x3bc90f88,0x3d83db0a
.long 0xbf0e39da,0xbf039c3d,0xbef15aea,0xbedae880,0xbed53641,0xbebca7af,0xbea395c5,0xbe8a11f7
.long 0x3f7f4e6d,0x3f7c7eb0,0x3f778bc5,0x3f708066,0x3f791298,0x3f725470,0x3f696591,0x3f5e5aa6
.long 0x3f7853f8,0x3f7cbfc9,0x3f7f4e6d,0x3f7ffb11,0x3f7f0e58,0x3f7fffb1,0x3f7eea9d,0x3f7bd14d
.long 0x3f584853,0x3f628210,0x3f6b4b0c,0x3f7294f8,0x3f6b4b0c,0x3f72d4eb,0x3f78b47b,0x3f7cdf6c
.long 0x3f226799,0x3f3085bb,0x3f3daef9,0x3f49d112,0x3f3fc767,0x3f4c3578,0x3f577026,0x3f61668a
.long 0x3f800000,0x3f800000,0x3f800000,0x3f800000,0x3f7c3b28,0x3f7c187a,0x3f7bf531,0x3f7bd14d
.long 0x3f710908,0x3f708066,0x3f6ff573,0x3f6f6830,0x3f5ebe05,0x3f5d924d,0x3f5c61c7,0x3f5b2c79
.long 0x3f45e403,0x3f43e200,0x3f41d870,0x3f3fc767,0x3f273656,0x3f24381a,0x3f212ff9,0x3f1e1e22
.long 0x3f039c3d,0x3eff17b2,0x3ef6e0cb,0x3eee9479,0x3eb8442a,0x3eadf73c,0x3ea395c5,0x3e9920fe
.long 0x3e47c5c2,0x3e2f10a2,0x3e164083,0x3dfab273,0x3cc90ab0,0xbb490fc6,0xbcfb49ba,0xbd6ea038
.long 0xbe164083,0xbe354098,0xbe541501,0xbe72b651,0xbea09ae5,0xbeb0eacb,0xbec1071e,0xbed0eb2a
.long 0xbef15aea,0xbf00e7e4,0xbf08f59b,0xbf10d3cd,0xbf1d7fd1,0xbf256bcb,0xbf2d1469,0xbf34768f
.long 0xbf3daef9,0xbf44e3f5,0xbf4bbbf8,0xbf5233c6,0xbf584853,0xbf5e5aa6,0xbf63f473,0xbf6912ae
.long 0xbf7fb10f,0xbf7ffec4,0xbf7f84ab,0xbf7e4323,0xbf7e1324,0xbf7bd14d,0xbf78b47b,0xbf74bf62
.long 0xbf6c835e,0xbf710908,0xbf74fa0b,0xbf7853f8,0xbf79c79d,0xbf7c5d3a,0xbf7e4323,0xbf7f7808
.long 0xbf4d9f02,0xbf42de29,0xbf373a23,0xbf2ac082,0xbf3085bb,0xbf2302d3,0xbf14b039,0xbf05a02c
.long 0xbf74fa0b,0xbf6ff573,0xbf6a09a7,0xbf633c5a,0xbf64aa59,0xbf5cc7d1,0xbf53fac3,0xbf4a4c87
.long 0xbe78cfcc,0xbe28defc,0xbdafb680,0xbbc90f88,0xbd96a905,0x3c16cb58,0x3dbc3ac3,0x3e3228d4
.long 0xbf0e39da,0xbefc5d27,0xbedae880,0xbeb8442a,0xbecf7bca,0xbeab0201,0xbe8586ce,0xbe3e853e
.long 0x3edae880,0x3f0242b1,0x3f15f6d9,0x3f286605,0x3f13682a,0x3f269de3,0x3f385216,0x3f485bca
.long 0x3dc8bd36,0x3e3b6ecf,0x3e888e93,0x3eb263ef,0x3e888e93,0x3eb3dca5,0x3eddbe79,0x3f02ef9f
.long 0x3f800000,0x3f800000,0x3f800000,0x3f800000,0x3f7baccd,0x3f7b87b2,0x3f7b61fc,0x3f7b3bab
.long 0x3f6ed89e,0x3f6e46be,0x3f6db293,0x3f6d1c1d,0x3f59f26a,0x3f58b3a1,0x3f577026,0x3f5627fe
.long 0x3f3daef9,0x3f3b8f3b,0x3f396842,0x3f373a23,0x3f1b02c6,0x3f17de12,0x3f14b039,0x3f11796b
.long 0x3ee63375,0x3eddbe79,0x3ed53641,0x3ecc9b8b,0x3e8e9a22,0x3e840270,0x3e72b651,0x3e5d4b1a
.long 0x3dc8bd36,0x3d96a905,0x3d48fb30,0x3cc90ab0,0xbdafb680,0xbde7fa9a,0xbe1008b7,0xbe2bf804
.long 0xbe888e93,0xbe97a117,0xbea68f12,0xbeb554ec,0xbee0924f,0xbeeff7fb,0xbeff17b2,0xbf06f686
.long 0xbf187fc0,0xbf1ff6cb,0xbf273656,0xbf2e3bde,0xbf3b8f3b,0xbf425b89,0xbf48d8b3,0xbf4f0417
.long 0xbf584853,0xbf5df6be,0xbf633c5a,0xbf6816a8,0xbf6db293,0xbf71d19f,0xbf756d97,0xbf788486
.long 0xbf7c3b28,0xbf796e4e,0xbf75dec6,0xbf718f57,0xbf6ff573,0xbf6a5ad9,0xbf63f473,0xbf5cc7d1
.long 0xbf7b14be,0xbf7d3aac,0xbf7ec46d,0xbf7fb10f,0xbf7ffb11,0xbf7fcbe2,0xbf7eea9d,0xbf7d57de
.long 0xbf1d7fd1,0xbf0f8784,0xbf00e7e4,0xbee363fa,0xbeebcbbb,0xbecb2aae,0xbea986c4,0xbe870ada
.long 0xbf5b941a,0xbf531849,0xbf49d112,0xbf3fc767,0xbf3fc767,0xbf34768f,0xbf286605,0xbf1ba299
.long 0x3d96a905,0x3e1c76de,0x3e6c9a7f,0x3e9d9e78,0x3e827dc0,0x3eab0201,0x3ed25a09,0x3ef840c8
.long 0xbe94a031,0xbe605c13,0xbe164083,0xbd96a905,0xbde1bc2e,0xbd0a342f,0x3d2fe007,0x3df475c0
.long 0x3f396842,0x3f48d8b3,0x3f5695e5,0x3f628210,0x3f5695e5,0x3f62df7b,0x3f6d1c1d,0x3f75341d
.long 0x3edae880,0x3f00e7e4,0x3f13682a,0x3f24d225,0x3f15f6d9,0x3f27ce61,0x3f385216,0x3f476085
.long 0xbf226799,0xbf24d225,0xbf273656,0xbf299415,0xbf41d870,0xbf446337,0xbf46e22a,0xbf495521
.long 0xbf5b941a,0xbf5df6be,0xbf604621,0xbf628210,0xbf6ed89e,0xbf70c501,0xbf7294f8,0xbf74484b
.long 0x80000000,0x80000000,0x80000000,0x80000000,0xbe2f10a2,0xbe3228d4,0xbe354098,0xbe3857ec
.long 0xbeac7cd4,0xbeaf713a,0xbeb263ef,0xbeb554ec,0xbefc5d27,0xbf003a06,0xbf0242b1,0xbf044889
.long 0xbf61c598,0xbf5d2d53,0xbf584853,0xbf531849,0xbf49d112,0xbf436051,0xbf3ca003,0xbf3592e7
.long 0xbf2beb4a,0xbf239da9,0xbf1b02c6,0xbf121eb0,0xbf08f59b,0xbefdbabb,0xbee900b7,0xbed3c867
.long 0xbf7b14be,0xbf7c3b28,0xbf7d3aac,0xbf7e1324,0xbf7fec43,0xbf7fffb1,0xbf7fe129,0xbf7f90b1
.long 0xbf7d3aac,0xbf7bf531,0xbf7a7302,0xbf78b47b,0xbf731447,0xbf703b37,0xbf6d1c1d,0xbf69b7e4
.long 0x3f187fc0,0x3f26050a,0x3f32c8c9,0x3f3ebc1b,0x3f396842,0x3f456439,0x3f5064af,0x3f5a5ba0
.long 0x3e94a031,0x3eb263ef,0x3ecf7bca,0x3eebcbbb,0x3ee63375,0x3f019573,0x3f0f8784,0x3f1ce11f
.long 0xbd48fb30,0x3bc90f88,0x3d7b2b74,0x3dee3876,0x3dfab273,0x3e3857ec,0x3e72b651,0x3e9620d2
.long 0xbec3ef15,0xbeac7cd4,0xbe94a031,0xbe78cfcc,0xbe605c13,0xbe2bf804,0xbdee3876,0xbd83db0a
.long 0x3f676bd8,0x3f5c61c7,0x3f4f7a1f,0x3f40d0da,0x3f514d3d,0x3f425b89,0x3f31a81d,0x3f1f599f
.long 0x3f7ec46d,0x3f7baccd,0x3f76ba07,0x3f6ff573,0x3f76ba07,0x3f6faf1b,0x3f66becc,0x3f5bfb34
.long 0x3f7853f8,0x3f7c7eb0,0x3f7f0e58,0x3f7ffec4,0x3f7f4e6d,0x3f7ffd39,0x3f7eea9d,0x3f7c187a
.long 0x3f54db31,0x3f5ebe05,0x3f676bd8,0x3f6ed89e,0x3f6a09a7,0x3f714c7a,0x3f772417,0x3f7b87b2
.long 0xbf2beb4a,0xbf2e3bde,0xbf3085bb,0xbf32c8c9,0xbf4bbbf8,0xbf4e1689,0xbf5064af,0xbf52a649
.long 0xbf64aa59,0xbf66becc,0xbf68bf3c,0xbf6aab7b,0xbf75dec6,0xbf77583a,0xbf78b47b,0xbf79f35e
.long 0x80000000,0x80000000,0x80000000,0x80000000,0xbe3b6ecf,0xbe3e853e,0xbe419b37,0xbe44b0b9
.long 0xbeb8442a,0xbebb31a0,0xbebe1d4a,0xbec1071e,0xbf064b82,0xbf084b92,0xbf0a48ad,0xbf0c42c9
.long 0xbf4d9f02,0xbf47de65,0xbf41d870,0xbf3b8f3b,0xbf2e3bde,0xbf269de3,0xbf1ebc12,0xbf16999f
.long 0xbf08f59b,0xbeff17b2,0xbeebcbbb,0xbed8106b,0xbebe1d4a,0xbea80b1f,0xbe919ddd,0xbe75c35a
.long 0xbf7ec46d,0xbf7f4e6d,0xbf7fb10f,0xbf7fec43,0xbf7f0e58,0xbf7e5a38,0xbf7d7474,0xbf7c5d3a
.long 0xbf76ba07,0xbf748422,0xbf721352,0xbf6f6830,0xbf660f88,0xbf62241a,0xbf5df6be,0xbf5988ad
.long 0x3f49d112,0x3f53fac3,0x3f5d2d53,0x3f655e0b,0x3f633c5a,0x3f6afb8c,0x3f718f57,0x3f76ef5b
.long 0x3f039c3d,0x3f10d3cd,0x3f1d7fd1,0x3f299415,0x3f299415,0x3f3592e7,0x3f40d0da,0x3f4b41fa
.long 0x3e2f10a2,0x3e667c66,0x3e8e9a22,0x3ea986c4,0x3eb263ef,0x3ece0bea,0x3ee900b7,0x3f019573
.long 0xbe47c5c2,0xbe164083,0xbdc8bd36,0xbd48fb30,0xbc490e90,0x3d2351cb,0x3dbc3ac3,0x3e1324ca
.long 0x3f3085bb,0x3f1ebc12,0x3f0b9a6b,0x3eee9479,0x3f0b9a6b,0x3eed3063,0x3ec1071e,0x3e931f35
.long 0x3f676bd8,0x3f5d2d53,0x3f514d3d,0x3f43e200,0x3f4f7a1f,0x3f4154e1,0x3f31a81d,0x3f209393
.long 0x3f7f4e6d,0x3f7cfe73,0x3f791298,0x3f73913f,0x3f778bc5,0x3f714c7a,0x3f696591,0x3f5fe4e9
.long 0x3f74fa0b,0x3f79c79d,0x3f7d3aac,0x3f7f4e6d,0x3f7e70b0,0x3f7fdaaf,0x3f7fc38f,0x3f7e2b72
.long 0x35638e39,0x35638e39,0x35638e39,0x35638e39,0x35638e39,0x35638df3,0x35638d20,0x35638bc1
.long 0x35638e39,0x35638d20,0x356389d6,0x3563845a,0x35638e39,0x35638bc1,0x3563845a,0x35637804
.long 0x35638e39,0x356389d6,0x35637cad,0x356366c0,0x35638e39,0x3563875e,0x356372cf,0x3563508c
.long 0x35638e39,0x3563845a,0x356366c0,0x3563356b,0x35638e39,0x356380ca,0x3563587f,0x3563155d
.long 0x35638e39,0x35637cad,0x3563480d,0x3562f061,0x35638e39,0x35637804,0x3563356b,0x3562c67a
.long 0x35638e39,0x356372cf,0x35632098,0x356297a8,0x35638e39,0x35636d0d,0x35630995,0x356263ec
.long 0x35638e39,0x356366c0,0x3562f061,0x35622b47,0x35638e39,0x35635fe5,0x3562d4fe,0x3561edbb
.long 0x35638e39,0x3563587f,0x3562b76b,0x3561ab48,0x35638e39,0x3563508c,0x356297a8,0x356163f0
.long 0x35638e39,0x3563356b,0x35622b47,0x3560709c,0x35638e39,0x35632b48,0x356202ca,0x356015c2
.long 0x35638e39,0x3563480d,0x356275b6,0x356117b5,0x35638e39,0x35633f02,0x35625196,0x3560c699
.long 0x35638e39,0x35630995,0x35617c43,0x355ee813,0x35638e39,0x3562fd41,0x35614b12,0x355e79d6
.long 0x35638e39,0x35632098,0x3561d820,0x355fb60c,0x35638e39,0x3563155d,0x3561ab48,0x355f517b
.long 0x35638e39,0x3562d4fe,0x3560aa7a,0x355d1234,0x35638e39,0x3562c67a,0x3560709c,0x355c90b9
.long 0x35638e39,0x3562f061,0x356117b5,0x355e06c5,0x35638e39,0x3562e2f5,0x3560e22d,0x355d8ee3
.long 0x35638e39,0x356297a8,0x355fb60c,0x355aefa2,0x35638e39,0x356286f5,0x355f738b,0x355a5b18
.long 0x35638e39,0x3562b76b,0x35603495,0x355c0a76,0x35638e39,0x3562a7cf,0x355ff665,0x355b7f6e
.long 0x35638e39,0x35638e39,0x35638e39,0x35638e39,0x356389d6,0x3563875e,0x3563845a,0x356380ca
.long 0x35637cad,0x356372cf,0x356366c0,0x3563587f,0x356366c0,0x3563508c,0x3563356b,0x3563155d
.long 0x3563480d,0x35632098,0x3562f061,0x3562b76b,0x35632098,0x3562e2f5,0x356297a8,0x35623eb4
.long 0x3562f061,0x356297a8,0x35622b47,0x3561ab48,0x3562b76b,0x35623eb4,0x3561ab48,0x3560fd37
.long 0x356275b6,0x3561d820,0x356117b5,0x35603495,0x35622b47,0x356163f0,0x3560709c,0x355f517b
.long 0x3561d820,0x3560e22d,0x355fb60c,0x355e5404,0x35617c43,0x356052de,0x355ee813,0x355d3c4c
.long 0x356117b5,0x355fb60c,0x355e06c5,0x355c0a76,0x3560aa7a,0x355f0bbf,0x355d1234,0x355abea6
.long 0x35603495,0x355e5404,0x355c0a76,0x35595902,0x355fb60c,0x355d8ee3,0x355aefa2,0x3557d9b4
.long 0x355e06c5,0x355aefa2,0x35572d9f,0x3552c3a8,0x355d65dc,0x3559f56f,0x3555c777,0x3550df99
.long 0x355f2ee2,0x355cbc6b,0x3559c1d1,0x355640eb,0x355e9f1e,0x355bdca6,0x3558811b,0x35548ed6
.long 0x355b5006,0x3556b84e,0x35512643,0x354aa066,0x355a8d22,0x355589f8,0x354f76ba,0x35485b26
.long 0x355cbc6b,0x3558ee1a,0x35544ec5,0x354ee2e0,0x355c0a76,0x3557d9b4,0x3552c3a8,0x354ccdba
.long 0x35581207,0x3551b215,0x3549fcc1,0x3540fe97,0x35572d9f,0x355050c1,0x3548062c,0x353e5c70
.long 0x3559c1d1,0x35544ec5,0x354db531,0x3545fe3e,0x3558ee1a,0x355306c8,0x354be1d1,0x354389f6
.long 0x35544ec5,0x354be1d1,0x3541bb09,0x3535f06c,0x35534966,0x354a4ed2,0x353f8021,0x3532f656
.long 0x355640eb,0x354ee2e0,0x3545fe3e,0x353ba3cf,0x35554bf5,0x354d6888,0x3543e522,0x3538d507
.long 0x0,0x3232b79c,0x32b2b42a,0x330602d1,0x0,0x325f64b5,0x32df5dfa,0x33277e13
.long 0x0,0x328608a2,0x330602d1,0x3348f5b2,0x0,0x329c5e96,0x331c555b,0x336a68f6
.long 0x0,0x0,0x0,0x0,0x0,0x3132b8b0,0x31b2b879,0x32060a16
.long 0x0,0x31b2b879,0x3232b79c,0x328608a2,0x0,0x32060a16,0x328608a2,0x32c90950
.long 0x0,0x330602d1,0x3385eb92,0x33c8a746,0x0,0x33112c43,0x33910eb5,0x33d94c39
.long 0x0,0x331c555b,0x339c3072,0x33e9ec76,0x0,0x33277e13,0x33a750ae,0x33fa87a0
.long 0x0,0x32b2b42a,0x3332a663,0x3385eb92,0x0,0x32c90950,0x3348f5b2,0x33969fc2
.long 0x0,0x32df5dfa,0x335f4312,0x33a750ae,0x0,0x32f5b21a,0x33758e4a,0x33b7fdf8
.long 0x0,0x33758e4a,0x33f4ff28,0x34370cc7,0x0,0x33805983,0x340007bf,0x343f3f9b
.long 0x0,0x335f4312,0x33ded782,0x34269b63,0x0,0x336a68f6,0x33e9ec76,0x342ed5fa
.long 0x0,0x3348f5b2,0x33c8a746,0x34161b8b,0x0,0x33541ca3,0x33d3c069,0x341e5d2e
.long 0x0,0x3332a663,0x33b26f4c,0x34058eae,0x0,0x333dce45,0x33bd8c33,0x340dd6a6
.long 0x0,0x33a750ae,0x34269b63,0x34782561,0x0,0x33ace032,0x342c1831,0x3480190b
.long 0x0,0x339c3072,0x341b9d02,0x3467fc01,0x0,0x33a1c0c2,0x34211cf9,0x3470134b
.long 0x0,0x33910eb5,0x341098a1,0x3457be81,0x0,0x33969fc2,0x34161b8b,0x345fdfae
.long 0x0,0x3385eb92,0x34058eae,0x34476e4a,0x0,0x338b7d4f,0x340b1453,0x344f98a6
.long 0x3332a663,0x335f4312,0x3385eb92,0x339c3072,0x335f4312,0x338b7d4f,0x33a750ae,0x33c319f8
.long 0x3385eb92,0x33a750ae,0x33c8a746,0x33e9ec76,0x339c3072,0x33c319f8,0x33e9ec76,0x340851aa
.long 0x0,0x0,0x0,0x0,0x3232b79c,0x325f64b5,0x328608a2,0x329c5e96
.long 0x32b2b42a,0x32df5dfa,0x330602d1,0x331c555b,0x330602d1,0x33277e13,0x3348f5b2,0x336a68f6
.long 0x34058eae,0x34269b63,0x34476e4a,0x3467fc01,0x341098a1,0x34345046,0x3457be81,0x347ad4e3
.long 0x341b9d02,0x3441fa4e,0x3467fc01,0x3486c814,0x34269b63,0x344f98a6,0x34782561,0x349015cd
.long 0x33b26f4c,0x33ded782,0x34058eae,0x341b9d02,0x33c8a746,0x33fa87a0,0x34161b8b,0x342ed5fa
.long 0x33ded782,0x340b1453,0x34269b63,0x3441fa4e,0x33f4ff28,0x3418dc76,0x34370cc7,0x345507bb
.long 0x3472c494,0x3496b0ae,0x34b34f66,0x34cf1d15,0x347d83cb,0x349d427b,0x34bafab3,0x34d7c4ae
.long 0x345d2a7c,0x3489723e,0x34a3cad0,0x34bd858f,0x3467fc01,0x349015cd,0x34ab948c,0x34c65d08
.long 0x34476e4a,0x34782561,0x34940d65,0x34ab948c,0x34525071,0x3482c668,0x349bf2de,0x34b497b7
.long 0x34319357,0x345d2a7c,0x34841c9e,0x34995283,0x343c8473,0x346aaf00,0x348c1b15,0x34a27d1f
.long 0x34a3cad0,0x34ca1ffb,0x34eebf21,0x3508ac72,0x34a8fd97,0x34d05b1e,0x34f5d68a,0x350c8c90
.long 0x34995283,0x34bd858f,0x34e052cd,0x3500bc44,0x349e91b8,0x34c3d8ab,0x34e79302,0x3504bc31
.long 0x348ec292,0x34b0bd7a,0x34d198a6,0x34f11e99,0x34940d65,0x34b72709,0x34d8ff23,0x34f95a49
.long 0x34841c9e,0x34a3cad0,0x34c295c7,0x34e052cd,0x3489723e,0x34aa4946,0x34ca1ffb,0x34e8c671
.long 0x35638e39,0x35638e39,0x35638e39,0x35638e39,0x35637cad,0x35637804,0x356372cf,0x35636d0d
.long 0x3563480d,0x3563356b,0x35632098,0x35630995,0x3562f061,0x3562c67a,0x356297a8,0x356263ec
.long 0x356275b6,0x35622b47,0x3561d820,0x35617c43,0x3561d820,0x356163f0,0x3560e22d,0x356052de
.long 0x356117b5,0x3560709c,0x355fb60c,0x355ee813,0x35603495,0x355f517b,0x355e5404,0x355d3c4c
.long 0x355f2ee2,0x355e06c5,0x355cbc6b,0x355b5006,0x355e06c5,0x355c90b9,0x355aefa2,0x355923d1
.long 0x355cbc6b,0x355aefa2,0x3558ee1a,0x3556b84e,0x355b5006,0x355923d1,0x3556b84e,0x35540e31
.long 0x3559c1d1,0x35572d9f,0x35544ec5,0x35512643,0x35581207,0x35550d6e,0x3551b215,0x354e015c
.long 0x355640eb,0x3552c3a8,0x354ee2e0,0x354aa066,0x35544ec5,0x355050c1,0x354be1d1,0x3547045d
.long 0x354db531,0x3548062c,0x3541bb09,0x353ad8b0,0x354b4216,0x3544f3d3,0x353dfa4a,0x35365b8c
.long 0x35523be2,0x354db531,0x3548afa3,0x35432e50,0x35500894,0x354af17d,0x35454d1b,0x353f1f5c
.long 0x35432e50,0x353ad8b0,0x3531a93d,0x3527aaad,0x3540404a,0x35373079,0x352d3741,0x35226155
.long 0x3548afa3,0x3541bb09,0x353a0bc4,0x3531a93d,0x3545fe3e,0x353e5c70,0x3535f06c,0x352cc324
.long 0x3536c63b,0x352b6450,0x351eeb5d,0x35116fb3,0x35336482,0x352731a4,0x3519d941,0x350b72c6
.long 0x353d349e,0x35336482,0x35289b88,0x351ce8a6,0x353a0bc4,0x352f7588,0x3523d730,0x35174239
.long 0x35289b88,0x3519d941,0x3509c993,0x34f11e99,0x3524ce73,0x3515293a,0x35042ade,0x34e3f560
.long 0x352fe71f,0x3522de58,0x3514a213,0x35054d33,0x352c4e9d,0x351e6b42,0x350f4716,0x34fe0186
.long 0x35638e39,0x35638e39,0x35638e39,0x35638e39,0x356366c0,0x35635fe5,0x3563587f,0x3563508c
.long 0x3562f061,0x3562d4fe,0x3562b76b,0x356297a8,0x35622b47,0x3561edbb,0x3561ab48,0x356163f0
.long 0x356117b5,0x3560aa7a,0x35603495,0x355fb60c,0x355fb60c,0x355f0bbf,0x355e5404,0x355d8ee3
.long 0x355e06c5,0x355d1234,0x355c0a76,0x355aefa2,0x355c0a76,0x355abea6,0x35595902,0x3557d9b4
.long 0x3559c1d1,0x35581207,0x355640eb,0x35544ec5,0x35572d9f,0x35550d6e,0x3552c3a8,0x355050c1
.long 0x35544ec5,0x3551b215,0x354ee2e0,0x354be1d1,0x35512643,0x354e015c,0x354aa066,0x3547045d
.long 0x354db531,0x3549fcc1,0x3545fe3e,0x3541bb09,0x3549fcc1,0x3545a5e9,0x3540fe97,0x353c08b1
.long 0x3545fe3e,0x3540fe97,0x353ba3cf,0x3535f06c,0x3541bb09,0x353c08b1,0x3535f06c,0x352f7588
.long 0x35336482,0x352b6450,0x3522de58,0x3519d941,0x352e1e39,0x3525497d,0x351be504,0x3511f8fa
.long 0x353d349e,0x3536c63b,0x352fe71f,0x35289b88,0x35386c8e,0x3531395a,0x35298ac3,0x35216623
.long 0x351ce8a6,0x35116fb3,0x35054d33,0x34f11e99,0x3516bc84,0x350a57a4,0x34fa8501,0x34df1b86
.long 0x35289b88,0x351eeb5d,0x3514a213,0x3509c993,0x3522de58,0x35184c89,0x350d18f3,0x35014f7c
.long 0x35030742,0x34e79302,0x34c79e7f,0x34a66500,0x34f82ef7,0x34d7c4ae,0x34b5df98,0x3492bb38
.long 0x35105c16,0x35030742,0x34e9f950,0x34cc9f84,0x3509c993,0x34f7030d,0x34d8ff23,0x34b9b497
.long 0x34cc9f84,0x34a66500,0x347d83cb,0x342c1831,0x34bd858f,0x34955f38,0x3457be81,0x3402cb5f
.long 0x34e9f950,0x34c79e7f,0x34a3cad0,0x347d83cb,0x34db727b,0x34b72709,0x349168af,0x345507bb
.long 0x33b26f4c,0x33c8a746,0x33ded782,0x33f4ff28,0x33ded782,0x33fa87a0,0x340b1453,0x3418dc76
.long 0x34058eae,0x34161b8b,0x34269b63,0x34370cc7,0x341b9d02,0x342ed5fa,0x3441fa4e,0x345507bb
.long 0x0,0x0,0x0,0x0,0x32b2b42a,0x32c90950,0x32df5dfa,0x32f5b21a
.long 0x3332a663,0x3348f5b2,0x335f4312,0x33758e4a,0x3385eb92,0x33969fc2,0x33a750ae,0x33b7fdf8
.long 0x34841c9e,0x34940d65,0x34a3cad0,0x34b34f66,0x348ec292,0x349fe093,0x34b0bd7a,0x34c1526b
.long 0x34995283,0x34ab948c,0x34bd858f,0x34cf1d15,0x34a3cad0,0x34b72709,0x34ca1ffb,0x34dcab5d
.long 0x34319357,0x34476e4a,0x345d2a7c,0x3472c494,0x34476e4a,0x345fdfae,0x34782561,0x34881d53
.long 0x345d2a7c,0x34782561,0x3489723e,0x3496b0ae,0x3472c494,0x34881d53,0x3496b0ae,0x34a5181b
.long 0x34e9f950,0x3501e263,0x350e30b4,0x3519d941,0x34f37bbe,0x3506fe49,0x351392b4,0x351f6b17
.long 0x34d689b3,0x34eebf21,0x35030742,0x350e30b4,0x34e052cd,0x34f95a49,0x3508ac72,0x35141a91
.long 0x34c295c7,0x34d8ff23,0x34eebf21,0x3501e263,0x34cc9f84,0x34e3f560,0x34fa8501,0x35081d63
.long 0x34ae29da,0x34c295c7,0x34d689b3,0x34e9f950,0x34b86e09,0x34cdde8c,0x34e2bfbb,0x34f7030d
.long 0x3518d125,0x3527aaad,0x353518dc,0x3540fe97,0x351ce8a6,0x352bd9ab,0x35393d0e,0x3544f3d3
.long 0x35105c16,0x351eeb5d,0x352c4e9d,0x35386c8e,0x3514a213,0x35235af6,0x3530c909,0x353cd118
.long 0x35078e00,0x3515b004,0x3522de58,0x352f0384,0x350bffd6,0x351a5cc1,0x3527aaad,0x3533d23f
.long 0x34fcd8a0,0x350bffd6,0x3518d125,0x3524ce73,0x35030742,0x3510e611,0x351deac5,0x352a01c4
.long 0x34058eae,0x341098a1,0x341b9d02,0x34269b63,0x34269b63,0x34345046,0x3441fa4e,0x344f98a6
.long 0x34476e4a,0x3457be81,0x3467fc01,0x34782561,0x3467fc01,0x347ad4e3,0x3486c814,0x349015cd
.long 0x0,0x0,0x0,0x0,0x330602d1,0x33112c43,0x331c555b,0x33277e13
.long 0x3385eb92,0x33910eb5,0x339c3072,0x33a750ae,0x33c8a746,0x33d94c39,0x33e9ec76,0x33fa87a0
.long 0x34c295c7,0x34d198a6,0x34e052cd,0x34eebf21,0x34d198a6,0x34e1898a,0x34f11e99,0x350028bd
.long 0x34e052cd,0x34f11e99,0x3500bc44,0x3508ac72,0x34eebf21,0x350028bd,0x3508ac72,0x3510e611
.long 0x34841c9e,0x348ec292,0x34995283,0x34a3cad0,0x34940d65,0x349fe093,0x34ab948c,0x34b72709
.long 0x34a3cad0,0x34b0bd7a,0x34bd858f,0x34ca1ffb,0x34b34f66,0x34c1526b,0x34cf1d15,0x34dcab5d
.long 0x3524ce73,0x352f0384,0x35386c8e,0x3540fe97,0x352a785c,0x3534ac6d,0x353dfa4a,0x35465618
.long 0x3518d125,0x3522de58,0x352c4e9d,0x353518dc,0x351eeb5d,0x3529135a,0x353287bc,0x353b3e79
.long 0x350bffd6,0x3515b004,0x351eeb5d,0x3527aaad,0x351281e8,0x351c6705,0x3525c420,0x352e9115
.long 0x34fcd8a0,0x35078e00,0x35105c16,0x3518d125,0x35054d33,0x350ebc11,0x3517c790,0x35206963
.long 0x354b4216,0x3553cd1b,0x355a8d22,0x355f738b,0x354ee2e0,0x3556f338,0x355d1234,0x356131a9
.long 0x35432e50,0x354c7f95,0x35544ec5,0x355a8d22,0x35475ac8,0x355050c1,0x3557a0dd,0x355d3c4c
.long 0x353a0bc4,0x3543e522,0x354c7f95,0x3553cd1b,0x353ebe21,0x35485b26,0x3550986d,0x35576780
.long 0x352fe71f,0x353a0bc4,0x35432e50,0x354b4216,0x353518dc,0x353f1f5c,0x3548062c,0x354fbfe7
.long 0x35638e39,0x35638e39,0x35638e39,0x35638e39,0x3563480d,0x35633f02,0x3563356b,0x35632b48
.long 0x356275b6,0x35625196,0x35622b47,0x356202ca,0x356117b5,0x3560c699,0x3560709c,0x356015c2
.long 0x355f2ee2,0x355e9f1e,0x355e06c5,0x355d65dc,0x355cbc6b,0x355bdca6,0x355aefa2,0x3559f56f
.long 0x3559c1d1,0x3558811b,0x35572d9f,0x3555c777,0x355640eb,0x35548ed6,0x3552c3a8,0x3550df99
.long 0x35523be2,0x35500894,0x354db531,0x354b4216,0x354db531,0x354af17d,0x3548062c,0x3544f3d3
.long 0x3548afa3,0x35454d1b,0x3541bb09,0x353dfa4a,0x35432e50,0x353f1f5c,0x353ad8b0,0x35365b8c
.long 0x353d349e,0x35386c8e,0x35336482,0x352e1e39,0x3536c63b,0x3531395a,0x352b6450,0x3525497d
.long 0x352fe71f,0x35298ac3,0x3522de58,0x351be504,0x35289b88,0x35216623,0x3519d941,0x3511f8fa
.long 0x35105c16,0x35066e3f,0x34f82ef7,0x34e2bfbb,0x35078e00,0x34f95a49,0x34e2bfbb,0x34cb5ffe
.long 0x3520e7f5,0x3518d125,0x35105c16,0x35078e00,0x3518d125,0x350fd1c3,0x35066e3f,0x34f95a49
.long 0x34d689b3,0x34bafab3,0x349e91b8,0x34816fe1,0x34c295c7,0x34a5181b,0x3486c814,0x344f98a6
.long 0x34fcd8a0,0x34e52a79,0x34cc9f84,0x34b34f66,0x34e9f950,0x34d05b1e,0x34b5df98,0x349aa2e0
.long 0x34841c9e,0x3441fa4e,0x33f4ff28,0x3348f5b2,0x345d2a7c,0x34135a44,0x33910eb5,0xb132b8b0
.long 0x34ae29da,0x348ec292,0x345d2a7c,0x341b9d02,0x34995283,0x3470134b,0x342c1831,0x33ce3417
.long 0x33b26f4c,0x31b2b879,0xb39c3072,0xb4211cf9,0x3332a663,0xb3277e13,0xb40007bf,0xb45507bb
.long 0x34319357,0x33c8a746,0x32b2b42a,0xb35f4312,0x34058eae,0x33541ca3,0xb2df5dfa,0xb3d94c39
.long 0x35638e39,0x35638e39,0x35638e39,0x35638e39,0x35632098,0x3563155d,0x35630995,0x3562fd41
.long 0x3561d820,0x3561ab48,0x35617c43,0x35614b12,0x355fb60c,0x355f517b,0x355ee813,0x355e79d6
.long 0x355cbc6b,0x355c0a76,0x355b5006,0x355a8d22,0x3558ee1a,0x3557d9b4,0x3556b84e,0x355589f8
.long 0x35544ec5,0x3552c3a8,0x35512643,0x354f76ba,0x354ee2e0,0x354ccdba,0x354aa066,0x35485b26
.long 0x3548afa3,0x3545fe3e,0x35432e50,0x3540404a,0x3541bb09,0x353e5c70,0x353ad8b0,0x35373079
.long 0x353a0bc4,0x3535f06c,0x3531a93d,0x352d3741,0x3531a93d,0x352cc324,0x3527aaad,0x35226155
.long 0x35289b88,0x3522de58,0x351ce8a6,0x3516bc84,0x351eeb5d,0x35184c89,0x35116fb3,0x350a57a4
.long 0x3514a213,0x350d18f3,0x35054d33,0x34fa8501,0x3509c993,0x35014f7c,0x34f11e99,0x34df1b86
.long 0x34cc9f84,0x34b5df98,0x349e91b8,0x3486c814,0x34b34f66,0x349aa2e0,0x34816fe1,0x344f98a6
.long 0x34fcd8a0,0x34e9f950,0x34d689b3,0x34c295c7,0x34e52a79,0x34d05b1e,0x34bafab3,0x34a5181b
.long 0x34476e4a,0x340b1453,0x339c3072,0x328608a2,0x341098a1,0x33a1c0c2,0x328608a2,0xb33dce45
.long 0x34995283,0x347d83cb,0x34476e4a,0x341098a1,0x347d83cb,0x3444b489,0x340b1453,0x33a1c0c2
.long 0xb2b2b42a,0xb3bd8c33,0xb4269b63,0xb46d616f,0xb39c3072,0xb418dc76,0xb4629456,0xb4955f38
.long 0x33b26f4c,0x32b2b42a,0xb332a663,0xb3ded782,0x330602d1,0xb3112c43,0xb3d3c069,0xb42ed5fa
.long 0xb472c494,0xb4a12f0b,0xb4c79e7f,0xb4ec5d5c,0xb4940d65,0xb4bc405b,0xb4e2bfbb,0xb5039938
.long 0xb4058eae,0xb4525071,0xb48ec292,0xb4b34f66,0xb43c8473,0xb4857282,0xb4ab948c,0xb4d05b1e
.long 0x34319357,0x343c8473,0x34476e4a,0x34525071,0x345d2a7c,0x346aaf00,0x34782561,0x3482c668
.long 0x34841c9e,0x348c1b15,0x34940d65,0x349bf2de,0x34995283,0x34a27d1f,0x34ab948c,0x34b497b7
.long 0x0,0x0,0x0,0x0,0x3332a663,0x333dce45,0x3348f5b2,0x33541ca3
.long 0x33b26f4c,0x33bd8c33,0x33c8a746,0x33d3c069,0x34058eae,0x340dd6a6,0x34161b8b,0x341e5d2e
.long 0x34fcd8a0,0x35054d33,0x350bffd6,0x351281e8,0x35078e00,0x350ebc11,0x3515b004,0x351c6705
.long 0x35105c16,0x3517c790,0x351eeb5d,0x3525c420,0x3518d125,0x35206963,0x3527aaad,0x352e9115
.long 0x34ae29da,0x34b86e09,0x34c295c7,0x34cc9f84,0x34c295c7,0x34cdde8c,0x34d8ff23,0x34e3f560
.long 0x34d689b3,0x34e2bfbb,0x34eebf21,0x34fa8501,0x34e9f950,0x34f7030d,0x3501e263,0x35081d63
.long 0x3548afa3,0x354f76ba,0x35554bf5,0x355a2886,0x354db531,0x35540e31,0x35595902,0x355d8ee3
.long 0x353d349e,0x35449a11,0x354b4216,0x35512643,0x35432e50,0x354a4ed2,0x3550986d,0x35560473
.long 0x352fe71f,0x35379a47,0x353ebe21,0x35454d1b,0x3536c63b,0x353e5c70,0x35454d1b,0x354b9232
.long 0x3520e7f5,0x35289b88,0x352fe71f,0x3536c63b,0x35289b88,0x3530584a,0x35379a47,0x353e5c70
.long 0x356275b6,0x35638d20,0x3562b76b,0x355ff665,0x3563480d,0x3563508c,0x35614b12,0x355d3c4c
.long 0x355f2ee2,0x35622b47,0x35637cad,0x35632098,0x356117b5,0x35632b48,0x356372cf,0x3561edbb
.long 0x3559c1d1,0x355e5404,0x35617c43,0x3563356b,0x355cbc6b,0x35608dd0,0x3562d4fe,0x35638df3
.long 0x35523be2,0x35581207,0x355cbc6b,0x35603495,0x355640eb,0x355b7f6e,0x355f738b,0x3562174e
.long 0x345d2a7c,0x3467fc01,0x3472c494,0x347d83cb,0x3489723e,0x349015cd,0x3496b0ae,0x349d427b
.long 0x34a3cad0,0x34ab948c,0x34b34f66,0x34bafab3,0x34bd858f,0x34c65d08,0x34cf1d15,0x34d7c4ae
.long 0x0,0x0,0x0,0x0,0x335f4312,0x336a68f6,0x33758e4a,0x33805983
.long 0x33ded782,0x33e9ec76,0x33f4ff28,0x340007bf,0x34269b63,0x342ed5fa,0x34370cc7,0x343f3f9b
.long 0x3518d125,0x351eeb5d,0x3524ce73,0x352a785c,0x3522de58,0x3529135a,0x352f0384,0x3534ac6d
.long 0x352c4e9d,0x353287bc,0x35386c8e,0x353dfa4a,0x353518dc,0x353b3e79,0x3540fe97,0x35465618
.long 0x34d689b3,0x34e052cd,0x34e9f950,0x34f37bbe,0x34eebf21,0x34f95a49,0x3501e263,0x3506fe49
.long 0x35030742,0x3508ac72,0x350e30b4,0x351392b4,0x350e30b4,0x35141a91,0x3519d941,0x351f6b17
.long 0x355e06c5,0x3560e22d,0x3562b76b,0x3563845a,0x3560aa7a,0x3562a7cf,0x3563845a,0x35633f02
.long 0x355640eb,0x355a8d22,0x355e06c5,0x3560aa7a,0x355a8d22,0x355e2da9,0x3560e22d,0x3562a7cf
.long 0x354b4216,0x3550986d,0x35554bf5,0x35595902,0x35512643,0x35560473,0x355a2886,0x355d8ee3
.long 0x353d349e,0x35432e50,0x3548afa3,0x354db531,0x35449a11,0x354a4ed2,0x354f76ba,0x35540e31
.long 0x355b5006,0x3554ce63,0x354c7f95,0x3542759c,0x35572d9f,0x354f2d0d,0x35454d1b,0x3539a4a2
.long 0x356117b5,0x355d65dc,0x35581207,0x35512643,0x355e9f1e,0x35598dac,0x3552c3a8,0x354a4ed2
.long 0x35637cad,0x35625196,0x355fb60c,0x355bae4d,0x3562b76b,0x356052de,0x355c6480,0x3556f338
.long 0x356275b6,0x35637cad,0x3563480d,0x3561d820,0x356366c0,0x35635fe5,0x356202ca,0x355f517b
.long 0x35638e39,0x35638e39,0x35638e39,0x35638e39,0x3562f061,0x3562e2f5,0x3562d4fe,0x3562c67a
.long 0x356117b5,0x3560e22d,0x3560aa7a,0x3560709c,0x355e06c5,0x355d8ee3,0x355d1234,0x355c90b9
.long 0x3559c1d1,0x3558ee1a,0x35581207,0x35572d9f,0x35544ec5,0x355306c8,0x3551b215,0x355050c1
.long 0x354db531,0x354be1d1,0x3549fcc1,0x3548062c,0x3545fe3e,0x354389f6,0x3540fe97,0x353e5c70
.long 0x353d349e,0x353a0bc4,0x3536c63b,0x35336482,0x35336482,0x352f7588,0x352b6450,0x352731a4
.long 0x35289b88,0x3523d730,0x351eeb5d,0x3519d941,0x351ce8a6,0x35174239,0x35116fb3,0x350b72c6
.long 0x35105c16,0x3509c993,0x35030742,0x34f82ef7,0x35030742,0x34f7030d,0x34e79302,0x34d7c4ae
.long 0x34e9f950,0x34d8ff23,0x34c79e7f,0x34b5df98,0x34cc9f84,0x34b9b497,0x34a66500,0x3492bb38
.long 0x345d2a7c,0x342c1831,0x33f4ff28,0x33910eb5,0x341b9d02,0x33ce3417,0x3348f5b2,0xb132b8b0
.long 0x34ae29da,0x34995283,0x34841c9e,0x345d2a7c,0x348ec292,0x3470134b,0x3441fa4e,0x34135a44
.long 0xb332a663,0xb3d3c069,0xb4269b63,0xb4629456,0xb3ded782,0xb42ed5fa,0xb46d616f,0xb4955f38
.long 0x33b26f4c,0x330602d1,0xb2b2b42a,0xb39c3072,0x32b2b42a,0xb3112c43,0xb3bd8c33,0xb418dc76
.long 0xb4995283,0xb4bafab3,0xb4db727b,0xb4fa8501,0xb4b86e09,0xb4da3912,0xb4fa8501,0xb50c8c90
.long 0xb4319357,0xb472c494,0xb4995283,0xb4b86e09,0xb472c494,0xb49aa2e0,0xb4bafab3,0xb4da3912
.long 0xb5078e00,0xb517c790,0xb526b834,0xb5343f8d,0xb514a213,0xb5245304,0xb53287bc,0xb53f1f5c
.long 0xb4d689b3,0xb4f82ef7,0xb50bffd6,0xb51adfe2,0xb4f37bbe,0xb50a57a4,0xb519d941,0xb528234e
.long 0x35638e39,0x35638e39,0x35638e39,0x35638e39,0x3562b76b,0x3562a7cf,0x356297a8,0x356286f5
.long 0x35603495,0x355ff665,0x355fb60c,0x355f738b,0x355c0a76,0x355b7f6e,0x355aefa2,0x355a5b18
.long 0x355640eb,0x35554bf5,0x35544ec5,0x35534966,0x354ee2e0,0x354d6888,0x354be1d1,0x354a4ed2
.long 0x3545fe3e,0x3543e522,0x3541bb09,0x353f8021,0x353ba3cf,0x3538d507,0x3535f06c,0x3532f656
.long 0x352fe71f,0x352c4e9d,0x35289b88,0x3524ce73,0x3522de58,0x351e6b42,0x3519d941,0x3515293a
.long 0x3514a213,0x350f4716,0x3509c993,0x35042ade,0x35054d33,0x34fe0186,0x34f11e99,0x34e3f560
.long 0x34e9f950,0x34db727b,0x34cc9f84,0x34bd858f,0x34c79e7f,0x34b72709,0x34a66500,0x34955f38
.long 0x34a3cad0,0x349168af,0x347d83cb,0x3457be81,0x347d83cb,0x345507bb,0x342c1831,0x3402cb5f
.long 0x32b2b42a,0xb2df5dfa,0xb39c3072,0xb40007bf,0xb35f4312,0xb3d94c39,0xb4211cf9,0xb45507bb
.long 0x34319357,0x34058eae,0x33b26f4c,0x3332a663,0x33c8a746,0x33541ca3,0x31b2b879,0xb3277e13
.long 0xb48ec292,0xb4ab948c,0xb4c79e7f,0xb4e2bfbb,0xb4b34f66,0xb4d05b1e,0xb4ec5d5c,0xb5039938
.long 0xb4058eae,0xb43c8473,0xb472c494,0xb4940d65,0xb4525071,0xb4857282,0xb4a12f0b,0xb4bc405b
.long 0xb50bffd6,0xb519d941,0xb526b834,0xb53287bc,0xb51adfe2,0xb528234e,0xb5343f8d,0xb53f1f5c
.long 0xb4d689b3,0xb4f37bbe,0xb5078e00,0xb514a213,0xb4f82ef7,0xb50a57a4,0xb517c790,0xb5245304
.long 0xb540404a,0xb54aa066,0xb5534966,0xb55a2886,0xb549fcc1,0xb55306c8,0xb55a2886,0xb55f517b
.long 0xb5289b88,0xb53518dc,0xb540404a,0xb549fcc1,0xb53518dc,0xb5409fac,0xb54aa066,0xb55306c8
.long 0x34841c9e,0x3489723e,0x348ec292,0x34940d65,0x34a3cad0,0x34aa4946,0x34b0bd7a,0x34b72709
.long 0x34c295c7,0x34ca1ffb,0x34d198a6,0x34d8ff23,0x34e052cd,0x34e8c671,0x34f11e99,0x34f95a49
.long 0x0,0x0,0x0,0x0,0x3385eb92,0x338b7d4f,0x33910eb5,0x33969fc2
.long 0x34058eae,0x340b1453,0x341098a1,0x34161b8b,0x34476e4a,0x344f98a6,0x3457be81,0x345fdfae
.long 0x352fe71f,0x353518dc,0x353a0bc4,0x353ebe21,0x353a0bc4,0x353f1f5c,0x3543e522,0x35485b26
.long 0x35432e50,0x3548062c,0x354c7f95,0x3550986d,0x354b4216,0x354fbfe7,0x3553cd1b,0x35576780
.long 0x34fcd8a0,0x35030742,0x35078e00,0x350bffd6,0x350bffd6,0x3510e611,0x3515b004,0x351a5cc1
.long 0x3518d125,0x351deac5,0x3522de58,0x3527aaad,0x3524ce73,0x352a01c4,0x352f0384,0x3533d23f
.long 0x3563480d,0x356202ca,0x355fb60c,0x355c6480,0x3561d820,0x355f517b,0x355bae4d,0x3556f338
.long 0x356275b6,0x356366c0,0x35637cad,0x3562b76b,0x35637cad,0x35635fe5,0x35625196,0x356052de
.long 0x355cbc6b,0x355f738b,0x35617c43,0x3562d4fe,0x35603495,0x3562174e,0x3563356b,0x35638df3
.long 0x35523be2,0x355640eb,0x3559c1d1,0x355cbc6b,0x35581207,0x355b7f6e,0x355e5404,0x35608dd0
.long 0x3536c63b,0x35298ac3,0x351adfe2,0x350ae560,0x352c4e9d,0x351d69e6,0x350d18f3,0x34f7030d
.long 0x3548afa3,0x353ebe21,0x35336482,0x3526b834,0x3540404a,0x3534ac6d,0x3527aaad,0x35195562
.long 0x355640eb,0x354f76ba,0x35475ac8,0x353dfa4a,0x35500894,0x3547b0b8,0x353dfa4a,0x3532f656
.long 0x355f2ee2,0x355b5006,0x355640eb,0x35500894,0x355b5006,0x35560473,0x354f76ba,0x3547b0b8
.long 0x34995283,0x349e91b8,0x34a3cad0,0x34a8fd97,0x34bd858f,0x34c3d8ab,0x34ca1ffb,0x34d05b1e
.long 0x34e052cd,0x34e79302,0x34eebf21,0x34f5d68a,0x3500bc44,0x3504bc31,0x3508ac72,0x350c8c90
.long 0x0,0x0,0x0,0x0,0x339c3072,0x33a1c0c2,0x33a750ae,0x33ace032
.long 0x341b9d02,0x34211cf9,0x34269b63,0x342c1831,0x3467fc01,0x3470134b,0x34782561,0x3480190b
.long 0x35432e50,0x35475ac8,0x354b4216,0x354ee2e0,0x354c7f95,0x355050c1,0x3553cd1b,0x3556f338
.long 0x35544ec5,0x3557a0dd,0x355a8d22,0x355d1234,0x355a8d22,0x355d3c4c,0x355f738b,0x356131a9
.long 0x35105c16,0x3514a213,0x3518d125,0x351ce8a6,0x351eeb5d,0x35235af6,0x3527aaad,0x352bd9ab
.long 0x352c4e9d,0x3530c909,0x353518dc,0x35393d0e,0x35386c8e,0x353cd118,0x3540fe97,0x3544f3d3
.long 0x35581207,0x3552c3a8,0x354c7f95,0x35454d1b,0x35512643,0x354a4ed2,0x3542759c,0x3539a4a2
.long 0x356117b5,0x355e9f1e,0x355b5006,0x35572d9f,0x355d65dc,0x35598dac,0x3554ce63,0x354f2d0d
.long 0x35637cad,0x356372cf,0x3562b76b,0x35614b12,0x35632098,0x3561edbb,0x355ff665,0x355d3c4c
.long 0x355f2ee2,0x356117b5,0x356275b6,0x3563480d,0x35622b47,0x35632b48,0x35638d20,0x3563508c
.long 0x34f37bbe,0x34cf1d15,0x34a8fd97,0x34816fe1,0x34d198a6,0x34aa4946,0x34816fe1,0x342ed5fa
.long 0x3518d125,0x3509c993,0x34f37bbe,0x34d198a6,0x3509c993,0x34f24d76,0x34cf1d15,0x34aa4946
.long 0x35336482,0x3527aaad,0x351adfe2,0x350d18f3,0x3526b834,0x35195562,0x350ae560,0x34f7030d
.long 0x3548afa3,0x3540404a,0x3536c63b,0x352c4e9d,0x353ebe21,0x3534ac6d,0x35298ac3,0x351d69e6
.long 0x35638e39,0x356275b6,0x355f2ee2,0x3559c1d1,0x35638e39,0x356263ec,0x355ee813,0x355923d1
.long 0x35638e39,0x35625196,0x355e9f1e,0x3558811b,0x35638e39,0x35623eb4,0x355e5404,0x3557d9b4
.long 0x35638e39,0x35622b47,0x355e06c5,0x35572d9f,0x35638e39,0x3562174e,0x355db762,0x35567cde
.long 0x35638e39,0x356202ca,0x355d65dc,0x3555c777,0x35638e39,0x3561edbb,0x355d1234,0x35550d6e
.long 0x35638e39,0x3561d820,0x355cbc6b,0x35544ec5,0x35638e39,0x3561c1f9,0x355c6480,0x35538b82
.long 0x35638e39,0x3561ab48,0x355c0a76,0x3552c3a8,0x35638e39,0x3561940b,0x355bae4d,0x3551f73d
.long 0x35638e39,0x35617c43,0x355b5006,0x35512643,0x35638e39,0x356163f0,0x355aefa2,0x355050c1
.long 0x35638e39,0x35614b12,0x355a8d22,0x354f76ba,0x35638e39,0x356131a9,0x355a2886,0x354e9833
.long 0x35638e39,0x3560e22d,0x3558ee1a,0x354be1d1,0x35638e39,0x3560c699,0x3558811b,0x354af17d
.long 0x35638e39,0x356117b5,0x3559c1d1,0x354db531,0x35638e39,0x3560fd37,0x35595902,0x354ccdba
.long 0x35638e39,0x3560709c,0x35572d9f,0x3548062c,0x35638e39,0x356052de,0x3556b84e,0x3547045d
.long 0x35638e39,0x3560aa7a,0x35581207,0x3549fcc1,0x35638e39,0x35608dd0,0x3557a0dd,0x354903a5
.long 0x35638e39,0x355ff665,0x35554bf5,0x3543e522,0x35638e39,0x355fd67d,0x3554ce63,0x3542d232
.long 0x35638e39,0x35603495,0x355640eb,0x3545fe3e,0x35638e39,0x356015c2,0x3555c777,0x3544f3d3
.long 0x35638e39,0x355f738b,0x35534966,0x353f8021,0x35638e39,0x355f517b,0x3552c3a8,0x353e5c70
.long 0x35638e39,0x355fb60c,0x35544ec5,0x3541bb09,0x35638e39,0x355f9510,0x3553cd1b,0x35409fac
.long 0x35523be2,0x3548afa3,0x353d349e,0x352fe71f,0x35512643,0x3547045d,0x353ad8b0,0x352cc324
.long 0x35500894,0x35454d1b,0x35386c8e,0x35298ac3,0x354ee2e0,0x354389f6,0x3535f06c,0x35263e5e
.long 0x354db531,0x3541bb09,0x35336482,0x3522de58,0x354c7f95,0x353fe071,0x3530c909,0x351f6b17
.long 0x354b4216,0x353dfa4a,0x352e1e39,0x351be504,0x3549fcc1,0x353c08b1,0x352b6450,0x35184c89
.long 0x3548afa3,0x353a0bc4,0x35289b88,0x3514a213,0x35475ac8,0x353803a3,0x3525c420,0x3510e611
.long 0x3545fe3e,0x3535f06c,0x3522de58,0x350d18f3,0x35449a11,0x3533d23f,0x351fea6e,0x35093b2d
.long 0x35432e50,0x3531a93d,0x351ce8a6,0x35054d33,0x3541bb09,0x352f7588,0x3519d941,0x35014f7c
.long 0x3540404a,0x352d3741,0x3516bc84,0x34fa8501,0x353ebe21,0x352aee8a,0x351392b4,0x34f24d76
.long 0x353a0bc4,0x3523d730,0x3509c993,0x34d8ff23,0x35386c8e,0x35216623,0x35066e3f,0x34d05b1e
.long 0x353d349e,0x35289b88,0x35105c16,0x34e9f950,0x353ba3cf,0x35263e5e,0x350d18f3,0x34e1898a
.long 0x35336482,0x3519d941,0x34f82ef7,0x34b5df98,0x3531a93d,0x35174239,0x34f11e99,0x34acdf68
.long 0x3536c63b,0x351eeb5d,0x35030742,0x34c79e7f,0x353518dc,0x351c6705,0x34ff29cf,0x34beca4f
.long 0x352c4e9d,0x350f4716,0x34db727b,0x349168af,0x352a785c,0x350c8c90,0x34d41232,0x34881d53
.long 0x352fe71f,0x3514a213,0x34e9f950,0x34a3cad0,0x352e1e39,0x3511f8fa,0x34e2bfbb,0x349aa2e0
.long 0x3524ce73,0x35042ade,0x34bd858f,0x3457be81,0x3522de58,0x35014f7c,0x34b5df98,0x3444b489
.long 0x35289b88,0x3509c993,0x34cc9f84,0x347d83cb,0x3526b834,0x3506fe49,0x34c51b16,0x346aaf00
.long 0x0,0x33c8a746,0x34476e4a,0x34940d65,0x0,0x33ce3417,0x344ce05a,0x349801c8
.long 0x0,0x33d3c069,0x34525071,0x349bf2de,0x0,0x33d94c39,0x3457be81,0x349fe093
.long 0x0,0x33b26f4c,0x34319357,0x34841c9e,0x0,0x33b7fdf8,0x34370cc7,0x34881d53
.long 0x0,0x33bd8c33,0x343c8473,0x348c1b15,0x0,0x33c319f8,0x3441fa4e,0x349015cd
.long 0x0,0x33f4ff28,0x3472c494,0x34b34f66,0x0,0x33fa87a0,0x34782561,0x34b72709
.long 0x0,0x340007bf,0x347d83cb,0x34bafab3,0x0,0x3402cb5f,0x34816fe1,0x34beca4f
.long 0x0,0x33ded782,0x345d2a7c,0x34a3cad0,0x0,0x33e46243,0x34629456,0x34a7b17f
.long 0x0,0x33e9ec76,0x3467fc01,0x34ab948c,0x0,0x33ef7619,0x346d616f,0x34af73e0
.long 0x0,0x34161b8b,0x34940d65,0x34d8ff23,0x0,0x3418dc76,0x3496b0ae,0x34dcab5d
.long 0x0,0x341098a1,0x348ec292,0x34d198a6,0x0,0x34135a44,0x349168af,0x34d54e35
.long 0x0,0x340b1453,0x3489723e,0x34ca1ffb,0x0,0x340dd6a6,0x348c1b15,0x34cdde8c
.long 0x0,0x34058eae,0x34841c9e,0x34c295c7,0x0,0x340851aa,0x3486c814,0x34c65d08
.long 0x0,0x342c1831,0x34a8fd97,0x34f5d68a,0x0,0x342ed5fa,0x34ab948c,0x34f95a49
.long 0x0,0x34269b63,0x34a3cad0,0x34eebf21,0x0,0x342959fe,0x34a66500,0x34f24d76
.long 0x0,0x34211cf9,0x349e91b8,0x34e79302,0x0,0x3423dc60,0x34a12f0b,0x34eb2b9e
.long 0x0,0x341b9d02,0x34995283,0x34e052cd,0x0,0x341e5d2e,0x349bf2de,0x34e3f560
.long 0x34c295c7,0x34eebf21,0x350bffd6,0x351eeb5d,0x34c79e7f,0x34f4a96f,0x350f4716,0x35226155
.long 0x34cc9f84,0x34fa8501,0x351281e8,0x3525c420,0x34d198a6,0x350028bd,0x3515b004,0x3529135a
.long 0x34ae29da,0x34d689b3,0x34fcd8a0,0x35105c16,0x34b34f66,0x34dcab5d,0x3501e263,0x35141a91
.long 0x34b86e09,0x34e2bfbb,0x35054d33,0x3517c790,0x34bd858f,0x34e8c671,0x3508ac72,0x351b62a3
.long 0x34e9f950,0x350e30b4,0x3524ce73,0x35386c8e,0x34eebf21,0x3510e611,0x3527aaad,0x353b3e79
.long 0x34f37bbe,0x351392b4,0x352a785c,0x353dfa4a,0x34f82ef7,0x35163673,0x352d3741,0x35409fac
.long 0x34d689b3,0x35030742,0x3518d125,0x352c4e9d,0x34db727b,0x3505dde2,0x351be504,0x352f7588
.long 0x34e052cd,0x3508ac72,0x351eeb5d,0x353287bc,0x34e52a79,0x350b72c6,0x3521e3ee,0x353584dc
.long 0x350bffd6,0x3527aaad,0x353ebe21,0x3550986d,0x350e30b4,0x352a01c4,0x3540fe97,0x35528006
.long 0x35078e00,0x3522de58,0x353a0bc4,0x354c7f95,0x3509c993,0x3525497d,0x353c6d1f,0x354e9833
.long 0x35030742,0x351deac5,0x353518dc,0x3548062c,0x35054d33,0x35206963,0x35379a47,0x354a4ed2
.long 0x34fcd8a0,0x3518d125,0x352fe71f,0x35432e50,0x3500bc44,0x351b62a3,0x353287bc,0x3545a5e9
.long 0x351ce8a6,0x35393d0e,0x354ee2e0,0x355d1234,0x351eeb5d,0x353b3e79,0x3550986d,0x355e2da9
.long 0x3518d125,0x353518dc,0x354b4216,0x355a8d22,0x351adfe2,0x35373079,0x354d1b60,0x355bdca6
.long 0x3514a213,0x3530c909,0x35475ac8,0x3557a0dd,0x3516bc84,0x3532f656,0x3549572b,0x355923d1
.long 0x35105c16,0x352c4e9d,0x35432e50,0x35544ec5,0x351281e8,0x352e9115,0x35454d1b,0x35560473
.long 0x3520e7f5,0x35105c16,0x34fcd8a0,0x34d689b3,0x351ce8a6,0x350b72c6,0x34f11e99,0x34c8df7b
.long 0x3518d125,0x35066e3f,0x34e52a79,0x34bafab3,0x3514a213,0x35014f7c,0x34d8ff23,0x34acdf68
.long 0x35105c16,0x34f82ef7,0x34cc9f84,0x349e91b8,0x350bffd6,0x34ed8e88,0x34c00e98,0x349015cd
.long 0x35078e00,0x34e2bfbb,0x34b34f66,0x34816fe1,0x35030742,0x34d7c4ae,0x34a66500,0x34654872
.long 0x34fcd8a0,0x34cc9f84,0x34995283,0x34476e4a,0x34f37bbe,0x34c1526b,0x348c1b15,0x342959fe
.long 0x34e9f950,0x34b5df98,0x347d83cb,0x340b1453,0x34e052cd,0x34aa4946,0x34629456,0x33d94c39
.long 0x34d689b3,0x349e91b8,0x34476e4a,0x339c3072,0x34cc9f84,0x3492bb38,0x342c1831,0x333dce45
.long 0x34c295c7,0x3486c814,0x341098a1,0x328608a2,0x34b86e09,0x34757546,0x33e9ec76,0xb25f64b5
.long 0x34995283,0x342c1831,0x330602d1,0xb3d3c069,0x348ec292,0x34135a44,0x31b2b879,0xb40851aa
.long 0x34ae29da,0x345d2a7c,0x33b26f4c,0xb332a663,0x34a3cad0,0x3444b489,0x33758e4a,0xb3969fc2
.long 0x345d2a7c,0x33910eb5,0xb39c3072,0xb4629456,0x34476e4a,0x333dce45,0xb3d3c069,0xb480190b
.long 0x34841c9e,0x33f4ff28,0xb2b2b42a,0xb4269b63,0x3472c494,0x33c319f8,0xb348f5b2,0xb444b489
.long 0x34058eae,0xb2df5dfa,0xb43c8473,0xb4ab948c,0x33ded782,0xb3541ca3,0xb457be81,0xb4b9b497
.long 0x34319357,0x32b2b42a,0xb4058eae,0xb48ec292,0x341b9d02,0xb132b8b0,0xb4211cf9,0xb49d427b
.long 0x3332a663,0xb40007bf,0xb4940d65,0xb4e2bfbb,0x32b2b42a,0xb418dc76,0xb4a12f0b,0xb4efef27
.long 0x33b26f4c,0xb39c3072,0xb472c494,0xb4c79e7f,0x3385eb92,0xb3ce3417,0xb486c814,0xb4d54e35
.long 0x34ae29da,0x34841c9e,0x34319357,0x33b26f4c,0x349e91b8,0x34654872,0x340b1453,0x333dce45
.long 0x348ec292,0x3441fa4e,0x33c8a746,0x31b2b879,0x347d83cb,0x341e5d2e,0x33758e4a,0xb3112c43
.long 0x345d2a7c,0x33f4ff28,0x32b2b42a,0xb39c3072,0x343c8473,0x33ace032,0xb28608a2,0xb3ef7619
.long 0x341b9d02,0x3348f5b2,0xb35f4312,0xb4211cf9,0x33f4ff28,0x325f64b5,0xb3bd8c33,0xb44a2791
.long 0x33b26f4c,0xb2b2b42a,0xb4058eae,0xb472c494,0x335f4312,0xb36a68f6,0xb42c1831,0xb48d6eff
.long 0x32b2b42a,0xb3bd8c33,0xb4525071,0xb4a12f0b,0xb232b79c,0xb402cb5f,0xb4782561,0xb4b497b7
.long 0xb332a663,0xb4269b63,0xb48ec292,0xb4c79e7f,0xb39c3072,0xb44a2791,0xb4a12f0b,0xb4da3912
.long 0xb3ded782,0xb46d616f,0xb4b34f66,0xb4ec5d5c,0xb41098a1,0xb4881d53,0xb4c51b16,0xb4fe0186
.long 0xb472c494,0xb4bafab3,0xb4f82ef7,0xb517c790,0xb489723e,0xb4cb5ffe,0xb5042ade,0xb51f6b17
.long 0xb4319357,0xb4995283,0xb4d689b3,0xb5078e00,0xb4525071,0xb4aa4946,0xb4e79302,0xb50fd1c3
.long 0xb4b86e09,0xb4fa8501,0xb51adfe2,0xb5343f8d,0xb4c79e7f,0xb504bc31,0xb521e3ee,0xb53a7274
.long 0xb4995283,0xb4db727b,0xb50bffd6,0xb526b834,0xb4a8fd97,0xb4eb2b9e,0xb51392b4,0xb52daaf3
.long 0xb4f37bbe,0xb519d941,0xb53518dc,0xb54aa066,0xb500bc44,0xb5206963,0xb53ad8b0,0xb54f2d0d
.long 0xb4d689b3,0xb50bffd6,0xb5289b88,0xb540404a,0xb4e52a79,0xb5130a7b,0xb52f0384,0xb545a5e9
.long 0xb514a213,0xb53287bc,0xb549fcc1,0xb55a2886,0xb51adfe2,0xb53803a3,0xb54e4d07,0xb55ce793
.long 0xb5078e00,0xb526b834,0xb540404a,0xb5534966,0xb50e30b4,0xb52cc324,0xb5454d1b,0xb556f338
.long 0x352fe71f,0x353ebe21,0x354b4216,0x35554bf5,0x35336482,0x3542188e,0x354e4d07,0x3557d9b4
.long 0x3536c63b,0x35454d1b,0x35512643,0x355a2886,0x353a0bc4,0x35485b26,0x3553cd1b,0x355c37bf
.long 0x3520e7f5,0x352fe71f,0x353d349e,0x3548afa3,0x3524ce73,0x3533d23f,0x3540fe97,0x354c30f2
.long 0x35289b88,0x35379a47,0x35449a11,0x354f76ba,0x352c4e9d,0x353b3e79,0x3548062c,0x35528006
.long 0x3548afa3,0x35554bf5,0x355e06c5,0x3562b76b,0x354b4216,0x35576780,0x355f738b,0x35633f02
.long 0x354db531,0x35595902,0x3560aa7a,0x3563845a,0x35500894,0x355b2018,0x3561ab48,0x3563875e
.long 0x353d349e,0x354b4216,0x355640eb,0x355e06c5,0x3540404a,0x354e015c,0x3558811b,0x355f9510
.long 0x35432e50,0x3550986d,0x355a8d22,0x3560e22d,0x3545fe3e,0x355306c8,0x355c6480,0x3561edbb
.long 0x355cbc6b,0x3562d4fe,0x3562b76b,0x355c6480,0x355e06c5,0x35633f02,0x356202ca,0x355a5b18
.long 0x3559c1d1,0x35617c43,0x35637cad,0x355fb60c,0x355b5006,0x35623eb4,0x3563356b,0x355e2da9
.long 0x355640eb,0x355f738b,0x356366c0,0x356202ca,0x35581207,0x35608dd0,0x35638d20,0x3560fd37
.long 0x35523be2,0x355cbc6b,0x356275b6,0x3563480d,0x35544ec5,0x355e2da9,0x35630995,0x3562c67a
.long 0x3563480d,0x35614b12,0x35572d9f,0x35454d1b,0x35637cad,0x356052de,0x3554ce63,0x35415d0c
.long 0x356275b6,0x3562b76b,0x355b5006,0x354c7f95,0x3562f061,0x3562174e,0x35595902,0x354903a5
.long 0x356117b5,0x356372cf,0x355e9f1e,0x3552c3a8,0x3561d820,0x35632b48,0x355d1234,0x354fbfe7
.long 0x355f2ee2,0x35637cad,0x356117b5,0x35581207,0x35603495,0x35638df3,0x355ff665,0x355589f8
.long 0x355cbc6b,0x35617c43,0x35637cad,0x3562b76b,0x355e9f1e,0x356286f5,0x3563845a,0x3561940b
.long 0x35603495,0x3563356b,0x35632098,0x355ff665,0x35617c43,0x3563875e,0x35625196,0x355ddf58
.long 0x35523be2,0x3559c1d1,0x355f2ee2,0x356275b6,0x35554bf5,0x355c37bf,0x3560e22d,0x35633f02
.long 0x35581207,0x355e5404,0x35622b47,0x35638d20,0x355a8d22,0x356015c2,0x35630995,0x35635fe5
.long 0x3563480d,0x355fb60c,0x35581207,0x354c7f95,0x3562b76b,0x355ddf58,0x3554ce63,0x3547b0b8
.long 0x3561d820,0x355bae4d,0x35512643,0x3542759c,0x3560aa7a,0x355923d1,0x354d1b60,0x353cd118
.long 0x356275b6,0x35637cad,0x356117b5,0x355b5006,0x35632098,0x3563155d,0x355f738b,0x355849d4
.long 0x35637cad,0x35625196,0x355d65dc,0x3554ce63,0x356389d6,0x356131a9,0x355aefa2,0x3550df99
.long 0x35500894,0x353dfa4a,0x3526b834,0x350ae560,0x354c7f95,0x3538d507,0x351fea6e,0x350274fb
.long 0x355640eb,0x35475ac8,0x35336482,0x351adfe2,0x35534966,0x3542d232,0x352d3741,0x35130a7b
.long 0x355b5006,0x354f76ba,0x353ebe21,0x35298ac3,0x3558ee1a,0x354b9232,0x35393d0e,0x35226155
.long 0x355f2ee2,0x355640eb,0x3548afa3,0x3536c63b,0x355d65dc,0x355306c8,0x3543e522,0x3530584a
.long 0x352c4e9d,0x350d18f3,0x34d198a6,0x34816fe1,0x3526b834,0x3505dde2,0x34c00e98,0x345a74c2
.long 0x3536c63b,0x351adfe2,0x34f37bbe,0x34a8fd97,0x3531a93d,0x35141a91,0x34e2bfbb,0x34955f38
.long 0x3540404a,0x3527aaad,0x3509c993,0x34cf1d15,0x353ba3cf,0x35216623,0x3501e263,0x34bc405b
.long 0x3548afa3,0x35336482,0x3518d125,0x34f37bbe,0x35449a11,0x352daaf3,0x35116fb3,0x34e1898a
.long 0x0,0xb3b26f4c,0xb4319357,0xb4841c9e,0xb332a663,0xb40851aa,0xb4629456,0xb49d427b
.long 0xb3b26f4c,0xb4370cc7,0xb489723e,0xb4b5df98,0xb4058eae,0xb4654872,0xb4a12f0b,0xb4cdde8c
.long 0xb4319357,0xb489723e,0xb4b86e09,0xb4e52a79,0xb45d2a7c,0xb49fe093,0xb4cf1d15,0xb4fbaf1e
.long 0xb4841c9e,0xb4b5df98,0xb4e52a79,0xb508ac72,0xb4995283,0xb4cb5ffe,0xb4fa8501,0xb5130a7b
.long 0xb4ae29da,0xb4e052cd,0xb5078e00,0xb51ce8a6,0xb4c295c7,0xb4f4a96f,0xb5116fb3,0xb5263e5e
.long 0xb4d689b3,0xb5042ade,0xb51adfe2,0xb52f0384,0xb4e9f950,0xb50da4ff,0xb523d730,0xb5373079
.long 0xb4fcd8a0,0xb516bc84,0xb52c4e9d,0xb53ebe21,0xb5078e00,0xb51f6b17,0xb5343f8d,0xb545a5e9
.long 0xb5105c16,0xb527aaad,0xb53ba3cf,0xb54be1d1,0xb518d125,0xb52f7588,0xb542759c,0xb5516c6d
.long 0xb52fe71f,0xb543e522,0xb5534966,0xb55db762,0xb536c63b,0xb549aa34,0xb557a0dd,0xb56052de
.long 0xb520e7f5,0xb536c63b,0xb548afa3,0xb55640eb,0xb5289b88,0xb53d97ae,0xb54e4d07,0xb55a5b18
.long 0xb548afa3,0xb557a0dd,0xb560aa7a,0xb5638d20,0xb54db531,0xb55b2018,0xb5625196,0xb563155d
.long 0xb53d349e,0xb54ee2e0,0xb55b5006,0xb5622b47,0xb5432e50,0xb5538b82,0xb55e5404,0xb5633f02
.long 0xb559c1d1,0xb56202ca,0xb5632098,0xb55d1234,0xb55cbc6b,0xb563155d,0xb56202ca,0xb5598dac
.long 0xb5523be2,0xb55e06c5,0xb563480d,0xb561d820,0xb55640eb,0xb56052de,0xb5638d20,0xb55fd67d
.long 0xb56275b6,0xb56297a8,0xb55a8d22,0xb54aa066,0xb563480d,0xb56131a9,0xb556b84e,0xb5443fd6
.long 0xb55f2ee2,0xb56389d6,0xb5603495,0xb5554bf5,0xb56117b5,0xb5635fe5,0xb55db762,0xb55050c1
.long 0xb4ae29da,0xb4d689b3,0xb4fcd8a0,0xb5105c16,0xb4c79e7f,0xb4efef27,0xb50ae560,0xb51c6705
.long 0xb4e052cd,0xb5042ade,0xb516bc84,0xb527aaad,0xb4f82ef7,0xb50fd1c3,0xb521e3ee,0xb53218b4
.long 0xb5078e00,0xb51adfe2,0xb52c4e9d,0xb53ba3cf,0xb51281e8,0xb525497d,0xb535f06c,0xb5443fd6
.long 0xb51ce8a6,0xb52f0384,0xb53ebe21,0xb54be1d1,0xb526b834,0xb53803a3,0xb546ad78,0xb5528006
.long 0xb52fe71f,0xb540404a,0xb54db531,0xb5581207,0xb5386c8e,0xb547b0b8,0xb553cd1b,0xb55c90b9
.long 0xb540404a,0xb54e4d07,0xb558ee1a,0xb55ff665,0xb5475ac8,0xb5540e31,0xb55d1234,0xb5623eb4
.long 0xb54db531,0xb558ee1a,0xb5603495,0xb56366c0,0xb5534966,0xb55ce793,0xb5625196,0xb5636d0d
.long 0xb5581207,0xb55ff665,0xb56366c0,0xb5625196,0xb55c0a76,0xb562174e,0xb56372cf,0xb56015c2
.long 0xb562f061,0xb562d4fe,0xb55d65dc,0xb552c3a8,0xb56389d6,0xb56131a9,0xb5595902,0xb54c30f2
.long 0xb55f2ee2,0xb563480d,0xb56275b6,0xb55cbc6b,0xb5617c43,0xb563875e,0xb560709c,0xb55849d4
.long 0xb5603495,0xb556b84e,0xb5475ac8,0xb53287bc,0xb55d65dc,0xb5516c6d,0xb53f8021,0xb528234e
.long 0xb563480d,0xb55e9f1e,0xb5544ec5,0xb5449a11,0xb5622b47,0xb55b2018,0xb54e4d07,0xb53c08b1
.long 0xb5500894,0xb53c6d1f,0xb522de58,0xb5042ade,0xb549fcc1,0xb533d23f,0xb517c790,0xb4ed8e88
.long 0xb559c1d1,0xb54b4216,0xb536c63b,0xb51ce8a6,0xb5554bf5,0xb5443fd6,0xb52d3741,0xb510e611
.long 0xb5336482,0xb515b004,0xb4e52a79,0xb496b0ae,0xb52a785c,0xb50a57a4,0xb4ca1ffb,0xb470134b
.long 0xb5432e50,0xb52a785c,0xb50bffd6,0xb4d198a6,0xb53ba3cf,0xb5206963,0xb4ff29cf,0xb4b497b7
.long 0x355f2ee2,0x3558ee1a,0x35500894,0x35449a11,0x355cbc6b,0x35550d6e,0x354aa066,0x353d97ae
.long 0x3559c1d1,0x3550986d,0x35449a11,0x3535f06c,0x355640eb,0x354b9232,0x353dfa4a,0x352daaf3
.long 0x35638e39,0x356275b6,0x355f2ee2,0x3559c1d1,0x3563480d,0x3560fd37,0x355c6480,0x355589f8
.long 0x356275b6,0x355ee813,0x3558ee1a,0x3550986d,0x356117b5,0x355c37bf,0x3554ce63,0x354af17d
.long 0x353d349e,0x352a785c,0x3514a213,0x34f82ef7,0x3536c63b,0x35226155,0x350ae560,0x34e1898a
.long 0x352fe71f,0x3519d941,0x3500bc44,0x34ca1ffb,0x35289b88,0x3510e611,0x34ec5d5c,0x34b206a7
.long 0x35523be2,0x3545fe3e,0x3536c63b,0x3524ce73,0x354db531,0x353fe071,0x352f0384,0x351b62a3
.long 0x3548afa3,0x35393d0e,0x3526b834,0x35116fb3,0x35432e50,0x353218b4,0x351deac5,0x3506fe49
.long 0x34d689b3,0x349168af,0x341098a1,0xb1b2b879,0x34c295c7,0x34757546,0x33bd8c33,0xb36a68f6
.long 0x34fcd8a0,0x34bd858f,0x3472c494,0x33c8a746,0x34e9f950,0x34a7b17f,0x3441fa4e,0x333dce45
.long 0x35105c16,0x34e79302,0x34a8fd97,0x344ce05a,0x35078e00,0x34d2d5ad,0x349168af,0x3418dc76
.long 0x3520e7f5,0x35078e00,0x34d689b3,0x34995283,0x3518d125,0x34fbaf1e,0x34c00e98,0x3480190b
.long 0x33b26f4c,0xb3a750ae,0xb47d83cb,0xb4cf1d15,0x3332a663,0xb402cb5f,0xb496b0ae,0xb4e65f05
.long 0x34319357,0x3232b79c,0xb41b9d02,0xb49e91b8,0x34058eae,0xb3112c43,0xb44ce05a,0xb4b72709
.long 0x34841c9e,0x33d3c069,0xb35f4312,0xb457be81,0x345d2a7c,0x336a68f6,0xb3d3c069,0xb4857282
.long 0x34ae29da,0x34476e4a,0x3332a663,0xb3ded782,0x34995283,0x3418dc76,0xb1b2b879,0xb423dc60
.long 0x3536c63b,0x3526b834,0x3514a213,0x3500bc44,0x352e1e39,0x351c6705,0x3508ac72,0x34e65f05
.long 0x3524ce73,0x35116fb3,0x34f82ef7,0x34ca1ffb,0x351adfe2,0x3505dde2,0x34dde3b6,0x34acdf68
.long 0x35523be2,0x3548afa3,0x353d349e,0x352fe71f,0x354c7f95,0x35415d0c,0x35343f8d,0x3525497d
.long 0x3545fe3e,0x35393d0e,0x352a785c,0x3519d941,0x353ebe21,0x3530584a,0x351fea6e,0x350da4ff
.long 0x34c295c7,0x3489723e,0x341b9d02,0x330602d1,0x34a8fd97,0x345a74c2,0x33bd8c33,0xb2f5b21a
.long 0x348ec292,0x34211cf9,0x330602d1,0xb3bd8c33,0x3467fc01,0x33ce3417,0xb2df5dfa,0xb41e5d2e
.long 0x35105c16,0x34f37bbe,0x34c295c7,0x348ec292,0x35054d33,0x34da3912,0x34a66500,0x345fdfae
.long 0x34f37bbe,0x34c00e98,0x3489723e,0x34211cf9,0x34db727b,0x34a5181b,0x3457be81,0x33c319f8
.long 0xb41b9d02,0xb496b0ae,0xb4db727b,0xb50d18f3,0xb4525071,0xb4b206a7,0xb4f5d68a,0xb5195562
.long 0xb332a663,0xb43c8473,0xb4a3cad0,0xb4e52a79,0xb3c8a746,0xb4757546,0xb4c00e98,0xb50028bd
.long 0x3385eb92,0xb3910eb5,0xb4525071,0xb4ab948c,0x3232b79c,0xb402cb5f,0xb486c814,0xb4c8df7b
.long 0x34319357,0x3332a663,0xb3b26f4c,0xb45d2a7c,0x33f4ff28,0xb25f64b5,0xb4161b8b,0xb48d6eff
.long 0xb50bffd6,0xb52b6450,0xb5449a11,0xb556b84e,0xb516bc84,0xb534ac6d,0xb54be1d1,0xb55b7f6e
.long 0xb4e9f950,0xb516bc84,0xb5336482,0xb549fcc1,0xb500bc44,0xb5216623,0xb53c6d1f,0xb550df99
.long 0xb4b86e09,0xb4ff29cf,0xb51eeb5d,0xb5393d0e,0xb4d198a6,0xb50b72c6,0xb5298ac3,0xb542188e
.long 0xb4841c9e,0xb4cc9f84,0xb5078e00,0xb524ce73,0xb49e91b8,0xb4e65f05,0xb51392b4,0xb52f7588
.long 0xb520e7f5,0xb52fe71f,0xb53d349e,0xb548afa3,0xb52c4e9d,0xb53a7274,0xb546ad78,0xb550df99
.long 0xb536c63b,0xb543e522,0xb54ee2e0,0xb557a0dd,0xb540404a,0xb54c30f2,0xb555c777,0xb55ce793
.long 0xb548afa3,0xb5534966,0xb55b5006,0xb560aa7a,0xb5500894,0xb55923d1,0xb55f738b,0xb562e2f5
.long 0xb55640eb,0xb55db762,0xb5622b47,0xb5638d20,0xb55b5006,0xb560fd37,0xb56372cf,0xb562a7cf
.long 0xb55f2ee2,0xb562f061,0xb563480d,0xb5603495,0xb561d820,0xb5638df3,0xb561ab48,0xb55c37bf
.long 0xb563480d,0xb562d4fe,0xb55e9f1e,0xb556b84e,0xb5637cad,0xb560c699,0xb55a2886,0xb54fbfe7
.long 0xb56275b6,0xb55d65dc,0xb5544ec5,0xb5475ac8,0xb5603495,0xb558b7de,0xb54d1b60,0xb53d97ae
.long 0xb55cbc6b,0xb552c3a8,0xb5449a11,0xb53287bc,0xb5581207,0xb54b9232,0xb53ad8b0,0xb5263e5e
.long 0xb5432e50,0xb52f0384,0xb516bc84,0xb4f5d68a,0xb53a0bc4,0xb5235af6,0xb508ac72,0xb4d54e35
.long 0xb5523be2,0xb5432e50,0xb52fe71f,0xb518d125,0xb54b4216,0xb539a4a2,0xb523d730,0xb50a57a4
.long 0xb518d125,0xb4f5d68a,0xb4b34f66,0xb457be81,0xb50bffd6,0xb4d7c4ae,0xb49168af,0xb40dd6a6
.long 0xb52fe71f,0xb516bc84,0xb4f37bbe,0xb4b34f66,0xb524ce73,0xb5093b2d,0xb4d41232,0xb49015cd
.long 0xb4c295c7,0xb46d616f,0xb39c3072,0x33a750ae,0xb4a3cad0,0xb42959fe,0xb1b2b879,0x341e5d2e
.long 0xb4fcd8a0,0xb4b86e09,0xb45d2a7c,0xb385eb92,0xb4e052cd,0xb49801c8,0xb4161b8b,0x32060a16
.long 0xb4058eae,0x331c555b,0x34525071,0x34bafab3,0xb385eb92,0x33d94c39,0x348c1b15,0x34dcab5d
.long 0xb4841c9e,0xb3c8a746,0x3385eb92,0x3467fc01,0xb4476e4a,0xb2f5b21a,0x340b1453,0x349801c8
.long 0xb5523be2,0xb559c1d1,0xb55f2ee2,0xb56275b6,0xb558ee1a,0xb55ec3dd,0xb5625196,0xb5638df3
.long 0xb55e06c5,0xb56202ca,0xb56389d6,0xb56297a8,0xb5617c43,0xb5637804,0xb562d4fe,0xb55f9510
.long 0xb563480d,0xb5632098,0xb5603495,0xb55a8d22,0xb56366c0,0xb560fd37,0xb55bae4d,0xb5538b82
.long 0xb561d820,0xb55d1234,0xb5554bf5,0xb54aa066,0xb55e9f1e,0xb5576780,0xb54d1b60,0xb53fe071
.long 0xb559c1d1,0xb5500894,0xb5432e50,0xb5336482,0xb5534966,0xb547045d,0xb5379a47,0xb525497d
.long 0xb54b4216,0xb53c6d1f,0xb52a785c,0xb515b004,0xb541bb09,0xb530584a,0xb51be504,0xb504bc31
.long 0xb536c63b,0xb522de58,0xb50bffd6,0xb4e52a79,0xb52a785c,0xb5141a91,0xb4f5d68a,0xb4beca4f
.long 0xb51ce8a6,0xb5042ade,0xb4d198a6,0xb496b0ae,0xb50e30b4,0xb4e65f05,0xb4ab948c,0xb45a74c2
.long 0xb4b86e09,0xb46d616f,0xb3c8a746,0x331c555b,0xb4940d65,0xb41e5d2e,0xb28608a2,0x33fa87a0
.long 0xb4fcd8a0,0xb4c295c7,0xb4841c9e,0xb4058eae,0xb4db727b,0xb49d427b,0xb4370cc7,0xb33dce45
.long 0xb385eb92,0x33a750ae,0x3467fc01,0x34bafab3,0x3232b79c,0x3423dc60,0x349bf2de,0x34e1898a
.long 0xb45d2a7c,0xb39c3072,0x3385eb92,0x34525071,0xb41098a1,0x3132b8b0,0x34161b8b,0x3492bb38
.long 0x3472c494,0x34c51b16,0x35054d33,0x3523d730,0x349e91b8,0x34e8c671,0x3515b004,0x353218b4
.long 0x33b26f4c,0x3472c494,0x34c295c7,0x35030742,0x34269b63,0x349fe093,0x34e79302,0x35141a91
.long 0x35030742,0x3523d730,0x353ebe21,0x3552c3a8,0x351281e8,0x3531395a,0x3549572b,0x3559f56f
.long 0x34c295c7,0x35054d33,0x3524ce73,0x353ebe21,0x34e52a79,0x3515293a,0x353287bc,0x3549aa34
.long 0x34d689b3,0x34a8fd97,0x3472c494,0x341098a1,0x34b86e09,0x34881d53,0x342c1831,0x338b7d4f
.long 0x34995283,0x344ce05a,0x33c8a746,0xb1b2b879,0x3472c494,0x340851aa,0x32df5dfa,0xb3a1c0c2
.long 0x3520e7f5,0x35105c16,0x34fcd8a0,0x34d689b3,0x3514a213,0x350274fb,0x34dde3b6,0x34b497b7
.long 0x35078e00,0x34e79302,0x34bd858f,0x349168af,0x34f37bbe,0x34c8df7b,0x349bf2de,0x345a74c2
.long 0xb3b26f4c,0xb4525071,0xb4a3cad0,0xb4db727b,0xb41b9d02,0xb48ac6d5,0xb4c51b16,0xb4fbaf1e
.long 0xb45d2a7c,0xb4ab948c,0xb4e52a79,0xb50d18f3,0xb48ec292,0xb4cb5ffe,0xb501e263,0xb51b62a3
.long 0x34319357,0x3385eb92,0xb332a663,0xb41b9d02,0x33ded782,0xb132b8b0,0xb3e9ec76,0xb4654872
.long 0x3332a663,0xb3910eb5,0xb43c8473,0xb496b0ae,0xb2b2b42a,0xb40dd6a6,0xb4816fe1,0xb4b9b497
.long 0xb5289b88,0xb53f8021,0xb5512643,0xb55d1234,0xb5336482,0xb5485b26,0xb557a0dd,0xb560c699
.long 0xb5105c16,0xb52a785c,0xb540404a,0xb5512643,0xb51ce8a6,0xb53584dc,0xb549572b,0xb557d9b4
.long 0xb4e9f950,0xb5116fb3,0xb52a785c,0xb53f8021,0xb5030742,0xb51e6b42,0xb535f06c,0xb54903a5
.long 0xb4ae29da,0xb4e9f950,0xb5105c16,0xb5289b88,0xb4cc9f84,0xb5039938,0xb51deac5,0xb534ac6d
.long 0xb56117b5,0xb563587f,0xb55d65dc,0xb54f76ba,0xb562f061,0xb561edbb,0xb558811b,0xb547045d
.long 0xb559c1d1,0xb5622b47,0xb562f061,0xb55c0a76,0xb55e06c5,0xb5636d0d,0xb560e22d,0xb5567cde
.long 0xb54db531,0xb55bae4d,0xb562b76b,0xb56297a8,0xb5544ec5,0xb55f9510,0xb5638d20,0xb56015c2
.long 0xb53d349e,0xb5500894,0xb55cbc6b,0xb562f061,0xb545fe3e,0xb5567cde,0xb560709c,0xb5638bc1
.long 0x3332a663,0xb35f4312,0xb41b9d02,0xb47d83cb,0xb30602d1,0xb40851aa,0xb46d616f,0xb4a7b17f
.long 0xb3ded782,0xb457be81,0xb49e91b8,0xb4cf1d15,0xb43c8473,0xb492bb38,0xb4c51b16,0xb4f4a96f
.long 0x34ae29da,0x34841c9e,0x34319357,0x33b26f4c,0x3489723e,0x3439c8d6,0x33bd8c33,0x3132b8b0
.long 0x34476e4a,0x33d3c069,0x3232b79c,0xb3a750ae,0x33f4ff28,0x32c90950,0xb3910eb5,0xb42959fe
.long 0xb5078e00,0xb51eeb5d,0xb5336482,0xb5449a11,0xb516bc84,0xb52cc324,0xb53f8021,0xb54e9833
.long 0xb524ce73,0xb5393d0e,0xb549fcc1,0xb556b84e,0xb531a93d,0xb5443fd6,0xb552c3a8,0xb55ce793
.long 0xb4841c9e,0xb4b86e09,0xb4e9f950,0xb50bffd6,0xb4a8fd97,0xb4dcab5d,0xb5066e3f,0xb51c6705
.long 0xb4cc9f84,0xb4ff29cf,0xb516bc84,0xb52b6450,0xb4eebf21,0xb50fd1c3,0xb525c420,0xb538d507
.long 0xb562f061,0xb56297a8,0xb55c0a76,0xb54f76ba,0xb56389d6,0xb55fd67d,0xb555c777,0xb545a5e9
.long 0xb55cbc6b,0xb562b76b,0xb562f061,0xb55d65dc,0xb560aa7a,0xb5638df3,0xb560709c,0xb5576780
.long 0xb5500894,0xb55bae4d,0xb5622b47,0xb563587f,0xb5572d9f,0xb56015c2,0xb563845a,0xb56163f0
.long 0xb53d349e,0xb54db531,0xb559c1d1,0xb56117b5,0xb5475ac8,0xb55589f8,0xb55ee813,0xb5633f02
.long 0xb53a0bc4,0xb51deac5,0xb4f82ef7,0xb4ab948c,0xb52e1e39,0xb50ebc11,0xb4d41232,0xb482c668
.long 0xb54db531,0xb5386c8e,0xb51ce8a6,0xb4f82ef7,0xb5449a11,0xb52bd9ab,0xb50d18f3,0xb4d2d5ad
.long 0xb55b5006,0xb54d1b60,0xb5386c8e,0xb51deac5,0xb5554bf5,0xb54389f6,0xb52b6450,0xb50da4ff
.long 0xb56275b6,0xb55b5006,0xb54db531,0xb53a0bc4,0xb55fb60c,0xb5550d6e,0xb543e522,0xb52cc324
```
